```python
import torch

def _softmax(x, axis=-1):
    return torch.softmax(x, dim=axis)
def _gelu(x):
    return torch.nn.functional.gelu(x, approximate="tanh")
def _silu(x):
    return torch.nn.functional.silu(x)
def _sigmoid(x):
    return torch.sigmoid(x)
def _layernorm(x, axis=-1, eps=1e-5):
    m = x.mean(dim=axis, keepdim=True)
    v = x.var(dim=axis, keepdim=True, unbiased=False)
    return (x - m) / torch.sqrt(v + eps)
def _scatter_add(tgt, idx, src, axis=0):
    return tgt.clone().index_add_(axis, idx, src)
def _segment_sum(src, seg, n):
    out = torch.zeros((n,) + src.shape[1:], dtype=src.dtype)
    return out.index_add_(0, seg, src)
def _pad(x, pw):
    flat = tuple(v for pair in reversed(pw) for v in pair)
    return torch.nn.functional.pad(x, flat)

kernel_name = 'recurrent_scan__compressed_kv_cla__geglu_ffn__prompt'

def setup_inputs():

    _w = (lambda a: (lambda t: t.to(torch.bfloat16) if t.is_floating_point() else t)(torch.as_tensor(a)))
    def _A_setup():
        B, H, Sq, Sk, D, M = 1, 32, 2048, 2048, 128, 640
        Dc = 4 * D
        return {
            "x": _w((lambda *s: torch.randn(*s, dtype=torch.bfloat16) * 0.05)(B, Sq, M)),
            "c_kv": _w((lambda *s: torch.randn(*s, dtype=torch.bfloat16) * 0.2)(B, Sk, Dc)),
            "w_q": _w((lambda *s: torch.randn(*s, dtype=torch.bfloat16) * 3.2)(M, H, D) * (M ** -0.5)),
            "w_uk": _w((lambda *s: torch.randn(*s, dtype=torch.bfloat16) * 3.2)(Dc, H, D) * (Dc ** -0.5)),
            "w_uv": _w((lambda *s: torch.randn(*s, dtype=torch.bfloat16) * 0.2)(Dc, H, D) * (Dc ** -0.5)),
            "w_o": _w((lambda *s: torch.randn(*s, dtype=torch.bfloat16) * 0.2)(H, D, M) * ((H * D) ** -0.5)),
        }
    _A_in = _A_setup()

    def _B_setup():
        B, S, D, F = 1, 2048, 640, 1728
        return {
            "x": _w((lambda *s: torch.randn(*s, dtype=torch.bfloat16) * 0.05)(B, S, D)),
            "w_gate": _w((lambda *s: torch.randn(*s, dtype=torch.bfloat16) * 0.1)(D, F)),
            "w_up": _w((lambda *s: torch.randn(*s, dtype=torch.bfloat16) * 0.1)(D, F)),
            "w_down": _w((lambda *s: torch.randn(*s, dtype=torch.bfloat16) * 0.1)(F, D)),
        }
    _B_in = _B_setup()

    return {
        "A_x": _A_in["x"],
        "A_c_kv": _A_in["c_kv"],
        "A_w_q": _A_in["w_q"],
        "A_w_uk": _A_in["w_uk"],
        "A_w_uv": _A_in["w_uv"],
        "A_w_o": _A_in["w_o"],
        "B_x": _B_in["x"],
        "B_w_gate": _B_in["w_gate"],
        "B_w_up": _B_in["w_up"],
        "B_w_down": _B_in["w_down"],
    }

def reference(A_x, A_c_kv, A_w_q, A_w_uk, A_w_uv, A_w_o, B_x, B_w_gate, B_w_up, B_w_down):
    def _A_ref(x, c_kv, w_q, w_uk, w_uv, w_o):
        B, Sq, M = x.shape[0], x.shape[1], x.shape[2]
        Sk = c_kv.shape[1]
        H, D = w_q.shape[1], w_q.shape[2]
        q = torch.einsum("bqm,mhd->bhqd", x, w_q)
        k = torch.einsum("bkc,chd->bhkd", c_kv, w_uk)
        v = torch.einsum("bkc,chd->bhkd", c_kv, w_uv)
        scores = torch.einsum("bhqd,bhkd->bhqk", q, k) * (D ** -0.5)
        off = Sk - Sq
        qi = torch.arange(Sq)[:, None]
        kj = torch.arange(Sk)[None, :]
        cmask = kj <= (qi + off)
        scores = torch.where(cmask[None, None], scores, -1e9)
        p = _softmax(scores, axis=-1)
        ctx = torch.einsum("bhqk,bhkd->bhqd", p, v)
        return torch.einsum("bhqd,hdm->bqm", ctx, w_o)

    def _B_ref(x, w_gate, w_up, w_down):
        return (_gelu(x @ w_gate) * (x @ w_up)) @ w_down

    x = A_x
    xn = _layernorm(x, axis=-1)
    s = _A_ref(xn, A_c_kv, A_w_q, A_w_uk, A_w_uv, A_w_o)
    g = _silu(_B_ref(xn, B_w_gate, B_w_up, B_w_down))
    return x + s * g
```

```asm
; @launch grid=(256,1,1) block=(256,1,1) lds=163840
.amdgcn_target "amdgcn-amd-amdhsa--gfx950"
.text
.globl recurrent_scan__compressed_kv_cla__geglu_ffn__prompt_kernel
.p2align 12
.p2align 8
.type recurrent_scan__compressed_kv_cla__geglu_ffn__prompt_kernel,@function
recurrent_scan__compressed_kv_cla__geglu_ffn__prompt_kernel:
 s_cmp_lt_u32 s2, 256
 s_cbranch_scc1 L_go
 s_endpgm
L_go:
 s_load_dwordx16 s[32:47], s[0:1], 0
 s_load_dwordx8 s[48:55], s[0:1], 64
 s_load_dwordx2 s[56:57], s[0:1], 96
 v_and_b32 v1, 63, v0
 v_lshrrev_b32 v29, 6, v0
 v_mov_b32 v31, 0
 v_readfirstlane_b32 s58, v29
 s_and_b32 s75, s2, 7
 s_bfe_u32 s76, s2, 0x20003
 s_lshr_b32 s60, s2, 5
 s_lshl_b32 s59, s75, 2
 s_add_u32 s59, s59, s76
 s_mul_i32 s74, s75, 3
 s_add_u32 s74, s74, s76
 s_mul_i32 s77, s60, 3
 s_sub_u32 s77, s75, s77
 s_and_b32 s77, s77, 7
 s_add_u32 s77, s77, 24
 s_cmp_eq_u32 s76, 3
 s_cselect_b32 s74, s77, s74
 s_lshl_b32 s88, s76, 1
 s_add_u32 s88, s88, s60
 s_and_b32 s84, s88, 7
 s_sub_u32 s85, s88, 10
 s_cselect_b32 s88, s88, s85
 s_and_b32 s84, s60, 0
 s_mul_i32 s84, s84, 8
 s_mov_b32 s88, s60
 s_mov_b32 s61, 0xffff0000
 s_lshl_b32 s62, s58, 12
 s_lshl_b32 s63, s58, 13
 s_add_u32 s63, s63, 0x10000
 s_lshl_b32 s75, s60, 2
 s_add_u32 s75, s75, s58
 s_lshl_b32 s64, s75, 16
 s_add_u32 s65, s64, 14336
 s_add_u32 s66, s64, 32768
 s_add_u32 s67, s64, 47104
 s_lshl_b32 s68, s58, 17
 s_lshl_b32 s76, s59, 8
 s_add_u32 s68, s68, s76
 s_add_u32 s69, s68, 31744
 s_add_u32 s70, s68, 63488
 s_add_u32 s71, s68, 95232
 v_lshrrev_b32 v29, 3, v1
 s_movk_i32 s3, 1024
 v_mul_lo_u32 v29, v29, s3
 v_lshl_add_u32 v29, s84, 7, v29
 v_lshrrev_b32 v30, 4, v1
 v_and_b32 v3, 7, v1
 v_xor_b32 v30, v30, v3
 v_lshl_add_u32 v2, v30, 4, v29
 v_xor_b32 v30, 4, v30
 v_lshl_add_u32 v3, v30, 4, v29
 v_add_u32 v3, 7168, v3
 v_lshrrev_b32 v29, 4, v1
 v_and_b32 v30, 15, v1
 v_lshlrev_b32 v5, 1, v29
 v_xor_b32 v30, v30, v5
 v_lshl_add_u32 v29, s84, 6, v29
 v_lshlrev_b32 v29, 13, v29
 v_lshl_add_u32 v4, v30, 4, v29
 v_xor_b32 v5, 0x80, v4
 s_lshl_b32 s77, s2, 2
 s_add_u32 s77, s77, s58
 s_lshl_b32 s76, s77, 1
 v_lshrrev_b32 v29, 5, v1
 v_add_u32 v29, s76, v29
 s_movk_i32 s76, 1280
 v_mul_lo_u32 v29, v29, s76
 v_and_b32 v30, 31, v1
 v_lshl_add_u32 v6, v30, 4, v29
 v_lshl_add_u32 v7, v30, 3, v29
 s_waitcnt lgkmcnt(0)
 s_mov_b32 s8, s38
 s_mov_b32 s9, s39
 s_mov_b32 s10, 0x400000
 s_mov_b32 s11, 0x00020000
 s_mov_b32 s4, s34
 s_mov_b32 s5, s35
 s_mov_b32 s6, 0x200000
 s_mov_b32 s7, 0x00020000
 s_mov_b32 s12, s40
 s_mov_b32 s13, s41
 s_mov_b32 s14, 0x400000
 s_mov_b32 s15, 0x00020000
 s_add_u32 m0, s62, 0
 s_nop 0
 buffer_load_dwordx4 v4, s[8:11], s68 offen offset:0 lds
 buffer_load_dwordx4 v4, s[8:11], s69 offen offset:1024 lds
 s_add_u32 s84, s84, 1
 s_cmp_eq_u32 s84, 8
 s_cselect_b32 s85, -7, 1
 s_cmov_b32 s84, 0
 s_lshl_b32 s86, s85, 19
 buffer_load_dwordx4 v5, s[8:11], s70 offen offset:2048 lds
 buffer_load_dwordx4 v5, s[8:11], s71 offen offset:3072 lds
 s_add_u32 m0, s63, 0
 s_nop 0
 buffer_load_dwordx4 v2, s[4:7], s64 offen offset:0 lds
 buffer_load_dwordx4 v3, s[4:7], s64 offen offset:1024 lds
 buffer_load_dwordx4 v2, s[4:7], s65 offen offset:2048 lds
 buffer_load_dwordx4 v3, s[4:7], s65 offen offset:3072 lds
 s_add_u32 m0, s62, 16384
 s_nop 0
 buffer_load_dwordx4 v4, s[12:15], s68 offen offset:0 lds
 buffer_load_dwordx4 v4, s[12:15], s69 offen offset:1024 lds
 buffer_load_dwordx4 v5, s[12:15], s70 offen offset:2048 lds
 buffer_load_dwordx4 v5, s[12:15], s71 offen offset:3072 lds
 v_add_u32 v4, s86, v4
 v_add_u32 v5, s86, v5
 s_add_u32 m0, s63, 4096
 s_nop 0
 buffer_load_dwordx4 v2, s[4:7], s66 offen offset:0 lds
 buffer_load_dwordx4 v3, s[4:7], s66 offen offset:1024 lds
 buffer_load_dwordx4 v2, s[4:7], s67 offen offset:2048 lds
 buffer_load_dwordx4 v3, s[4:7], s67 offen offset:3072 lds
 v_lshl_add_u32 v2, s85, 7, v2
 v_lshl_add_u32 v3, s85, 7, v3
 s_add_u32 s24, s56, 0x2300000
 s_addc_u32 s25, s57, 0
 s_mov_b32 s26, 0x8004
 s_mov_b32 s27, 0x00020000
 s_buffer_load_dword s89, s[24:27], 0x8000
 s_getpc_b64 s[80:81]
L_pc:
 s_lshr_b32 s3, s2, 3
 s_lshl_b32 s3, s3, 2
 s_add_u32 s3, s3, s58
 v_lshl_add_u32 v34, v1, 7, s3
 v_lshlrev_b32 v34, 7, v34
 v_mov_b32 v33, s81
 v_cmp_gt_u32 vcc, L_end-L_pc-4, v34
 s_and_saveexec_b64 s[82:83], vcc
 v_add_co_u32 v32, vcc, s80, v34
 s_nop 1
 v_addc_co_u32 v33, vcc, 0, v33, vcc
 global_load_dword a112, v[32:33], off
 s_mov_b64 exec, -1
 v_and_b32 v29, 15, v1
 v_lshrrev_b32 v30, 1, v29
 v_lshrrev_b32 v8, 4, v1
 v_xor_b32 v30, v30, v8
 v_lshlrev_b32 v29, 7, v29
 v_lshl_add_u32 v29, v30, 4, v29
 s_and_b32 s3, s58, 1
 s_lshl_b32 s3, s3, 14
 s_add_u32 s3, s3, 0x10000
 v_add_u32 v8, s3, v29
 v_xor_b32 v9, 64, v8
 v_lshrrev_b32 v29, 4, v1
 v_lshlrev_b32 v29, 11, v29
 v_bfe_u32 v30, v1, 2, 2
 v_lshl_add_u32 v29, v30, 8, v29
 v_bfe_u32 v30, v1, 2, 3
 v_lshl_add_u32 v29, v30, 5, v29
 v_and_b32 v30, 3, v1
 v_lshl_add_u32 v29, v30, 3, v29
 s_lshr_b32 s3, s58, 1
 s_lshl_b32 s3, s3, 7
 v_xor_b32 v12, s3, v29
 v_xor_b32 v13, 32, v12
 v_xor_b32 v14, 64, v12
 v_xor_b32 v15, 96, v12
 s_lshl_b32 s3, s2, 7
 v_mov_b32 v26, s3
 v_mov_b32 v29, 0x7fff0000
 v_cmp_eq_u32 vcc, 0, v0
 s_nop 1
 v_cndmask_b32 v26, v29, v26, vcc
 v_mov_b32 v39, 0x7fff0000
 s_lshr_b32 s3, s2, 3
 s_lshl_b32 s3, s3, 2
 s_add_u32 s3, s3, s58
 s_lshl_b32 s3, s3, 4
 v_add_lshl_u32 v36, s3, v1, 10
 v_cmp_gt_u32 vcc, 16, v1
 s_nop 0
 s_nop 0
 v_cndmask_b32 v36, v39, v36, vcc
 v_accvgpr_write_b32 a118, v36
 s_cmp_lt_u32 s58, 2
 s_cselect_b32 s80, s38, s40
 s_cselect_b32 s81, s39, s41
 s_mov_b32 s82, 0x400000
 s_mov_b32 s83, 0x00020000
 s_and_b32 s3, s58, 1
 s_lshr_b32 s75, s60, 0
 s_lshl_b32 s75, s75, 1
 s_add_u32 s3, s3, s75
 s_lshl_b32 s3, s3, 7
 s_add_u32 s3, s3, s59
 s_lshl_b32 s3, s3, 1
 v_lshrrev_b32 v36, 1, v1
 v_and_b32 v37, 1, v1
 v_lshl_add_u32 v36, v36, 6, v37
 v_add_lshl_u32 v36, s3, v36, 7
 v_cmp_gt_u32 vcc, 8, v1
 s_nop 0
 s_nop 0
 v_cndmask_b32 v36, v39, v36, vcc
 v_accvgpr_write_b32 a119, v36
 s_cmp_eq_u32 s58, 2
 s_cselect_b32 s16, s46, s48
 s_cselect_b32 s17, s47, s49
 s_cmp_lt_u32 s74, 27
 s_cselect_b32 s18, 0x21c000, 0
 s_mov_b32 s19, 0x00020000
 s_lshl_b32 s75, s59, 1
 s_add_u32 s75, s75, s58
 s_movk_i32 s97, 3456
 s_cmp_lt_u32 s58, 2
 s_cmov_b32 s16, s36
 s_cmov_b32 s17, s37
 s_cmov_b32 s18, 0x500000
 s_cselect_b32 s75, s75, s74
 s_cmov_b32 s97, 8192
 s_mul_i32 s3, s60, 80
 v_add_u32 v36, s3, v1
 v_mul_lo_u32 v36, v36, s97
 s_lshl_b32 s91, s75, 7
 s_mul_i32 s97, s97, 16
 v_cmp_gt_u32 vcc, 16, v1
 s_nop 0
 s_nop 0
 v_cndmask_b32 v36, v39, v36, vcc
 v_accvgpr_write_b32 a120, v36
 s_add_u32 s20, s56, 0x2000000
 s_addc_u32 s21, s57, 0
 s_mov_b32 s22, 0x280000
 s_mov_b32 s23, 0x00020000
 s_mov_b32 s28, s32
 s_mov_b32 s29, s33
 s_mov_b32 s30, 0x280000
 s_mov_b32 s31, 0x00020000
 s_add_u32 m0, s62, 32768
 s_nop 0
 buffer_load_dwordx4 v4, s[8:11], s68 offen offset:0 lds
 buffer_load_dwordx4 v4, s[8:11], s69 offen offset:1024 lds
 s_add_u32 s84, s84, 1
 s_cmp_eq_u32 s84, 8
 s_cselect_b32 s85, -7, 1
 s_cmov_b32 s84, 0
 s_lshl_b32 s86, s85, 19
 buffer_load_dwordx4 v5, s[8:11], s70 offen offset:2048 lds
 buffer_load_dwordx4 v5, s[8:11], s71 offen offset:3072 lds
 s_add_u32 s3, s84, 0
 s_and_b32 s3, s3, 7
 s_lshl_b32 s3, s3, 7
 v_accvgpr_read_b32 v29, a118
 buffer_load_dword a133, v29, s[4:7], s3 offen
 s_lshl_b32 s3, s3, 12
 v_accvgpr_read_b32 v29, a119
 buffer_load_dword a140, v29, s[80:83], s3 offen
 s_mov_b64 exec, 0
 s_cmp_eq_u32 s58, 0
 s_cbranch_scc1 L_pg1
 s_cmp_eq_u32 s58, 1
 s_cbranch_scc1 L_pg2
 s_cmp_eq_u32 s58, 2
 s_cbranch_scc1 L_pg3
 s_branch L_pg4
L_hopr0:
 s_mov_b64 exec, -1
 s_waitcnt vmcnt(7)
 s_barrier
 ds_read_b128 a[0:3], v8 offset:0
 ds_read_b128 a[4:7], v8 offset:2048
 ds_read_b128 a[8:11], v8 offset:4096
 ds_read_b128 a[12:15], v8 offset:6144
 ds_read_b128 a[16:19], v8 offset:8192
 ds_read_b128 a[20:23], v8 offset:10240
 ds_read_b128 a[24:27], v8 offset:12288
 ds_read_b128 a[28:31], v8 offset:14336
 ds_read_b64_tr_b16 a[64:65], v12 offset:0
 ds_read_b64_tr_b16 a[66:67], v12 offset:1024
 ds_read_b64_tr_b16 a[68:69], v13 offset:0
 ds_read_b64_tr_b16 a[70:71], v13 offset:1024
 ds_read_b64_tr_b16 a[72:73], v14 offset:0
 ds_read_b64_tr_b16 a[74:75], v14 offset:1024
 ds_read_b64_tr_b16 a[76:77], v15 offset:0
 ds_read_b64_tr_b16 a[78:79], v15 offset:1024
 s_waitcnt lgkmcnt(0)
 v_mfma_f32_16x16x32_bf16 v[32:35], a[64:67], a[0:3], 0
 s_add_u32 m0, s63, 32768
 v_mfma_f32_16x16x32_bf16 v[36:39], a[64:67], a[4:7], 0
 buffer_load_dwordx4 v2, s[4:7], s64 offen offset:0 lds
 v_mfma_f32_16x16x32_bf16 v[40:43], a[64:67], a[8:11], 0
 v_mfma_f32_16x16x32_bf16 v[44:47], a[64:67], a[12:15], 0
 v_mfma_f32_16x16x32_bf16 v[48:51], a[64:67], a[16:19], 0
 buffer_load_dwordx4 v3, s[4:7], s64 offen offset:1024 lds
 v_mfma_f32_16x16x32_bf16 v[52:55], a[64:67], a[20:23], 0
 v_mfma_f32_16x16x32_bf16 v[56:59], a[64:67], a[24:27], 0
 v_mfma_f32_16x16x32_bf16 v[60:63], a[64:67], a[28:31], 0
 buffer_load_dwordx4 v2, s[4:7], s65 offen offset:2048 lds
 ds_read_b64_tr_b16 a[64:65], v12 offset:16384
 ds_read_b64_tr_b16 a[66:67], v12 offset:17408
 v_mfma_f32_16x16x32_bf16 v[172:175], a[68:71], a[28:31], 0
 ds_read_b128 a[32:35], v9 offset:0
 v_mfma_f32_16x16x32_bf16 v[168:171], a[68:71], a[24:27], 0
 v_mfma_f32_16x16x32_bf16 v[164:167], a[68:71], a[20:23], 0
 buffer_load_dwordx4 v3, s[4:7], s65 offen offset:3072 lds
 v_mfma_f32_16x16x32_bf16 v[160:163], a[68:71], a[16:19], 0
 v_mfma_f32_16x16x32_bf16 v[156:159], a[68:71], a[12:15], 0
 s_add_u32 m0, s62, 49152
 v_mfma_f32_16x16x32_bf16 v[152:155], a[68:71], a[8:11], 0
 buffer_load_dwordx4 v4, s[12:15], s68 offen offset:0 lds
 ds_read_b128 a[36:39], v9 offset:2048
 v_mfma_f32_16x16x32_bf16 v[148:151], a[68:71], a[4:7], 0
 v_mfma_f32_16x16x32_bf16 v[144:147], a[68:71], a[0:3], 0
 ds_read_b64_tr_b16 a[68:69], v13 offset:16384
 ds_read_b64_tr_b16 a[70:71], v13 offset:17408
 v_mfma_f32_16x16x32_bf16 v[64:67], a[72:75], a[0:3], 0
 buffer_load_dwordx4 v4, s[12:15], s69 offen offset:1024 lds
 v_mfma_f32_16x16x32_bf16 v[68:71], a[72:75], a[4:7], 0
 v_mfma_f32_16x16x32_bf16 v[72:75], a[72:75], a[8:11], 0
 ds_read_b128 a[40:43], v9 offset:4096
 v_mfma_f32_16x16x32_bf16 v[76:79], a[72:75], a[12:15], 0
 buffer_load_dwordx4 v5, s[12:15], s70 offen offset:2048 lds
 v_mfma_f32_16x16x32_bf16 v[80:83], a[72:75], a[16:19], 0
 v_mfma_f32_16x16x32_bf16 v[84:87], a[72:75], a[20:23], 0
 v_mfma_f32_16x16x32_bf16 v[88:91], a[72:75], a[24:27], 0
 buffer_load_dwordx4 v5, s[12:15], s71 offen offset:3072 lds
 v_add_u32 v4, s86, v4
 v_mfma_f32_16x16x32_bf16 v[92:95], a[72:75], a[28:31], 0
 ds_read_b64_tr_b16 a[72:73], v14 offset:16384
 ds_read_b64_tr_b16 a[74:75], v14 offset:17408
 v_mfma_f32_16x16x32_bf16 v[204:207], a[76:79], a[28:31], 0
 ds_read_b128 a[44:47], v9 offset:6144
 v_add_u32_e64 v5, s86, v5
 s_add_u32 m0, s63, 36864
 v_mfma_f32_16x16x32_bf16 v[200:203], a[76:79], a[24:27], 0
 buffer_load_dwordx4 v2, s[4:7], s66 offen offset:0 lds
 v_mfma_f32_16x16x32_bf16 v[196:199], a[76:79], a[20:23], 0
 v_mfma_f32_16x16x32_bf16 v[192:195], a[76:79], a[16:19], 0
 v_mfma_f32_16x16x32_bf16 v[188:191], a[76:79], a[12:15], 0
 buffer_load_dwordx4 v3, s[4:7], s66 offen offset:1024 lds
 ds_read_b128 a[48:51], v9 offset:8192
 v_mfma_f32_16x16x32_bf16 v[184:187], a[76:79], a[8:11], 0
 v_mfma_f32_16x16x32_bf16 v[180:183], a[76:79], a[4:7], 0
 v_mfma_f32_16x16x32_bf16 v[176:179], a[76:79], a[0:3], 0
 buffer_load_dwordx4 v2, s[4:7], s67 offen offset:2048 lds
 ds_read_b64_tr_b16 a[76:77], v15 offset:16384
 ds_read_b64_tr_b16 a[78:79], v15 offset:17408
 s_waitcnt lgkmcnt(4)
 v_mfma_f32_16x16x32_bf16 v[96:99], a[0:3], a[64:67], 0
 v_mfma_f32_16x16x32_bf16 v[208:211], a[4:7], a[64:67], 0
 ds_read_b128 a[52:55], v9 offset:10240
 v_mfma_f32_16x16x32_bf16 v[100:103], a[8:11], a[64:67], 0
 buffer_load_dwordx4 v3, s[4:7], s67 offen offset:3072 lds
 v_lshl_add_u32 v2, s85, 7, v2
 v_mfma_f32_16x16x32_bf16 v[212:215], a[12:15], a[64:67], 0
 v_lshl_add_u32 v3, s85, 7, v3
 v_mfma_f32_16x16x32_bf16 v[104:107], a[16:19], a[64:67], 0
 v_mfma_f32_16x16x32_bf16 v[216:219], a[20:23], a[64:67], 0
 v_mfma_f32_16x16x32_bf16 v[108:111], a[24:27], a[64:67], 0
 ds_read_b128 a[56:59], v9 offset:12288
 v_mfma_f32_16x16x32_bf16 v[220:223], a[28:31], a[64:67], 0
 ds_read_b64_tr_b16 a[64:65], v12 offset:8192
 ds_read_b64_tr_b16 a[66:67], v12 offset:9216
 v_mfma_f32_16x16x32_bf16 v[236:239], a[28:31], a[68:71], 0
 v_mfma_f32_16x16x32_bf16 v[124:127], a[24:27], a[68:71], 0
 v_mfma_f32_16x16x32_bf16 v[232:235], a[20:23], a[68:71], 0
 s_add_u32 s3, s84, 1
 s_and_b32 s3, s3, 7
 v_mfma_f32_16x16x32_bf16 v[120:123], a[16:19], a[68:71], 0
 ds_read_b128 a[60:63], v9 offset:14336
 s_lshl_b32 s3, s3, 7
 v_mfma_f32_16x16x32_bf16 v[228:231], a[12:15], a[68:71], 0
 v_accvgpr_read_b32 v29, a118
 buffer_load_dword a149, v29, s[4:7], s3 offen
 v_mfma_f32_16x16x32_bf16 v[116:119], a[8:11], a[68:71], 0
 v_mfma_f32_16x16x32_bf16 v[224:227], a[4:7], a[68:71], 0
 v_mfma_f32_16x16x32_bf16 v[112:115], a[0:3], a[68:71], 0
 ds_read_b64_tr_b16 a[68:69], v13 offset:8192
 ds_read_b64_tr_b16 a[70:71], v13 offset:9216
 v_mfma_f32_16x16x32_bf16 v[128:131], a[0:3], a[72:75], 0
 s_lshl_b32 s3, s3, 12
 v_accvgpr_read_b32 v29, a119
 v_mfma_f32_16x16x32_bf16 v[240:243], a[4:7], a[72:75], 0
 buffer_load_dword a156, v29, s[80:83], s3 offen
 v_mfma_f32_16x16x32_bf16 v[132:135], a[8:11], a[72:75], 0
 v_mfma_f32_16x16x32_bf16 v[244:247], a[12:15], a[72:75], 0
 v_mfma_f32_16x16x32_bf16 v[136:139], a[16:19], a[72:75], 0
 buffer_load_dwordx4 v[16:19], v6, s[28:31], 0 offen
 v_mfma_f32_16x16x32_bf16 v[248:251], a[20:23], a[72:75], 0
 v_mfma_f32_16x16x32_bf16 v[140:143], a[24:27], a[72:75], 0
 v_mfma_f32_16x16x32_bf16 v[252:255], a[28:31], a[72:75], 0
 ds_read_b64_tr_b16 a[72:73], v14 offset:8192
 ds_read_b64_tr_b16 a[74:75], v14 offset:9216
 s_waitcnt lgkmcnt(2)
 v_mfma_f32_16x16x32_bf16 a[252:255], a[28:31], a[76:79], 0
 buffer_load_dwordx4 v[20:23], v6, s[28:31], 0 offen offset:512
 v_mfma_f32_16x16x32_bf16 a[248:251], a[24:27], a[76:79], 0
 v_mfma_f32_16x16x32_bf16 a[244:247], a[20:23], a[76:79], 0
 v_mfma_f32_16x16x32_bf16 a[240:243], a[16:19], a[76:79], 0
 buffer_load_dwordx2 v[24:25], v7, s[28:31], 0 offen offset:1024
 v_mfma_f32_16x16x32_bf16 a[236:239], a[12:15], a[76:79], 0
 v_mfma_f32_16x16x32_bf16 a[232:235], a[8:11], a[76:79], 0
 v_mfma_f32_16x16x32_bf16 a[228:231], a[4:7], a[76:79], 0
 v_mfma_f32_16x16x32_bf16 a[224:227], a[0:3], a[76:79], 0
 ds_read_b64_tr_b16 a[76:77], v15 offset:8192
 ds_read_b64_tr_b16 a[78:79], v15 offset:9216
 v_mfma_f32_16x16x32_bf16 v[32:35], a[64:67], a[32:35], v[32:35]
 v_mfma_f32_16x16x32_bf16 v[36:39], a[64:67], a[36:39], v[36:39]
 v_mfma_f32_16x16x32_bf16 v[40:43], a[64:67], a[40:43], v[40:43]
 v_mfma_f32_16x16x32_bf16 v[44:47], a[64:67], a[44:47], v[44:47]
 v_mfma_f32_16x16x32_bf16 v[48:51], a[64:67], a[48:51], v[48:51]
 v_mfma_f32_16x16x32_bf16 v[52:55], a[64:67], a[52:55], v[52:55]
 v_mfma_f32_16x16x32_bf16 v[56:59], a[64:67], a[56:59], v[56:59]
 v_mfma_f32_16x16x32_bf16 v[60:63], a[64:67], a[60:63], v[60:63]
 ds_read_b64_tr_b16 a[64:65], v12 offset:24576
 ds_read_b64_tr_b16 a[66:67], v12 offset:25600
 v_mfma_f32_16x16x32_bf16 v[172:175], a[68:71], a[60:63], v[172:175]
 v_mfma_f32_16x16x32_bf16 v[168:171], a[68:71], a[56:59], v[168:171]
 v_mfma_f32_16x16x32_bf16 v[164:167], a[68:71], a[52:55], v[164:167]
 v_mfma_f32_16x16x32_bf16 v[160:163], a[68:71], a[48:51], v[160:163]
 v_mfma_f32_16x16x32_bf16 v[156:159], a[68:71], a[44:47], v[156:159]
 v_mfma_f32_16x16x32_bf16 v[152:155], a[68:71], a[40:43], v[152:155]
 v_mfma_f32_16x16x32_bf16 v[148:151], a[68:71], a[36:39], v[148:151]
 v_mfma_f32_16x16x32_bf16 v[144:147], a[68:71], a[32:35], v[144:147]
 ds_read_b64_tr_b16 a[68:69], v13 offset:24576
 ds_read_b64_tr_b16 a[70:71], v13 offset:25600
 s_waitcnt lgkmcnt(2)
 v_mfma_f32_16x16x32_bf16 v[64:67], a[72:75], a[32:35], v[64:67]
 v_mfma_f32_16x16x32_bf16 v[68:71], a[72:75], a[36:39], v[68:71]
 v_mfma_f32_16x16x32_bf16 v[72:75], a[72:75], a[40:43], v[72:75]
 v_mfma_f32_16x16x32_bf16 v[76:79], a[72:75], a[44:47], v[76:79]
 v_mfma_f32_16x16x32_bf16 v[80:83], a[72:75], a[48:51], v[80:83]
 v_mfma_f32_16x16x32_bf16 v[84:87], a[72:75], a[52:55], v[84:87]
 v_mfma_f32_16x16x32_bf16 v[88:91], a[72:75], a[56:59], v[88:91]
 v_mfma_f32_16x16x32_bf16 v[92:95], a[72:75], a[60:63], v[92:95]
 ds_read_b64_tr_b16 a[72:73], v14 offset:24576
 ds_read_b64_tr_b16 a[74:75], v14 offset:25600
 v_mfma_f32_16x16x32_bf16 v[204:207], a[76:79], a[60:63], v[204:207]
 v_mfma_f32_16x16x32_bf16 v[200:203], a[76:79], a[56:59], v[200:203]
 v_mfma_f32_16x16x32_bf16 v[196:199], a[76:79], a[52:55], v[196:199]
 v_mfma_f32_16x16x32_bf16 v[192:195], a[76:79], a[48:51], v[192:195]
 v_mfma_f32_16x16x32_bf16 v[188:191], a[76:79], a[44:47], v[188:191]
 v_mfma_f32_16x16x32_bf16 v[184:187], a[76:79], a[40:43], v[184:187]
 v_mfma_f32_16x16x32_bf16 v[180:183], a[76:79], a[36:39], v[180:183]
 v_mfma_f32_16x16x32_bf16 v[176:179], a[76:79], a[32:35], v[176:179]
 ds_read_b64_tr_b16 a[76:77], v15 offset:24576
 ds_read_b64_tr_b16 a[78:79], v15 offset:25600
 v_mfma_f32_16x16x32_bf16 v[96:99], a[32:35], a[64:67], v[96:99]
 v_mfma_f32_16x16x32_bf16 v[208:211], a[36:39], a[64:67], v[208:211]
 v_mfma_f32_16x16x32_bf16 v[100:103], a[40:43], a[64:67], v[100:103]
 v_mfma_f32_16x16x32_bf16 v[212:215], a[44:47], a[64:67], v[212:215]
 v_mfma_f32_16x16x32_bf16 v[104:107], a[48:51], a[64:67], v[104:107]
 v_mfma_f32_16x16x32_bf16 v[216:219], a[52:55], a[64:67], v[216:219]
 v_mfma_f32_16x16x32_bf16 v[108:111], a[56:59], a[64:67], v[108:111]
 v_mfma_f32_16x16x32_bf16 v[220:223], a[60:63], a[64:67], v[220:223]
 s_waitcnt vmcnt(5)
 s_waitcnt lgkmcnt(0)
 s_barrier
 v_mfma_f32_16x16x32_bf16 v[236:239], a[60:63], a[68:71], v[236:239]
 ds_read_b64_tr_b16 a[64:65], v12 offset:32768
 ds_read_b64_tr_b16 a[66:67], v12 offset:33792
 s_add_u32 m0, s62, 0
 v_mfma_f32_16x16x32_bf16 v[124:127], a[56:59], a[68:71], v[124:127]
 buffer_load_dwordx4 v4, s[8:11], s68 offen offset:0 lds
 ds_read_b128 a[0:3], v8 offset:32768
 v_mfma_f32_16x16x32_bf16 v[232:235], a[52:55], a[68:71], v[232:235]
 ds_read_b128 a[4:7], v8 offset:34816
 s_mul_i32 s90, s89, 0x9e3779b1
 v_mfma_f32_16x16x32_bf16 v[120:123], a[48:51], a[68:71], v[120:123]
 v_mov_b32 v0, s90
 v_mfma_f32_16x16x32_bf16 v[228:231], a[44:47], a[68:71], v[228:231]
 ds_read_b128 a[8:11], v8 offset:36864
 v_mfma_f32_16x16x32_bf16 v[116:119], a[40:43], a[68:71], v[116:119]
 buffer_load_dwordx4 v4, s[8:11], s69 offen offset:1024 lds
 v_mfma_f32_16x16x32_bf16 v[224:227], a[36:39], a[68:71], v[224:227]
 ds_read_b128 a[12:15], v8 offset:38912
 v_mfma_f32_16x16x32_bf16 v[112:115], a[32:35], a[68:71], v[112:115]
 ds_read_b64_tr_b16 a[68:69], v13 offset:32768
 ds_read_b64_tr_b16 a[70:71], v13 offset:33792
 v_mfma_f32_16x16x32_bf16 v[128:131], a[32:35], a[72:75], v[128:131]
 ds_read_b128 a[16:19], v8 offset:40960
 v_mfma_f32_16x16x32_bf16 v[240:243], a[36:39], a[72:75], v[240:243]
 buffer_load_dwordx4 v5, s[8:11], s70 offen offset:2048 lds
 s_add_u32 s84, s84, 1
 s_cmp_eq_u32 s84, 8
 s_cselect_b32 s85, -7, 1
 s_cmov_b32 s84, 0
 v_mfma_f32_16x16x32_bf16 v[132:135], a[40:43], a[72:75], v[132:135]
 ds_read_b128 a[20:23], v8 offset:43008
 s_lshl_b32 s86, s85, 19
 v_mfma_f32_16x16x32_bf16 v[244:247], a[44:47], a[72:75], v[244:247]
 v_mfma_f32_16x16x32_bf16 v[136:139], a[48:51], a[72:75], v[136:139]
 ds_read_b128 a[24:27], v8 offset:45056
 v_mfma_f32_16x16x32_bf16 v[248:251], a[52:55], a[72:75], v[248:251]
 buffer_load_dwordx4 v5, s[8:11], s71 offen offset:3072 lds
 v_mfma_f32_16x16x32_bf16 v[140:143], a[56:59], a[72:75], v[140:143]
 ds_read_b128 a[28:31], v8 offset:47104
 v_mfma_f32_16x16x32_bf16 v[252:255], a[60:63], a[72:75], v[252:255]
 ds_read_b64_tr_b16 a[72:73], v14 offset:32768
 ds_read_b64_tr_b16 a[74:75], v14 offset:33792
 v_mfma_f32_16x16x32_bf16 a[252:255], a[60:63], a[76:79], a[252:255]
 s_add_u32 m0, s63, 0
 v_mfma_f32_16x16x32_bf16 a[248:251], a[56:59], a[76:79], a[248:251]
 buffer_load_dwordx4 v2, s[4:7], s64 offen offset:0 lds
 v_mfma_f32_16x16x32_bf16 a[244:247], a[52:55], a[76:79], a[244:247]
 v_mfma_f32_16x16x32_bf16 a[240:243], a[48:51], a[76:79], a[240:243]
 v_mfma_f32_16x16x32_bf16 a[236:239], a[44:47], a[76:79], a[236:239]
 v_mfma_f32_16x16x32_bf16 a[232:235], a[40:43], a[76:79], a[232:235]
 buffer_load_dwordx4 v3, s[4:7], s64 offen offset:1024 lds
 v_mfma_f32_16x16x32_bf16 a[228:231], a[36:39], a[76:79], a[228:231]
 v_mfma_f32_16x16x32_bf16 a[224:227], a[32:35], a[76:79], a[224:227]
 ds_read_b64_tr_b16 a[76:77], v15 offset:32768
 ds_read_b64_tr_b16 a[78:79], v15 offset:33792
 s_waitcnt lgkmcnt(2)
 v_mfma_f32_16x16x32_bf16 v[32:35], a[64:67], a[0:3], v[32:35]
L_pg1:
 s_cbranch_execz L_hopr0
 v_mfma_f32_16x16x32_bf16 v[36:39], a[64:67], a[4:7], v[36:39]
 buffer_load_dwordx4 v2, s[4:7], s65 offen offset:2048 lds
 v_mfma_f32_16x16x32_bf16 v[40:43], a[64:67], a[8:11], v[40:43]
 v_mfma_f32_16x16x32_bf16 v[44:47], a[64:67], a[12:15], v[44:47]
 v_mfma_f32_16x16x32_bf16 v[48:51], a[64:67], a[16:19], v[48:51]
 v_mfma_f32_16x16x32_bf16 v[52:55], a[64:67], a[20:23], v[52:55]
 buffer_load_dwordx4 v3, s[4:7], s65 offen offset:3072 lds
 v_mfma_f32_16x16x32_bf16 v[56:59], a[64:67], a[24:27], v[56:59]
 v_mfma_f32_16x16x32_bf16 v[60:63], a[64:67], a[28:31], v[60:63]
 ds_read_b64_tr_b16 a[64:65], v12 offset:49152
 ds_read_b64_tr_b16 a[66:67], v12 offset:50176
 v_mfma_f32_16x16x32_bf16 v[172:175], a[68:71], a[28:31], v[172:175]
 ds_read_b128 a[32:35], v9 offset:32768
 s_add_u32 m0, s62, 16384
 v_mfma_f32_16x16x32_bf16 v[168:171], a[68:71], a[24:27], v[168:171]
 buffer_load_dwordx4 v4, s[12:15], s68 offen offset:0 lds
 v_mfma_f32_16x16x32_bf16 v[164:167], a[68:71], a[20:23], v[164:167]
 v_mfma_f32_16x16x32_bf16 v[160:163], a[68:71], a[16:19], v[160:163]
 v_mfma_f32_16x16x32_bf16 v[156:159], a[68:71], a[12:15], v[156:159]
 v_mfma_f32_16x16x32_bf16 v[152:155], a[68:71], a[8:11], v[152:155]
 buffer_load_dwordx4 v4, s[12:15], s69 offen offset:1024 lds
 ds_read_b128 a[36:39], v9 offset:34816
 v_mfma_f32_16x16x32_bf16 v[148:151], a[68:71], a[4:7], v[148:151]
 v_mfma_f32_16x16x32_bf16 v[144:147], a[68:71], a[0:3], v[144:147]
 ds_read_b64_tr_b16 a[68:69], v13 offset:49152
 ds_read_b64_tr_b16 a[70:71], v13 offset:50176
 v_mfma_f32_16x16x32_bf16 v[64:67], a[72:75], a[0:3], v[64:67]
 v_mfma_f32_16x16x32_bf16 v[68:71], a[72:75], a[4:7], v[68:71]
 buffer_load_dwordx4 v5, s[12:15], s70 offen offset:2048 lds
 v_mfma_f32_16x16x32_bf16 v[72:75], a[72:75], a[8:11], v[72:75]
 ds_read_b128 a[40:43], v9 offset:36864
 v_mfma_f32_16x16x32_bf16 v[76:79], a[72:75], a[12:15], v[76:79]
 v_mfma_f32_16x16x32_bf16 v[80:83], a[72:75], a[16:19], v[80:83]
 v_mfma_f32_16x16x32_bf16 v[84:87], a[72:75], a[20:23], v[84:87]
 buffer_load_dwordx4 v5, s[12:15], s71 offen offset:3072 lds
 v_add_u32_e64 v4, s86, v4
 v_mfma_f32_16x16x32_bf16 v[88:91], a[72:75], a[24:27], v[88:91]
 v_add_u32_e64 v5, s86, v5
 v_mfma_f32_16x16x32_bf16 v[92:95], a[72:75], a[28:31], v[92:95]
 ds_read_b64_tr_b16 a[72:73], v14 offset:49152
 ds_read_b64_tr_b16 a[74:75], v14 offset:50176
 s_waitcnt lgkmcnt(3)
 v_mfma_f32_16x16x32_bf16 v[204:207], a[76:79], a[28:31], v[204:207]
 ds_read_b128 a[44:47], v9 offset:38912
 s_add_u32 m0, s63, 4096
 v_mfma_f32_16x16x32_bf16 v[200:203], a[76:79], a[24:27], v[200:203]
 buffer_load_dwordx4 v2, s[4:7], s66 offen offset:0 lds
 v_mfma_f32_16x16x32_bf16 v[196:199], a[76:79], a[20:23], v[196:199]
 v_mfma_f32_16x16x32_bf16 v[192:195], a[76:79], a[16:19], v[192:195]
 v_mfma_f32_16x16x32_bf16 v[188:191], a[76:79], a[12:15], v[188:191]
 ds_read_b128 a[48:51], v9 offset:40960
 v_mfma_f32_16x16x32_bf16 v[184:187], a[76:79], a[8:11], v[184:187]
 buffer_load_dwordx4 v3, s[4:7], s66 offen offset:1024 lds
 v_mfma_f32_16x16x32_bf16 v[180:183], a[76:79], a[4:7], v[180:183]
 v_mfma_f32_16x16x32_bf16 v[176:179], a[76:79], a[0:3], v[176:179]
 ds_read_b64_tr_b16 a[76:77], v15 offset:49152
 ds_read_b64_tr_b16 a[78:79], v15 offset:50176
 v_mfma_f32_16x16x32_bf16 v[96:99], a[0:3], a[64:67], v[96:99]
 v_mfma_f32_16x16x32_bf16 v[208:211], a[4:7], a[64:67], v[208:211]
 buffer_load_dwordx4 v2, s[4:7], s67 offen offset:2048 lds
 ds_read_b128 a[52:55], v9 offset:43008
 v_mfma_f32_16x16x32_bf16 v[100:103], a[8:11], a[64:67], v[100:103]
 v_mfma_f32_16x16x32_bf16 v[212:215], a[12:15], a[64:67], v[212:215]
 v_mfma_f32_16x16x32_bf16 v[104:107], a[16:19], a[64:67], v[104:107]
 v_mfma_f32_16x16x32_bf16 v[216:219], a[20:23], a[64:67], v[216:219]
 buffer_load_dwordx4 v3, s[4:7], s67 offen offset:3072 lds
 v_lshl_add_u32 v2, s85, 7, v2
 v_mfma_f32_16x16x32_bf16 v[108:111], a[24:27], a[64:67], v[108:111]
 ds_read_b128 a[56:59], v9 offset:45056
 v_lshl_add_u32 v3, s85, 7, v3
 v_mfma_f32_16x16x32_bf16 v[220:223], a[28:31], a[64:67], v[220:223]
 ds_read_b64_tr_b16 a[64:65], v12 offset:40960
 ds_read_b64_tr_b16 a[66:67], v12 offset:41984
 v_mfma_f32_16x16x32_bf16 v[236:239], a[28:31], a[68:71], v[236:239]
 v_mfma_f32_16x16x32_bf16 v[124:127], a[24:27], a[68:71], v[124:127]
 v_mfma_f32_16x16x32_bf16 v[232:235], a[20:23], a[68:71], v[232:235]
 s_add_u32 s3, s84, 1
 s_and_b32 s3, s3, 7
 v_mfma_f32_16x16x32_bf16 v[120:123], a[16:19], a[68:71], v[120:123]
 ds_read_b128 a[60:63], v9 offset:47104
 s_lshl_b32 s3, s3, 7
 v_mfma_f32_16x16x32_bf16 v[228:231], a[12:15], a[68:71], v[228:231]
 v_accvgpr_read_b32 v29, a118
 buffer_load_dword a165, v29, s[4:7], s3 offen
 v_mfma_f32_16x16x32_bf16 v[116:119], a[8:11], a[68:71], v[116:119]
 v_mfma_f32_16x16x32_bf16 v[224:227], a[4:7], a[68:71], v[224:227]
 v_mfma_f32_16x16x32_bf16 v[112:115], a[0:3], a[68:71], v[112:115]
 ds_read_b64_tr_b16 a[68:69], v13 offset:40960
 ds_read_b64_tr_b16 a[70:71], v13 offset:41984
 s_waitcnt lgkmcnt(3)
 v_mfma_f32_16x16x32_bf16 v[128:131], a[0:3], a[72:75], v[128:131]
 s_lshl_b32 s3, s3, 12
 v_accvgpr_read_b32 v29, a119
 v_mfma_f32_16x16x32_bf16 v[240:243], a[4:7], a[72:75], v[240:243]
 buffer_load_dword a172, v29, s[80:83], s3 offen
 v_mfma_f32_16x16x32_bf16 v[132:135], a[8:11], a[72:75], v[132:135]
 v_mfma_f32_16x16x32_bf16 v[244:247], a[12:15], a[72:75], v[244:247]
 v_mfma_f32_16x16x32_bf16 v[136:139], a[16:19], a[72:75], v[136:139]
 v_accvgpr_read_b32 v29, a120
 buffer_load_dword a173, v29, s[16:19], s91 offen
 v_mfma_f32_16x16x32_bf16 v[248:251], a[20:23], a[72:75], v[248:251]
 v_mfma_f32_16x16x32_bf16 v[140:143], a[24:27], a[72:75], v[140:143]
 v_mfma_f32_16x16x32_bf16 v[252:255], a[28:31], a[72:75], v[252:255]
 ds_read_b64_tr_b16 a[72:73], v14 offset:40960
 ds_read_b64_tr_b16 a[74:75], v14 offset:41984
 v_mfma_f32_16x16x32_bf16 a[252:255], a[28:31], a[76:79], a[252:255]
 s_add_u32 s91, s91, s97
 v_mfma_f32_16x16x32_bf16 a[248:251], a[24:27], a[76:79], a[248:251]
 v_mfma_f32_16x16x32_bf16 a[244:247], a[20:23], a[76:79], a[244:247]
 v_mfma_f32_16x16x32_bf16 a[240:243], a[16:19], a[76:79], a[240:243]
 v_mfma_f32_16x16x32_bf16 a[236:239], a[12:15], a[76:79], a[236:239]
 v_mfma_f32_16x16x32_bf16 a[232:235], a[8:11], a[76:79], a[232:235]
 v_mfma_f32_16x16x32_bf16 a[228:231], a[4:7], a[76:79], a[228:231]
 v_mfma_f32_16x16x32_bf16 a[224:227], a[0:3], a[76:79], a[224:227]
 ds_read_b64_tr_b16 a[76:77], v15 offset:40960
 ds_read_b64_tr_b16 a[78:79], v15 offset:41984
 v_mfma_f32_16x16x32_bf16 v[32:35], a[64:67], a[32:35], v[32:35]
 v_mfma_f32_16x16x32_bf16 v[36:39], a[64:67], a[36:39], v[36:39]
 v_mfma_f32_16x16x32_bf16 v[40:43], a[64:67], a[40:43], v[40:43]
 v_mfma_f32_16x16x32_bf16 v[44:47], a[64:67], a[44:47], v[44:47]
 v_mfma_f32_16x16x32_bf16 v[48:51], a[64:67], a[48:51], v[48:51]
 v_mfma_f32_16x16x32_bf16 v[52:55], a[64:67], a[52:55], v[52:55]
 v_mfma_f32_16x16x32_bf16 v[56:59], a[64:67], a[56:59], v[56:59]
 s_waitcnt lgkmcnt(2)
 v_mfma_f32_16x16x32_bf16 v[60:63], a[64:67], a[60:63], v[60:63]
 ds_read_b64_tr_b16 a[64:65], v12 offset:57344
 ds_read_b64_tr_b16 a[66:67], v12 offset:58368
 v_mfma_f32_16x16x32_bf16 v[172:175], a[68:71], a[60:63], v[172:175]
 v_mfma_f32_16x16x32_bf16 v[168:171], a[68:71], a[56:59], v[168:171]
 v_mfma_f32_16x16x32_bf16 v[164:167], a[68:71], a[52:55], v[164:167]
 v_mfma_f32_16x16x32_bf16 v[160:163], a[68:71], a[48:51], v[160:163]
 v_mfma_f32_16x16x32_bf16 v[156:159], a[68:71], a[44:47], v[156:159]
 v_mfma_f32_16x16x32_bf16 v[152:155], a[68:71], a[40:43], v[152:155]
 v_mfma_f32_16x16x32_bf16 v[148:151], a[68:71], a[36:39], v[148:151]
 v_mfma_f32_16x16x32_bf16 v[144:147], a[68:71], a[32:35], v[144:147]
 ds_read_b64_tr_b16 a[68:69], v13 offset:57344
 ds_read_b64_tr_b16 a[70:71], v13 offset:58368
 v_mfma_f32_16x16x32_bf16 v[64:67], a[72:75], a[32:35], v[64:67]
 v_mfma_f32_16x16x32_bf16 v[68:71], a[72:75], a[36:39], v[68:71]
 v_mfma_f32_16x16x32_bf16 v[72:75], a[72:75], a[40:43], v[72:75]
 v_mfma_f32_16x16x32_bf16 v[76:79], a[72:75], a[44:47], v[76:79]
 v_mfma_f32_16x16x32_bf16 v[80:83], a[72:75], a[48:51], v[80:83]
 v_mfma_f32_16x16x32_bf16 v[84:87], a[72:75], a[52:55], v[84:87]
 v_mfma_f32_16x16x32_bf16 v[88:91], a[72:75], a[56:59], v[88:91]
 v_mfma_f32_16x16x32_bf16 v[92:95], a[72:75], a[60:63], v[92:95]
 ds_read_b64_tr_b16 a[72:73], v14 offset:57344
 ds_read_b64_tr_b16 a[74:75], v14 offset:58368
 s_waitcnt lgkmcnt(2)
 v_mfma_f32_16x16x32_bf16 v[204:207], a[76:79], a[60:63], v[204:207]
 v_mfma_f32_16x16x32_bf16 v[200:203], a[76:79], a[56:59], v[200:203]
 v_mfma_f32_16x16x32_bf16 v[196:199], a[76:79], a[52:55], v[196:199]
 v_mfma_f32_16x16x32_bf16 v[192:195], a[76:79], a[48:51], v[192:195]
 v_mfma_f32_16x16x32_bf16 v[188:191], a[76:79], a[44:47], v[188:191]
 v_mfma_f32_16x16x32_bf16 v[184:187], a[76:79], a[40:43], v[184:187]
 v_mfma_f32_16x16x32_bf16 v[180:183], a[76:79], a[36:39], v[180:183]
 v_mfma_f32_16x16x32_bf16 v[176:179], a[76:79], a[32:35], v[176:179]
 ds_read_b64_tr_b16 a[76:77], v15 offset:57344
 ds_read_b64_tr_b16 a[78:79], v15 offset:58368
 v_mfma_f32_16x16x32_bf16 v[96:99], a[32:35], a[64:67], v[96:99]
 v_mfma_f32_16x16x32_bf16 v[208:211], a[36:39], a[64:67], v[208:211]
 v_mfma_f32_16x16x32_bf16 v[100:103], a[40:43], a[64:67], v[100:103]
 v_mfma_f32_16x16x32_bf16 v[212:215], a[44:47], a[64:67], v[212:215]
 v_mfma_f32_16x16x32_bf16 v[104:107], a[48:51], a[64:67], v[104:107]
 v_mfma_f32_16x16x32_bf16 v[216:219], a[52:55], a[64:67], v[216:219]
 v_mfma_f32_16x16x32_bf16 v[108:111], a[56:59], a[64:67], v[108:111]
 v_mfma_f32_16x16x32_bf16 v[220:223], a[60:63], a[64:67], v[220:223]
 s_waitcnt vmcnt(3)
 s_waitcnt lgkmcnt(0)
 s_barrier
 v_mfma_f32_16x16x32_bf16 v[236:239], a[60:63], a[68:71], v[236:239]
 ds_read_b64_tr_b16 a[64:65], v12 offset:0
 ds_read_b64_tr_b16 a[66:67], v12 offset:1024
 s_add_u32 m0, s62, 32768
 v_mfma_f32_16x16x32_bf16 v[124:127], a[56:59], a[68:71], v[124:127]
 buffer_load_dwordx4 v4, s[8:11], s68 offen offset:0 lds
 ds_read_b128 a[0:3], v8 offset:0
 v_mfma_f32_16x16x32_bf16 v[232:235], a[52:55], a[68:71], v[232:235]
 ds_read_b128 a[4:7], v8 offset:2048
 v_lshlrev_b32_e64 v10, 16, v16
 v_mfma_f32_16x16x32_bf16 v[120:123], a[48:51], a[68:71], v[120:123]
 v_and_b32 v27, s61, v16
 v_lshlrev_b32 v28, 16, v17
 v_mfma_f32_16x16x32_bf16 v[228:231], a[44:47], a[68:71], v[228:231]
 ds_read_b128 a[8:11], v8 offset:4096
 v_and_b32_e64 v30, s61, v17
 v_mfma_f32_16x16x32_bf16 v[116:119], a[40:43], a[68:71], v[116:119]
 buffer_load_dwordx4 v4, s[8:11], s69 offen offset:1024 lds
 v_add_f32_e64 v10, v10, v28
 v_mfma_f32_16x16x32_bf16 v[224:227], a[36:39], a[68:71], v[224:227]
 ds_read_b128 a[12:15], v8 offset:6144
 v_add_f32_e64 v27, v27, v30
 v_mfma_f32_16x16x32_bf16 v[112:115], a[32:35], a[68:71], v[112:115]
 ds_read_b64_tr_b16 a[68:69], v13 offset:0
 ds_read_b64_tr_b16 a[70:71], v13 offset:1024
 v_mfma_f32_16x16x32_bf16 v[128:131], a[32:35], a[72:75], v[128:131]
 ds_read_b128 a[16:19], v8 offset:8192
 v_lshlrev_b32_e64 v28, 16, v18
 v_mfma_f32_16x16x32_bf16 v[240:243], a[36:39], a[72:75], v[240:243]
 buffer_load_dwordx4 v5, s[8:11], s70 offen offset:2048 lds
 s_add_u32 s84, s84, 1
 s_cmp_eq_u32 s84, 8
 s_cselect_b32 s85, -7, 1
 s_cmov_b32 s84, 0
 v_mfma_f32_16x16x32_bf16 v[132:135], a[40:43], a[72:75], v[132:135]
 ds_read_b128 a[20:23], v8 offset:10240
 s_lshl_b32 s86, s85, 19
 v_mfma_f32_16x16x32_bf16 v[244:247], a[44:47], a[72:75], v[244:247]
 v_and_b32 v30, s61, v18
 v_add_f32_e64 v10, v10, v28
 v_mfma_f32_16x16x32_bf16 v[136:139], a[48:51], a[72:75], v[136:139]
 ds_read_b128 a[24:27], v8 offset:12288
 v_add_f32_e64 v27, v27, v30
 v_mfma_f32_16x16x32_bf16 v[248:251], a[52:55], a[72:75], v[248:251]
 buffer_load_dwordx4 v5, s[8:11], s71 offen offset:3072 lds
 v_lshlrev_b32_e64 v28, 16, v19
 v_mfma_f32_16x16x32_bf16 v[140:143], a[56:59], a[72:75], v[140:143]
 ds_read_b128 a[28:31], v8 offset:14336
 v_and_b32_e64 v30, s61, v19
 v_mfma_f32_16x16x32_bf16 v[252:255], a[60:63], a[72:75], v[252:255]
 ds_read_b64_tr_b16 a[72:73], v14 offset:0
 ds_read_b64_tr_b16 a[74:75], v14 offset:1024
 v_mfma_f32_16x16x32_bf16 a[252:255], a[60:63], a[76:79], a[252:255]
 s_add_u32 m0, s63, 32768
 v_add_f32_e64 v10, v10, v28
 v_mfma_f32_16x16x32_bf16 a[248:251], a[56:59], a[76:79], a[248:251]
 buffer_load_dwordx4 v2, s[4:7], s64 offen offset:0 lds
 v_add_f32_e64 v27, v27, v30
 v_mfma_f32_16x16x32_bf16 a[244:247], a[52:55], a[76:79], a[244:247]
 v_lshlrev_b32 v28, 16, v20
 v_and_b32 v30, s61, v20
 v_mfma_f32_16x16x32_bf16 a[240:243], a[48:51], a[76:79], a[240:243]
 v_add_f32 v10, v10, v28
 v_add_f32 v27, v27, v30
 v_mfma_f32_16x16x32_bf16 a[236:239], a[44:47], a[76:79], a[236:239]
 v_lshlrev_b32 v28, 16, v21
 v_and_b32 v30, s61, v21
 v_mfma_f32_16x16x32_bf16 a[232:235], a[40:43], a[76:79], a[232:235]
 buffer_load_dwordx4 v3, s[4:7], s64 offen offset:1024 lds
 v_add_f32_e64 v10, v10, v28
 v_mfma_f32_16x16x32_bf16 a[228:231], a[36:39], a[76:79], a[228:231]
 v_add_f32 v27, v27, v30
 v_lshlrev_b32 v28, 16, v22
 v_mfma_f32_16x16x32_bf16 a[224:227], a[32:35], a[76:79], a[224:227]
 ds_read_b64_tr_b16 a[76:77], v15 offset:0
 ds_read_b64_tr_b16 a[78:79], v15 offset:1024
 s_waitcnt lgkmcnt(2)
 v_mfma_f32_16x16x32_bf16 v[32:35], a[64:67], a[0:3], v[32:35]
 v_and_b32 v30, s61, v22
 v_add_f32_e64 v10, v10, v28
 v_mfma_f32_16x16x32_bf16 v[36:39], a[64:67], a[4:7], v[36:39]
 buffer_load_dwordx4 v2, s[4:7], s65 offen offset:2048 lds
 v_add_f32_e64 v27, v27, v30
 v_mfma_f32_16x16x32_bf16 v[40:43], a[64:67], a[8:11], v[40:43]
 v_lshlrev_b32 v28, 16, v23
 v_and_b32 v30, s61, v23
 v_mfma_f32_16x16x32_bf16 v[44:47], a[64:67], a[12:15], v[44:47]
 v_add_f32 v10, v10, v28
 v_add_f32 v27, v27, v30
 v_mfma_f32_16x16x32_bf16 v[48:51], a[64:67], a[16:19], v[48:51]
 v_lshlrev_b32 v28, 16, v24
 v_and_b32 v30, s61, v24
 v_mfma_f32_16x16x32_bf16 v[52:55], a[64:67], a[20:23], v[52:55]
 buffer_load_dwordx4 v3, s[4:7], s65 offen offset:3072 lds
 v_add_f32_e64 v10, v10, v28
 v_mfma_f32_16x16x32_bf16 v[56:59], a[64:67], a[24:27], v[56:59]
 v_add_f32 v27, v27, v30
 v_lshlrev_b32 v28, 16, v25
 v_mfma_f32_16x16x32_bf16 v[60:63], a[64:67], a[28:31], v[60:63]
 ds_read_b64_tr_b16 a[64:65], v12 offset:16384
 ds_read_b64_tr_b16 a[66:67], v12 offset:17408
 v_mfma_f32_16x16x32_bf16 v[172:175], a[68:71], a[28:31], v[172:175]
 ds_read_b128 a[32:35], v9 offset:0
 s_add_u32 m0, s62, 49152
 v_mfma_f32_16x16x32_bf16 v[168:171], a[68:71], a[24:27], v[168:171]
 buffer_load_dwordx4 v4, s[12:15], s68 offen offset:0 lds
 v_and_b32_e64 v30, s61, v25
 v_mfma_f32_16x16x32_bf16 v[164:167], a[68:71], a[20:23], v[164:167]
 v_add_f32 v10, v10, v28
 v_add_f32 v27, v27, v30
 v_mfma_f32_16x16x32_bf16 v[160:163], a[68:71], a[16:19], v[160:163]
 v_add_f32 v10, v10, v27
 s_nop 1
 v_add_f32_dpp v10, v10, v10 quad_perm:[1,0,3,2] row_mask:0xf bank_mask:0xf
 v_mfma_f32_16x16x32_bf16 v[156:159], a[68:71], a[12:15], v[156:159]
 s_nop 0
 v_add_f32_dpp v10, v10, v10 quad_perm:[2,3,0,1] row_mask:0xf bank_mask:0xf
 s_nop 1
 v_add_f32_dpp v10, v10, v10 row_half_mirror row_mask:0xf bank_mask:0xf
 v_mfma_f32_16x16x32_bf16 v[152:155], a[68:71], a[8:11], v[152:155]
 buffer_load_dwordx4 v4, s[12:15], s69 offen offset:1024 lds
 ds_read_b128 a[36:39], v9 offset:2048
 v_mfma_f32_16x16x32_bf16 v[148:151], a[68:71], a[4:7], v[148:151]
 v_add_f32_dpp v10, v10, v10 row_mirror row_mask:0xf bank_mask:0xf
 v_mov_b32_e64 v27, v10
 v_mfma_f32_16x16x32_bf16 v[144:147], a[68:71], a[0:3], v[144:147]
 ds_read_b64_tr_b16 a[68:69], v13 offset:16384
 ds_read_b64_tr_b16 a[70:71], v13 offset:17408
 v_mfma_f32_16x16x32_bf16 v[64:67], a[72:75], a[0:3], v[64:67]
 v_permlane16_swap_b32 v10, v27
 v_add_f32 v10, v10, v27
 v_mfma_f32_16x16x32_bf16 v[68:71], a[72:75], a[4:7], v[68:71]
 buffer_load_dwordx4 v5, s[12:15], s70 offen offset:2048 lds
 v_mul_f32 v10, 0x3acccccd, v10
 v_mfma_f32_16x16x32_bf16 v[72:75], a[72:75], a[8:11], v[72:75]
 ds_read_b128 a[40:43], v9 offset:4096
 v_lshlrev_b32_e64 v28, 16, v16
 v_mfma_f32_16x16x32_bf16 v[76:79], a[72:75], a[12:15], v[76:79]
 v_and_b32 v30, s61, v16
 v_sub_f32 v28, v28, v10
 v_mfma_f32_16x16x32_bf16 v[80:83], a[72:75], a[16:19], v[80:83]
 v_sub_f32 v30, v30, v10
 v_mul_f32 v11, v28, v28
 v_mfma_f32_16x16x32_bf16 v[84:87], a[72:75], a[20:23], v[84:87]
 buffer_load_dwordx4 v5, s[12:15], s71 offen offset:3072 lds
 v_add_u32_e64 v4, s86, v4
 v_mfma_f32_16x16x32_bf16 v[88:91], a[72:75], a[24:27], v[88:91]
 v_add_u32 v5, s86, v5
 v_mul_f32 v27, v30, v30
 v_mfma_f32_16x16x32_bf16 v[92:95], a[72:75], a[28:31], v[92:95]
 ds_read_b64_tr_b16 a[72:73], v14 offset:16384
 ds_read_b64_tr_b16 a[74:75], v14 offset:17408
 s_waitcnt lgkmcnt(3)
 v_mfma_f32_16x16x32_bf16 v[204:207], a[76:79], a[28:31], v[204:207]
 ds_read_b128 a[44:47], v9 offset:6144
 s_add_u32 m0, s63, 36864
 v_mfma_f32_16x16x32_bf16 v[200:203], a[76:79], a[24:27], v[200:203]
 buffer_load_dwordx4 v2, s[4:7], s66 offen offset:0 lds
 v_lshlrev_b32 v28, 16, v17
 v_mfma_f32_16x16x32_bf16 v[196:199], a[76:79], a[20:23], v[196:199]
 v_and_b32 v30, s61, v17
 v_sub_f32 v28, v28, v10
 v_mfma_f32_16x16x32_bf16 v[192:195], a[76:79], a[16:19], v[192:195]
 v_sub_f32 v30, v30, v10
 v_fmac_f32 v11, v28, v28
 v_mfma_f32_16x16x32_bf16 v[188:191], a[76:79], a[12:15], v[188:191]
 ds_read_b128 a[48:51], v9 offset:8192
 v_fmac_f32_e64 v27, v30, v30
 v_mfma_f32_16x16x32_bf16 v[184:187], a[76:79], a[8:11], v[184:187]
 buffer_load_dwordx4 v3, s[4:7], s66 offen offset:1024 lds
 v_lshlrev_b32_e64 v28, 16, v18
 v_mfma_f32_16x16x32_bf16 v[180:183], a[76:79], a[4:7], v[180:183]
 v_and_b32 v30, s61, v18
 v_sub_f32 v28, v28, v10
 v_mfma_f32_16x16x32_bf16 v[176:179], a[76:79], a[0:3], v[176:179]
 ds_read_b64_tr_b16 a[76:77], v15 offset:16384
 ds_read_b64_tr_b16 a[78:79], v15 offset:17408
 v_mfma_f32_16x16x32_bf16 v[96:99], a[0:3], a[64:67], v[96:99]
 v_sub_f32 v30, v30, v10
 v_fmac_f32 v11, v28, v28
 v_mfma_f32_16x16x32_bf16 v[208:211], a[4:7], a[64:67], v[208:211]
 buffer_load_dwordx4 v2, s[4:7], s67 offen offset:2048 lds
 ds_read_b128 a[52:55], v9 offset:10240
 v_mfma_f32_16x16x32_bf16 v[100:103], a[8:11], a[64:67], v[100:103]
 v_fmac_f32 v27, v30, v30
 v_lshlrev_b32 v28, 16, v19
 v_mfma_f32_16x16x32_bf16 v[212:215], a[12:15], a[64:67], v[212:215]
 v_and_b32 v30, s61, v19
 v_sub_f32 v28, v28, v10
 v_mfma_f32_16x16x32_bf16 v[104:107], a[16:19], a[64:67], v[104:107]
 v_sub_f32 v30, v30, v10
 v_fmac_f32 v11, v28, v28
 v_mfma_f32_16x16x32_bf16 v[216:219], a[20:23], a[64:67], v[216:219]
 buffer_load_dwordx4 v3, s[4:7], s67 offen offset:3072 lds
 v_lshl_add_u32 v2, s85, 7, v2
 v_mfma_f32_16x16x32_bf16 v[108:111], a[24:27], a[64:67], v[108:111]
 ds_read_b128 a[56:59], v9 offset:12288
 v_lshl_add_u32 v3, s85, 7, v3
 v_mfma_f32_16x16x32_bf16 v[220:223], a[28:31], a[64:67], v[220:223]
 ds_read_b64_tr_b16 a[64:65], v12 offset:8192
 ds_read_b64_tr_b16 a[66:67], v12 offset:9216
 v_mfma_f32_16x16x32_bf16 v[236:239], a[28:31], a[68:71], v[236:239]
 v_fmac_f32 v27, v30, v30
 v_lshlrev_b32 v28, 16, v20
 v_mfma_f32_16x16x32_bf16 v[124:127], a[24:27], a[68:71], v[124:127]
 v_and_b32 v30, s61, v20
 v_sub_f32 v28, v28, v10
 v_mfma_f32_16x16x32_bf16 v[232:235], a[20:23], a[68:71], v[232:235]
 s_add_u32 s3, s84, 1
 s_and_b32 s3, s3, 7
 v_mfma_f32_16x16x32_bf16 v[120:123], a[16:19], a[68:71], v[120:123]
 ds_read_b128 a[60:63], v9 offset:14336
 s_lshl_b32 s3, s3, 7
 v_mfma_f32_16x16x32_bf16 v[228:231], a[12:15], a[68:71], v[228:231]
 v_accvgpr_read_b32 v29, a118
 buffer_load_dword a182, v29, s[4:7], s3 offen
 v_mfma_f32_16x16x32_bf16 v[116:119], a[8:11], a[68:71], v[116:119]
 v_sub_f32 v30, v30, v10
 v_fmac_f32_e64 v11, v28, v28
 v_mfma_f32_16x16x32_bf16 v[224:227], a[4:7], a[68:71], v[224:227]
 v_fmac_f32 v27, v30, v30
 v_lshlrev_b32 v28, 16, v21
 v_mfma_f32_16x16x32_bf16 v[112:115], a[0:3], a[68:71], v[112:115]
 ds_read_b64_tr_b16 a[68:69], v13 offset:8192
 ds_read_b64_tr_b16 a[70:71], v13 offset:9216
 s_waitcnt lgkmcnt(3)
 v_mfma_f32_16x16x32_bf16 v[128:131], a[0:3], a[72:75], v[128:131]
 s_lshl_b32 s3, s3, 12
 v_accvgpr_read_b32 v29, a119
 v_mfma_f32_16x16x32_bf16 v[240:243], a[4:7], a[72:75], v[240:243]
 buffer_load_dword a189, v29, s[80:83], s3 offen
 v_and_b32_e64 v30, s61, v21
 v_mfma_f32_16x16x32_bf16 v[132:135], a[8:11], a[72:75], v[132:135]
 v_sub_f32 v28, v28, v10
 v_sub_f32 v30, v30, v10
 v_mfma_f32_16x16x32_bf16 v[244:247], a[12:15], a[72:75], v[244:247]
 v_fmac_f32 v11, v28, v28
 v_fmac_f32 v27, v30, v30
 v_mfma_f32_16x16x32_bf16 v[136:139], a[16:19], a[72:75], v[136:139]
 v_accvgpr_read_b32 v29, a120
 buffer_load_dword a190, v29, s[16:19], s91 offen
 v_mfma_f32_16x16x32_bf16 v[248:251], a[20:23], a[72:75], v[248:251]
 v_lshlrev_b32 v28, 16, v22
 v_and_b32 v30, s61, v22
 v_mfma_f32_16x16x32_bf16 v[140:143], a[24:27], a[72:75], v[140:143]
 v_sub_f32 v28, v28, v10
 v_sub_f32 v30, v30, v10
 v_mfma_f32_16x16x32_bf16 v[252:255], a[28:31], a[72:75], v[252:255]
 ds_read_b64_tr_b16 a[72:73], v14 offset:8192
 ds_read_b64_tr_b16 a[74:75], v14 offset:9216
 v_mfma_f32_16x16x32_bf16 a[252:255], a[28:31], a[76:79], a[252:255]
 s_add_u32 s91, s91, s97
 v_fmac_f32 v11, v28, v28
 v_mfma_f32_16x16x32_bf16 a[248:251], a[24:27], a[76:79], a[248:251]
 v_fmac_f32 v27, v30, v30
 v_lshlrev_b32 v28, 16, v23
 v_mfma_f32_16x16x32_bf16 a[244:247], a[20:23], a[76:79], a[244:247]
 v_and_b32 v30, s61, v23
 v_sub_f32 v28, v28, v10
 v_mfma_f32_16x16x32_bf16 a[240:243], a[16:19], a[76:79], a[240:243]
 v_sub_f32 v30, v30, v10
 v_fmac_f32 v11, v28, v28
 v_mfma_f32_16x16x32_bf16 a[236:239], a[12:15], a[76:79], a[236:239]
 v_fmac_f32 v27, v30, v30
 v_lshlrev_b32 v28, 16, v24
 v_mfma_f32_16x16x32_bf16 a[232:235], a[8:11], a[76:79], a[232:235]
 v_and_b32 v30, s61, v24
 v_sub_f32 v28, v28, v10
 v_mfma_f32_16x16x32_bf16 a[228:231], a[4:7], a[76:79], a[228:231]
 v_sub_f32 v30, v30, v10
 v_fmac_f32 v11, v28, v28
 v_mfma_f32_16x16x32_bf16 a[224:227], a[0:3], a[76:79], a[224:227]
 ds_read_b64_tr_b16 a[76:77], v15 offset:8192
 ds_read_b64_tr_b16 a[78:79], v15 offset:9216
 v_mfma_f32_16x16x32_bf16 v[32:35], a[64:67], a[32:35], v[32:35]
 v_fmac_f32 v27, v30, v30
 v_lshlrev_b32 v28, 16, v25
 v_mfma_f32_16x16x32_bf16 v[36:39], a[64:67], a[36:39], v[36:39]
 v_and_b32 v30, s61, v25
 v_sub_f32 v28, v28, v10
 v_mfma_f32_16x16x32_bf16 v[40:43], a[64:67], a[40:43], v[40:43]
 v_sub_f32 v30, v30, v10
 v_fmac_f32 v11, v28, v28
 v_mfma_f32_16x16x32_bf16 v[44:47], a[64:67], a[44:47], v[44:47]
 v_fmac_f32 v27, v30, v30
 v_add_f32 v11, v11, v27
 v_mfma_f32_16x16x32_bf16 v[48:51], a[64:67], a[48:51], v[48:51]
 s_nop 0
 v_add_f32_dpp v11, v11, v11 quad_perm:[1,0,3,2] row_mask:0xf bank_mask:0xf
 s_nop 1
 v_add_f32_dpp v11, v11, v11 quad_perm:[2,3,0,1] row_mask:0xf bank_mask:0xf
 v_mfma_f32_16x16x32_bf16 v[52:55], a[64:67], a[52:55], v[52:55]
 s_nop 0
 v_add_f32_dpp v11, v11, v11 row_half_mirror row_mask:0xf bank_mask:0xf
 s_nop 1
 v_add_f32_dpp v11, v11, v11 row_mirror row_mask:0xf bank_mask:0xf
 v_mfma_f32_16x16x32_bf16 v[56:59], a[64:67], a[56:59], v[56:59]
 v_mov_b32 v27, v11
 s_nop 1
 v_permlane16_swap_b32 v11, v27
 s_waitcnt lgkmcnt(2)
 v_mfma_f32_16x16x32_bf16 v[60:63], a[64:67], a[60:63], v[60:63]
 ds_read_b64_tr_b16 a[64:65], v12 offset:24576
 ds_read_b64_tr_b16 a[66:67], v12 offset:25600
 v_mfma_f32_16x16x32_bf16 v[172:175], a[68:71], a[60:63], v[172:175]
 v_add_f32_e64 v11, v11, v27
 v_mul_f32 v11, 0x3acccccd, v11
 v_mfma_f32_16x16x32_bf16 v[168:171], a[68:71], a[56:59], v[168:171]
 v_cvt_pk_bf16_f32 v27, v10, v11
 v_lshlrev_b32_e64 v10, 16, v27
 v_mfma_f32_16x16x32_bf16 v[164:167], a[68:71], a[52:55], v[164:167]
 v_and_b32_e64 v11, s61, v27
 v_add_f32 v11, 0x3727c5ac, v11
 v_mfma_f32_16x16x32_bf16 v[160:163], a[68:71], a[48:51], v[160:163]
 v_cvt_pk_bf16_f32 v11, v11, v11
 v_lshlrev_b32_e64 v11, 16, v11
 v_mfma_f32_16x16x32_bf16 v[156:159], a[68:71], a[44:47], v[156:159]
 v_sqrt_f32 v11, v11
 v_mfma_f32_16x16x32_bf16 v[152:155], a[68:71], a[40:43], v[152:155]
 v_cvt_pk_bf16_f32 v11, v11, v11
 v_lshlrev_b32 v11, 16, v11
 v_mfma_f32_16x16x32_bf16 v[148:151], a[68:71], a[36:39], v[148:151]
 v_rcp_f32_e64 v11, v11
 v_mfma_f32_16x16x32_bf16 v[144:147], a[68:71], a[32:35], v[144:147]
 ds_read_b64_tr_b16 a[68:69], v13 offset:24576
 ds_read_b64_tr_b16 a[70:71], v13 offset:25600
 v_mfma_f32_16x16x32_bf16 v[64:67], a[72:75], a[32:35], v[64:67]
 v_lshlrev_b32 v28, 16, v16
 v_and_b32 v30, s61, v16
 v_mfma_f32_16x16x32_bf16 v[68:71], a[72:75], a[36:39], v[68:71]
 v_sub_f32 v28, v28, v10
 v_sub_f32 v30, v30, v10
 v_mfma_f32_16x16x32_bf16 v[72:75], a[72:75], a[40:43], v[72:75]
 v_cvt_pk_bf16_f32 v16, v28, v30
 v_lshlrev_b32_e64 v28, 16, v16
 v_mfma_f32_16x16x32_bf16 v[76:79], a[72:75], a[44:47], v[76:79]
 v_and_b32 v30, s61, v16
 v_mul_f32 v28, v28, v11
 v_mfma_f32_16x16x32_bf16 v[80:83], a[72:75], a[48:51], v[80:83]
 v_mul_f32_e64 v30, v30, v11
 v_cvt_pk_bf16_f32 v16, v28, v30
 v_mfma_f32_16x16x32_bf16 v[84:87], a[72:75], a[52:55], v[84:87]
 v_lshlrev_b32 v28, 16, v17
 v_and_b32 v30, s61, v17
 v_mfma_f32_16x16x32_bf16 v[88:91], a[72:75], a[56:59], v[88:91]
 v_sub_f32 v28, v28, v10
 v_sub_f32 v30, v30, v10
 v_mfma_f32_16x16x32_bf16 v[92:95], a[72:75], a[60:63], v[92:95]
 ds_read_b64_tr_b16 a[72:73], v14 offset:24576
 ds_read_b64_tr_b16 a[74:75], v14 offset:25600
 s_waitcnt lgkmcnt(2)
 v_mfma_f32_16x16x32_bf16 v[204:207], a[76:79], a[60:63], v[204:207]
 v_cvt_pk_bf16_f32 v17, v28, v30
 v_lshlrev_b32 v28, 16, v17
 v_mfma_f32_16x16x32_bf16 v[200:203], a[76:79], a[56:59], v[200:203]
 v_and_b32 v30, s61, v17
 v_mul_f32 v28, v28, v11
 v_mfma_f32_16x16x32_bf16 v[196:199], a[76:79], a[52:55], v[196:199]
 v_mul_f32_e64 v30, v30, v11
 v_cvt_pk_bf16_f32 v17, v28, v30
 v_mfma_f32_16x16x32_bf16 v[192:195], a[76:79], a[48:51], v[192:195]
 v_lshlrev_b32 v28, 16, v18
 v_and_b32 v30, s61, v18
 v_mfma_f32_16x16x32_bf16 v[188:191], a[76:79], a[44:47], v[188:191]
 v_sub_f32 v28, v28, v10
 v_sub_f32 v30, v30, v10
 v_mfma_f32_16x16x32_bf16 v[184:187], a[76:79], a[40:43], v[184:187]
 v_cvt_pk_bf16_f32 v18, v28, v30
 v_lshlrev_b32_e64 v28, 16, v18
 v_mfma_f32_16x16x32_bf16 v[180:183], a[76:79], a[36:39], v[180:183]
 v_and_b32 v30, s61, v18
 v_mul_f32 v28, v28, v11
 v_mfma_f32_16x16x32_bf16 v[176:179], a[76:79], a[32:35], v[176:179]
 ds_read_b64_tr_b16 a[76:77], v15 offset:24576
 ds_read_b64_tr_b16 a[78:79], v15 offset:25600
 v_mfma_f32_16x16x32_bf16 v[96:99], a[32:35], a[64:67], v[96:99]
 v_mul_f32_e64 v30, v30, v11
 v_cvt_pk_bf16_f32 v18, v28, v30
 v_mfma_f32_16x16x32_bf16 v[208:211], a[36:39], a[64:67], v[208:211]
 v_lshlrev_b32 v28, 16, v19
 v_and_b32 v30, s61, v19
 v_mfma_f32_16x16x32_bf16 v[100:103], a[40:43], a[64:67], v[100:103]
 v_sub_f32 v28, v28, v10
 v_sub_f32 v30, v30, v10
 v_mfma_f32_16x16x32_bf16 v[212:215], a[44:47], a[64:67], v[212:215]
 v_cvt_pk_bf16_f32 v19, v28, v30
 v_lshlrev_b32_e64 v28, 16, v19
 v_mfma_f32_16x16x32_bf16 v[104:107], a[48:51], a[64:67], v[104:107]
 v_and_b32 v30, s61, v19
 v_mul_f32 v28, v28, v11
 v_mfma_f32_16x16x32_bf16 v[216:219], a[52:55], a[64:67], v[216:219]
 v_mul_f32_e64 v30, v30, v11
 v_cvt_pk_bf16_f32 v19, v28, v30
 v_mfma_f32_16x16x32_bf16 v[108:111], a[56:59], a[64:67], v[108:111]
 v_lshlrev_b32 v28, 16, v20
 v_and_b32 v30, s61, v20
 v_mfma_f32_16x16x32_bf16 v[220:223], a[60:63], a[64:67], v[220:223]
 s_waitcnt vmcnt(3)
 s_waitcnt lgkmcnt(0)
 s_barrier
 v_mfma_f32_16x16x32_bf16 v[236:239], a[60:63], a[68:71], v[236:239]
 ds_read_b64_tr_b16 a[64:65], v12 offset:32768
 ds_read_b64_tr_b16 a[66:67], v12 offset:33792
 s_add_u32 m0, s62, 0
 v_mfma_f32_16x16x32_bf16 v[124:127], a[56:59], a[68:71], v[124:127]
 buffer_load_dwordx4 v4, s[8:11], s68 offen offset:0 lds
 ds_read_b128 a[0:3], v8 offset:32768
 v_mfma_f32_16x16x32_bf16 v[232:235], a[52:55], a[68:71], v[232:235]
 ds_read_b128 a[4:7], v8 offset:34816
 v_sub_f32_e64 v28, v28, v10
 v_mfma_f32_16x16x32_bf16 v[120:123], a[48:51], a[68:71], v[120:123]
 v_sub_f32_e64 v30, v30, v10
 v_cvt_pk_bf16_f32 v20, v28, v30
 v_mfma_f32_16x16x32_bf16 v[228:231], a[44:47], a[68:71], v[228:231]
 ds_read_b128 a[8:11], v8 offset:36864
 v_lshlrev_b32_e64 v28, 16, v20
 v_mfma_f32_16x16x32_bf16 v[116:119], a[40:43], a[68:71], v[116:119]
 buffer_load_dwordx4 v4, s[8:11], s69 offen offset:1024 lds
L_pg2:
 s_cbranch_execz L_hopr0
 v_and_b32 v30, s61, v20
 v_mfma_f32_16x16x32_bf16 v[224:227], a[36:39], a[68:71], v[224:227]
 ds_read_b128 a[12:15], v8 offset:38912
 v_mul_f32_e64 v28, v28, v11
 v_mfma_f32_16x16x32_bf16 v[112:115], a[32:35], a[68:71], v[112:115]
 ds_read_b64_tr_b16 a[68:69], v13 offset:32768
 ds_read_b64_tr_b16 a[70:71], v13 offset:33792
 v_mfma_f32_16x16x32_bf16 v[128:131], a[32:35], a[72:75], v[128:131]
 ds_read_b128 a[16:19], v8 offset:40960
 v_mul_f32_e64 v30, v30, v11
 v_mfma_f32_16x16x32_bf16 v[240:243], a[36:39], a[72:75], v[240:243]
 buffer_load_dwordx4 v5, s[8:11], s70 offen offset:2048 lds
 s_add_u32 s84, s84, 1
 s_cmp_eq_u32 s84, 8
 s_cselect_b32 s85, -7, 1
 s_cmov_b32 s84, 0
 v_mfma_f32_16x16x32_bf16 v[132:135], a[40:43], a[72:75], v[132:135]
 ds_read_b128 a[20:23], v8 offset:43008
 s_lshl_b32 s86, s85, 19
 v_mfma_f32_16x16x32_bf16 v[244:247], a[44:47], a[72:75], v[244:247]
 v_cvt_pk_bf16_f32 v20, v28, v30
 v_lshlrev_b32 v28, 16, v21
 v_mfma_f32_16x16x32_bf16 v[136:139], a[48:51], a[72:75], v[136:139]
 ds_read_b128 a[24:27], v8 offset:45056
 v_and_b32_e64 v30, s61, v21
 v_mfma_f32_16x16x32_bf16 v[248:251], a[52:55], a[72:75], v[248:251]
 buffer_load_dwordx4 v5, s[8:11], s71 offen offset:3072 lds
 v_sub_f32_e64 v28, v28, v10
 v_mfma_f32_16x16x32_bf16 v[140:143], a[56:59], a[72:75], v[140:143]
 ds_read_b128 a[28:31], v8 offset:47104
 v_sub_f32_e64 v30, v30, v10
 v_mfma_f32_16x16x32_bf16 v[252:255], a[60:63], a[72:75], v[252:255]
 ds_read_b64_tr_b16 a[72:73], v14 offset:32768
 ds_read_b64_tr_b16 a[74:75], v14 offset:33792
 v_mfma_f32_16x16x32_bf16 a[252:255], a[60:63], a[76:79], a[252:255]
 s_add_u32 m0, s63, 0
 v_cvt_pk_bf16_f32 v21, v28, v30
 v_mfma_f32_16x16x32_bf16 a[248:251], a[56:59], a[76:79], a[248:251]
 buffer_load_dwordx4 v2, s[4:7], s64 offen offset:0 lds
 v_lshlrev_b32 v28, 16, v21
 v_mfma_f32_16x16x32_bf16 a[244:247], a[52:55], a[76:79], a[244:247]
 v_and_b32 v30, s61, v21
 v_mul_f32 v28, v28, v11
 v_mfma_f32_16x16x32_bf16 a[240:243], a[48:51], a[76:79], a[240:243]
 v_mul_f32_e64 v30, v30, v11
 v_cvt_pk_bf16_f32 v21, v28, v30
 v_mfma_f32_16x16x32_bf16 a[236:239], a[44:47], a[76:79], a[236:239]
 v_lshlrev_b32 v28, 16, v22
 v_and_b32 v30, s61, v22
 v_mfma_f32_16x16x32_bf16 a[232:235], a[40:43], a[76:79], a[232:235]
 buffer_load_dwordx4 v3, s[4:7], s64 offen offset:1024 lds
 v_sub_f32_e64 v28, v28, v10
 v_mfma_f32_16x16x32_bf16 a[228:231], a[36:39], a[76:79], a[228:231]
 v_sub_f32_e64 v30, v30, v10
 v_cvt_pk_bf16_f32 v22, v28, v30
 v_mfma_f32_16x16x32_bf16 a[224:227], a[32:35], a[76:79], a[224:227]
 ds_read_b64_tr_b16 a[76:77], v15 offset:32768
 ds_read_b64_tr_b16 a[78:79], v15 offset:33792
 s_waitcnt lgkmcnt(2)
 v_mfma_f32_16x16x32_bf16 v[32:35], a[64:67], a[0:3], v[32:35]
 v_lshlrev_b32 v28, 16, v22
 v_and_b32_e64 v30, s61, v22
 v_mfma_f32_16x16x32_bf16 v[36:39], a[64:67], a[4:7], v[36:39]
 buffer_load_dwordx4 v2, s[4:7], s65 offen offset:2048 lds
 v_mul_f32_e64 v28, v28, v11
 v_mfma_f32_16x16x32_bf16 v[40:43], a[64:67], a[8:11], v[40:43]
 v_mul_f32_e64 v30, v30, v11
 v_cvt_pk_bf16_f32 v22, v28, v30
 v_mfma_f32_16x16x32_bf16 v[44:47], a[64:67], a[12:15], v[44:47]
 v_lshlrev_b32 v28, 16, v23
 v_and_b32 v30, s61, v23
 v_mfma_f32_16x16x32_bf16 v[48:51], a[64:67], a[16:19], v[48:51]
 v_sub_f32 v28, v28, v10
 v_sub_f32 v30, v30, v10
 v_mfma_f32_16x16x32_bf16 v[52:55], a[64:67], a[20:23], v[52:55]
 buffer_load_dwordx4 v3, s[4:7], s65 offen offset:3072 lds
 v_cvt_pk_bf16_f32 v23, v28, v30
 v_mfma_f32_16x16x32_bf16 v[56:59], a[64:67], a[24:27], v[56:59]
 v_lshlrev_b32 v28, 16, v23
 v_and_b32 v30, s61, v23
 v_mfma_f32_16x16x32_bf16 v[60:63], a[64:67], a[28:31], v[60:63]
 ds_read_b64_tr_b16 a[64:65], v12 offset:49152
 ds_read_b64_tr_b16 a[66:67], v12 offset:50176
 v_mfma_f32_16x16x32_bf16 v[172:175], a[68:71], a[28:31], v[172:175]
 ds_read_b128 a[32:35], v9 offset:32768
 s_add_u32 m0, s62, 16384
 v_mfma_f32_16x16x32_bf16 v[168:171], a[68:71], a[24:27], v[168:171]
 buffer_load_dwordx4 v4, s[12:15], s68 offen offset:0 lds
 v_mul_f32_e64 v28, v28, v11
 v_mfma_f32_16x16x32_bf16 v[164:167], a[68:71], a[20:23], v[164:167]
 v_mul_f32_e64 v30, v30, v11
 v_cvt_pk_bf16_f32 v23, v28, v30
 v_mfma_f32_16x16x32_bf16 v[160:163], a[68:71], a[16:19], v[160:163]
 v_lshlrev_b32 v28, 16, v24
 v_and_b32 v30, s61, v24
 v_mfma_f32_16x16x32_bf16 v[156:159], a[68:71], a[12:15], v[156:159]
 v_sub_f32 v28, v28, v10
 v_sub_f32 v30, v30, v10
 v_mfma_f32_16x16x32_bf16 v[152:155], a[68:71], a[8:11], v[152:155]
 buffer_load_dwordx4 v4, s[12:15], s69 offen offset:1024 lds
 ds_read_b128 a[36:39], v9 offset:34816
 v_mfma_f32_16x16x32_bf16 v[148:151], a[68:71], a[4:7], v[148:151]
 v_cvt_pk_bf16_f32 v24, v28, v30
 v_lshlrev_b32_e64 v28, 16, v24
 v_mfma_f32_16x16x32_bf16 v[144:147], a[68:71], a[0:3], v[144:147]
 ds_read_b64_tr_b16 a[68:69], v13 offset:49152
 ds_read_b64_tr_b16 a[70:71], v13 offset:50176
 v_mfma_f32_16x16x32_bf16 v[64:67], a[72:75], a[0:3], v[64:67]
 v_and_b32 v30, s61, v24
 v_mul_f32 v28, v28, v11
 v_mfma_f32_16x16x32_bf16 v[68:71], a[72:75], a[4:7], v[68:71]
 buffer_load_dwordx4 v5, s[12:15], s70 offen offset:2048 lds
 v_mul_f32_e64 v30, v30, v11
 v_mfma_f32_16x16x32_bf16 v[72:75], a[72:75], a[8:11], v[72:75]
 ds_read_b128 a[40:43], v9 offset:36864
 v_cvt_pk_bf16_f32 v24, v28, v30
 v_mfma_f32_16x16x32_bf16 v[76:79], a[72:75], a[12:15], v[76:79]
 v_lshlrev_b32 v28, 16, v25
 v_and_b32 v30, s61, v25
 v_mfma_f32_16x16x32_bf16 v[80:83], a[72:75], a[16:19], v[80:83]
 v_sub_f32 v28, v28, v10
 v_sub_f32 v30, v30, v10
 v_mfma_f32_16x16x32_bf16 v[84:87], a[72:75], a[20:23], v[84:87]
 buffer_load_dwordx4 v5, s[12:15], s71 offen offset:3072 lds
 v_add_u32_e64 v4, s86, v4
 v_mfma_f32_16x16x32_bf16 v[88:91], a[72:75], a[24:27], v[88:91]
 v_add_u32_e64 v5, s86, v5
 v_cvt_pk_bf16_f32 v25, v28, v30
 v_mfma_f32_16x16x32_bf16 v[92:95], a[72:75], a[28:31], v[92:95]
 ds_read_b64_tr_b16 a[72:73], v14 offset:49152
 ds_read_b64_tr_b16 a[74:75], v14 offset:50176
 s_waitcnt lgkmcnt(3)
 v_mfma_f32_16x16x32_bf16 v[204:207], a[76:79], a[28:31], v[204:207]
 ds_read_b128 a[44:47], v9 offset:38912
 s_add_u32 m0, s63, 4096
 v_mfma_f32_16x16x32_bf16 v[200:203], a[76:79], a[24:27], v[200:203]
 buffer_load_dwordx4 v2, s[4:7], s66 offen offset:0 lds
 v_lshlrev_b32 v28, 16, v25
 v_mfma_f32_16x16x32_bf16 v[196:199], a[76:79], a[20:23], v[196:199]
 v_and_b32 v30, s61, v25
 v_mul_f32 v28, v28, v11
 v_mfma_f32_16x16x32_bf16 v[192:195], a[76:79], a[16:19], v[192:195]
 v_mul_f32_e64 v30, v30, v11
 v_cvt_pk_bf16_f32 v25, v28, v30
 v_mfma_f32_16x16x32_bf16 v[188:191], a[76:79], a[12:15], v[188:191]
 ds_read_b128 a[48:51], v9 offset:40960
 v_mfma_f32_16x16x32_bf16 v[184:187], a[76:79], a[8:11], v[184:187]
 buffer_load_dwordx4 v3, s[4:7], s66 offen offset:1024 lds
 buffer_store_dwordx4 v[16:19], v6, s[20:23], 0 offen sc1
 v_mfma_f32_16x16x32_bf16 v[180:183], a[76:79], a[4:7], v[180:183]
 v_mfma_f32_16x16x32_bf16 v[176:179], a[76:79], a[0:3], v[176:179]
 ds_read_b64_tr_b16 a[76:77], v15 offset:49152
 ds_read_b64_tr_b16 a[78:79], v15 offset:50176
 v_mfma_f32_16x16x32_bf16 v[96:99], a[0:3], a[64:67], v[96:99]
 buffer_store_dwordx4 v[20:23], v6, s[20:23], 0 offen offset:512 sc1
 v_mfma_f32_16x16x32_bf16 v[208:211], a[4:7], a[64:67], v[208:211]
 buffer_load_dwordx4 v2, s[4:7], s67 offen offset:2048 lds
 ds_read_b128 a[52:55], v9 offset:43008
 v_mfma_f32_16x16x32_bf16 v[100:103], a[8:11], a[64:67], v[100:103]
 buffer_store_dwordx2 v[24:25], v7, s[20:23], 0 offen offset:1024 sc1
 v_mfma_f32_16x16x32_bf16 v[212:215], a[12:15], a[64:67], v[212:215]
 v_mfma_f32_16x16x32_bf16 v[104:107], a[16:19], a[64:67], v[104:107]
 v_mfma_f32_16x16x32_bf16 v[216:219], a[20:23], a[64:67], v[216:219]
 buffer_load_dwordx4 v3, s[4:7], s67 offen offset:3072 lds
 v_lshl_add_u32 v2, s85, 7, v2
 v_mfma_f32_16x16x32_bf16 v[108:111], a[24:27], a[64:67], v[108:111]
 ds_read_b128 a[56:59], v9 offset:45056
 v_lshl_add_u32 v3, s85, 7, v3
 v_mfma_f32_16x16x32_bf16 v[220:223], a[28:31], a[64:67], v[220:223]
 ds_read_b64_tr_b16 a[64:65], v12 offset:40960
 ds_read_b64_tr_b16 a[66:67], v12 offset:41984
 v_mfma_f32_16x16x32_bf16 v[236:239], a[28:31], a[68:71], v[236:239]
 v_mfma_f32_16x16x32_bf16 v[124:127], a[24:27], a[68:71], v[124:127]
 v_mfma_f32_16x16x32_bf16 v[232:235], a[20:23], a[68:71], v[232:235]
 s_add_u32 s3, s84, 1
 s_and_b32 s3, s3, 7
 v_mfma_f32_16x16x32_bf16 v[120:123], a[16:19], a[68:71], v[120:123]
 ds_read_b128 a[60:63], v9 offset:47104
 s_lshl_b32 s3, s3, 7
 v_mfma_f32_16x16x32_bf16 v[228:231], a[12:15], a[68:71], v[228:231]
 v_accvgpr_read_b32 v29, a118
 buffer_load_dword a199, v29, s[4:7], s3 offen
 v_mfma_f32_16x16x32_bf16 v[116:119], a[8:11], a[68:71], v[116:119]
 v_mfma_f32_16x16x32_bf16 v[224:227], a[4:7], a[68:71], v[224:227]
 v_mfma_f32_16x16x32_bf16 v[112:115], a[0:3], a[68:71], v[112:115]
 ds_read_b64_tr_b16 a[68:69], v13 offset:40960
 ds_read_b64_tr_b16 a[70:71], v13 offset:41984
 s_waitcnt lgkmcnt(3)
 v_mfma_f32_16x16x32_bf16 v[128:131], a[0:3], a[72:75], v[128:131]
 s_lshl_b32 s3, s3, 12
 v_accvgpr_read_b32 v29, a119
 v_mfma_f32_16x16x32_bf16 v[240:243], a[4:7], a[72:75], v[240:243]
 buffer_load_dword a206, v29, s[80:83], s3 offen
 v_mfma_f32_16x16x32_bf16 v[132:135], a[8:11], a[72:75], v[132:135]
 v_mfma_f32_16x16x32_bf16 v[244:247], a[12:15], a[72:75], v[244:247]
 v_mfma_f32_16x16x32_bf16 v[136:139], a[16:19], a[72:75], v[136:139]
 v_accvgpr_read_b32 v29, a120
 buffer_load_dword a207, v29, s[16:19], s91 offen
 v_mfma_f32_16x16x32_bf16 v[248:251], a[20:23], a[72:75], v[248:251]
 v_mfma_f32_16x16x32_bf16 v[140:143], a[24:27], a[72:75], v[140:143]
 v_mfma_f32_16x16x32_bf16 v[252:255], a[28:31], a[72:75], v[252:255]
 ds_read_b64_tr_b16 a[72:73], v14 offset:40960
 ds_read_b64_tr_b16 a[74:75], v14 offset:41984
 v_mfma_f32_16x16x32_bf16 a[252:255], a[28:31], a[76:79], a[252:255]
 s_add_u32 s91, s91, s97
 v_mfma_f32_16x16x32_bf16 a[248:251], a[24:27], a[76:79], a[248:251]
 v_mfma_f32_16x16x32_bf16 a[244:247], a[20:23], a[76:79], a[244:247]
 v_mfma_f32_16x16x32_bf16 a[240:243], a[16:19], a[76:79], a[240:243]
 v_mfma_f32_16x16x32_bf16 a[236:239], a[12:15], a[76:79], a[236:239]
 v_mfma_f32_16x16x32_bf16 a[232:235], a[8:11], a[76:79], a[232:235]
 v_mfma_f32_16x16x32_bf16 a[228:231], a[4:7], a[76:79], a[228:231]
 v_mfma_f32_16x16x32_bf16 a[224:227], a[0:3], a[76:79], a[224:227]
 ds_read_b64_tr_b16 a[76:77], v15 offset:40960
 ds_read_b64_tr_b16 a[78:79], v15 offset:41984
 v_mfma_f32_16x16x32_bf16 v[32:35], a[64:67], a[32:35], v[32:35]
 v_mfma_f32_16x16x32_bf16 v[36:39], a[64:67], a[36:39], v[36:39]
 v_mfma_f32_16x16x32_bf16 v[40:43], a[64:67], a[40:43], v[40:43]
 v_mfma_f32_16x16x32_bf16 v[44:47], a[64:67], a[44:47], v[44:47]
 v_mfma_f32_16x16x32_bf16 v[48:51], a[64:67], a[48:51], v[48:51]
 v_mfma_f32_16x16x32_bf16 v[52:55], a[64:67], a[52:55], v[52:55]
 v_mfma_f32_16x16x32_bf16 v[56:59], a[64:67], a[56:59], v[56:59]
 s_waitcnt lgkmcnt(2)
 v_mfma_f32_16x16x32_bf16 v[60:63], a[64:67], a[60:63], v[60:63]
 ds_read_b64_tr_b16 a[64:65], v12 offset:57344
 ds_read_b64_tr_b16 a[66:67], v12 offset:58368
 v_mfma_f32_16x16x32_bf16 v[172:175], a[68:71], a[60:63], v[172:175]
 v_mfma_f32_16x16x32_bf16 v[168:171], a[68:71], a[56:59], v[168:171]
 v_mfma_f32_16x16x32_bf16 v[164:167], a[68:71], a[52:55], v[164:167]
 v_mfma_f32_16x16x32_bf16 v[160:163], a[68:71], a[48:51], v[160:163]
 v_mfma_f32_16x16x32_bf16 v[156:159], a[68:71], a[44:47], v[156:159]
 v_mfma_f32_16x16x32_bf16 v[152:155], a[68:71], a[40:43], v[152:155]
 v_mfma_f32_16x16x32_bf16 v[148:151], a[68:71], a[36:39], v[148:151]
 v_mfma_f32_16x16x32_bf16 v[144:147], a[68:71], a[32:35], v[144:147]
 ds_read_b64_tr_b16 a[68:69], v13 offset:57344
 ds_read_b64_tr_b16 a[70:71], v13 offset:58368
 v_mfma_f32_16x16x32_bf16 v[64:67], a[72:75], a[32:35], v[64:67]
 v_mfma_f32_16x16x32_bf16 v[68:71], a[72:75], a[36:39], v[68:71]
 v_mfma_f32_16x16x32_bf16 v[72:75], a[72:75], a[40:43], v[72:75]
 v_mfma_f32_16x16x32_bf16 v[76:79], a[72:75], a[44:47], v[76:79]
 v_mfma_f32_16x16x32_bf16 v[80:83], a[72:75], a[48:51], v[80:83]
 v_mfma_f32_16x16x32_bf16 v[84:87], a[72:75], a[52:55], v[84:87]
 v_mfma_f32_16x16x32_bf16 v[88:91], a[72:75], a[56:59], v[88:91]
 v_mfma_f32_16x16x32_bf16 v[92:95], a[72:75], a[60:63], v[92:95]
 ds_read_b64_tr_b16 a[72:73], v14 offset:57344
 ds_read_b64_tr_b16 a[74:75], v14 offset:58368
 s_waitcnt lgkmcnt(2)
 v_mfma_f32_16x16x32_bf16 v[204:207], a[76:79], a[60:63], v[204:207]
 v_mfma_f32_16x16x32_bf16 v[200:203], a[76:79], a[56:59], v[200:203]
 v_mfma_f32_16x16x32_bf16 v[196:199], a[76:79], a[52:55], v[196:199]
 v_mfma_f32_16x16x32_bf16 v[192:195], a[76:79], a[48:51], v[192:195]
 v_mfma_f32_16x16x32_bf16 v[188:191], a[76:79], a[44:47], v[188:191]
 v_mfma_f32_16x16x32_bf16 v[184:187], a[76:79], a[40:43], v[184:187]
 v_mfma_f32_16x16x32_bf16 v[180:183], a[76:79], a[36:39], v[180:183]
 v_mfma_f32_16x16x32_bf16 v[176:179], a[76:79], a[32:35], v[176:179]
 ds_read_b64_tr_b16 a[76:77], v15 offset:57344
 ds_read_b64_tr_b16 a[78:79], v15 offset:58368
 v_mfma_f32_16x16x32_bf16 v[96:99], a[32:35], a[64:67], v[96:99]
 v_mfma_f32_16x16x32_bf16 v[208:211], a[36:39], a[64:67], v[208:211]
 v_mfma_f32_16x16x32_bf16 v[100:103], a[40:43], a[64:67], v[100:103]
 v_mfma_f32_16x16x32_bf16 v[212:215], a[44:47], a[64:67], v[212:215]
 v_mfma_f32_16x16x32_bf16 v[104:107], a[48:51], a[64:67], v[104:107]
 v_mfma_f32_16x16x32_bf16 v[216:219], a[52:55], a[64:67], v[216:219]
 v_mfma_f32_16x16x32_bf16 v[108:111], a[56:59], a[64:67], v[108:111]
 v_mfma_f32_16x16x32_bf16 v[220:223], a[60:63], a[64:67], v[220:223]
 s_waitcnt vmcnt(3)
 s_waitcnt lgkmcnt(0)
 s_barrier
 v_mfma_f32_16x16x32_bf16 v[236:239], a[60:63], a[68:71], v[236:239]
 ds_read_b64_tr_b16 a[64:65], v12 offset:0
 ds_read_b64_tr_b16 a[66:67], v12 offset:1024
 s_add_u32 m0, s62, 32768
 v_mfma_f32_16x16x32_bf16 v[124:127], a[56:59], a[68:71], v[124:127]
 buffer_load_dwordx4 v4, s[8:11], s68 offen offset:0 lds
 ds_read_b128 a[0:3], v8 offset:0
 v_mfma_f32_16x16x32_bf16 v[232:235], a[52:55], a[68:71], v[232:235]
 ds_read_b128 a[4:7], v8 offset:2048
 v_mfma_f32_16x16x32_bf16 v[120:123], a[48:51], a[68:71], v[120:123]
 v_mfma_f32_16x16x32_bf16 v[228:231], a[44:47], a[68:71], v[228:231]
 ds_read_b128 a[8:11], v8 offset:4096
 v_mfma_f32_16x16x32_bf16 v[116:119], a[40:43], a[68:71], v[116:119]
 buffer_load_dwordx4 v4, s[8:11], s69 offen offset:1024 lds
 v_mfma_f32_16x16x32_bf16 v[224:227], a[36:39], a[68:71], v[224:227]
 ds_read_b128 a[12:15], v8 offset:6144
 v_mfma_f32_16x16x32_bf16 v[112:115], a[32:35], a[68:71], v[112:115]
 ds_read_b64_tr_b16 a[68:69], v13 offset:0
 ds_read_b64_tr_b16 a[70:71], v13 offset:1024
 v_mfma_f32_16x16x32_bf16 v[128:131], a[32:35], a[72:75], v[128:131]
 ds_read_b128 a[16:19], v8 offset:8192
 v_mfma_f32_16x16x32_bf16 v[240:243], a[36:39], a[72:75], v[240:243]
 buffer_load_dwordx4 v5, s[8:11], s70 offen offset:2048 lds
 s_add_u32 s84, s84, 1
 s_cmp_eq_u32 s84, 8
 s_cselect_b32 s85, -7, 1
 s_cmov_b32 s84, 0
 v_mfma_f32_16x16x32_bf16 v[132:135], a[40:43], a[72:75], v[132:135]
 ds_read_b128 a[20:23], v8 offset:10240
 s_lshl_b32 s86, s85, 19
 v_mfma_f32_16x16x32_bf16 v[244:247], a[44:47], a[72:75], v[244:247]
 v_mfma_f32_16x16x32_bf16 v[136:139], a[48:51], a[72:75], v[136:139]
 ds_read_b128 a[24:27], v8 offset:12288
 v_mfma_f32_16x16x32_bf16 v[248:251], a[52:55], a[72:75], v[248:251]
 buffer_load_dwordx4 v5, s[8:11], s71 offen offset:3072 lds
 v_mfma_f32_16x16x32_bf16 v[140:143], a[56:59], a[72:75], v[140:143]
 ds_read_b128 a[28:31], v8 offset:14336
 v_mfma_f32_16x16x32_bf16 v[252:255], a[60:63], a[72:75], v[252:255]
 ds_read_b64_tr_b16 a[72:73], v14 offset:0
 ds_read_b64_tr_b16 a[74:75], v14 offset:1024
 v_mfma_f32_16x16x32_bf16 a[252:255], a[60:63], a[76:79], a[252:255]
 s_add_u32 m0, s63, 32768
 v_mfma_f32_16x16x32_bf16 a[248:251], a[56:59], a[76:79], a[248:251]
 buffer_load_dwordx4 v2, s[4:7], s64 offen offset:0 lds
 v_mfma_f32_16x16x32_bf16 a[244:247], a[52:55], a[76:79], a[244:247]
 v_mfma_f32_16x16x32_bf16 a[240:243], a[48:51], a[76:79], a[240:243]
 v_mfma_f32_16x16x32_bf16 a[236:239], a[44:47], a[76:79], a[236:239]
 v_mfma_f32_16x16x32_bf16 a[232:235], a[40:43], a[76:79], a[232:235]
 buffer_load_dwordx4 v3, s[4:7], s64 offen offset:1024 lds
 v_mfma_f32_16x16x32_bf16 a[228:231], a[36:39], a[76:79], a[228:231]
 v_mfma_f32_16x16x32_bf16 a[224:227], a[32:35], a[76:79], a[224:227]
 ds_read_b64_tr_b16 a[76:77], v15 offset:0
 ds_read_b64_tr_b16 a[78:79], v15 offset:1024
 s_waitcnt lgkmcnt(2)
 v_mfma_f32_16x16x32_bf16 v[32:35], a[64:67], a[0:3], v[32:35]
 v_mfma_f32_16x16x32_bf16 v[36:39], a[64:67], a[4:7], v[36:39]
 buffer_load_dwordx4 v2, s[4:7], s65 offen offset:2048 lds
 v_mfma_f32_16x16x32_bf16 v[40:43], a[64:67], a[8:11], v[40:43]
 v_mfma_f32_16x16x32_bf16 v[44:47], a[64:67], a[12:15], v[44:47]
 v_mfma_f32_16x16x32_bf16 v[48:51], a[64:67], a[16:19], v[48:51]
 v_mfma_f32_16x16x32_bf16 v[52:55], a[64:67], a[20:23], v[52:55]
 buffer_load_dwordx4 v3, s[4:7], s65 offen offset:3072 lds
 v_mfma_f32_16x16x32_bf16 v[56:59], a[64:67], a[24:27], v[56:59]
 v_mfma_f32_16x16x32_bf16 v[60:63], a[64:67], a[28:31], v[60:63]
 ds_read_b64_tr_b16 a[64:65], v12 offset:16384
 ds_read_b64_tr_b16 a[66:67], v12 offset:17408
 v_mfma_f32_16x16x32_bf16 v[172:175], a[68:71], a[28:31], v[172:175]
 ds_read_b128 a[32:35], v9 offset:0
 s_add_u32 m0, s62, 49152
 v_mfma_f32_16x16x32_bf16 v[168:171], a[68:71], a[24:27], v[168:171]
 buffer_load_dwordx4 v4, s[12:15], s68 offen offset:0 lds
 v_mfma_f32_16x16x32_bf16 v[164:167], a[68:71], a[20:23], v[164:167]
 v_mfma_f32_16x16x32_bf16 v[160:163], a[68:71], a[16:19], v[160:163]
 v_mfma_f32_16x16x32_bf16 v[156:159], a[68:71], a[12:15], v[156:159]
 v_mfma_f32_16x16x32_bf16 v[152:155], a[68:71], a[8:11], v[152:155]
 buffer_load_dwordx4 v4, s[12:15], s69 offen offset:1024 lds
 ds_read_b128 a[36:39], v9 offset:2048
 v_mfma_f32_16x16x32_bf16 v[148:151], a[68:71], a[4:7], v[148:151]
 v_mfma_f32_16x16x32_bf16 v[144:147], a[68:71], a[0:3], v[144:147]
 ds_read_b64_tr_b16 a[68:69], v13 offset:16384
 ds_read_b64_tr_b16 a[70:71], v13 offset:17408
 v_mfma_f32_16x16x32_bf16 v[64:67], a[72:75], a[0:3], v[64:67]
 v_mfma_f32_16x16x32_bf16 v[68:71], a[72:75], a[4:7], v[68:71]
 buffer_load_dwordx4 v5, s[12:15], s70 offen offset:2048 lds
 v_mfma_f32_16x16x32_bf16 v[72:75], a[72:75], a[8:11], v[72:75]
 ds_read_b128 a[40:43], v9 offset:4096
 v_mfma_f32_16x16x32_bf16 v[76:79], a[72:75], a[12:15], v[76:79]
 v_mfma_f32_16x16x32_bf16 v[80:83], a[72:75], a[16:19], v[80:83]
 v_mfma_f32_16x16x32_bf16 v[84:87], a[72:75], a[20:23], v[84:87]
 buffer_load_dwordx4 v5, s[12:15], s71 offen offset:3072 lds
 v_add_u32 v4, s86, v4
 v_mfma_f32_16x16x32_bf16 v[88:91], a[72:75], a[24:27], v[88:91]
 v_add_u32_e64 v5, s86, v5
 v_mfma_f32_16x16x32_bf16 v[92:95], a[72:75], a[28:31], v[92:95]
 ds_read_b64_tr_b16 a[72:73], v14 offset:16384
 ds_read_b64_tr_b16 a[74:75], v14 offset:17408
 s_waitcnt lgkmcnt(3)
 v_mfma_f32_16x16x32_bf16 v[204:207], a[76:79], a[28:31], v[204:207]
 ds_read_b128 a[44:47], v9 offset:6144
 s_add_u32 m0, s63, 36864
 v_mfma_f32_16x16x32_bf16 v[200:203], a[76:79], a[24:27], v[200:203]
 buffer_load_dwordx4 v2, s[4:7], s66 offen offset:0 lds
 v_mfma_f32_16x16x32_bf16 v[196:199], a[76:79], a[20:23], v[196:199]
 v_mfma_f32_16x16x32_bf16 v[192:195], a[76:79], a[16:19], v[192:195]
 v_mfma_f32_16x16x32_bf16 v[188:191], a[76:79], a[12:15], v[188:191]
 ds_read_b128 a[48:51], v9 offset:8192
 v_mfma_f32_16x16x32_bf16 v[184:187], a[76:79], a[8:11], v[184:187]
 buffer_load_dwordx4 v3, s[4:7], s66 offen offset:1024 lds
 v_mfma_f32_16x16x32_bf16 v[180:183], a[76:79], a[4:7], v[180:183]
 v_mfma_f32_16x16x32_bf16 v[176:179], a[76:79], a[0:3], v[176:179]
 ds_read_b64_tr_b16 a[76:77], v15 offset:16384
 ds_read_b64_tr_b16 a[78:79], v15 offset:17408
 v_mfma_f32_16x16x32_bf16 v[96:99], a[0:3], a[64:67], v[96:99]
 v_mfma_f32_16x16x32_bf16 v[208:211], a[4:7], a[64:67], v[208:211]
 buffer_load_dwordx4 v2, s[4:7], s67 offen offset:2048 lds
 ds_read_b128 a[52:55], v9 offset:10240
 v_mfma_f32_16x16x32_bf16 v[100:103], a[8:11], a[64:67], v[100:103]
 v_mfma_f32_16x16x32_bf16 v[212:215], a[12:15], a[64:67], v[212:215]
 v_mfma_f32_16x16x32_bf16 v[104:107], a[16:19], a[64:67], v[104:107]
 v_mfma_f32_16x16x32_bf16 v[216:219], a[20:23], a[64:67], v[216:219]
 buffer_load_dwordx4 v3, s[4:7], s67 offen offset:3072 lds
 v_lshl_add_u32 v2, s85, 7, v2
 v_mfma_f32_16x16x32_bf16 v[108:111], a[24:27], a[64:67], v[108:111]
 ds_read_b128 a[56:59], v9 offset:12288
 v_lshl_add_u32 v3, s85, 7, v3
 v_mfma_f32_16x16x32_bf16 v[220:223], a[28:31], a[64:67], v[220:223]
 ds_read_b64_tr_b16 a[64:65], v12 offset:8192
 ds_read_b64_tr_b16 a[66:67], v12 offset:9216
 v_mfma_f32_16x16x32_bf16 v[236:239], a[28:31], a[68:71], v[236:239]
 v_mfma_f32_16x16x32_bf16 v[124:127], a[24:27], a[68:71], v[124:127]
 v_mfma_f32_16x16x32_bf16 v[232:235], a[20:23], a[68:71], v[232:235]
 s_add_u32 s3, s84, 1
 s_and_b32 s3, s3, 7
 v_mfma_f32_16x16x32_bf16 v[120:123], a[16:19], a[68:71], v[120:123]
 ds_read_b128 a[60:63], v9 offset:14336
 s_lshl_b32 s3, s3, 7
 v_mfma_f32_16x16x32_bf16 v[228:231], a[12:15], a[68:71], v[228:231]
 v_accvgpr_read_b32 v29, a118
 buffer_load_dword a216, v29, s[4:7], s3 offen
 v_mfma_f32_16x16x32_bf16 v[116:119], a[8:11], a[68:71], v[116:119]
 v_mfma_f32_16x16x32_bf16 v[224:227], a[4:7], a[68:71], v[224:227]
 v_mfma_f32_16x16x32_bf16 v[112:115], a[0:3], a[68:71], v[112:115]
 ds_read_b64_tr_b16 a[68:69], v13 offset:8192
 ds_read_b64_tr_b16 a[70:71], v13 offset:9216
 s_waitcnt lgkmcnt(3)
 v_mfma_f32_16x16x32_bf16 v[128:131], a[0:3], a[72:75], v[128:131]
 s_lshl_b32 s3, s3, 12
 v_accvgpr_read_b32 v29, a119
 v_mfma_f32_16x16x32_bf16 v[240:243], a[4:7], a[72:75], v[240:243]
 buffer_load_dword a127, v29, s[80:83], s3 offen
 v_mfma_f32_16x16x32_bf16 v[132:135], a[8:11], a[72:75], v[132:135]
 v_mfma_f32_16x16x32_bf16 v[244:247], a[12:15], a[72:75], v[244:247]
 v_mfma_f32_16x16x32_bf16 v[136:139], a[16:19], a[72:75], v[136:139]
 v_accvgpr_read_b32 v29, a120
 buffer_load_dword a128, v29, s[16:19], s91 offen
 v_mfma_f32_16x16x32_bf16 v[248:251], a[20:23], a[72:75], v[248:251]
 v_mfma_f32_16x16x32_bf16 v[140:143], a[24:27], a[72:75], v[140:143]
 v_mfma_f32_16x16x32_bf16 v[252:255], a[28:31], a[72:75], v[252:255]
 ds_read_b64_tr_b16 a[72:73], v14 offset:8192
 ds_read_b64_tr_b16 a[74:75], v14 offset:9216
 v_mfma_f32_16x16x32_bf16 a[252:255], a[28:31], a[76:79], a[252:255]
 s_add_u32 s91, s91, s97
 v_mfma_f32_16x16x32_bf16 a[248:251], a[24:27], a[76:79], a[248:251]
 v_xor_b32 v16, 128, v12
 v_xor_b32 v17, 160, v12
 v_mfma_f32_16x16x32_bf16 a[244:247], a[20:23], a[76:79], a[244:247]
 v_xor_b32 v18, 192, v12
 v_xor_b32 v19, 224, v12
 v_mfma_f32_16x16x32_bf16 a[240:243], a[16:19], a[76:79], a[240:243]
 v_and_b32 v29, 0x7ff, v8
 v_add_u32 v10, s63, v29
 v_mfma_f32_16x16x32_bf16 a[236:239], a[12:15], a[76:79], a[236:239]
 v_xor_b32 v11, 64, v10
 v_lshrrev_b32 v29, 5, v1
 v_mfma_f32_16x16x32_bf16 a[232:235], a[8:11], a[76:79], a[232:235]
 v_lshlrev_b32_e64 v29, 12, v29
 v_bfe_u32 v30, v1, 4, 1
 v_mfma_f32_16x16x32_bf16 a[228:231], a[4:7], a[76:79], a[228:231]
 v_lshl_add_u32 v29, v30, 10, v29
 v_bfe_u32 v30, v1, 2, 2
 v_mfma_f32_16x16x32_bf16 a[224:227], a[0:3], a[76:79], a[224:227]
 ds_read_b64_tr_b16 a[76:77], v15 offset:8192
 ds_read_b64_tr_b16 a[78:79], v15 offset:9216
 v_mfma_f32_16x16x32_bf16 v[32:35], a[64:67], a[32:35], v[32:35]
 v_lshl_add_u32 v29, v30, 7, v29
 v_bfe_u32 v30, v1, 3, 2
 v_mfma_f32_16x16x32_bf16 v[36:39], a[64:67], a[36:39], v[36:39]
 v_lshl_add_u32 v29, v30, 5, v29
 v_and_b32_e64 v30, 3, v1
 v_mfma_f32_16x16x32_bf16 v[40:43], a[64:67], a[40:43], v[40:43]
 v_lshl_add_u32 v20, v30, 3, v29
 v_xor_b32_e64 v21, 32, v20
 v_mfma_f32_16x16x32_bf16 v[44:47], a[64:67], a[44:47], v[44:47]
 v_xor_b32_e64 v22, 64, v20
 v_xor_b32 v23, 96, v20
 v_mfma_f32_16x16x32_bf16 v[48:51], a[64:67], a[48:51], v[48:51]
 v_lshrrev_b32_e64 v29, 3, v1
 v_lshl_add_u32 v29, s88, 6, v29
 v_mfma_f32_16x16x32_bf16 v[52:55], a[64:67], a[52:55], v[52:55]
 s_movk_i32 s3, 3456
 v_mul_lo_u32 v29, v29, s3
 v_mfma_f32_16x16x32_bf16 v[56:59], a[64:67], a[56:59], v[56:59]
 v_bfe_u32 v30, v1, 4, 1
 v_lshlrev_b32 v30, 1, v30
 s_waitcnt lgkmcnt(2)
 v_mfma_f32_16x16x32_bf16 v[60:63], a[64:67], a[60:63], v[60:63]
 ds_read_b64_tr_b16 a[64:65], v12 offset:24576
 ds_read_b64_tr_b16 a[66:67], v12 offset:25600
 v_mfma_f32_16x16x32_bf16 v[172:175], a[68:71], a[60:63], v[172:175]
 v_and_b32 v7, 7, v1
 v_xor_b32_e64 v30, v30, v7
 v_mfma_f32_16x16x32_bf16 v[168:171], a[68:71], a[56:59], v[168:171]
 v_lshl_add_u32 v6, v30, 4, v29
 v_xor_b32_e64 v30, 4, v30
 v_mfma_f32_16x16x32_bf16 v[164:167], a[68:71], a[52:55], v[164:167]
 v_lshl_add_u32 v7, v30, 4, v29
 s_mul_i32 s72, s58, 55296
 v_mfma_f32_16x16x32_bf16 v[160:163], a[68:71], a[48:51], v[160:163]
 s_lshl_b32 s3, s74, 7
 s_add_u32 s72, s72, s3
 v_mfma_f32_16x16x32_bf16 v[156:159], a[68:71], a[44:47], v[156:159]
 s_add_u32 s73, s72, 26624
 s_lshl_b32 s75, s60, 4
 v_mfma_f32_16x16x32_bf16 v[152:155], a[68:71], a[40:43], v[152:155]
 s_lshl_b32 s3, s58, 2
 s_sub_u32 s76, 240, s75
 v_mfma_f32_16x16x32_bf16 v[148:151], a[68:71], a[36:39], v[148:151]
 s_add_u32 s75, s75, s3
 s_add_u32 s76, s76, s3
 v_mfma_f32_16x16x32_bf16 v[144:147], a[68:71], a[32:35], v[144:147]
 ds_read_b64_tr_b16 a[68:69], v13 offset:24576
 ds_read_b64_tr_b16 a[70:71], v13 offset:25600
 v_mfma_f32_16x16x32_bf16 v[64:67], a[72:75], a[32:35], v[64:67]
 v_mov_b32 v29, s75
 v_mov_b32 v30, s76
 v_mfma_f32_16x16x32_bf16 v[68:71], a[72:75], a[36:39], v[68:71]
 v_cmp_lt_u32 vcc, 31, v1
 v_and_b32 v27, 3, v1
 s_nop 0
 v_cndmask_b32 v29, v29, v30, vcc
 v_mfma_f32_16x16x32_bf16 v[72:75], a[72:75], a[40:43], v[72:75]
 v_add_lshl_u32 v27, v27, v29, 7
 v_mfma_f32_16x16x32_bf16 v[76:79], a[72:75], a[44:47], v[76:79]
 v_mfma_f32_16x16x32_bf16 v[80:83], a[72:75], a[48:51], v[80:83]
 v_mfma_f32_16x16x32_bf16 v[84:87], a[72:75], a[52:55], v[84:87]
 v_mfma_f32_16x16x32_bf16 v[88:91], a[72:75], a[56:59], v[88:91]
 v_mfma_f32_16x16x32_bf16 v[92:95], a[72:75], a[60:63], v[92:95]
 ds_read_b64_tr_b16 a[72:73], v14 offset:24576
 ds_read_b64_tr_b16 a[74:75], v14 offset:25600
 s_waitcnt lgkmcnt(2)
 v_mfma_f32_16x16x32_bf16 v[204:207], a[76:79], a[60:63], v[204:207]
 v_mfma_f32_16x16x32_bf16 v[200:203], a[76:79], a[56:59], v[200:203]
 v_mfma_f32_16x16x32_bf16 v[196:199], a[76:79], a[52:55], v[196:199]
 v_mfma_f32_16x16x32_bf16 v[192:195], a[76:79], a[48:51], v[192:195]
 v_mfma_f32_16x16x32_bf16 v[188:191], a[76:79], a[44:47], v[188:191]
 v_mfma_f32_16x16x32_bf16 v[184:187], a[76:79], a[40:43], v[184:187]
 v_mfma_f32_16x16x32_bf16 v[180:183], a[76:79], a[36:39], v[180:183]
 v_mfma_f32_16x16x32_bf16 v[176:179], a[76:79], a[32:35], v[176:179]
 ds_read_b64_tr_b16 a[76:77], v15 offset:24576
 ds_read_b64_tr_b16 a[78:79], v15 offset:25600
 v_mfma_f32_16x16x32_bf16 v[96:99], a[32:35], a[64:67], v[96:99]
 v_mfma_f32_16x16x32_bf16 v[208:211], a[36:39], a[64:67], v[208:211]
 v_mfma_f32_16x16x32_bf16 v[100:103], a[40:43], a[64:67], v[100:103]
 v_mfma_f32_16x16x32_bf16 v[212:215], a[44:47], a[64:67], v[212:215]
 v_mfma_f32_16x16x32_bf16 v[104:107], a[48:51], a[64:67], v[104:107]
 v_mfma_f32_16x16x32_bf16 v[216:219], a[52:55], a[64:67], v[216:219]
 v_mfma_f32_16x16x32_bf16 v[108:111], a[56:59], a[64:67], v[108:111]
 v_mfma_f32_16x16x32_bf16 v[220:223], a[60:63], a[64:67], v[220:223]
 s_waitcnt vmcnt(3)
 s_waitcnt lgkmcnt(0)
 s_barrier
 v_mfma_f32_16x16x32_bf16 v[236:239], a[60:63], a[68:71], v[236:239]
 ds_read_b64_tr_b16 a[64:65], v12 offset:32768
 ds_read_b64_tr_b16 a[66:67], v12 offset:33792
 s_add_u32 m0, s62, 0
 v_mfma_f32_16x16x32_bf16 v[124:127], a[56:59], a[68:71], v[124:127]
 buffer_load_dwordx4 v4, s[8:11], s68 offen offset:0 lds
 ds_read_b128 a[0:3], v8 offset:32768
 v_mfma_f32_16x16x32_bf16 v[232:235], a[52:55], a[68:71], v[232:235]
 ds_read_b128 a[4:7], v8 offset:34816
 v_mfma_f32_16x16x32_bf16 v[120:123], a[48:51], a[68:71], v[120:123]
 v_add_u32 v29, 1, v0
 buffer_store_dword v29, v26, s[24:27], 0 offen sc1
 v_mfma_f32_16x16x32_bf16 v[228:231], a[44:47], a[68:71], v[228:231]
 ds_read_b128 a[8:11], v8 offset:36864
 v_mfma_f32_16x16x32_bf16 v[116:119], a[40:43], a[68:71], v[116:119]
 buffer_load_dwordx4 v4, s[8:11], s69 offen offset:1024 lds
L_pg3:
 s_cbranch_execz L_hopr0
 v_mfma_f32_16x16x32_bf16 v[224:227], a[36:39], a[68:71], v[224:227]
 ds_read_b128 a[12:15], v8 offset:38912
 v_mfma_f32_16x16x32_bf16 v[112:115], a[32:35], a[68:71], v[112:115]
 ds_read_b64_tr_b16 a[68:69], v13 offset:32768
 ds_read_b64_tr_b16 a[70:71], v13 offset:33792
 v_mfma_f32_16x16x32_bf16 v[128:131], a[32:35], a[72:75], v[128:131]
 ds_read_b128 a[16:19], v8 offset:40960
 v_mfma_f32_16x16x32_bf16 v[240:243], a[36:39], a[72:75], v[240:243]
 buffer_load_dwordx4 v5, s[8:11], s70 offen offset:2048 lds
 s_add_u32 s84, s84, 1
 s_cmp_eq_u32 s84, 8
 s_cselect_b32 s85, -7, 1
 s_cmov_b32 s84, 0
 v_mfma_f32_16x16x32_bf16 v[132:135], a[40:43], a[72:75], v[132:135]
 ds_read_b128 a[20:23], v8 offset:43008
 s_lshl_b32 s86, s85, 19
 v_mfma_f32_16x16x32_bf16 v[244:247], a[44:47], a[72:75], v[244:247]
 v_mfma_f32_16x16x32_bf16 v[136:139], a[48:51], a[72:75], v[136:139]
 ds_read_b128 a[24:27], v8 offset:45056
 v_mfma_f32_16x16x32_bf16 v[248:251], a[52:55], a[72:75], v[248:251]
 buffer_load_dwordx4 v5, s[8:11], s71 offen offset:3072 lds
 v_mfma_f32_16x16x32_bf16 v[140:143], a[56:59], a[72:75], v[140:143]
 ds_read_b128 a[28:31], v8 offset:47104
 v_mfma_f32_16x16x32_bf16 v[252:255], a[60:63], a[72:75], v[252:255]
 ds_read_b64_tr_b16 a[72:73], v14 offset:32768
 ds_read_b64_tr_b16 a[74:75], v14 offset:33792
 v_mfma_f32_16x16x32_bf16 a[252:255], a[60:63], a[76:79], a[252:255]
 s_add_u32 m0, s63, 0
 v_mfma_f32_16x16x32_bf16 a[248:251], a[56:59], a[76:79], a[248:251]
 buffer_load_dwordx4 v2, s[4:7], s64 offen offset:0 lds
 v_mfma_f32_16x16x32_bf16 a[244:247], a[52:55], a[76:79], a[244:247]
 v_mfma_f32_16x16x32_bf16 a[240:243], a[48:51], a[76:79], a[240:243]
 v_mfma_f32_16x16x32_bf16 a[236:239], a[44:47], a[76:79], a[236:239]
 v_mfma_f32_16x16x32_bf16 a[232:235], a[40:43], a[76:79], a[232:235]
 buffer_load_dwordx4 v3, s[4:7], s64 offen offset:1024 lds
 v_mfma_f32_16x16x32_bf16 a[228:231], a[36:39], a[76:79], a[228:231]
 v_mfma_f32_16x16x32_bf16 a[224:227], a[32:35], a[76:79], a[224:227]
 ds_read_b64_tr_b16 a[76:77], v15 offset:32768
 ds_read_b64_tr_b16 a[78:79], v15 offset:33792
 s_waitcnt lgkmcnt(2)
 v_mfma_f32_16x16x32_bf16 v[32:35], a[64:67], a[0:3], v[32:35]
 v_mfma_f32_16x16x32_bf16 v[36:39], a[64:67], a[4:7], v[36:39]
 buffer_load_dwordx4 v2, s[4:7], s65 offen offset:2048 lds
 v_mfma_f32_16x16x32_bf16 v[40:43], a[64:67], a[8:11], v[40:43]
 v_mfma_f32_16x16x32_bf16 v[44:47], a[64:67], a[12:15], v[44:47]
 v_mfma_f32_16x16x32_bf16 v[48:51], a[64:67], a[16:19], v[48:51]
 v_mfma_f32_16x16x32_bf16 v[52:55], a[64:67], a[20:23], v[52:55]
 buffer_load_dwordx4 v3, s[4:7], s65 offen offset:3072 lds
 v_mfma_f32_16x16x32_bf16 v[56:59], a[64:67], a[24:27], v[56:59]
 v_mfma_f32_16x16x32_bf16 v[60:63], a[64:67], a[28:31], v[60:63]
 ds_read_b64_tr_b16 a[64:65], v12 offset:49152
 ds_read_b64_tr_b16 a[66:67], v12 offset:50176
 v_mfma_f32_16x16x32_bf16 v[172:175], a[68:71], a[28:31], v[172:175]
 ds_read_b128 a[32:35], v9 offset:32768
 s_add_u32 m0, s62, 16384
 v_mfma_f32_16x16x32_bf16 v[168:171], a[68:71], a[24:27], v[168:171]
 buffer_load_dwordx4 v4, s[12:15], s68 offen offset:0 lds
 v_mfma_f32_16x16x32_bf16 v[164:167], a[68:71], a[20:23], v[164:167]
 v_mfma_f32_16x16x32_bf16 v[160:163], a[68:71], a[16:19], v[160:163]
 v_mfma_f32_16x16x32_bf16 v[156:159], a[68:71], a[12:15], v[156:159]
 v_mfma_f32_16x16x32_bf16 v[152:155], a[68:71], a[8:11], v[152:155]
 buffer_load_dwordx4 v4, s[12:15], s69 offen offset:1024 lds
 ds_read_b128 a[36:39], v9 offset:34816
 v_mfma_f32_16x16x32_bf16 v[148:151], a[68:71], a[4:7], v[148:151]
 v_mfma_f32_16x16x32_bf16 v[144:147], a[68:71], a[0:3], v[144:147]
 ds_read_b64_tr_b16 a[68:69], v13 offset:49152
 ds_read_b64_tr_b16 a[70:71], v13 offset:50176
 v_mfma_f32_16x16x32_bf16 v[64:67], a[72:75], a[0:3], v[64:67]
 v_mfma_f32_16x16x32_bf16 v[68:71], a[72:75], a[4:7], v[68:71]
 buffer_load_dwordx4 v5, s[12:15], s70 offen offset:2048 lds
 v_mfma_f32_16x16x32_bf16 v[72:75], a[72:75], a[8:11], v[72:75]
 ds_read_b128 a[40:43], v9 offset:36864
 v_mfma_f32_16x16x32_bf16 v[76:79], a[72:75], a[12:15], v[76:79]
 v_mfma_f32_16x16x32_bf16 v[80:83], a[72:75], a[16:19], v[80:83]
 v_mfma_f32_16x16x32_bf16 v[84:87], a[72:75], a[20:23], v[84:87]
 buffer_load_dwordx4 v5, s[12:15], s71 offen offset:3072 lds
 v_add_u32_e64 v4, s86, v4
 v_mfma_f32_16x16x32_bf16 v[88:91], a[72:75], a[24:27], v[88:91]
 v_add_u32_e64 v5, s86, v5
 v_mfma_f32_16x16x32_bf16 v[92:95], a[72:75], a[28:31], v[92:95]
 ds_read_b64_tr_b16 a[72:73], v14 offset:49152
 ds_read_b64_tr_b16 a[74:75], v14 offset:50176
 s_waitcnt lgkmcnt(3)
 v_mfma_f32_16x16x32_bf16 v[204:207], a[76:79], a[28:31], v[204:207]
 ds_read_b128 a[44:47], v9 offset:38912
 s_add_u32 m0, s63, 4096
 v_mfma_f32_16x16x32_bf16 v[200:203], a[76:79], a[24:27], v[200:203]
 buffer_load_dwordx4 v2, s[4:7], s66 offen offset:0 lds
 v_mfma_f32_16x16x32_bf16 v[196:199], a[76:79], a[20:23], v[196:199]
 v_mfma_f32_16x16x32_bf16 v[192:195], a[76:79], a[16:19], v[192:195]
 v_mfma_f32_16x16x32_bf16 v[188:191], a[76:79], a[12:15], v[188:191]
 ds_read_b128 a[48:51], v9 offset:40960
 v_mfma_f32_16x16x32_bf16 v[184:187], a[76:79], a[8:11], v[184:187]
 buffer_load_dwordx4 v3, s[4:7], s66 offen offset:1024 lds
 v_mfma_f32_16x16x32_bf16 v[180:183], a[76:79], a[4:7], v[180:183]
 v_mfma_f32_16x16x32_bf16 v[176:179], a[76:79], a[0:3], v[176:179]
 ds_read_b64_tr_b16 a[76:77], v15 offset:49152
 ds_read_b64_tr_b16 a[78:79], v15 offset:50176
 v_mfma_f32_16x16x32_bf16 v[96:99], a[0:3], a[64:67], v[96:99]
 v_mfma_f32_16x16x32_bf16 v[208:211], a[4:7], a[64:67], v[208:211]
 buffer_load_dwordx4 v2, s[4:7], s67 offen offset:2048 lds
 ds_read_b128 a[52:55], v9 offset:43008
 v_mfma_f32_16x16x32_bf16 v[100:103], a[8:11], a[64:67], v[100:103]
 v_mfma_f32_16x16x32_bf16 v[212:215], a[12:15], a[64:67], v[212:215]
 v_mfma_f32_16x16x32_bf16 v[104:107], a[16:19], a[64:67], v[104:107]
 v_mfma_f32_16x16x32_bf16 v[216:219], a[20:23], a[64:67], v[216:219]
 buffer_load_dwordx4 v3, s[4:7], s67 offen offset:3072 lds
 v_lshl_add_u32 v2, s85, 7, v2
 v_mfma_f32_16x16x32_bf16 v[108:111], a[24:27], a[64:67], v[108:111]
 ds_read_b128 a[56:59], v9 offset:45056
 v_lshl_add_u32 v3, s85, 7, v3
 v_mfma_f32_16x16x32_bf16 v[220:223], a[28:31], a[64:67], v[220:223]
 ds_read_b64_tr_b16 a[64:65], v12 offset:40960
 ds_read_b64_tr_b16 a[66:67], v12 offset:41984
 v_mfma_f32_16x16x32_bf16 v[236:239], a[28:31], a[68:71], v[236:239]
 v_mfma_f32_16x16x32_bf16 v[124:127], a[24:27], a[68:71], v[124:127]
 v_mfma_f32_16x16x32_bf16 v[232:235], a[20:23], a[68:71], v[232:235]
 v_accvgpr_read_b32 v29, a120
 buffer_load_dword a129, v29, s[16:19], s91 offen
 v_mfma_f32_16x16x32_bf16 v[120:123], a[16:19], a[68:71], v[120:123]
 ds_read_b128 a[60:63], v9 offset:47104
 v_mfma_f32_16x16x32_bf16 v[228:231], a[12:15], a[68:71], v[228:231]
 v_mfma_f32_16x16x32_bf16 v[116:119], a[8:11], a[68:71], v[116:119]
 s_add_u32 s91, s91, s97
 v_mfma_f32_16x16x32_bf16 v[224:227], a[4:7], a[68:71], v[224:227]
 s_lshl_b32 s77, s2, 2
 s_add_u32 s77, s77, s58
 v_mfma_f32_16x16x32_bf16 v[112:115], a[0:3], a[68:71], v[112:115]
 ds_read_b64_tr_b16 a[68:69], v13 offset:40960
 ds_read_b64_tr_b16 a[70:71], v13 offset:41984
 s_waitcnt lgkmcnt(3)
 v_mfma_f32_16x16x32_bf16 v[128:131], a[0:3], a[72:75], v[128:131]
 s_mov_b32 s82, 0x21c000
 v_mfma_f32_16x16x32_bf16 v[240:243], a[4:7], a[72:75], v[240:243]
 s_cmp_lt_u32 s77, 640
 s_cselect_b32 s80, s42, s50
 s_cselect_b32 s81, s43, s51
 s_cmov_b32 s82, 0x500000
 s_cselect_b32 s75, 0, 640
 v_mfma_f32_16x16x32_bf16 v[132:135], a[8:11], a[72:75], v[132:135]
 s_mov_b32 s83, 0x00020000
 s_sub_u32 s75, s77, s75
 v_mfma_f32_16x16x32_bf16 v[244:247], a[12:15], a[72:75], v[244:247]
 s_mul_i32 s76, s75, 52429
 s_lshr_b32 s76, s76, 18
 v_mfma_f32_16x16x32_bf16 v[136:139], a[16:19], a[72:75], v[136:139]
 s_mul_i32 s3, s76, 5
 s_sub_u32 s75, s75, s3
 v_mfma_f32_16x16x32_bf16 v[248:251], a[20:23], a[72:75], v[248:251]
 s_mul_i32 s76, s76, 40960
 s_lshl_b32 s75, s75, 8
 v_mfma_f32_16x16x32_bf16 v[140:143], a[24:27], a[72:75], v[140:143]
 s_add_u32 s75, s75, s76
 v_lshrrev_b32 v24, 4, v1
 v_mfma_f32_16x16x32_bf16 v[252:255], a[28:31], a[72:75], v[252:255]
 ds_read_b64_tr_b16 a[72:73], v14 offset:40960
 ds_read_b64_tr_b16 a[74:75], v14 offset:41984
 v_mfma_f32_16x16x32_bf16 a[252:255], a[28:31], a[76:79], a[252:255]
 v_mul_u32_u24 v24, 1280, v24
 v_lshrrev_b32_e64 v29, 3, v1
 v_mfma_f32_16x16x32_bf16 a[248:251], a[24:27], a[76:79], a[248:251]
 v_xor_b32 v29, v29, v1
 v_and_b32 v30, 1, v1
 v_mfma_f32_16x16x32_bf16 a[244:247], a[20:23], a[76:79], a[244:247]
 v_and_or_b32 v29, v29, 14, v30
 v_lshl_add_u32 v24, v29, 4, v24
 v_mfma_f32_16x16x32_bf16 a[240:243], a[16:19], a[76:79], a[240:243]
 v_add_u32_e64 v24, s75, v24
 v_mfma_f32_16x16x32_bf16 a[236:239], a[12:15], a[76:79], a[236:239]
 s_add_u32 m0, s63, 65536
 s_mov_b32 s78, 0
 v_mfma_f32_16x16x32_bf16 a[232:235], a[8:11], a[76:79], a[232:235]
 buffer_load_dwordx4 v24, s[80:83], s78 offen offset:0 lds
 v_mfma_f32_16x16x32_bf16 a[228:231], a[4:7], a[76:79], a[228:231]
 v_mfma_f32_16x16x32_bf16 a[224:227], a[0:3], a[76:79], a[224:227]
 ds_read_b64_tr_b16 a[76:77], v15 offset:40960
 ds_read_b64_tr_b16 a[78:79], v15 offset:41984
 v_mfma_f32_16x16x32_bf16 v[32:35], a[64:67], a[32:35], v[32:35]
 v_mfma_f32_16x16x32_bf16 v[36:39], a[64:67], a[36:39], v[36:39]
 v_mfma_f32_16x16x32_bf16 v[40:43], a[64:67], a[40:43], v[40:43]
 s_add_u32 m0, s63, 65536
 s_mov_b32 s78, 4096
 v_mfma_f32_16x16x32_bf16 v[44:47], a[64:67], a[44:47], v[44:47]
 v_xor_b32 v24, 0x80, v24
 v_mfma_f32_16x16x32_bf16 v[48:51], a[64:67], a[48:51], v[48:51]
 buffer_load_dwordx4 v24, s[80:83], s78 offen offset:1024 lds
 v_mfma_f32_16x16x32_bf16 v[52:55], a[64:67], a[52:55], v[52:55]
 v_mfma_f32_16x16x32_bf16 v[56:59], a[64:67], a[56:59], v[56:59]
 s_waitcnt lgkmcnt(2)
 v_mfma_f32_16x16x32_bf16 v[60:63], a[64:67], a[60:63], v[60:63]
 ds_read_b64_tr_b16 a[64:65], v12 offset:57344
 ds_read_b64_tr_b16 a[66:67], v12 offset:58368
 v_mfma_f32_16x16x32_bf16 v[172:175], a[68:71], a[60:63], v[172:175]
 v_mfma_f32_16x16x32_bf16 v[168:171], a[68:71], a[56:59], v[168:171]
 s_add_u32 m0, s63, 65536
 s_mov_b32 s78, 8192
 v_mfma_f32_16x16x32_bf16 v[164:167], a[68:71], a[52:55], v[164:167]
 v_xor_b32 v24, 0x80, v24
 v_mfma_f32_16x16x32_bf16 v[160:163], a[68:71], a[48:51], v[160:163]
 buffer_load_dwordx4 v24, s[80:83], s78 offen offset:2048 lds
 v_mfma_f32_16x16x32_bf16 v[156:159], a[68:71], a[44:47], v[156:159]
 v_mfma_f32_16x16x32_bf16 v[152:155], a[68:71], a[40:43], v[152:155]
 v_mfma_f32_16x16x32_bf16 v[148:151], a[68:71], a[36:39], v[148:151]
 v_mfma_f32_16x16x32_bf16 v[144:147], a[68:71], a[32:35], v[144:147]
 ds_read_b64_tr_b16 a[68:69], v13 offset:57344
 ds_read_b64_tr_b16 a[70:71], v13 offset:58368
 v_mfma_f32_16x16x32_bf16 v[64:67], a[72:75], a[32:35], v[64:67]
 v_mfma_f32_16x16x32_bf16 v[68:71], a[72:75], a[36:39], v[68:71]
 v_mfma_f32_16x16x32_bf16 v[72:75], a[72:75], a[40:43], v[72:75]
 v_mfma_f32_16x16x32_bf16 v[76:79], a[72:75], a[44:47], v[76:79]
 v_mfma_f32_16x16x32_bf16 v[80:83], a[72:75], a[48:51], v[80:83]
 v_mfma_f32_16x16x32_bf16 v[84:87], a[72:75], a[52:55], v[84:87]
 v_mfma_f32_16x16x32_bf16 v[88:91], a[72:75], a[56:59], v[88:91]
 v_mfma_f32_16x16x32_bf16 v[92:95], a[72:75], a[60:63], v[92:95]
 ds_read_b64_tr_b16 a[72:73], v14 offset:57344
 ds_read_b64_tr_b16 a[74:75], v14 offset:58368
 s_waitcnt lgkmcnt(2)
 v_mfma_f32_16x16x32_bf16 v[204:207], a[76:79], a[60:63], v[204:207]
 v_mfma_f32_16x16x32_bf16 v[200:203], a[76:79], a[56:59], v[200:203]
 v_mfma_f32_16x16x32_bf16 v[196:199], a[76:79], a[52:55], v[196:199]
 v_mfma_f32_16x16x32_bf16 v[192:195], a[76:79], a[48:51], v[192:195]
 v_mfma_f32_16x16x32_bf16 v[188:191], a[76:79], a[44:47], v[188:191]
 v_mfma_f32_16x16x32_bf16 v[184:187], a[76:79], a[40:43], v[184:187]
 v_mfma_f32_16x16x32_bf16 v[180:183], a[76:79], a[36:39], v[180:183]
 v_mfma_f32_16x16x32_bf16 v[176:179], a[76:79], a[32:35], v[176:179]
 ds_read_b64_tr_b16 a[76:77], v15 offset:57344
 ds_read_b64_tr_b16 a[78:79], v15 offset:58368
 v_mfma_f32_16x16x32_bf16 v[96:99], a[32:35], a[64:67], v[96:99]
 v_mfma_f32_16x16x32_bf16 v[208:211], a[36:39], a[64:67], v[208:211]
 v_mfma_f32_16x16x32_bf16 v[100:103], a[40:43], a[64:67], v[100:103]
 v_mfma_f32_16x16x32_bf16 v[212:215], a[44:47], a[64:67], v[212:215]
 v_mfma_f32_16x16x32_bf16 v[104:107], a[48:51], a[64:67], v[104:107]
 v_mfma_f32_16x16x32_bf16 v[216:219], a[52:55], a[64:67], v[216:219]
 v_mfma_f32_16x16x32_bf16 v[108:111], a[56:59], a[64:67], v[108:111]
 v_mfma_f32_16x16x32_bf16 v[220:223], a[60:63], a[64:67], v[220:223]
 s_waitcnt vmcnt(4)
 s_waitcnt lgkmcnt(0)
 s_barrier
 v_mfma_f32_16x16x32_bf16 v[236:239], a[60:63], a[68:71], v[236:239]
 ds_read_b64_tr_b16 a[64:65], v12 offset:0
 ds_read_b64_tr_b16 a[66:67], v12 offset:1024
 s_add_u32 m0, s62, 32768
 v_mfma_f32_16x16x32_bf16 v[124:127], a[56:59], a[68:71], v[124:127]
 buffer_load_dwordx4 v4, s[8:11], s68 offen offset:0 lds
 ds_read_b128 a[0:3], v8 offset:0
 v_mfma_f32_16x16x32_bf16 v[232:235], a[52:55], a[68:71], v[232:235]
 ds_read_b128 a[4:7], v8 offset:2048
 v_mfma_f32_16x16x32_bf16 v[120:123], a[48:51], a[68:71], v[120:123]
 v_mfma_f32_16x16x32_bf16 v[228:231], a[44:47], a[68:71], v[228:231]
 ds_read_b128 a[8:11], v8 offset:4096
 v_mfma_f32_16x16x32_bf16 v[116:119], a[40:43], a[68:71], v[116:119]
 buffer_load_dwordx4 v4, s[8:11], s69 offen offset:1024 lds
 v_mfma_f32_16x16x32_bf16 v[224:227], a[36:39], a[68:71], v[224:227]
 ds_read_b128 a[12:15], v8 offset:6144
 v_mfma_f32_16x16x32_bf16 v[112:115], a[32:35], a[68:71], v[112:115]
 ds_read_b64_tr_b16 a[68:69], v13 offset:0
 ds_read_b64_tr_b16 a[70:71], v13 offset:1024
 v_mfma_f32_16x16x32_bf16 v[128:131], a[32:35], a[72:75], v[128:131]
 ds_read_b128 a[16:19], v8 offset:8192
 v_mfma_f32_16x16x32_bf16 v[240:243], a[36:39], a[72:75], v[240:243]
 buffer_load_dwordx4 v5, s[8:11], s70 offen offset:2048 lds
 s_add_u32 s84, s84, 1
 s_cmp_eq_u32 s84, 8
 s_cselect_b32 s85, -7, 1
 s_cmov_b32 s84, 0
 v_mfma_f32_16x16x32_bf16 v[132:135], a[40:43], a[72:75], v[132:135]
 ds_read_b128 a[20:23], v8 offset:10240
 s_lshl_b32 s86, s85, 19
 v_mfma_f32_16x16x32_bf16 v[244:247], a[44:47], a[72:75], v[244:247]
 v_mfma_f32_16x16x32_bf16 v[136:139], a[48:51], a[72:75], v[136:139]
 ds_read_b128 a[24:27], v8 offset:12288
 v_mfma_f32_16x16x32_bf16 v[248:251], a[52:55], a[72:75], v[248:251]
 buffer_load_dwordx4 v5, s[8:11], s71 offen offset:3072 lds
 v_mfma_f32_16x16x32_bf16 v[140:143], a[56:59], a[72:75], v[140:143]
 ds_read_b128 a[28:31], v8 offset:14336
 v_mfma_f32_16x16x32_bf16 v[252:255], a[60:63], a[72:75], v[252:255]
 ds_read_b64_tr_b16 a[72:73], v14 offset:0
 ds_read_b64_tr_b16 a[74:75], v14 offset:1024
 v_mfma_f32_16x16x32_bf16 a[252:255], a[60:63], a[76:79], a[252:255]
 s_add_u32 m0, s63, 32768
 v_mfma_f32_16x16x32_bf16 a[248:251], a[56:59], a[76:79], a[248:251]
 buffer_load_dwordx4 v2, s[4:7], s64 offen offset:0 lds
 v_mfma_f32_16x16x32_bf16 a[244:247], a[52:55], a[76:79], a[244:247]
 v_mfma_f32_16x16x32_bf16 a[240:243], a[48:51], a[76:79], a[240:243]
 v_mfma_f32_16x16x32_bf16 a[236:239], a[44:47], a[76:79], a[236:239]
 v_mfma_f32_16x16x32_bf16 a[232:235], a[40:43], a[76:79], a[232:235]
 buffer_load_dwordx4 v3, s[4:7], s64 offen offset:1024 lds
 v_mfma_f32_16x16x32_bf16 a[228:231], a[36:39], a[76:79], a[228:231]
 v_mfma_f32_16x16x32_bf16 a[224:227], a[32:35], a[76:79], a[224:227]
 ds_read_b64_tr_b16 a[76:77], v15 offset:0
 ds_read_b64_tr_b16 a[78:79], v15 offset:1024
 s_waitcnt lgkmcnt(2)
 v_mfma_f32_16x16x32_bf16 v[32:35], a[64:67], a[0:3], v[32:35]
 v_mfma_f32_16x16x32_bf16 v[36:39], a[64:67], a[4:7], v[36:39]
 buffer_load_dwordx4 v2, s[4:7], s65 offen offset:2048 lds
 v_mfma_f32_16x16x32_bf16 v[40:43], a[64:67], a[8:11], v[40:43]
 v_mfma_f32_16x16x32_bf16 v[44:47], a[64:67], a[12:15], v[44:47]
 v_mfma_f32_16x16x32_bf16 v[48:51], a[64:67], a[16:19], v[48:51]
 v_mfma_f32_16x16x32_bf16 v[52:55], a[64:67], a[20:23], v[52:55]
 buffer_load_dwordx4 v3, s[4:7], s65 offen offset:3072 lds
 v_mfma_f32_16x16x32_bf16 v[56:59], a[64:67], a[24:27], v[56:59]
 v_mfma_f32_16x16x32_bf16 v[60:63], a[64:67], a[28:31], v[60:63]
 ds_read_b64_tr_b16 a[64:65], v12 offset:16384
 ds_read_b64_tr_b16 a[66:67], v12 offset:17408
 v_mfma_f32_16x16x32_bf16 v[172:175], a[68:71], a[28:31], v[172:175]
 ds_read_b128 a[32:35], v9 offset:0
 s_add_u32 m0, s62, 49152
 v_mfma_f32_16x16x32_bf16 v[168:171], a[68:71], a[24:27], v[168:171]
 buffer_load_dwordx4 v4, s[12:15], s68 offen offset:0 lds
 v_mfma_f32_16x16x32_bf16 v[164:167], a[68:71], a[20:23], v[164:167]
 v_mfma_f32_16x16x32_bf16 v[160:163], a[68:71], a[16:19], v[160:163]
 v_mfma_f32_16x16x32_bf16 v[156:159], a[68:71], a[12:15], v[156:159]
 v_mfma_f32_16x16x32_bf16 v[152:155], a[68:71], a[8:11], v[152:155]
 buffer_load_dwordx4 v4, s[12:15], s69 offen offset:1024 lds
 ds_read_b128 a[36:39], v9 offset:2048
 v_mfma_f32_16x16x32_bf16 v[148:151], a[68:71], a[4:7], v[148:151]
 v_mfma_f32_16x16x32_bf16 v[144:147], a[68:71], a[0:3], v[144:147]
 ds_read_b64_tr_b16 a[68:69], v13 offset:16384
 ds_read_b64_tr_b16 a[70:71], v13 offset:17408
 v_mfma_f32_16x16x32_bf16 v[64:67], a[72:75], a[0:3], v[64:67]
 v_mfma_f32_16x16x32_bf16 v[68:71], a[72:75], a[4:7], v[68:71]
 buffer_load_dwordx4 v5, s[12:15], s70 offen offset:2048 lds
 v_mfma_f32_16x16x32_bf16 v[72:75], a[72:75], a[8:11], v[72:75]
 ds_read_b128 a[40:43], v9 offset:4096
 v_mfma_f32_16x16x32_bf16 v[76:79], a[72:75], a[12:15], v[76:79]
 v_mfma_f32_16x16x32_bf16 v[80:83], a[72:75], a[16:19], v[80:83]
 v_mfma_f32_16x16x32_bf16 v[84:87], a[72:75], a[20:23], v[84:87]
 buffer_load_dwordx4 v5, s[12:15], s71 offen offset:3072 lds
 v_add_u32_e64 v4, s86, v4
 v_mfma_f32_16x16x32_bf16 v[88:91], a[72:75], a[24:27], v[88:91]
 v_add_u32_e64 v5, s86, v5
 v_mfma_f32_16x16x32_bf16 v[92:95], a[72:75], a[28:31], v[92:95]
 ds_read_b64_tr_b16 a[72:73], v14 offset:16384
 ds_read_b64_tr_b16 a[74:75], v14 offset:17408
 s_waitcnt lgkmcnt(3)
 v_mfma_f32_16x16x32_bf16 v[204:207], a[76:79], a[28:31], v[204:207]
 ds_read_b128 a[44:47], v9 offset:6144
 s_add_u32 m0, s63, 36864
 v_mfma_f32_16x16x32_bf16 v[200:203], a[76:79], a[24:27], v[200:203]
 buffer_load_dwordx4 v2, s[4:7], s66 offen offset:0 lds
 v_mfma_f32_16x16x32_bf16 v[196:199], a[76:79], a[20:23], v[196:199]
 v_mfma_f32_16x16x32_bf16 v[192:195], a[76:79], a[16:19], v[192:195]
 v_mfma_f32_16x16x32_bf16 v[188:191], a[76:79], a[12:15], v[188:191]
 ds_read_b128 a[48:51], v9 offset:8192
 v_mfma_f32_16x16x32_bf16 v[184:187], a[76:79], a[8:11], v[184:187]
 buffer_load_dwordx4 v3, s[4:7], s66 offen offset:1024 lds
 v_mfma_f32_16x16x32_bf16 v[180:183], a[76:79], a[4:7], v[180:183]
 v_mfma_f32_16x16x32_bf16 v[176:179], a[76:79], a[0:3], v[176:179]
 ds_read_b64_tr_b16 a[76:77], v15 offset:16384
 ds_read_b64_tr_b16 a[78:79], v15 offset:17408
 v_mfma_f32_16x16x32_bf16 v[96:99], a[0:3], a[64:67], v[96:99]
 v_mfma_f32_16x16x32_bf16 v[208:211], a[4:7], a[64:67], v[208:211]
 buffer_load_dwordx4 v2, s[4:7], s67 offen offset:2048 lds
 ds_read_b128 a[52:55], v9 offset:10240
 v_mfma_f32_16x16x32_bf16 v[100:103], a[8:11], a[64:67], v[100:103]
 v_mfma_f32_16x16x32_bf16 v[212:215], a[12:15], a[64:67], v[212:215]
 v_mfma_f32_16x16x32_bf16 v[104:107], a[16:19], a[64:67], v[104:107]
 v_mfma_f32_16x16x32_bf16 v[216:219], a[20:23], a[64:67], v[216:219]
 buffer_load_dwordx4 v3, s[4:7], s67 offen offset:3072 lds
 v_mfma_f32_16x16x32_bf16 v[108:111], a[24:27], a[64:67], v[108:111]
 ds_read_b128 a[56:59], v9 offset:12288
 v_mfma_f32_16x16x32_bf16 v[220:223], a[28:31], a[64:67], v[220:223]
 ds_read_b64_tr_b16 a[64:65], v12 offset:8192
 ds_read_b64_tr_b16 a[66:67], v12 offset:9216
 v_mfma_f32_16x16x32_bf16 v[236:239], a[28:31], a[68:71], v[236:239]
 v_mfma_f32_16x16x32_bf16 v[124:127], a[24:27], a[68:71], v[124:127]
 buffer_load_dword v28, v27, s[24:27], 0 offen sc1
 v_mfma_f32_16x16x32_bf16 v[232:235], a[20:23], a[68:71], v[232:235]
 v_mfma_f32_16x16x32_bf16 v[120:123], a[16:19], a[68:71], v[120:123]
 ds_read_b128 a[60:63], v9 offset:14336
 s_add_u32 m0, s63, 65536
 v_mfma_f32_16x16x32_bf16 v[228:231], a[12:15], a[68:71], v[228:231]
 s_mov_b32 s78, 12288
 v_xor_b32 v24, 0x80, v24
 v_mfma_f32_16x16x32_bf16 v[116:119], a[8:11], a[68:71], v[116:119]
 buffer_load_dwordx4 v24, s[80:83], s78 offen offset:3072 lds
 v_mfma_f32_16x16x32_bf16 v[224:227], a[4:7], a[68:71], v[224:227]
 s_add_u32 s4, s56, 0x2000000
 s_addc_u32 s5, s57, 0
 v_mfma_f32_16x16x32_bf16 v[112:115], a[0:3], a[68:71], v[112:115]
 ds_read_b64_tr_b16 a[68:69], v13 offset:8192
 ds_read_b64_tr_b16 a[70:71], v13 offset:9216
 s_waitcnt lgkmcnt(3)
 v_mfma_f32_16x16x32_bf16 v[128:131], a[0:3], a[72:75], v[128:131]
 s_mov_b32 s6, 0x280000
 s_mov_b32 s7, 0x00020000
 v_mfma_f32_16x16x32_bf16 v[240:243], a[4:7], a[72:75], v[240:243]
 s_mov_b32 s8, s36
 s_mov_b32 s9, s37
 v_mfma_f32_16x16x32_bf16 v[132:135], a[8:11], a[72:75], v[132:135]
 s_add_u32 m0, s63, 69632
 s_mov_b32 s78, 20480
 v_mfma_f32_16x16x32_bf16 v[244:247], a[12:15], a[72:75], v[244:247]
 v_xor_b32 v24, 0x80, v24
 s_mov_b32 s10, 0x500000
 v_mfma_f32_16x16x32_bf16 v[136:139], a[16:19], a[72:75], v[136:139]
 buffer_load_dwordx4 v24, s[80:83], s78 offen offset:0 lds
 s_mov_b32 s11, 0x00020000
 v_mfma_f32_16x16x32_bf16 v[248:251], a[20:23], a[72:75], v[248:251]
 s_cmp_lt_u32 s74, 27
 s_cselect_b32 s14, 0x21c000, 0
 v_mfma_f32_16x16x32_bf16 v[140:143], a[24:27], a[72:75], v[140:143]
 s_mov_b32 s18, s14
 s_mov_b32 s12, s46
 v_mfma_f32_16x16x32_bf16 v[252:255], a[28:31], a[72:75], v[252:255]
 ds_read_b64_tr_b16 a[72:73], v14 offset:8192
 ds_read_b64_tr_b16 a[74:75], v14 offset:9216
 v_mfma_f32_16x16x32_bf16 a[252:255], a[28:31], a[76:79], a[252:255]
 s_mov_b32 s13, s47
 s_mov_b32 s16, s48
 v_mfma_f32_16x16x32_bf16 a[248:251], a[24:27], a[76:79], a[248:251]
 s_add_u32 m0, s63, 69632
 s_mov_b32 s78, 24576
 v_mfma_f32_16x16x32_bf16 a[244:247], a[20:23], a[76:79], a[244:247]
 v_xor_b32 v24, 0x80, v24
 s_mov_b32 s17, s49
 v_mfma_f32_16x16x32_bf16 a[240:243], a[16:19], a[76:79], a[240:243]
 buffer_load_dwordx4 v24, s[80:83], s78 offen offset:1024 lds
 s_mov_b32 s19, 0x00020000
 v_mfma_f32_16x16x32_bf16 a[236:239], a[12:15], a[76:79], a[236:239]
 s_lshl_b32 s75, s60, 2
 s_sub_u32 s76, 60, s75
 v_mfma_f32_16x16x32_bf16 a[232:235], a[8:11], a[76:79], a[232:235]
 s_add_u32 s75, s75, s58
 s_add_u32 s76, s76, s58
 v_mfma_f32_16x16x32_bf16 a[228:231], a[4:7], a[76:79], a[228:231]
 s_mul_i32 s64, s75, 40960
 s_mul_i32 s66, s76, 40960
 v_mfma_f32_16x16x32_bf16 a[224:227], a[0:3], a[76:79], a[224:227]
 ds_read_b64_tr_b16 a[76:77], v15 offset:8192
 ds_read_b64_tr_b16 a[78:79], v15 offset:9216
 v_mfma_f32_16x16x32_bf16 v[32:35], a[64:67], a[32:35], v[32:35]
 s_add_u32 s65, s64, 18432
 s_add_u32 s67, s66, 18432
 v_mfma_f32_16x16x32_bf16 v[36:39], a[64:67], a[36:39], v[36:39]
 v_lshrrev_b32 v29, 3, v1
 s_movk_i32 s3, 1280
 v_mfma_f32_16x16x32_bf16 v[40:43], a[64:67], a[40:43], v[40:43]
 v_mul_lo_u32 v29, v29, s3
 v_lshl_add_u32 v29, s88, 7, v29
 v_mfma_f32_16x16x32_bf16 v[44:47], a[64:67], a[44:47], v[44:47]
 v_lshrrev_b32 v30, 4, v1
 v_and_b32_e64 v3, 7, v1
 v_mfma_f32_16x16x32_bf16 v[48:51], a[64:67], a[48:51], v[48:51]
 v_xor_b32_e64 v30, v30, v3
 v_lshl_add_u32 v2, v30, 4, v29
 v_mfma_f32_16x16x32_bf16 v[52:55], a[64:67], a[52:55], v[52:55]
 v_xor_b32_e64 v30, 4, v30
 v_lshl_add_u32 v3, v30, 4, v29
 v_mfma_f32_16x16x32_bf16 v[56:59], a[64:67], a[56:59], v[56:59]
 v_add_u32 v3, 9216, v3
 s_sub_u32 s85, s88, s84
 s_waitcnt lgkmcnt(2)
 v_mfma_f32_16x16x32_bf16 v[60:63], a[64:67], a[60:63], v[60:63]
 ds_read_b64_tr_b16 a[64:65], v12 offset:24576
 ds_read_b64_tr_b16 a[66:67], v12 offset:25600
 v_mfma_f32_16x16x32_bf16 v[172:175], a[68:71], a[60:63], v[172:175]
 s_mov_b32 s84, s88
 s_lshl_b32 s87, s85, 19
 v_mfma_f32_16x16x32_bf16 v[168:171], a[68:71], a[56:59], v[168:171]
 v_add_u32 v4, s87, v4
 v_add_u32 v5, s87, v5
 v_mfma_f32_16x16x32_bf16 v[164:167], a[68:71], a[52:55], v[164:167]
 s_lshl_b32 s75, s59, 4
 s_lshl_b32 s76, s60, 1
 v_mfma_f32_16x16x32_bf16 v[160:163], a[68:71], a[48:51], v[160:163]
 s_add_u32 s75, s75, s76
 s_and_b32 s76, s58, 1
 v_mfma_f32_16x16x32_bf16 v[156:159], a[68:71], a[44:47], v[156:159]
 s_add_u32 s75, s75, s76
 s_lshl_b32 s75, s75, 16
 v_mfma_f32_16x16x32_bf16 v[152:155], a[68:71], a[40:43], v[152:155]
 s_add_u32 s20, s56, s75
 s_addc_u32 s21, s57, 0
 v_mfma_f32_16x16x32_bf16 v[148:151], a[68:71], a[36:39], v[148:151]
 s_mov_b32 s22, 0x10000
 s_mov_b32 s23, 0x00020000
 v_mfma_f32_16x16x32_bf16 v[144:147], a[68:71], a[32:35], v[144:147]
 ds_read_b64_tr_b16 a[68:69], v13 offset:24576
 ds_read_b64_tr_b16 a[70:71], v13 offset:25600
 v_mfma_f32_16x16x32_bf16 v[64:67], a[72:75], a[32:35], v[64:67]
 v_mfma_f32_16x16x32_bf16 v[68:71], a[72:75], a[36:39], v[68:71]
 v_mfma_f32_16x16x32_bf16 v[72:75], a[72:75], a[40:43], v[72:75]
 v_mfma_f32_16x16x32_bf16 v[76:79], a[72:75], a[44:47], v[76:79]
 v_mfma_f32_16x16x32_bf16 v[80:83], a[72:75], a[48:51], v[80:83]
 v_mfma_f32_16x16x32_bf16 v[84:87], a[72:75], a[52:55], v[84:87]
 v_mfma_f32_16x16x32_bf16 v[88:91], a[72:75], a[56:59], v[88:91]
 v_mfma_f32_16x16x32_bf16 v[92:95], a[72:75], a[60:63], v[92:95]
 ds_read_b64_tr_b16 a[72:73], v14 offset:24576
 ds_read_b64_tr_b16 a[74:75], v14 offset:25600
 s_waitcnt lgkmcnt(2)
 v_mfma_f32_16x16x32_bf16 v[204:207], a[76:79], a[60:63], v[204:207]
 v_mfma_f32_16x16x32_bf16 v[200:203], a[76:79], a[56:59], v[200:203]
 v_mfma_f32_16x16x32_bf16 v[196:199], a[76:79], a[52:55], v[196:199]
 v_mfma_f32_16x16x32_bf16 v[192:195], a[76:79], a[48:51], v[192:195]
 v_mfma_f32_16x16x32_bf16 v[188:191], a[76:79], a[44:47], v[188:191]
 v_mfma_f32_16x16x32_bf16 v[184:187], a[76:79], a[40:43], v[184:187]
 v_mfma_f32_16x16x32_bf16 v[180:183], a[76:79], a[36:39], v[180:183]
 v_mfma_f32_16x16x32_bf16 v[176:179], a[76:79], a[32:35], v[176:179]
 ds_read_b64_tr_b16 a[76:77], v15 offset:24576
 ds_read_b64_tr_b16 a[78:79], v15 offset:25600
 v_mfma_f32_16x16x32_bf16 v[96:99], a[32:35], a[64:67], v[96:99]
 v_mfma_f32_16x16x32_bf16 v[208:211], a[36:39], a[64:67], v[208:211]
 v_mfma_f32_16x16x32_bf16 v[100:103], a[40:43], a[64:67], v[100:103]
 v_mfma_f32_16x16x32_bf16 v[212:215], a[44:47], a[64:67], v[212:215]
 v_mfma_f32_16x16x32_bf16 v[104:107], a[48:51], a[64:67], v[104:107]
 v_mfma_f32_16x16x32_bf16 v[216:219], a[52:55], a[64:67], v[216:219]
 v_mfma_f32_16x16x32_bf16 v[108:111], a[56:59], a[64:67], v[108:111]
 s_waitcnt vmcnt(3)
 v_sub_u32 v28, v28, v0
 v_subrev_u32 v28, 1, v28
 v_cmp_ge_u32 vcc, 11, v28
 s_mov_b32 s79, 0
 s_cmp_eq_u64 vcc, -1
 s_cbranch_scc0 L_pl1
L_pd1:
 v_mfma_f32_16x16x32_bf16 v[220:223], a[60:63], a[64:67], v[220:223]
 s_waitcnt lgkmcnt(0)
 s_barrier
 v_mfma_f32_16x16x32_bf16 v[236:239], a[60:63], a[68:71], v[236:239]
 ds_read_b64_tr_b16 a[64:65], v12 offset:32768
 ds_read_b64_tr_b16 a[66:67], v12 offset:33792
 s_add_u32 m0, s62, 16384
 v_mfma_f32_16x16x32_bf16 v[124:127], a[56:59], a[68:71], v[124:127]
 buffer_load_dwordx4 v6, s[12:15], s72 offen offset:0 lds
 ds_read_b128 a[0:3], v8 offset:32768
 v_mfma_f32_16x16x32_bf16 v[232:235], a[52:55], a[68:71], v[232:235]
 ds_read_b128 a[4:7], v8 offset:34816
 v_mfma_f32_16x16x32_bf16 v[120:123], a[48:51], a[68:71], v[120:123]
 v_mfma_f32_16x16x32_bf16 v[228:231], a[44:47], a[68:71], v[228:231]
 ds_read_b128 a[8:11], v8 offset:36864
 v_mfma_f32_16x16x32_bf16 v[116:119], a[40:43], a[68:71], v[116:119]
 buffer_load_dwordx4 v7, s[12:15], s73 offen offset:1024 lds
 v_mfma_f32_16x16x32_bf16 v[224:227], a[36:39], a[68:71], v[224:227]
 ds_read_b128 a[12:15], v8 offset:38912
 v_mfma_f32_16x16x32_bf16 v[112:115], a[32:35], a[68:71], v[112:115]
 ds_read_b64_tr_b16 a[68:69], v13 offset:32768
 ds_read_b64_tr_b16 a[70:71], v13 offset:33792
 v_mfma_f32_16x16x32_bf16 v[128:131], a[32:35], a[72:75], v[128:131]
 ds_read_b128 a[16:19], v8 offset:40960
 s_add_u32 m0, s62, 18432
 v_mfma_f32_16x16x32_bf16 v[240:243], a[36:39], a[72:75], v[240:243]
 buffer_load_dwordx4 v6, s[16:19], s72 offen offset:0 lds
 s_add_u32 s84, s84, 1
 s_cmp_eq_u32 s84, 10
 s_cselect_b32 s85, -9, 1
 s_cmov_b32 s84, 0
 v_mfma_f32_16x16x32_bf16 v[132:135], a[40:43], a[72:75], v[132:135]
 ds_read_b128 a[20:23], v8 offset:43008
 s_lshl_b32 s86, s85, 19
 v_mfma_f32_16x16x32_bf16 v[244:247], a[44:47], a[72:75], v[244:247]
 s_mul_i32 s87, s85, 221184
 v_mfma_f32_16x16x32_bf16 v[136:139], a[48:51], a[72:75], v[136:139]
 ds_read_b128 a[24:27], v8 offset:45056
L_pg4:
 s_cbranch_execz L_hopr0
 v_mfma_f32_16x16x32_bf16 v[248:251], a[52:55], a[72:75], v[248:251]
 buffer_load_dwordx4 v7, s[16:19], s73 offen offset:1024 lds
 v_mfma_f32_16x16x32_bf16 v[140:143], a[56:59], a[72:75], v[140:143]
 ds_read_b128 a[28:31], v8 offset:47104
 v_mfma_f32_16x16x32_bf16 v[252:255], a[60:63], a[72:75], v[252:255]
 ds_read_b64_tr_b16 a[72:73], v14 offset:32768
 ds_read_b64_tr_b16 a[74:75], v14 offset:33792
 v_mfma_f32_16x16x32_bf16 a[252:255], a[60:63], a[76:79], a[252:255]
 s_add_u32 m0, s63, 0
 v_mfma_f32_16x16x32_bf16 a[248:251], a[56:59], a[76:79], a[248:251]
 buffer_load_dwordx4 v2, s[4:7], s64 offen offset:0 sc1 lds
 v_mfma_f32_16x16x32_bf16 a[244:247], a[52:55], a[76:79], a[244:247]
 v_mfma_f32_16x16x32_bf16 a[240:243], a[48:51], a[76:79], a[240:243]
 v_mfma_f32_16x16x32_bf16 a[236:239], a[44:47], a[76:79], a[236:239]
 v_mfma_f32_16x16x32_bf16 a[232:235], a[40:43], a[76:79], a[232:235]
 buffer_load_dwordx4 v3, s[4:7], s64 offen offset:1024 sc1 lds
 v_add_u32 v6, s87, v6
 v_mfma_f32_16x16x32_bf16 a[228:231], a[36:39], a[76:79], a[228:231]
 v_add_u32_e64 v7, s87, v7
 v_mfma_f32_16x16x32_bf16 a[224:227], a[32:35], a[76:79], a[224:227]
 ds_read_b64_tr_b16 a[76:77], v15 offset:32768
 ds_read_b64_tr_b16 a[78:79], v15 offset:33792
 s_waitcnt lgkmcnt(2)
 v_mfma_f32_16x16x32_bf16 v[32:35], a[64:67], a[0:3], v[32:35]
 v_mfma_f32_16x16x32_bf16 v[36:39], a[64:67], a[4:7], v[36:39]
 buffer_load_dwordx4 v2, s[4:7], s65 offen offset:2048 sc1 lds
 v_mfma_f32_16x16x32_bf16 v[40:43], a[64:67], a[8:11], v[40:43]
 v_mfma_f32_16x16x32_bf16 v[44:47], a[64:67], a[12:15], v[44:47]
 v_mfma_f32_16x16x32_bf16 v[48:51], a[64:67], a[16:19], v[48:51]
 v_mfma_f32_16x16x32_bf16 v[52:55], a[64:67], a[20:23], v[52:55]
 buffer_load_dwordx4 v3, s[4:7], s65 offen offset:3072 sc1 lds
 v_mfma_f32_16x16x32_bf16 v[56:59], a[64:67], a[24:27], v[56:59]
 v_mfma_f32_16x16x32_bf16 v[60:63], a[64:67], a[28:31], v[60:63]
 ds_read_b64_tr_b16 a[64:65], v12 offset:49152
 ds_read_b64_tr_b16 a[66:67], v12 offset:50176
 v_mfma_f32_16x16x32_bf16 v[172:175], a[68:71], a[28:31], v[172:175]
 ds_read_b128 a[32:35], v9 offset:32768
 s_add_u32 m0, s62, 0
 v_mfma_f32_16x16x32_bf16 v[168:171], a[68:71], a[24:27], v[168:171]
 buffer_load_dwordx4 v4, s[8:11], s68 offen offset:0 lds
 v_mfma_f32_16x16x32_bf16 v[164:167], a[68:71], a[20:23], v[164:167]
 v_mfma_f32_16x16x32_bf16 v[160:163], a[68:71], a[16:19], v[160:163]
 v_mfma_f32_16x16x32_bf16 v[156:159], a[68:71], a[12:15], v[156:159]
 v_mfma_f32_16x16x32_bf16 v[152:155], a[68:71], a[8:11], v[152:155]
 buffer_load_dwordx4 v4, s[8:11], s69 offen offset:1024 lds
 ds_read_b128 a[36:39], v9 offset:34816
 v_mfma_f32_16x16x32_bf16 v[148:151], a[68:71], a[4:7], v[148:151]
 v_mfma_f32_16x16x32_bf16 v[144:147], a[68:71], a[0:3], v[144:147]
 ds_read_b64_tr_b16 a[68:69], v13 offset:49152
 ds_read_b64_tr_b16 a[70:71], v13 offset:50176
 v_mfma_f32_16x16x32_bf16 v[64:67], a[72:75], a[0:3], v[64:67]
 v_mfma_f32_16x16x32_bf16 v[68:71], a[72:75], a[4:7], v[68:71]
 buffer_load_dwordx4 v5, s[8:11], s70 offen offset:2048 lds
 v_mfma_f32_16x16x32_bf16 v[72:75], a[72:75], a[8:11], v[72:75]
 ds_read_b128 a[40:43], v9 offset:36864
 v_mfma_f32_16x16x32_bf16 v[76:79], a[72:75], a[12:15], v[76:79]
 v_mfma_f32_16x16x32_bf16 v[80:83], a[72:75], a[16:19], v[80:83]
 v_mfma_f32_16x16x32_bf16 v[84:87], a[72:75], a[20:23], v[84:87]
 buffer_load_dwordx4 v5, s[8:11], s71 offen offset:3072 lds
 v_add_u32_e64 v4, s86, v4
 v_mfma_f32_16x16x32_bf16 v[88:91], a[72:75], a[24:27], v[88:91]
 v_add_u32_e64 v5, s86, v5
 v_mfma_f32_16x16x32_bf16 v[92:95], a[72:75], a[28:31], v[92:95]
 ds_read_b64_tr_b16 a[72:73], v14 offset:49152
 ds_read_b64_tr_b16 a[74:75], v14 offset:50176
 s_waitcnt lgkmcnt(3)
 v_mfma_f32_16x16x32_bf16 v[204:207], a[76:79], a[28:31], v[204:207]
 ds_read_b128 a[44:47], v9 offset:38912
 s_add_u32 m0, s63, 4096
 v_mfma_f32_16x16x32_bf16 v[200:203], a[76:79], a[24:27], v[200:203]
 buffer_load_dwordx4 v2, s[4:7], s66 offen offset:0 sc1 lds
 v_mfma_f32_16x16x32_bf16 v[196:199], a[76:79], a[20:23], v[196:199]
 v_mfma_f32_16x16x32_bf16 v[192:195], a[76:79], a[16:19], v[192:195]
 v_mfma_f32_16x16x32_bf16 v[188:191], a[76:79], a[12:15], v[188:191]
 ds_read_b128 a[48:51], v9 offset:40960
 v_mfma_f32_16x16x32_bf16 v[184:187], a[76:79], a[8:11], v[184:187]
 buffer_load_dwordx4 v3, s[4:7], s66 offen offset:1024 sc1 lds
 v_mfma_f32_16x16x32_bf16 v[180:183], a[76:79], a[4:7], v[180:183]
 v_mfma_f32_16x16x32_bf16 v[176:179], a[76:79], a[0:3], v[176:179]
 ds_read_b64_tr_b16 a[76:77], v15 offset:49152
 ds_read_b64_tr_b16 a[78:79], v15 offset:50176
 v_mfma_f32_16x16x32_bf16 v[96:99], a[0:3], a[64:67], v[96:99]
 v_mfma_f32_16x16x32_bf16 v[208:211], a[4:7], a[64:67], v[208:211]
 buffer_load_dwordx4 v2, s[4:7], s67 offen offset:2048 sc1 lds
 ds_read_b128 a[52:55], v9 offset:43008
 v_mfma_f32_16x16x32_bf16 v[100:103], a[8:11], a[64:67], v[100:103]
 v_mfma_f32_16x16x32_bf16 v[212:215], a[12:15], a[64:67], v[212:215]
 v_mfma_f32_16x16x32_bf16 v[104:107], a[16:19], a[64:67], v[104:107]
 v_mfma_f32_16x16x32_bf16 v[216:219], a[20:23], a[64:67], v[216:219]
 buffer_load_dwordx4 v3, s[4:7], s67 offen offset:3072 sc1 lds
 v_lshl_add_u32 v2, s85, 7, v2
 v_mfma_f32_16x16x32_bf16 v[108:111], a[24:27], a[64:67], v[108:111]
 ds_read_b128 a[56:59], v9 offset:45056
 v_lshl_add_u32 v3, s85, 7, v3
 v_mfma_f32_16x16x32_bf16 v[220:223], a[28:31], a[64:67], v[220:223]
 ds_read_b64_tr_b16 a[64:65], v12 offset:40960
 ds_read_b64_tr_b16 a[66:67], v12 offset:41984
 v_mfma_f32_16x16x32_bf16 v[236:239], a[28:31], a[68:71], v[236:239]
 v_mfma_f32_16x16x32_bf16 v[124:127], a[24:27], a[68:71], v[124:127]
 v_mfma_f32_16x16x32_bf16 v[232:235], a[20:23], a[68:71], v[232:235]
 v_mfma_f32_16x16x32_bf16 v[120:123], a[16:19], a[68:71], v[120:123]
 ds_read_b128 a[60:63], v9 offset:47104
 s_add_u32 m0, s63, 69632
 v_mfma_f32_16x16x32_bf16 v[228:231], a[12:15], a[68:71], v[228:231]
 s_mov_b32 s78, 28672
 v_xor_b32 v24, 0x80, v24
 v_mfma_f32_16x16x32_bf16 v[116:119], a[8:11], a[68:71], v[116:119]
 buffer_load_dwordx4 v24, s[80:83], s78 offen offset:2048 lds
 v_mfma_f32_16x16x32_bf16 v[224:227], a[4:7], a[68:71], v[224:227]
 v_mfma_f32_16x16x32_bf16 v[112:115], a[0:3], a[68:71], v[112:115]
 ds_read_b64_tr_b16 a[68:69], v13 offset:40960
 ds_read_b64_tr_b16 a[70:71], v13 offset:41984
 s_waitcnt lgkmcnt(3)
 v_mfma_f32_16x16x32_bf16 v[128:131], a[0:3], a[72:75], v[128:131]
 v_mfma_f32_16x16x32_bf16 v[240:243], a[4:7], a[72:75], v[240:243]
 v_mfma_f32_16x16x32_bf16 v[132:135], a[8:11], a[72:75], v[132:135]
 s_add_u32 m0, s63, 69632
 s_mov_b32 s78, 32768
 v_mfma_f32_16x16x32_bf16 v[244:247], a[12:15], a[72:75], v[244:247]
 v_xor_b32 v24, 0x80, v24
 v_mfma_f32_16x16x32_bf16 v[136:139], a[16:19], a[72:75], v[136:139]
 buffer_load_dwordx4 v24, s[80:83], s78 offen offset:3072 lds
 v_mfma_f32_16x16x32_bf16 v[248:251], a[20:23], a[72:75], v[248:251]
 v_mfma_f32_16x16x32_bf16 v[140:143], a[24:27], a[72:75], v[140:143]
 v_mfma_f32_16x16x32_bf16 v[252:255], a[28:31], a[72:75], v[252:255]
 ds_read_b64_tr_b16 a[72:73], v14 offset:40960
 ds_read_b64_tr_b16 a[74:75], v14 offset:41984
 v_mfma_f32_16x16x32_bf16 a[252:255], a[28:31], a[76:79], a[252:255]
 s_lshr_b32 s3, s58, 1
 s_lshl_b32 s3, s3, 11
 v_mfma_f32_16x16x32_bf16 a[248:251], a[24:27], a[76:79], a[248:251]
 v_lshl_add_u32 v24, v1, 4, s3
 v_add_u32_e64 v25, s3, v24
 v_mfma_f32_16x16x32_bf16 a[244:247], a[20:23], a[76:79], a[244:247]
 v_mfma_f32_16x16x32_bf16 a[240:243], a[16:19], a[76:79], a[240:243]
 v_mfma_f32_16x16x32_bf16 a[236:239], a[12:15], a[76:79], a[236:239]
 v_mfma_f32_16x16x32_bf16 a[232:235], a[8:11], a[76:79], a[232:235]
 v_mfma_f32_16x16x32_bf16 a[228:231], a[4:7], a[76:79], a[228:231]
 v_mfma_f32_16x16x32_bf16 a[224:227], a[0:3], a[76:79], a[224:227]
 ds_read_b64_tr_b16 a[76:77], v15 offset:40960
 ds_read_b64_tr_b16 a[78:79], v15 offset:41984
 v_mfma_f32_16x16x32_bf16 v[32:35], a[64:67], a[32:35], v[32:35]
 v_mfma_f32_16x16x32_bf16 v[36:39], a[64:67], a[36:39], v[36:39]
 v_mfma_f32_16x16x32_bf16 v[40:43], a[64:67], a[40:43], v[40:43]
 v_mfma_f32_16x16x32_bf16 v[44:47], a[64:67], a[44:47], v[44:47]
 v_mfma_f32_16x16x32_bf16 v[48:51], a[64:67], a[48:51], v[48:51]
 v_mfma_f32_16x16x32_bf16 v[52:55], a[64:67], a[52:55], v[52:55]
 v_mfma_f32_16x16x32_bf16 v[56:59], a[64:67], a[56:59], v[56:59]
 s_waitcnt lgkmcnt(2)
 v_mfma_f32_16x16x32_bf16 v[60:63], a[64:67], a[60:63], v[60:63]
 ds_read_b64_tr_b16 a[64:65], v12 offset:57344
 ds_read_b64_tr_b16 a[66:67], v12 offset:58368
 v_mfma_f32_16x16x32_bf16 v[172:175], a[68:71], a[60:63], v[172:175]
 v_mfma_f32_16x16x32_bf16 v[168:171], a[68:71], a[56:59], v[168:171]
 v_mfma_f32_16x16x32_bf16 v[164:167], a[68:71], a[52:55], v[164:167]
 v_mfma_f32_16x16x32_bf16 v[160:163], a[68:71], a[48:51], v[160:163]
 v_mfma_f32_16x16x32_bf16 v[156:159], a[68:71], a[44:47], v[156:159]
 v_mfma_f32_16x16x32_bf16 v[152:155], a[68:71], a[40:43], v[152:155]
 v_mfma_f32_16x16x32_bf16 v[148:151], a[68:71], a[36:39], v[148:151]
 v_mfma_f32_16x16x32_bf16 v[144:147], a[68:71], a[32:35], v[144:147]
 ds_read_b64_tr_b16 a[68:69], v13 offset:57344
 ds_read_b64_tr_b16 a[70:71], v13 offset:58368
 v_mfma_f32_16x16x32_bf16 v[64:67], a[72:75], a[32:35], v[64:67]
 v_mfma_f32_16x16x32_bf16 v[68:71], a[72:75], a[36:39], v[68:71]
 v_cvt_pk_bf16_f32 v32, v32, v33
 v_cvt_pk_bf16_f32 v33, v34, v35
 v_mfma_f32_16x16x32_bf16 v[72:75], a[72:75], a[40:43], v[72:75]
 s_nop 0
 v_cvt_pk_bf16_f32 v34, v144, v145
 v_cvt_pk_bf16_f32 v35, v146, v147
 v_mfma_f32_16x16x32_bf16 v[76:79], a[72:75], a[44:47], v[76:79]
 v_cvt_pk_bf16_f32 v36, v36, v37
 v_cvt_pk_bf16_f32 v37, v38, v39
 v_mfma_f32_16x16x32_bf16 v[80:83], a[72:75], a[48:51], v[80:83]
 v_cvt_pk_bf16_f32 v38, v148, v149
 v_cvt_pk_bf16_f32 v39, v150, v151
 v_mfma_f32_16x16x32_bf16 v[84:87], a[72:75], a[52:55], v[84:87]
 v_cvt_pk_bf16_f32 v40, v40, v41
 v_cvt_pk_bf16_f32 v41, v42, v43
 v_mfma_f32_16x16x32_bf16 v[88:91], a[72:75], a[56:59], v[88:91]
 v_cvt_pk_bf16_f32 v42, v152, v153
 v_cvt_pk_bf16_f32 v43, v154, v155
 v_mfma_f32_16x16x32_bf16 v[92:95], a[72:75], a[60:63], v[92:95]
 ds_read_b64_tr_b16 a[72:73], v14 offset:57344
 ds_read_b64_tr_b16 a[74:75], v14 offset:58368
 s_waitcnt lgkmcnt(2)
 v_mfma_f32_16x16x32_bf16 v[204:207], a[76:79], a[60:63], v[204:207]
 v_cvt_pk_bf16_f32 v44, v44, v45
 v_cvt_pk_bf16_f32 v45, v46, v47
 v_mfma_f32_16x16x32_bf16 v[200:203], a[76:79], a[56:59], v[200:203]
 v_cvt_pk_bf16_f32 v46, v156, v157
 v_cvt_pk_bf16_f32 v47, v158, v159
 v_mfma_f32_16x16x32_bf16 v[196:199], a[76:79], a[52:55], v[196:199]
 v_cvt_pk_bf16_f32 v48, v48, v49
 v_cvt_pk_bf16_f32 v49, v50, v51
 v_mfma_f32_16x16x32_bf16 v[192:195], a[76:79], a[48:51], v[192:195]
 v_cvt_pk_bf16_f32 v50, v160, v161
 v_cvt_pk_bf16_f32 v51, v162, v163
 v_mfma_f32_16x16x32_bf16 v[188:191], a[76:79], a[44:47], v[188:191]
 v_cvt_pk_bf16_f32 v52, v52, v53
 v_cvt_pk_bf16_f32 v53, v54, v55
 v_mfma_f32_16x16x32_bf16 v[184:187], a[76:79], a[40:43], v[184:187]
 v_cvt_pk_bf16_f32 v54, v164, v165
 v_cvt_pk_bf16_f32 v55, v166, v167
 v_mfma_f32_16x16x32_bf16 v[180:183], a[76:79], a[36:39], v[180:183]
 v_cvt_pk_bf16_f32 v56, v56, v57
 v_cvt_pk_bf16_f32 v57, v58, v59
 v_mfma_f32_16x16x32_bf16 v[176:179], a[76:79], a[32:35], v[176:179]
 ds_read_b64_tr_b16 a[76:77], v15 offset:57344
 ds_read_b64_tr_b16 a[78:79], v15 offset:58368
 v_mfma_f32_16x16x32_bf16 v[96:99], a[32:35], a[64:67], v[96:99]
 v_cvt_pk_bf16_f32 v58, v168, v169
 v_cvt_pk_bf16_f32 v59, v170, v171
 v_mfma_f32_16x16x32_bf16 v[208:211], a[36:39], a[64:67], v[208:211]
 v_cvt_pk_bf16_f32 v60, v60, v61
 v_cvt_pk_bf16_f32 v61, v62, v63
 v_mfma_f32_16x16x32_bf16 v[100:103], a[40:43], a[64:67], v[100:103]
 s_lshr_b32 s3, s58, 1
 s_lshl_b32 s3, s3, 7
 v_mfma_f32_16x16x32_bf16 v[212:215], a[44:47], a[64:67], v[212:215]
 v_xor_b32 v12, s3, v12
 v_xor_b32_e64 v13, s3, v13
 v_mfma_f32_16x16x32_bf16 v[104:107], a[48:51], a[64:67], v[104:107]
 v_xor_b32 v14, s3, v14
 v_xor_b32 v15, s3, v15
 v_mfma_f32_16x16x32_bf16 v[216:219], a[52:55], a[64:67], v[216:219]
 v_xor_b32 v16, s3, v16
 v_xor_b32 v17, s3, v17
 v_mfma_f32_16x16x32_bf16 v[108:111], a[56:59], a[64:67], v[108:111]
 v_xor_b32 v18, s3, v18
 v_xor_b32 v19, s3, v19
 v_mfma_f32_16x16x32_bf16 v[220:223], a[60:63], a[64:67], v[220:223]
 s_mov_b64 exec, 0
 s_cmp_eq_u32 s58, 0
 s_cbranch_scc1 L_pg5
 s_cmp_eq_u32 s58, 1
 s_cbranch_scc1 L_pg6
 s_cmp_eq_u32 s58, 2
 s_cbranch_scc1 L_pg7
 s_branch L_pg8
L_hopr1:
 s_mov_b64 exec, -1
 s_waitcnt vmcnt(2)
 s_waitcnt lgkmcnt(0)
 s_barrier
 v_mfma_f32_16x16x32_bf16 v[236:239], a[60:63], a[68:71], v[236:239]
 ds_read_b64_tr_b16 a[16:17], v20 offset:16384
 ds_read_b64_tr_b16 a[18:19], v20 offset:16896
 s_add_u32 m0, s62, 49152
 v_mfma_f32_16x16x32_bf16 v[124:127], a[56:59], a[68:71], v[124:127]
 buffer_load_dwordx4 v6, s[12:15], s72 offen offset:0 lds
 ds_read_b64_tr_b16 a[20:21], v20 offset:18432
 ds_read_b64_tr_b16 a[22:23], v20 offset:18944
 v_mfma_f32_16x16x32_bf16 v[232:235], a[52:55], a[68:71], v[232:235]
 ds_read_b64_tr_b16 a[24:25], v21 offset:16384
 ds_read_b64_tr_b16 a[26:27], v21 offset:16896
 v_mfma_f32_16x16x32_bf16 v[120:123], a[48:51], a[68:71], v[120:123]
 ds_read_b64_tr_b16 a[28:29], v21 offset:18432
 ds_read_b64_tr_b16 a[30:31], v21 offset:18944
 v_mfma_f32_16x16x32_bf16 v[228:231], a[44:47], a[68:71], v[228:231]
 ds_read_b128 a[0:3], v10 offset:0
 ds_read_b128 a[4:7], v10 offset:2048
 v_mfma_f32_16x16x32_bf16 v[116:119], a[40:43], a[68:71], v[116:119]
 buffer_load_dwordx4 v7, s[12:15], s73 offen offset:1024 lds
 ds_read_b128 a[8:11], v10 offset:4096
 v_mfma_f32_16x16x32_bf16 v[224:227], a[36:39], a[68:71], v[224:227]
 ds_read_b128 a[12:15], v10 offset:6144
 v_cvt_pk_bf16_f32 v62, v172, v173
 v_mfma_f32_16x16x32_bf16 v[112:115], a[32:35], a[68:71], v[112:115]
 s_add_u32 s84, s84, 1
 s_cmp_eq_u32 s84, 10
 s_cselect_b32 s85, -9, 1
 s_cmov_b32 s84, 0
 v_mfma_f32_16x16x32_bf16 v[128:131], a[32:35], a[72:75], v[128:131]
 s_lshl_b32 s86, s85, 19
 s_mul_i32 s87, s85, 221184
 s_add_u32 m0, s62, 51200
 v_mfma_f32_16x16x32_bf16 v[240:243], a[36:39], a[72:75], v[240:243]
 buffer_load_dwordx4 v6, s[16:19], s72 offen offset:0 lds
 v_cvt_pk_bf16_f32 v63, v174, v175
 v_mfma_f32_16x16x32_bf16 v[132:135], a[40:43], a[72:75], v[132:135]
 v_cvt_pk_bf16_f32 v64, v64, v65
 v_cvt_pk_bf16_f32 v65, v66, v67
 v_mfma_f32_16x16x32_bf16 v[244:247], a[44:47], a[72:75], v[244:247]
 v_cvt_pk_bf16_f32 v66, v176, v177
 v_cvt_pk_bf16_f32 v67, v178, v179
 v_mfma_f32_16x16x32_bf16 v[136:139], a[48:51], a[72:75], v[136:139]
 v_cvt_pk_bf16_f32 v68, v68, v69
 v_cvt_pk_bf16_f32 v69, v70, v71
 v_mfma_f32_16x16x32_bf16 v[248:251], a[52:55], a[72:75], v[248:251]
 buffer_load_dwordx4 v7, s[16:19], s73 offen offset:1024 lds
 v_cvt_pk_bf16_f32 v70, v180, v181
 v_mfma_f32_16x16x32_bf16 v[140:143], a[56:59], a[72:75], v[140:143]
 v_cvt_pk_bf16_f32 v71, v182, v183
 v_cvt_pk_bf16_f32 v72, v72, v73
 v_mfma_f32_16x16x32_bf16 v[252:255], a[60:63], a[72:75], v[252:255]
 v_cvt_pk_bf16_f32 v73, v74, v75
 v_cvt_pk_bf16_f32 v74, v184, v185
 v_mfma_f32_16x16x32_bf16 a[252:255], a[60:63], a[76:79], a[252:255]
 s_add_u32 m0, s63, 32768
 v_cvt_pk_bf16_f32 v75, v186, v187
 v_mfma_f32_16x16x32_bf16 a[248:251], a[56:59], a[76:79], a[248:251]
 buffer_load_dwordx4 v2, s[4:7], s64 offen offset:0 sc1 lds
 v_cvt_pk_bf16_f32 v76, v76, v77
 v_mfma_f32_16x16x32_bf16 a[244:247], a[52:55], a[76:79], a[244:247]
 v_cvt_pk_bf16_f32 v77, v78, v79
 v_cvt_pk_bf16_f32 v78, v188, v189
 v_mfma_f32_16x16x32_bf16 a[240:243], a[48:51], a[76:79], a[240:243]
 v_cvt_pk_bf16_f32 v79, v190, v191
 v_cvt_pk_bf16_f32 v80, v80, v81
 v_mfma_f32_16x16x32_bf16 a[236:239], a[44:47], a[76:79], a[236:239]
 v_cvt_pk_bf16_f32 v81, v82, v83
 v_cvt_pk_bf16_f32 v82, v192, v193
 v_mfma_f32_16x16x32_bf16 a[232:235], a[40:43], a[76:79], a[232:235]
 buffer_load_dwordx4 v3, s[4:7], s64 offen offset:1024 sc1 lds
 v_add_u32 v6, s87, v6
 v_mfma_f32_16x16x32_bf16 a[228:231], a[36:39], a[76:79], a[228:231]
 v_add_u32_e64 v7, s87, v7
 v_cvt_pk_bf16_f32 v83, v194, v195
 v_mfma_f32_16x16x32_bf16 a[224:227], a[32:35], a[76:79], a[224:227]
 ds_read_b64_tr_b16 a[48:49], v22 offset:16384
 ds_read_b64_tr_b16 a[50:51], v22 offset:16896
 s_waitcnt lgkmcnt(2)
 v_mfma_f32_16x16x32_bf16 a[64:67], a[16:19], a[0:3], 0
 ds_read_b64_tr_b16 a[52:53], v22 offset:18432
 ds_read_b64_tr_b16 a[54:55], v22 offset:18944
 v_mfma_f32_16x16x32_bf16 a[68:71], a[16:19], a[4:7], 0
 buffer_load_dwordx4 v2, s[4:7], s65 offen offset:2048 sc1 lds
 ds_read_b64_tr_b16 a[56:57], v23 offset:16384
 ds_read_b64_tr_b16 a[58:59], v23 offset:16896
 v_mfma_f32_16x16x32_bf16 a[72:75], a[16:19], a[8:11], 0
 ds_read_b64_tr_b16 a[60:61], v23 offset:18432
 ds_read_b64_tr_b16 a[62:63], v23 offset:18944
 v_mfma_f32_16x16x32_bf16 a[76:79], a[16:19], a[12:15], 0
 ds_read_b64_tr_b16 a[16:17], v12 offset:0
 ds_read_b64_tr_b16 a[18:19], v12 offset:1024
 v_mfma_f32_16x16x32_bf16 a[92:95], a[20:23], a[12:15], 0
 v_cvt_pk_bf16_f32 v84, v84, v85
 v_cvt_pk_bf16_f32 v85, v86, v87
 v_mfma_f32_16x16x32_bf16 a[88:91], a[20:23], a[8:11], 0
 buffer_load_dwordx4 v3, s[4:7], s65 offen offset:3072 sc1 lds
 v_cvt_pk_bf16_f32 v86, v196, v197
 v_mfma_f32_16x16x32_bf16 a[84:87], a[20:23], a[4:7], 0
 v_cvt_pk_bf16_f32 v87, v198, v199
 v_cvt_pk_bf16_f32 v88, v88, v89
 v_mfma_f32_16x16x32_bf16 a[80:83], a[20:23], a[0:3], 0
 ds_read_b64_tr_b16 a[20:21], v13 offset:0
 ds_read_b64_tr_b16 a[22:23], v13 offset:1024
 v_mfma_f32_16x16x32_bf16 a[96:99], a[24:27], a[0:3], 0
 ds_read_b128 a[32:35], v11 offset:0
 s_add_u32 m0, s62, 32768
 v_mfma_f32_16x16x32_bf16 a[100:103], a[24:27], a[4:7], 0
 buffer_load_dwordx4 v4, s[8:11], s68 offen offset:0 lds
 v_cvt_pk_bf16_f32 v89, v90, v91
 v_mfma_f32_16x16x32_bf16 a[104:107], a[24:27], a[8:11], 0
 v_cvt_pk_bf16_f32 v90, v200, v201
 v_cvt_pk_bf16_f32 v91, v202, v203
 v_mfma_f32_16x16x32_bf16 a[108:111], a[24:27], a[12:15], 0
 ds_read_b64_tr_b16 a[24:25], v14 offset:0
 ds_read_b64_tr_b16 a[26:27], v14 offset:1024
 v_mfma_f32_16x16x32_bf16 a[124:127], a[28:31], a[12:15], 0
 v_cvt_pk_bf16_f32 v92, v92, v93
 v_cvt_pk_bf16_f32 v93, v94, v95
 v_mfma_f32_16x16x32_bf16 a[120:123], a[28:31], a[8:11], 0
 buffer_load_dwordx4 v4, s[8:11], s69 offen offset:1024 lds
 v_cvt_pk_bf16_f32 v94, v204, v205
 v_mfma_f32_16x16x32_bf16 a[116:119], a[28:31], a[4:7], 0
 v_cvt_pk_bf16_f32 v95, v206, v207
 v_cvt_pk_bf16_f32 v96, v96, v97
 v_mfma_f32_16x16x32_bf16 a[112:115], a[28:31], a[0:3], 0
 ds_read_b64_tr_b16 a[28:29], v15 offset:0
 ds_read_b64_tr_b16 a[30:31], v15 offset:1024
 s_waitcnt lgkmcnt(5)
 v_mfma_f32_16x16x32_bf16 a[128:131], a[48:51], a[0:3], 0
 v_cvt_pk_bf16_f32 v97, v98, v99
 v_cvt_pk_bf16_f32 v98, v208, v209
 v_mfma_f32_16x16x32_bf16 a[132:135], a[48:51], a[4:7], 0
 buffer_load_dwordx4 v5, s[8:11], s70 offen offset:2048 lds
 v_cvt_pk_bf16_f32 v99, v210, v211
 v_mfma_f32_16x16x32_bf16 a[136:139], a[48:51], a[8:11], 0
 ds_read_b128 a[36:39], v11 offset:2048
 v_cvt_pk_bf16_f32 v100, v100, v101
 v_mfma_f32_16x16x32_bf16 a[140:143], a[48:51], a[12:15], 0
 ds_read_b64_tr_b16 a[48:49], v16 offset:0
 ds_read_b64_tr_b16 a[50:51], v16 offset:1024
 v_mfma_f32_16x16x32_bf16 a[156:159], a[52:55], a[12:15], 0
 v_cvt_pk_bf16_f32 v101, v102, v103
 v_cvt_pk_bf16_f32 v102, v212, v213
 v_mfma_f32_16x16x32_bf16 a[152:155], a[52:55], a[8:11], 0
 buffer_load_dwordx4 v5, s[8:11], s71 offen offset:3072 lds
 v_add_u32_e64 v4, s86, v4
 v_mfma_f32_16x16x32_bf16 a[148:151], a[52:55], a[4:7], 0
 v_add_u32_e64 v5, s86, v5
 v_cvt_pk_bf16_f32 v103, v214, v215
 v_mfma_f32_16x16x32_bf16 a[144:147], a[52:55], a[0:3], 0
 ds_read_b64_tr_b16 a[52:53], v17 offset:0
 ds_read_b64_tr_b16 a[54:55], v17 offset:1024
 v_mfma_f32_16x16x32_bf16 a[160:163], a[56:59], a[0:3], 0
 s_add_u32 m0, s63, 36864
 v_cvt_pk_bf16_f32 v104, v104, v105
 v_mfma_f32_16x16x32_bf16 a[164:167], a[56:59], a[4:7], 0
 buffer_load_dwordx4 v2, s[4:7], s66 offen offset:0 sc1 lds
 v_cvt_pk_bf16_f32 v105, v106, v107
 v_mfma_f32_16x16x32_bf16 a[168:171], a[56:59], a[8:11], 0
 v_cvt_pk_bf16_f32 v106, v216, v217
 v_cvt_pk_bf16_f32 v107, v218, v219
 v_mfma_f32_16x16x32_bf16 a[172:175], a[56:59], a[12:15], 0
 ds_read_b64_tr_b16 a[56:57], v18 offset:0
 ds_read_b64_tr_b16 a[58:59], v18 offset:1024
 v_mfma_f32_16x16x32_bf16 a[188:191], a[60:63], a[12:15], 0
 ds_read_b128 a[40:43], v11 offset:4096
 v_cvt_pk_bf16_f32 v108, v108, v109
 v_mfma_f32_16x16x32_bf16 a[184:187], a[60:63], a[8:11], 0
 buffer_load_dwordx4 v3, s[4:7], s66 offen offset:1024 sc1 lds
 v_cvt_pk_bf16_f32 v109, v110, v111
 v_mfma_f32_16x16x32_bf16 a[180:183], a[60:63], a[4:7], 0
 v_cvt_pk_bf16_f32 v110, v220, v221
 v_cvt_pk_bf16_f32 v111, v222, v223
 v_mfma_f32_16x16x32_bf16 a[176:179], a[60:63], a[0:3], 0
 ds_read_b64_tr_b16 a[60:61], v19 offset:0
 ds_read_b64_tr_b16 a[62:63], v19 offset:1024
 v_mfma_f32_16x16x32_bf16 a[192:195], a[16:19], a[0:3], 0
 v_cvt_pk_bf16_f32 v112, v112, v113
 v_cvt_pk_bf16_f32 v113, v114, v115
 v_mfma_f32_16x16x32_bf16 a[196:199], a[16:19], a[4:7], 0
 buffer_load_dwordx4 v2, s[4:7], s67 offen offset:2048 sc1 lds
 v_cvt_pk_bf16_f32 v114, v224, v225
 v_mfma_f32_16x16x32_bf16 a[200:203], a[16:19], a[8:11], 0
 v_cvt_pk_bf16_f32 v115, v226, v227
 v_cvt_pk_bf16_f32 v116, v116, v117
 v_mfma_f32_16x16x32_bf16 a[204:207], a[16:19], a[12:15], 0
 ds_read_b64_tr_b16 a[16:17], v20 offset:24576
 ds_read_b64_tr_b16 a[18:19], v20 offset:25088
 v_mfma_f32_16x16x32_bf16 a[220:223], a[20:23], a[12:15], 0
 v_cvt_pk_bf16_f32 v117, v118, v119
 v_cvt_pk_bf16_f32 v118, v228, v229
 v_mfma_f32_16x16x32_bf16 a[216:219], a[20:23], a[8:11], 0
 buffer_load_dwordx4 v3, s[4:7], s67 offen offset:3072 sc1 lds
 v_lshl_add_u32 v2, s85, 7, v2
 v_mfma_f32_16x16x32_bf16 a[212:215], a[20:23], a[4:7], 0
 ds_read_b128 a[44:47], v11 offset:6144
 v_lshl_add_u32 v3, s85, 7, v3
 v_mfma_f32_16x16x32_bf16 a[208:211], a[20:23], a[0:3], 0
 ds_read_b64_tr_b16 a[20:21], v20 offset:26624
 ds_read_b64_tr_b16 a[22:23], v20 offset:27136
 s_waitcnt lgkmcnt(5)
 v_mfma_f32_16x16x32_bf16 v[160:163], a[24:27], a[0:3], 0
 v_cvt_pk_bf16_f32 v119, v230, v231
 v_cvt_pk_bf16_f32 v120, v120, v121
 v_mfma_f32_16x16x32_bf16 v[164:167], a[24:27], a[4:7], 0
 v_cvt_pk_bf16_f32 v121, v122, v123
 v_cvt_pk_bf16_f32 v122, v232, v233
 v_mfma_f32_16x16x32_bf16 v[168:171], a[24:27], a[8:11], 0
 v_cvt_pk_bf16_f32 v123, v234, v235
 v_cvt_pk_bf16_f32 v124, v124, v125
 s_mov_b32 s78, 0
 buffer_store_dwordx4 v[32:35], v24, s[20:23], s78 offen offset:0 sc1
 v_mfma_f32_16x16x32_bf16 v[172:175], a[24:27], a[12:15], 0
 v_cvt_pk_bf16_f32 v125, v126, v127
 v_cvt_pk_bf16_f32 v126, v236, v237
 v_mfma_f32_16x16x32_bf16 v[188:191], a[28:31], a[12:15], 0
 v_cvt_pk_bf16_f32 v127, v238, v239
 v_cvt_pk_bf16_f32 v128, v128, v129
 v_mfma_f32_16x16x32_bf16 v[184:187], a[28:31], a[8:11], 0
 v_cvt_pk_bf16_f32 v129, v130, v131
 v_cvt_pk_bf16_f32 v130, v240, v241
 v_mfma_f32_16x16x32_bf16 v[180:183], a[28:31], a[4:7], 0
 ds_read_b64_tr_b16 a[24:25], v21 offset:24576
 ds_read_b64_tr_b16 a[26:27], v21 offset:25088
 v_mfma_f32_16x16x32_bf16 v[176:179], a[28:31], a[0:3], 0
 ds_read_b64_tr_b16 a[28:29], v21 offset:26624
 ds_read_b64_tr_b16 a[30:31], v21 offset:27136
 v_mfma_f32_16x16x32_bf16 v[192:195], a[48:51], a[0:3], 0
 v_cvt_pk_bf16_f32 v131, v242, v243
 v_cvt_pk_bf16_f32 v132, v132, v133
 v_mfma_f32_16x16x32_bf16 v[196:199], a[48:51], a[4:7], 0
 v_cvt_pk_bf16_f32 v133, v134, v135
 v_cvt_pk_bf16_f32 v134, v244, v245
 v_mfma_f32_16x16x32_bf16 v[200:203], a[48:51], a[8:11], 0
 v_cvt_pk_bf16_f32 v135, v246, v247
 v_cvt_pk_bf16_f32 v136, v136, v137
 v_mfma_f32_16x16x32_bf16 v[204:207], a[48:51], a[12:15], 0
 ds_read_b64_tr_b16 a[48:49], v22 offset:24576
 ds_read_b64_tr_b16 a[50:51], v22 offset:25088
 v_mfma_f32_16x16x32_bf16 v[220:223], a[52:55], a[12:15], 0
 v_cvt_pk_bf16_f32 v137, v138, v139
 v_cvt_pk_bf16_f32 v138, v248, v249
 v_mfma_f32_16x16x32_bf16 v[216:219], a[52:55], a[8:11], 0
 v_cvt_pk_bf16_f32 v139, v250, v251
 v_cvt_pk_bf16_f32 v140, v140, v141
 v_mfma_f32_16x16x32_bf16 v[212:215], a[52:55], a[4:7], 0
 v_cvt_pk_bf16_f32 v141, v142, v143
 v_cvt_pk_bf16_f32 v142, v252, v253
 v_mfma_f32_16x16x32_bf16 v[208:211], a[52:55], a[0:3], 0
 ds_read_b64_tr_b16 a[52:53], v22 offset:26624
 ds_read_b64_tr_b16 a[54:55], v22 offset:27136
 v_mfma_f32_16x16x32_bf16 v[224:227], a[56:59], a[0:3], 0
 v_cvt_pk_bf16_f32 v143, v254, v255
 v_accvgpr_read_b32 v29, a224
 v_mfma_f32_16x16x32_bf16 v[228:231], a[56:59], a[4:7], 0
 v_accvgpr_read_b32 v30, a225
 v_cvt_pk_bf16_f32 v144, v29, v30
 buffer_store_dwordx4 v[64:67], v24, s[20:23], s78 offen offset:1024 sc1
 v_mfma_f32_16x16x32_bf16 v[232:235], a[56:59], a[8:11], 0
 v_accvgpr_read_b32 v29, a226
 v_accvgpr_read_b32 v30, a227
 v_mfma_f32_16x16x32_bf16 v[236:239], a[56:59], a[12:15], 0
 v_cvt_pk_bf16_f32 v145, v29, v30
 v_accvgpr_read_b32 v29, a228
 v_mfma_f32_16x16x32_bf16 v[252:255], a[60:63], a[12:15], 0
 v_accvgpr_read_b32 v30, a229
 v_cvt_pk_bf16_f32 v146, v29, v30
 v_mfma_f32_16x16x32_bf16 v[248:251], a[60:63], a[8:11], 0
 ds_read_b64_tr_b16 a[56:57], v23 offset:24576
 ds_read_b64_tr_b16 a[58:59], v23 offset:25088
 v_mfma_f32_16x16x32_bf16 v[244:247], a[60:63], a[4:7], 0
 v_accvgpr_read_b32 v29, a230
 v_accvgpr_read_b32 v30, a231
 v_mfma_f32_16x16x32_bf16 v[240:243], a[60:63], a[0:3], 0
 ds_read_b64_tr_b16 a[60:61], v23 offset:26624
 ds_read_b64_tr_b16 a[62:63], v23 offset:27136
 s_waitcnt lgkmcnt(4)
 v_mfma_f32_16x16x32_bf16 a[64:67], a[16:19], a[32:35], a[64:67]
 v_cvt_pk_bf16_f32 v147, v29, v30
 v_accvgpr_read_b32 v29, a232
 v_mfma_f32_16x16x32_bf16 a[68:71], a[16:19], a[36:39], a[68:71]
 v_accvgpr_read_b32 v30, a233
 v_cvt_pk_bf16_f32 v148, v29, v30
 v_mfma_f32_16x16x32_bf16 a[72:75], a[16:19], a[40:43], a[72:75]
 v_accvgpr_read_b32 v29, a234
 v_accvgpr_read_b32 v30, a235
 v_mfma_f32_16x16x32_bf16 a[76:79], a[16:19], a[44:47], a[76:79]
 ds_read_b64_tr_b16 a[16:17], v12 offset:8192
 ds_read_b64_tr_b16 a[18:19], v12 offset:9216
L_pg5:
 s_cbranch_execz L_pg9
 v_mfma_f32_16x16x32_bf16 a[92:95], a[20:23], a[44:47], a[92:95]
 v_cvt_pk_bf16_f32 v149, v29, v30
 v_accvgpr_read_b32 v29, a236
 v_mfma_f32_16x16x32_bf16 a[88:91], a[20:23], a[40:43], a[88:91]
 v_accvgpr_read_b32 v30, a237
 v_cvt_pk_bf16_f32 v150, v29, v30
 v_mfma_f32_16x16x32_bf16 a[84:87], a[20:23], a[36:39], a[84:87]
 v_accvgpr_read_b32 v29, a238
 v_accvgpr_read_b32 v30, a239
 v_mfma_f32_16x16x32_bf16 a[80:83], a[20:23], a[32:35], a[80:83]
 ds_read_b64_tr_b16 a[20:21], v13 offset:8192
 ds_read_b64_tr_b16 a[22:23], v13 offset:9216
 v_mfma_f32_16x16x32_bf16 a[96:99], a[24:27], a[32:35], a[96:99]
 v_cvt_pk_bf16_f32 v151, v29, v30
 v_accvgpr_read_b32 v29, a240
 s_mov_b32 s78, 4096
 buffer_store_dwordx4 v[36:39], v24, s[20:23], s78 offen offset:0 sc1
 v_mfma_f32_16x16x32_bf16 a[100:103], a[24:27], a[36:39], a[100:103]
 v_accvgpr_read_b32 v30, a241
 v_cvt_pk_bf16_f32 v152, v29, v30
 v_mfma_f32_16x16x32_bf16 a[104:107], a[24:27], a[40:43], a[104:107]
 v_accvgpr_read_b32 v29, a242
 v_accvgpr_read_b32 v30, a243
 v_mfma_f32_16x16x32_bf16 a[108:111], a[24:27], a[44:47], a[108:111]
 v_cvt_pk_bf16_f32 v153, v29, v30
 v_accvgpr_read_b32 v29, a244
 v_mfma_f32_16x16x32_bf16 a[124:127], a[28:31], a[44:47], a[124:127]
 ds_read_b64_tr_b16 a[24:25], v14 offset:8192
 ds_read_b64_tr_b16 a[26:27], v14 offset:9216
 v_mfma_f32_16x16x32_bf16 a[120:123], a[28:31], a[40:43], a[120:123]
 v_accvgpr_read_b32 v30, a245
 v_cvt_pk_bf16_f32 v154, v29, v30
 v_mfma_f32_16x16x32_bf16 a[116:119], a[28:31], a[36:39], a[116:119]
 v_accvgpr_read_b32 v29, a246
 v_accvgpr_read_b32 v30, a247
 v_mfma_f32_16x16x32_bf16 a[112:115], a[28:31], a[32:35], a[112:115]
 ds_read_b64_tr_b16 a[28:29], v15 offset:8192
 ds_read_b64_tr_b16 a[30:31], v15 offset:9216
 v_mfma_f32_16x16x32_bf16 a[128:131], a[48:51], a[32:35], a[128:131]
 v_cvt_pk_bf16_f32 v155, v29, v30
 v_accvgpr_read_b32 v29, a248
 v_mfma_f32_16x16x32_bf16 a[132:135], a[48:51], a[36:39], a[132:135]
 v_accvgpr_read_b32 v30, a249
 v_cvt_pk_bf16_f32 v156, v29, v30
 v_mfma_f32_16x16x32_bf16 a[136:139], a[48:51], a[40:43], a[136:139]
 v_accvgpr_read_b32 v29, a250
 v_accvgpr_read_b32 v30, a251
 v_mfma_f32_16x16x32_bf16 a[140:143], a[48:51], a[44:47], a[140:143]
 ds_read_b64_tr_b16 a[48:49], v16 offset:8192
 ds_read_b64_tr_b16 a[50:51], v16 offset:9216
 v_mfma_f32_16x16x32_bf16 a[156:159], a[52:55], a[44:47], a[156:159]
 v_cvt_pk_bf16_f32 v157, v29, v30
 v_accvgpr_read_b32 v29, a252
 v_mfma_f32_16x16x32_bf16 a[152:155], a[52:55], a[40:43], a[152:155]
 v_accvgpr_read_b32 v30, a253
 v_cvt_pk_bf16_f32 v158, v29, v30
 v_mfma_f32_16x16x32_bf16 a[148:151], a[52:55], a[36:39], a[148:151]
 v_accvgpr_read_b32 v29, a254
 v_accvgpr_read_b32 v30, a255
 v_mfma_f32_16x16x32_bf16 a[144:147], a[52:55], a[32:35], a[144:147]
 v_cvt_pk_bf16_f32 v159, v29, v30
 buffer_store_dwordx4 v[68:71], v24, s[20:23], s78 offen offset:1024 sc1
 s_waitcnt lgkmcnt(2)
 v_mfma_f32_16x16x32_bf16 a[160:163], a[56:59], a[32:35], a[160:163]
 v_mfma_f32_16x16x32_bf16 a[164:167], a[56:59], a[36:39], a[164:167]
 v_mfma_f32_16x16x32_bf16 a[168:171], a[56:59], a[40:43], a[168:171]
 v_mfma_f32_16x16x32_bf16 a[172:175], a[56:59], a[44:47], a[172:175]
 ds_read_b64_tr_b16 a[52:53], v17 offset:8192
 ds_read_b64_tr_b16 a[54:55], v17 offset:9216
 v_mfma_f32_16x16x32_bf16 a[188:191], a[60:63], a[44:47], a[188:191]
 ds_read_b64_tr_b16 a[56:57], v18 offset:8192
 ds_read_b64_tr_b16 a[58:59], v18 offset:9216
 v_mfma_f32_16x16x32_bf16 a[184:187], a[60:63], a[40:43], a[184:187]
 v_mfma_f32_16x16x32_bf16 a[180:183], a[60:63], a[36:39], a[180:183]
 v_mfma_f32_16x16x32_bf16 a[176:179], a[60:63], a[32:35], a[176:179]
 ds_read_b64_tr_b16 a[60:61], v19 offset:8192
 ds_read_b64_tr_b16 a[62:63], v19 offset:9216
 v_mfma_f32_16x16x32_bf16 a[192:195], a[16:19], a[32:35], a[192:195]
 v_mfma_f32_16x16x32_bf16 a[196:199], a[16:19], a[36:39], a[196:199]
 v_mfma_f32_16x16x32_bf16 a[200:203], a[16:19], a[40:43], a[200:203]
 v_mfma_f32_16x16x32_bf16 a[204:207], a[16:19], a[44:47], a[204:207]
 v_mfma_f32_16x16x32_bf16 a[220:223], a[20:23], a[44:47], a[220:223]
 v_mfma_f32_16x16x32_bf16 a[216:219], a[20:23], a[40:43], a[216:219]
 v_mfma_f32_16x16x32_bf16 a[212:215], a[20:23], a[36:39], a[212:215]
 v_mfma_f32_16x16x32_bf16 a[208:211], a[20:23], a[32:35], a[208:211]
 s_waitcnt vmcnt(4)
 s_waitcnt lgkmcnt(0)
 s_barrier
 v_mfma_f32_16x16x32_bf16 v[160:163], a[24:27], a[32:35], v[160:163]
 ds_read_b64_tr_b16 a[16:17], v20 offset:49152
 ds_read_b64_tr_b16 a[18:19], v20 offset:49664
 s_add_u32 m0, s62, 16384
 v_mfma_f32_16x16x32_bf16 v[164:167], a[24:27], a[36:39], v[164:167]
 buffer_load_dwordx4 v6, s[12:15], s72 offen offset:0 lds
 ds_read_b64_tr_b16 a[20:21], v20 offset:51200
 ds_read_b64_tr_b16 a[22:23], v20 offset:51712
 v_mfma_f32_16x16x32_bf16 v[168:171], a[24:27], a[40:43], v[168:171]
 ds_read_b128 a[0:3], v10 offset:32768
 ds_read_b128 a[4:7], v10 offset:34816
 v_mfma_f32_16x16x32_bf16 v[172:175], a[24:27], a[44:47], v[172:175]
 ds_read_b64_tr_b16 a[24:25], v21 offset:49152
 ds_read_b64_tr_b16 a[26:27], v21 offset:49664
 v_mfma_f32_16x16x32_bf16 v[188:191], a[28:31], a[44:47], v[188:191]
 ds_read_b128 a[8:11], v10 offset:36864
 v_mfma_f32_16x16x32_bf16 v[184:187], a[28:31], a[40:43], v[184:187]
 buffer_load_dwordx4 v7, s[12:15], s73 offen offset:1024 lds
 v_mfma_f32_16x16x32_bf16 v[180:183], a[28:31], a[36:39], v[180:183]
 ds_read_b128 a[12:15], v10 offset:38912
 v_mfma_f32_16x16x32_bf16 v[176:179], a[28:31], a[32:35], v[176:179]
 ds_read_b64_tr_b16 a[28:29], v21 offset:51200
 ds_read_b64_tr_b16 a[30:31], v21 offset:51712
 v_mfma_f32_16x16x32_bf16 v[192:195], a[48:51], a[32:35], v[192:195]
 s_add_u32 s84, s84, 1
 s_cmp_eq_u32 s84, 10
 s_cselect_b32 s85, -9, 1
 s_cmov_b32 s84, 0
 s_add_u32 m0, s62, 18432
 v_mfma_f32_16x16x32_bf16 v[196:199], a[48:51], a[36:39], v[196:199]
 buffer_load_dwordx4 v6, s[16:19], s72 offen offset:0 lds
 s_lshl_b32 s86, s85, 19
 s_mul_i32 s87, s85, 221184
 v_mfma_f32_16x16x32_bf16 v[200:203], a[48:51], a[40:43], v[200:203]
 v_mfma_f32_16x16x32_bf16 v[204:207], a[48:51], a[44:47], v[204:207]
 ds_read_b64_tr_b16 a[48:49], v22 offset:49152
 ds_read_b64_tr_b16 a[50:51], v22 offset:49664
 v_mfma_f32_16x16x32_bf16 v[220:223], a[52:55], a[44:47], v[220:223]
 v_mfma_f32_16x16x32_bf16 v[216:219], a[52:55], a[40:43], v[216:219]
 buffer_load_dwordx4 v7, s[16:19], s73 offen offset:1024 lds
 v_mfma_f32_16x16x32_bf16 v[212:215], a[52:55], a[36:39], v[212:215]
 v_mfma_f32_16x16x32_bf16 v[208:211], a[52:55], a[32:35], v[208:211]
 ds_read_b64_tr_b16 a[52:53], v22 offset:51200
 ds_read_b64_tr_b16 a[54:55], v22 offset:51712
 v_mfma_f32_16x16x32_bf16 v[224:227], a[56:59], a[32:35], v[224:227]
 s_add_u32 m0, s63, 0
 v_mfma_f32_16x16x32_bf16 v[228:231], a[56:59], a[36:39], v[228:231]
 buffer_load_dwordx4 v2, s[4:7], s64 offen offset:0 sc1 lds
 v_mfma_f32_16x16x32_bf16 v[232:235], a[56:59], a[40:43], v[232:235]
 v_mfma_f32_16x16x32_bf16 v[236:239], a[56:59], a[44:47], v[236:239]
 ds_read_b64_tr_b16 a[56:57], v23 offset:49152
 ds_read_b64_tr_b16 a[58:59], v23 offset:49664
 v_mfma_f32_16x16x32_bf16 v[252:255], a[60:63], a[44:47], v[252:255]
 v_mfma_f32_16x16x32_bf16 v[248:251], a[60:63], a[40:43], v[248:251]
 buffer_load_dwordx4 v3, s[4:7], s64 offen offset:1024 sc1 lds
 v_add_u32_e64 v6, s87, v6
 v_mfma_f32_16x16x32_bf16 v[244:247], a[60:63], a[36:39], v[244:247]
 v_add_u32_e64 v7, s87, v7
 v_mfma_f32_16x16x32_bf16 v[240:243], a[60:63], a[32:35], v[240:243]
 ds_read_b64_tr_b16 a[60:61], v23 offset:51200
 ds_read_b64_tr_b16 a[62:63], v23 offset:51712
 s_waitcnt lgkmcnt(4)
 v_mfma_f32_16x16x32_bf16 a[64:67], a[16:19], a[0:3], a[64:67]
 v_mfma_f32_16x16x32_bf16 a[68:71], a[16:19], a[4:7], a[68:71]
 buffer_load_dwordx4 v2, s[4:7], s65 offen offset:2048 sc1 lds
 v_mfma_f32_16x16x32_bf16 a[72:75], a[16:19], a[8:11], a[72:75]
 s_lshl_b32 s77, s2, 2
 s_add_u32 s77, s77, s58
 v_mfma_f32_16x16x32_bf16 a[76:79], a[16:19], a[12:15], a[76:79]
 ds_read_b64_tr_b16 a[16:17], v12 offset:32768
 ds_read_b64_tr_b16 a[18:19], v12 offset:33792
 v_mfma_f32_16x16x32_bf16 a[92:95], a[20:23], a[12:15], a[92:95]
 s_lshl_b32 s75, s77, 13
 s_add_u32 s75, s75, 0x3c00000
 v_mfma_f32_16x16x32_bf16 a[88:91], a[20:23], a[8:11], a[88:91]
 buffer_load_dwordx4 v3, s[4:7], s65 offen offset:3072 sc1 lds
 v_mfma_f32_16x16x32_bf16 a[84:87], a[20:23], a[4:7], a[84:87]
 s_cmp_lt_u32 s77, 910
 s_cselect_b32 s76, 8192, 0
 v_mfma_f32_16x16x32_bf16 a[80:83], a[20:23], a[0:3], a[80:83]
 ds_read_b64_tr_b16 a[20:21], v13 offset:32768
 ds_read_b64_tr_b16 a[22:23], v13 offset:33792
 v_mfma_f32_16x16x32_bf16 a[96:99], a[24:27], a[0:3], a[96:99]
 ds_read_b128 a[32:35], v11 offset:32768
 s_add_u32 m0, s62, 0
 v_mfma_f32_16x16x32_bf16 a[100:103], a[24:27], a[4:7], a[100:103]
 buffer_load_dwordx4 v4, s[8:11], s68 offen offset:0 lds
 v_mfma_f32_16x16x32_bf16 a[104:107], a[24:27], a[8:11], a[104:107]
 s_add_u32 s80, s56, s75
 s_addc_u32 s81, s57, 0
 v_mfma_f32_16x16x32_bf16 a[108:111], a[24:27], a[12:15], a[108:111]
 ds_read_b64_tr_b16 a[24:25], v14 offset:32768
 ds_read_b64_tr_b16 a[26:27], v14 offset:33792
 v_mfma_f32_16x16x32_bf16 a[124:127], a[28:31], a[12:15], a[124:127]
 s_mov_b32 s82, s76
 s_mov_b32 s83, 0x00020000
 v_mfma_f32_16x16x32_bf16 a[120:123], a[28:31], a[8:11], a[120:123]
 buffer_load_dwordx4 v4, s[8:11], s69 offen offset:1024 lds
 v_lshrrev_b32_e64 v8, 2, v1
 v_mfma_f32_16x16x32_bf16 a[116:119], a[28:31], a[4:7], a[116:119]
 v_lshlrev_b32 v8, 8, v8
 v_and_b32 v9, 31, v1
 v_mfma_f32_16x16x32_bf16 a[112:115], a[28:31], a[0:3], a[112:115]
 ds_read_b64_tr_b16 a[28:29], v15 offset:32768
 ds_read_b64_tr_b16 a[30:31], v15 offset:33792
 v_mfma_f32_16x16x32_bf16 a[128:131], a[48:51], a[0:3], a[128:131]
 v_lshl_add_u32 v8, v9, 3, v8
 s_add_u32 s3, s63, 0x10000
 v_mfma_f32_16x16x32_bf16 a[132:135], a[48:51], a[4:7], a[132:135]
 buffer_load_dwordx4 v5, s[8:11], s70 offen offset:2048 lds
 v_add_u32_e64 v8, s3, v8
 v_mfma_f32_16x16x32_bf16 a[136:139], a[48:51], a[8:11], a[136:139]
 ds_read_b128 a[36:39], v11 offset:34816
 v_lshlrev_b32_e64 v9, 4, v1
 v_mfma_f32_16x16x32_bf16 a[140:143], a[48:51], a[12:15], a[140:143]
 ds_read_b64_tr_b16 a[48:49], v16 offset:32768
 ds_read_b64_tr_b16 a[50:51], v16 offset:33792
 v_mfma_f32_16x16x32_bf16 a[156:159], a[52:55], a[12:15], a[156:159]
 s_movk_i32 s75, 4096
 ds_read_b64_tr_b16 a[224:225], v8 offset:0
 v_mfma_f32_16x16x32_bf16 a[152:155], a[52:55], a[8:11], a[152:155]
 buffer_load_dwordx4 v5, s[8:11], s71 offen offset:3072 lds
 v_add_u32 v4, s86, v4
 v_mfma_f32_16x16x32_bf16 a[148:151], a[52:55], a[4:7], a[148:151]
 v_add_u32_e64 v5, s86, v5
 ds_read_b64_tr_b16 a[226:227], v8 offset:4096
 v_mfma_f32_16x16x32_bf16 a[144:147], a[52:55], a[0:3], a[144:147]
 ds_read_b64_tr_b16 a[52:53], v17 offset:32768
 ds_read_b64_tr_b16 a[54:55], v17 offset:33792
 s_waitcnt lgkmcnt(7)
 v_mfma_f32_16x16x32_bf16 a[160:163], a[56:59], a[0:3], a[160:163]
 s_add_u32 m0, s63, 4096
 v_xor_b32 v8, 32, v8
 v_mfma_f32_16x16x32_bf16 a[164:167], a[56:59], a[4:7], a[164:167]
 buffer_load_dwordx4 v2, s[4:7], s66 offen offset:0 sc1 lds
 ds_read_b64_tr_b16 a[228:229], v8 offset:0
 v_mfma_f32_16x16x32_bf16 a[168:171], a[56:59], a[8:11], a[168:171]
 ds_read_b64_tr_b16 a[230:231], v8 offset:4096
 v_xor_b32 v8, 96, v8
 v_mfma_f32_16x16x32_bf16 a[172:175], a[56:59], a[12:15], a[172:175]
 ds_read_b64_tr_b16 a[56:57], v18 offset:32768
 ds_read_b64_tr_b16 a[58:59], v18 offset:33792
 v_mfma_f32_16x16x32_bf16 a[188:191], a[60:63], a[12:15], a[188:191]
 ds_read_b128 a[40:43], v11 offset:36864
 ds_read_b64_tr_b16 a[232:233], v8 offset:0
 v_mfma_f32_16x16x32_bf16 a[184:187], a[60:63], a[8:11], a[184:187]
 buffer_load_dwordx4 v3, s[4:7], s66 offen offset:1024 sc1 lds
 ds_read_b64_tr_b16 a[234:235], v8 offset:4096
 v_mfma_f32_16x16x32_bf16 a[180:183], a[60:63], a[4:7], a[180:183]
 v_xor_b32_e64 v8, 32, v8
 ds_read_b64_tr_b16 a[236:237], v8 offset:0
 v_mfma_f32_16x16x32_bf16 a[176:179], a[60:63], a[0:3], a[176:179]
 ds_read_b64_tr_b16 a[60:61], v19 offset:32768
 ds_read_b64_tr_b16 a[62:63], v19 offset:33792
 v_mfma_f32_16x16x32_bf16 a[192:195], a[16:19], a[0:3], a[192:195]
 ds_read_b64_tr_b16 a[238:239], v8 offset:4096
 v_xor_b32 v8, 224, v8
 v_mfma_f32_16x16x32_bf16 a[196:199], a[16:19], a[4:7], a[196:199]
 buffer_load_dwordx4 v2, s[4:7], s67 offen offset:2048 sc1 lds
 ds_read_b64_tr_b16 a[240:241], v8 offset:0
 v_mfma_f32_16x16x32_bf16 a[200:203], a[16:19], a[8:11], a[200:203]
 ds_read_b64_tr_b16 a[242:243], v8 offset:4096
 v_xor_b32_e64 v8, 32, v8
 v_mfma_f32_16x16x32_bf16 a[204:207], a[16:19], a[12:15], a[204:207]
 ds_read_b64_tr_b16 a[16:17], v20 offset:57344
 ds_read_b64_tr_b16 a[18:19], v20 offset:57856
 v_mfma_f32_16x16x32_bf16 a[220:223], a[20:23], a[12:15], a[220:223]
 ds_read_b64_tr_b16 a[244:245], v8 offset:0
 ds_read_b64_tr_b16 a[246:247], v8 offset:4096
 v_mfma_f32_16x16x32_bf16 a[216:219], a[20:23], a[8:11], a[216:219]
 buffer_load_dwordx4 v3, s[4:7], s67 offen offset:3072 sc1 lds
 v_lshl_add_u32 v2, s85, 7, v2
 v_mfma_f32_16x16x32_bf16 a[212:215], a[20:23], a[4:7], a[212:215]
 ds_read_b128 a[44:47], v11 offset:38912
 v_lshl_add_u32 v3, s85, 7, v3
 v_mfma_f32_16x16x32_bf16 a[208:211], a[20:23], a[0:3], a[208:211]
 ds_read_b64_tr_b16 a[20:21], v20 offset:59392
 ds_read_b64_tr_b16 a[22:23], v20 offset:59904
 v_mfma_f32_16x16x32_bf16 v[160:163], a[24:27], a[0:3], v[160:163]
 v_xor_b32 v8, 96, v8
 ds_read_b64_tr_b16 a[248:249], v8 offset:0
 v_mfma_f32_16x16x32_bf16 v[164:167], a[24:27], a[4:7], v[164:167]
 ds_read_b64_tr_b16 a[250:251], v8 offset:4096
 v_xor_b32_e64 v8, 32, v8
 v_mfma_f32_16x16x32_bf16 v[168:171], a[24:27], a[8:11], v[168:171]
 ds_read_b64_tr_b16 a[252:253], v8 offset:0
 ds_read_b64_tr_b16 a[254:255], v8 offset:4096
 s_mov_b32 s78, 8192
 buffer_store_dwordx4 v[40:43], v24, s[20:23], s78 offen offset:0 sc1
 v_mfma_f32_16x16x32_bf16 v[172:175], a[24:27], a[12:15], v[172:175]
 v_mfma_f32_16x16x32_bf16 v[188:191], a[28:31], a[12:15], v[188:191]
 v_mfma_f32_16x16x32_bf16 v[184:187], a[28:31], a[8:11], v[184:187]
 v_mfma_f32_16x16x32_bf16 v[180:183], a[28:31], a[4:7], v[180:183]
 ds_read_b64_tr_b16 a[24:25], v21 offset:57344
 ds_read_b64_tr_b16 a[26:27], v21 offset:57856
 v_mfma_f32_16x16x32_bf16 v[176:179], a[28:31], a[0:3], v[176:179]
 ds_read_b64_tr_b16 a[28:29], v21 offset:59392
 ds_read_b64_tr_b16 a[30:31], v21 offset:59904
 s_waitcnt lgkmcnt(8)
 v_mfma_f32_16x16x32_bf16 v[192:195], a[48:51], a[0:3], v[192:195]
 v_mfma_f32_16x16x32_bf16 v[196:199], a[48:51], a[4:7], v[196:199]
 v_mfma_f32_16x16x32_bf16 v[200:203], a[48:51], a[8:11], v[200:203]
 v_mfma_f32_16x16x32_bf16 v[204:207], a[48:51], a[12:15], v[204:207]
 ds_read_b64_tr_b16 a[48:49], v22 offset:57344
 ds_read_b64_tr_b16 a[50:51], v22 offset:57856
 v_mfma_f32_16x16x32_bf16 v[220:223], a[52:55], a[12:15], v[220:223]
 v_mfma_f32_16x16x32_bf16 v[216:219], a[52:55], a[8:11], v[216:219]
 v_mfma_f32_16x16x32_bf16 v[212:215], a[52:55], a[4:7], v[212:215]
 buffer_store_dwordx4 v[72:75], v24, s[20:23], s78 offen offset:1024 sc1
 v_mfma_f32_16x16x32_bf16 v[208:211], a[52:55], a[0:3], v[208:211]
 v_mfma_f32_16x16x32_bf16 v[224:227], a[56:59], a[0:3], v[224:227]
 v_mfma_f32_16x16x32_bf16 v[228:231], a[56:59], a[4:7], v[228:231]
 v_mfma_f32_16x16x32_bf16 v[232:235], a[56:59], a[8:11], v[232:235]
 ds_read_b64_tr_b16 a[52:53], v22 offset:59392
 ds_read_b64_tr_b16 a[54:55], v22 offset:59904
 v_mfma_f32_16x16x32_bf16 v[236:239], a[56:59], a[12:15], v[236:239]
 ds_read_b64_tr_b16 a[56:57], v23 offset:57344
 ds_read_b64_tr_b16 a[58:59], v23 offset:57856
 v_mfma_f32_16x16x32_bf16 v[252:255], a[60:63], a[12:15], v[252:255]
 v_mfma_f32_16x16x32_bf16 v[248:251], a[60:63], a[8:11], v[248:251]
 v_mfma_f32_16x16x32_bf16 v[244:247], a[60:63], a[4:7], v[244:247]
 v_mfma_f32_16x16x32_bf16 v[240:243], a[60:63], a[0:3], v[240:243]
 ds_read_b64_tr_b16 a[60:61], v23 offset:59392
 ds_read_b64_tr_b16 a[62:63], v23 offset:59904
 v_mfma_f32_16x16x32_bf16 a[64:67], a[16:19], a[32:35], a[64:67]
 v_mfma_f32_16x16x32_bf16 a[68:71], a[16:19], a[36:39], a[68:71]
 v_mfma_f32_16x16x32_bf16 a[72:75], a[16:19], a[40:43], a[72:75]
 s_mov_b32 s78, 12288
 buffer_store_dwordx4 v[44:47], v24, s[20:23], s78 offen offset:0 sc1
 v_mfma_f32_16x16x32_bf16 a[76:79], a[16:19], a[44:47], a[76:79]
 v_mfma_f32_16x16x32_bf16 a[92:95], a[20:23], a[44:47], a[92:95]
 v_mfma_f32_16x16x32_bf16 a[88:91], a[20:23], a[40:43], a[88:91]
 v_mfma_f32_16x16x32_bf16 a[84:87], a[20:23], a[36:39], a[84:87]
 ds_read_b64_tr_b16 a[16:17], v12 offset:40960
 ds_read_b64_tr_b16 a[18:19], v12 offset:41984
 v_mfma_f32_16x16x32_bf16 a[80:83], a[20:23], a[32:35], a[80:83]
 ds_read_b64_tr_b16 a[20:21], v13 offset:40960
 ds_read_b64_tr_b16 a[22:23], v13 offset:41984
 s_waitcnt lgkmcnt(4)
 v_mfma_f32_16x16x32_bf16 a[96:99], a[24:27], a[32:35], a[96:99]
 v_mfma_f32_16x16x32_bf16 a[100:103], a[24:27], a[36:39], a[100:103]
 v_mfma_f32_16x16x32_bf16 a[104:107], a[24:27], a[40:43], a[104:107]
 v_mfma_f32_16x16x32_bf16 a[108:111], a[24:27], a[44:47], a[108:111]
 ds_read_b64_tr_b16 a[24:25], v14 offset:40960
 ds_read_b64_tr_b16 a[26:27], v14 offset:41984
 v_mfma_f32_16x16x32_bf16 a[124:127], a[28:31], a[44:47], a[124:127]
 v_mfma_f32_16x16x32_bf16 a[120:123], a[28:31], a[40:43], a[120:123]
 v_mfma_f32_16x16x32_bf16 a[116:119], a[28:31], a[36:39], a[116:119]
 buffer_store_dwordx4 v[76:79], v24, s[20:23], s78 offen offset:1024 sc1
 v_mfma_f32_16x16x32_bf16 a[112:115], a[28:31], a[32:35], a[112:115]
 v_mfma_f32_16x16x32_bf16 a[128:131], a[48:51], a[32:35], a[128:131]
 v_mfma_f32_16x16x32_bf16 a[132:135], a[48:51], a[36:39], a[132:135]
 v_mfma_f32_16x16x32_bf16 a[136:139], a[48:51], a[40:43], a[136:139]
 ds_read_b64_tr_b16 a[28:29], v15 offset:40960
 ds_read_b64_tr_b16 a[30:31], v15 offset:41984
 v_mfma_f32_16x16x32_bf16 a[140:143], a[48:51], a[44:47], a[140:143]
 ds_read_b64_tr_b16 a[48:49], v16 offset:40960
 ds_read_b64_tr_b16 a[50:51], v16 offset:41984
 v_mfma_f32_16x16x32_bf16 a[156:159], a[52:55], a[44:47], a[156:159]
 v_mfma_f32_16x16x32_bf16 a[152:155], a[52:55], a[40:43], a[152:155]
 v_mfma_f32_16x16x32_bf16 a[148:151], a[52:55], a[36:39], a[148:151]
 v_mfma_f32_16x16x32_bf16 a[144:147], a[52:55], a[32:35], a[144:147]
 ds_read_b64_tr_b16 a[52:53], v17 offset:40960
 ds_read_b64_tr_b16 a[54:55], v17 offset:41984
 v_mfma_f32_16x16x32_bf16 a[160:163], a[56:59], a[32:35], a[160:163]
 v_mfma_f32_16x16x32_bf16 a[164:167], a[56:59], a[36:39], a[164:167]
 v_mfma_f32_16x16x32_bf16 a[168:171], a[56:59], a[40:43], a[168:171]
 s_mov_b32 s78, 16384
 buffer_store_dwordx4 v[96:99], v25, s[20:23], s78 offen offset:0 sc1
 v_mfma_f32_16x16x32_bf16 a[172:175], a[56:59], a[44:47], a[172:175]
 v_mfma_f32_16x16x32_bf16 a[188:191], a[60:63], a[44:47], a[188:191]
 v_mfma_f32_16x16x32_bf16 a[184:187], a[60:63], a[40:43], a[184:187]
 v_mfma_f32_16x16x32_bf16 a[180:183], a[60:63], a[36:39], a[180:183]
 ds_read_b64_tr_b16 a[56:57], v18 offset:40960
 ds_read_b64_tr_b16 a[58:59], v18 offset:41984
 v_mfma_f32_16x16x32_bf16 a[176:179], a[60:63], a[32:35], a[176:179]
 ds_read_b64_tr_b16 a[60:61], v19 offset:40960
 ds_read_b64_tr_b16 a[62:63], v19 offset:41984
 s_waitcnt lgkmcnt(4)
 v_mfma_f32_16x16x32_bf16 a[192:195], a[16:19], a[32:35], a[192:195]
 v_mfma_f32_16x16x32_bf16 a[196:199], a[16:19], a[36:39], a[196:199]
 v_mfma_f32_16x16x32_bf16 a[200:203], a[16:19], a[40:43], a[200:203]
 v_mfma_f32_16x16x32_bf16 a[204:207], a[16:19], a[44:47], a[204:207]
 v_mfma_f32_16x16x32_bf16 a[220:223], a[20:23], a[44:47], a[220:223]
 v_mfma_f32_16x16x32_bf16 a[216:219], a[20:23], a[40:43], a[216:219]
 v_mfma_f32_16x16x32_bf16 a[212:215], a[20:23], a[36:39], a[212:215]
 v_mfma_f32_16x16x32_bf16 a[208:211], a[20:23], a[32:35], a[208:211]
 s_waitcnt vmcnt(5)
 s_waitcnt lgkmcnt(0)
 s_barrier
 v_mfma_f32_16x16x32_bf16 v[160:163], a[24:27], a[32:35], v[160:163]
 ds_read_b64_tr_b16 a[16:17], v20 offset:16384
 ds_read_b64_tr_b16 a[18:19], v20 offset:16896
 s_add_u32 m0, s62, 49152
 v_mfma_f32_16x16x32_bf16 v[164:167], a[24:27], a[36:39], v[164:167]
 buffer_load_dwordx4 v6, s[12:15], s72 offen offset:0 lds
 ds_read_b64_tr_b16 a[20:21], v20 offset:18432
 ds_read_b64_tr_b16 a[22:23], v20 offset:18944
 v_mfma_f32_16x16x32_bf16 v[168:171], a[24:27], a[40:43], v[168:171]
 ds_read_b128 a[0:3], v10 offset:0
 ds_read_b128 a[4:7], v10 offset:2048
 v_mfma_f32_16x16x32_bf16 v[172:175], a[24:27], a[44:47], v[172:175]
 ds_read_b64_tr_b16 a[24:25], v21 offset:16384
 ds_read_b64_tr_b16 a[26:27], v21 offset:16896
 v_mfma_f32_16x16x32_bf16 v[188:191], a[28:31], a[44:47], v[188:191]
 ds_read_b128 a[8:11], v10 offset:4096
 v_mfma_f32_16x16x32_bf16 v[184:187], a[28:31], a[40:43], v[184:187]
 buffer_load_dwordx4 v7, s[12:15], s73 offen offset:1024 lds
 v_mfma_f32_16x16x32_bf16 v[180:183], a[28:31], a[36:39], v[180:183]
 ds_read_b128 a[12:15], v10 offset:6144
 v_mfma_f32_16x16x32_bf16 v[176:179], a[28:31], a[32:35], v[176:179]
 ds_read_b64_tr_b16 a[28:29], v21 offset:18432
 ds_read_b64_tr_b16 a[30:31], v21 offset:18944
 v_mfma_f32_16x16x32_bf16 v[192:195], a[48:51], a[32:35], v[192:195]
 s_add_u32 s84, s84, 1
 s_cmp_eq_u32 s84, 10
 s_cselect_b32 s85, -9, 1
 s_cmov_b32 s84, 0
 s_add_u32 m0, s62, 51200
 v_mfma_f32_16x16x32_bf16 v[196:199], a[48:51], a[36:39], v[196:199]
 buffer_load_dwordx4 v6, s[16:19], s72 offen offset:0 lds
 s_lshl_b32 s86, s85, 19
 s_mul_i32 s87, s85, 221184
 v_mfma_f32_16x16x32_bf16 v[200:203], a[48:51], a[40:43], v[200:203]
 v_mfma_f32_16x16x32_bf16 v[204:207], a[48:51], a[44:47], v[204:207]
 ds_read_b64_tr_b16 a[48:49], v22 offset:16384
 ds_read_b64_tr_b16 a[50:51], v22 offset:16896
 v_mfma_f32_16x16x32_bf16 v[220:223], a[52:55], a[44:47], v[220:223]
 v_mfma_f32_16x16x32_bf16 v[216:219], a[52:55], a[40:43], v[216:219]
 buffer_load_dwordx4 v7, s[16:19], s73 offen offset:1024 lds
 v_mfma_f32_16x16x32_bf16 v[212:215], a[52:55], a[36:39], v[212:215]
 v_mfma_f32_16x16x32_bf16 v[208:211], a[52:55], a[32:35], v[208:211]
 ds_read_b64_tr_b16 a[52:53], v22 offset:18432
 ds_read_b64_tr_b16 a[54:55], v22 offset:18944
 v_mfma_f32_16x16x32_bf16 v[224:227], a[56:59], a[32:35], v[224:227]
 s_add_u32 m0, s63, 32768
 v_mfma_f32_16x16x32_bf16 v[228:231], a[56:59], a[36:39], v[228:231]
 buffer_load_dwordx4 v2, s[4:7], s64 offen offset:0 sc1 lds
 v_mfma_f32_16x16x32_bf16 v[232:235], a[56:59], a[40:43], v[232:235]
 v_mfma_f32_16x16x32_bf16 v[236:239], a[56:59], a[44:47], v[236:239]
 ds_read_b64_tr_b16 a[56:57], v23 offset:16384
 ds_read_b64_tr_b16 a[58:59], v23 offset:16896
 v_mfma_f32_16x16x32_bf16 v[252:255], a[60:63], a[44:47], v[252:255]
 v_mfma_f32_16x16x32_bf16 v[248:251], a[60:63], a[40:43], v[248:251]
 buffer_load_dwordx4 v3, s[4:7], s64 offen offset:1024 sc1 lds
 v_add_u32 v6, s87, v6
 v_mfma_f32_16x16x32_bf16 v[244:247], a[60:63], a[36:39], v[244:247]
 v_add_u32_e64 v7, s87, v7
 v_mfma_f32_16x16x32_bf16 v[240:243], a[60:63], a[32:35], v[240:243]
 ds_read_b64_tr_b16 a[60:61], v23 offset:18432
 ds_read_b64_tr_b16 a[62:63], v23 offset:18944
 s_waitcnt lgkmcnt(4)
 v_mfma_f32_16x16x32_bf16 a[64:67], a[16:19], a[0:3], a[64:67]
 v_mfma_f32_16x16x32_bf16 a[68:71], a[16:19], a[4:7], a[68:71]
 buffer_load_dwordx4 v2, s[4:7], s65 offen offset:2048 sc1 lds
 v_mfma_f32_16x16x32_bf16 a[72:75], a[16:19], a[8:11], a[72:75]
 v_mfma_f32_16x16x32_bf16 a[76:79], a[16:19], a[12:15], a[76:79]
 ds_read_b64_tr_b16 a[16:17], v12 offset:0
 ds_read_b64_tr_b16 a[18:19], v12 offset:1024
 v_mfma_f32_16x16x32_bf16 a[92:95], a[20:23], a[12:15], a[92:95]
 v_mfma_f32_16x16x32_bf16 a[88:91], a[20:23], a[8:11], a[88:91]
 buffer_load_dwordx4 v3, s[4:7], s65 offen offset:3072 sc1 lds
 v_mfma_f32_16x16x32_bf16 a[84:87], a[20:23], a[4:7], a[84:87]
 v_mfma_f32_16x16x32_bf16 a[80:83], a[20:23], a[0:3], a[80:83]
 ds_read_b64_tr_b16 a[20:21], v13 offset:0
 ds_read_b64_tr_b16 a[22:23], v13 offset:1024
 v_mfma_f32_16x16x32_bf16 a[96:99], a[24:27], a[0:3], a[96:99]
 ds_read_b128 a[32:35], v11 offset:0
 s_add_u32 m0, s62, 32768
 v_mfma_f32_16x16x32_bf16 a[100:103], a[24:27], a[4:7], a[100:103]
 buffer_load_dwordx4 v4, s[8:11], s68 offen offset:0 lds
 v_mfma_f32_16x16x32_bf16 a[104:107], a[24:27], a[8:11], a[104:107]
 v_mfma_f32_16x16x32_bf16 a[108:111], a[24:27], a[12:15], a[108:111]
 ds_read_b64_tr_b16 a[24:25], v14 offset:0
 ds_read_b64_tr_b16 a[26:27], v14 offset:1024
 v_mfma_f32_16x16x32_bf16 a[124:127], a[28:31], a[12:15], a[124:127]
 v_mfma_f32_16x16x32_bf16 a[120:123], a[28:31], a[8:11], a[120:123]
 buffer_load_dwordx4 v4, s[8:11], s69 offen offset:1024 lds
 v_mfma_f32_16x16x32_bf16 a[116:119], a[28:31], a[4:7], a[116:119]
 v_mfma_f32_16x16x32_bf16 a[112:115], a[28:31], a[0:3], a[112:115]
 ds_read_b64_tr_b16 a[28:29], v15 offset:0
 ds_read_b64_tr_b16 a[30:31], v15 offset:1024
 v_mfma_f32_16x16x32_bf16 a[128:131], a[48:51], a[0:3], a[128:131]
 v_mfma_f32_16x16x32_bf16 a[132:135], a[48:51], a[4:7], a[132:135]
 buffer_load_dwordx4 v5, s[8:11], s70 offen offset:2048 lds
 v_mfma_f32_16x16x32_bf16 a[136:139], a[48:51], a[8:11], a[136:139]
 ds_read_b128 a[36:39], v11 offset:2048
 v_mfma_f32_16x16x32_bf16 a[140:143], a[48:51], a[12:15], a[140:143]
 ds_read_b64_tr_b16 a[48:49], v16 offset:0
 ds_read_b64_tr_b16 a[50:51], v16 offset:1024
 v_mfma_f32_16x16x32_bf16 a[156:159], a[52:55], a[12:15], a[156:159]
 v_mfma_f32_16x16x32_bf16 a[152:155], a[52:55], a[8:11], a[152:155]
 buffer_load_dwordx4 v5, s[8:11], s71 offen offset:3072 lds
 v_add_u32 v4, s86, v4
 v_mfma_f32_16x16x32_bf16 a[148:151], a[52:55], a[4:7], a[148:151]
 v_add_u32_e64 v5, s86, v5
 v_mfma_f32_16x16x32_bf16 a[144:147], a[52:55], a[0:3], a[144:147]
 ds_read_b64_tr_b16 a[52:53], v17 offset:0
 ds_read_b64_tr_b16 a[54:55], v17 offset:1024
 s_waitcnt lgkmcnt(5)
 v_mfma_f32_16x16x32_bf16 a[160:163], a[56:59], a[0:3], a[160:163]
 s_add_u32 m0, s63, 36864
 v_mfma_f32_16x16x32_bf16 a[164:167], a[56:59], a[4:7], a[164:167]
 buffer_load_dwordx4 v2, s[4:7], s66 offen offset:0 sc1 lds
 v_mfma_f32_16x16x32_bf16 a[168:171], a[56:59], a[8:11], a[168:171]
 v_mfma_f32_16x16x32_bf16 a[172:175], a[56:59], a[12:15], a[172:175]
 ds_read_b64_tr_b16 a[56:57], v18 offset:0
 ds_read_b64_tr_b16 a[58:59], v18 offset:1024
 v_mfma_f32_16x16x32_bf16 a[188:191], a[60:63], a[12:15], a[188:191]
 ds_read_b128 a[40:43], v11 offset:4096
 v_mfma_f32_16x16x32_bf16 a[184:187], a[60:63], a[8:11], a[184:187]
 buffer_load_dwordx4 v3, s[4:7], s66 offen offset:1024 sc1 lds
 v_mfma_f32_16x16x32_bf16 a[180:183], a[60:63], a[4:7], a[180:183]
 v_mfma_f32_16x16x32_bf16 a[176:179], a[60:63], a[0:3], a[176:179]
 ds_read_b64_tr_b16 a[60:61], v19 offset:0
 ds_read_b64_tr_b16 a[62:63], v19 offset:1024
 v_mfma_f32_16x16x32_bf16 a[192:195], a[16:19], a[0:3], a[192:195]
 v_mfma_f32_16x16x32_bf16 a[196:199], a[16:19], a[4:7], a[196:199]
 buffer_load_dwordx4 v2, s[4:7], s67 offen offset:2048 sc1 lds
 v_mfma_f32_16x16x32_bf16 a[200:203], a[16:19], a[8:11], a[200:203]
 v_mfma_f32_16x16x32_bf16 a[204:207], a[16:19], a[12:15], a[204:207]
 ds_read_b64_tr_b16 a[16:17], v20 offset:24576
 ds_read_b64_tr_b16 a[18:19], v20 offset:25088
 v_mfma_f32_16x16x32_bf16 a[220:223], a[20:23], a[12:15], a[220:223]
 v_mfma_f32_16x16x32_bf16 a[216:219], a[20:23], a[8:11], a[216:219]
 buffer_load_dwordx4 v3, s[4:7], s67 offen offset:3072 sc1 lds
 v_lshl_add_u32 v2, s85, 7, v2
 v_mfma_f32_16x16x32_bf16 a[212:215], a[20:23], a[4:7], a[212:215]
 ds_read_b128 a[44:47], v11 offset:6144
 v_lshl_add_u32 v3, s85, 7, v3
 v_mfma_f32_16x16x32_bf16 a[208:211], a[20:23], a[0:3], a[208:211]
 ds_read_b64_tr_b16 a[20:21], v20 offset:26624
 ds_read_b64_tr_b16 a[22:23], v20 offset:27136
 v_mfma_f32_16x16x32_bf16 v[160:163], a[24:27], a[0:3], v[160:163]
 v_mfma_f32_16x16x32_bf16 v[164:167], a[24:27], a[4:7], v[164:167]
 v_mfma_f32_16x16x32_bf16 v[168:171], a[24:27], a[8:11], v[168:171]
 buffer_store_dwordx4 v[112:115], v25, s[20:23], s78 offen offset:1024 sc1
 v_mfma_f32_16x16x32_bf16 v[172:175], a[24:27], a[12:15], v[172:175]
 v_mfma_f32_16x16x32_bf16 v[188:191], a[28:31], a[12:15], v[188:191]
 v_mfma_f32_16x16x32_bf16 v[184:187], a[28:31], a[8:11], v[184:187]
 v_mfma_f32_16x16x32_bf16 v[180:183], a[28:31], a[4:7], v[180:183]
 ds_read_b64_tr_b16 a[24:25], v21 offset:24576
 ds_read_b64_tr_b16 a[26:27], v21 offset:25088
L_pg6:
 s_cbranch_execz L_hopr1
 v_mfma_f32_16x16x32_bf16 v[176:179], a[28:31], a[0:3], v[176:179]
 ds_read_b64_tr_b16 a[28:29], v21 offset:26624
 ds_read_b64_tr_b16 a[30:31], v21 offset:27136
 s_waitcnt lgkmcnt(4)
 v_mfma_f32_16x16x32_bf16 v[192:195], a[48:51], a[0:3], v[192:195]
 v_mfma_f32_16x16x32_bf16 v[196:199], a[48:51], a[4:7], v[196:199]
 v_mfma_f32_16x16x32_bf16 v[200:203], a[48:51], a[8:11], v[200:203]
 v_mfma_f32_16x16x32_bf16 v[204:207], a[48:51], a[12:15], v[204:207]
 ds_read_b64_tr_b16 a[48:49], v22 offset:24576
 ds_read_b64_tr_b16 a[50:51], v22 offset:25088
 v_mfma_f32_16x16x32_bf16 v[220:223], a[52:55], a[12:15], v[220:223]
 v_mfma_f32_16x16x32_bf16 v[216:219], a[52:55], a[8:11], v[216:219]
 v_mfma_f32_16x16x32_bf16 v[212:215], a[52:55], a[4:7], v[212:215]
 buffer_store_dwordx4 v[128:131], v25, s[20:23], s78 offen offset:2048 sc1
 v_mfma_f32_16x16x32_bf16 v[208:211], a[52:55], a[0:3], v[208:211]
 v_mfma_f32_16x16x32_bf16 v[224:227], a[56:59], a[0:3], v[224:227]
 v_mfma_f32_16x16x32_bf16 v[228:231], a[56:59], a[4:7], v[228:231]
 v_mfma_f32_16x16x32_bf16 v[232:235], a[56:59], a[8:11], v[232:235]
 ds_read_b64_tr_b16 a[52:53], v22 offset:26624
 ds_read_b64_tr_b16 a[54:55], v22 offset:27136
 v_mfma_f32_16x16x32_bf16 v[236:239], a[56:59], a[12:15], v[236:239]
 ds_read_b64_tr_b16 a[56:57], v23 offset:24576
 ds_read_b64_tr_b16 a[58:59], v23 offset:25088
 v_mfma_f32_16x16x32_bf16 v[252:255], a[60:63], a[12:15], v[252:255]
 v_mfma_f32_16x16x32_bf16 v[248:251], a[60:63], a[8:11], v[248:251]
 v_mfma_f32_16x16x32_bf16 v[244:247], a[60:63], a[4:7], v[244:247]
 v_mfma_f32_16x16x32_bf16 v[240:243], a[60:63], a[0:3], v[240:243]
 ds_read_b64_tr_b16 a[60:61], v23 offset:26624
 ds_read_b64_tr_b16 a[62:63], v23 offset:27136
 v_mfma_f32_16x16x32_bf16 a[64:67], a[16:19], a[32:35], a[64:67]
 v_mfma_f32_16x16x32_bf16 a[68:71], a[16:19], a[36:39], a[68:71]
 v_mfma_f32_16x16x32_bf16 a[72:75], a[16:19], a[40:43], a[72:75]
 buffer_store_dwordx4 v[144:147], v25, s[20:23], s78 offen offset:3072 sc1
 v_mfma_f32_16x16x32_bf16 a[76:79], a[16:19], a[44:47], a[76:79]
 v_mfma_f32_16x16x32_bf16 a[92:95], a[20:23], a[44:47], a[92:95]
 v_mfma_f32_16x16x32_bf16 a[88:91], a[20:23], a[40:43], a[88:91]
 v_mfma_f32_16x16x32_bf16 a[84:87], a[20:23], a[36:39], a[84:87]
 ds_read_b64_tr_b16 a[16:17], v12 offset:8192
 ds_read_b64_tr_b16 a[18:19], v12 offset:9216
 v_mfma_f32_16x16x32_bf16 a[80:83], a[20:23], a[32:35], a[80:83]
 ds_read_b64_tr_b16 a[20:21], v13 offset:8192
 ds_read_b64_tr_b16 a[22:23], v13 offset:9216
 s_waitcnt lgkmcnt(4)
 v_mfma_f32_16x16x32_bf16 a[96:99], a[24:27], a[32:35], a[96:99]
 v_mfma_f32_16x16x32_bf16 a[100:103], a[24:27], a[36:39], a[100:103]
 v_mfma_f32_16x16x32_bf16 a[104:107], a[24:27], a[40:43], a[104:107]
 v_mfma_f32_16x16x32_bf16 a[108:111], a[24:27], a[44:47], a[108:111]
 ds_read_b64_tr_b16 a[24:25], v14 offset:8192
 ds_read_b64_tr_b16 a[26:27], v14 offset:9216
 v_mfma_f32_16x16x32_bf16 a[124:127], a[28:31], a[44:47], a[124:127]
 v_mfma_f32_16x16x32_bf16 a[120:123], a[28:31], a[40:43], a[120:123]
 v_mfma_f32_16x16x32_bf16 a[116:119], a[28:31], a[36:39], a[116:119]
 s_mov_b32 s78, 24576
 buffer_store_dwordx4 v[100:103], v25, s[20:23], s78 offen offset:0 sc1
 v_mfma_f32_16x16x32_bf16 a[112:115], a[28:31], a[32:35], a[112:115]
 v_mfma_f32_16x16x32_bf16 a[128:131], a[48:51], a[32:35], a[128:131]
 v_mfma_f32_16x16x32_bf16 a[132:135], a[48:51], a[36:39], a[132:135]
 v_mfma_f32_16x16x32_bf16 a[136:139], a[48:51], a[40:43], a[136:139]
 ds_read_b64_tr_b16 a[28:29], v15 offset:8192
 ds_read_b64_tr_b16 a[30:31], v15 offset:9216
 v_mfma_f32_16x16x32_bf16 a[140:143], a[48:51], a[44:47], a[140:143]
 ds_read_b64_tr_b16 a[48:49], v16 offset:8192
 ds_read_b64_tr_b16 a[50:51], v16 offset:9216
 v_mfma_f32_16x16x32_bf16 a[156:159], a[52:55], a[44:47], a[156:159]
 v_mfma_f32_16x16x32_bf16 a[152:155], a[52:55], a[40:43], a[152:155]
 v_mfma_f32_16x16x32_bf16 a[148:151], a[52:55], a[36:39], a[148:151]
 v_mfma_f32_16x16x32_bf16 a[144:147], a[52:55], a[32:35], a[144:147]
 ds_read_b64_tr_b16 a[52:53], v17 offset:8192
 ds_read_b64_tr_b16 a[54:55], v17 offset:9216
 v_mfma_f32_16x16x32_bf16 a[160:163], a[56:59], a[32:35], a[160:163]
 v_mfma_f32_16x16x32_bf16 a[164:167], a[56:59], a[36:39], a[164:167]
 v_mfma_f32_16x16x32_bf16 a[168:171], a[56:59], a[40:43], a[168:171]
 buffer_store_dwordx4 v[116:119], v25, s[20:23], s78 offen offset:1024 sc1
 v_mfma_f32_16x16x32_bf16 a[172:175], a[56:59], a[44:47], a[172:175]
 v_mfma_f32_16x16x32_bf16 a[188:191], a[60:63], a[44:47], a[188:191]
 v_mfma_f32_16x16x32_bf16 a[184:187], a[60:63], a[40:43], a[184:187]
 v_mfma_f32_16x16x32_bf16 a[180:183], a[60:63], a[36:39], a[180:183]
 ds_read_b64_tr_b16 a[56:57], v18 offset:8192
 ds_read_b64_tr_b16 a[58:59], v18 offset:9216
 v_mfma_f32_16x16x32_bf16 a[176:179], a[60:63], a[32:35], a[176:179]
 ds_read_b64_tr_b16 a[60:61], v19 offset:8192
 ds_read_b64_tr_b16 a[62:63], v19 offset:9216
 s_waitcnt lgkmcnt(4)
 v_mfma_f32_16x16x32_bf16 a[192:195], a[16:19], a[32:35], a[192:195]
 v_mfma_f32_16x16x32_bf16 a[196:199], a[16:19], a[36:39], a[196:199]
 v_mfma_f32_16x16x32_bf16 a[200:203], a[16:19], a[40:43], a[200:203]
 v_mfma_f32_16x16x32_bf16 a[204:207], a[16:19], a[44:47], a[204:207]
 v_mfma_f32_16x16x32_bf16 a[220:223], a[20:23], a[44:47], a[220:223]
 v_mfma_f32_16x16x32_bf16 a[216:219], a[20:23], a[40:43], a[216:219]
 v_mfma_f32_16x16x32_bf16 a[212:215], a[20:23], a[36:39], a[212:215]
 v_mfma_f32_16x16x32_bf16 a[208:211], a[20:23], a[32:35], a[208:211]
 s_waitcnt vmcnt(5)
 s_waitcnt lgkmcnt(0)
 s_barrier
 v_mfma_f32_16x16x32_bf16 v[160:163], a[24:27], a[32:35], v[160:163]
 ds_read_b64_tr_b16 a[16:17], v20 offset:49152
 ds_read_b64_tr_b16 a[18:19], v20 offset:49664
 s_add_u32 m0, s62, 16384
 v_mfma_f32_16x16x32_bf16 v[164:167], a[24:27], a[36:39], v[164:167]
 buffer_load_dwordx4 v6, s[12:15], s72 offen offset:0 lds
 ds_read_b64_tr_b16 a[20:21], v20 offset:51200
 ds_read_b64_tr_b16 a[22:23], v20 offset:51712
 v_mfma_f32_16x16x32_bf16 v[168:171], a[24:27], a[40:43], v[168:171]
 ds_read_b128 a[0:3], v10 offset:32768
 ds_read_b128 a[4:7], v10 offset:34816
 v_mfma_f32_16x16x32_bf16 v[172:175], a[24:27], a[44:47], v[172:175]
 ds_read_b64_tr_b16 a[24:25], v21 offset:49152
 ds_read_b64_tr_b16 a[26:27], v21 offset:49664
 v_mfma_f32_16x16x32_bf16 v[188:191], a[28:31], a[44:47], v[188:191]
 ds_read_b128 a[8:11], v10 offset:36864
 v_mfma_f32_16x16x32_bf16 v[184:187], a[28:31], a[40:43], v[184:187]
 buffer_load_dwordx4 v7, s[12:15], s73 offen offset:1024 lds
 v_mfma_f32_16x16x32_bf16 v[180:183], a[28:31], a[36:39], v[180:183]
 ds_read_b128 a[12:15], v10 offset:38912
 v_mfma_f32_16x16x32_bf16 v[176:179], a[28:31], a[32:35], v[176:179]
 ds_read_b64_tr_b16 a[28:29], v21 offset:51200
 ds_read_b64_tr_b16 a[30:31], v21 offset:51712
 v_mfma_f32_16x16x32_bf16 v[192:195], a[48:51], a[32:35], v[192:195]
 s_add_u32 s84, s84, 1
 s_cmp_eq_u32 s84, 10
 s_cselect_b32 s85, -9, 1
 s_cmov_b32 s84, 0
 s_add_u32 m0, s62, 18432
 v_mfma_f32_16x16x32_bf16 v[196:199], a[48:51], a[36:39], v[196:199]
 buffer_load_dwordx4 v6, s[16:19], s72 offen offset:0 lds
 s_lshl_b32 s86, s85, 19
 s_mul_i32 s87, s85, 221184
 v_mfma_f32_16x16x32_bf16 v[200:203], a[48:51], a[40:43], v[200:203]
 v_mfma_f32_16x16x32_bf16 v[204:207], a[48:51], a[44:47], v[204:207]
 ds_read_b64_tr_b16 a[48:49], v22 offset:49152
 ds_read_b64_tr_b16 a[50:51], v22 offset:49664
 v_mfma_f32_16x16x32_bf16 v[220:223], a[52:55], a[44:47], v[220:223]
 v_mfma_f32_16x16x32_bf16 v[216:219], a[52:55], a[40:43], v[216:219]
 buffer_load_dwordx4 v7, s[16:19], s73 offen offset:1024 lds
 v_mfma_f32_16x16x32_bf16 v[212:215], a[52:55], a[36:39], v[212:215]
 v_mfma_f32_16x16x32_bf16 v[208:211], a[52:55], a[32:35], v[208:211]
 ds_read_b64_tr_b16 a[52:53], v22 offset:51200
 ds_read_b64_tr_b16 a[54:55], v22 offset:51712
 v_mfma_f32_16x16x32_bf16 v[224:227], a[56:59], a[32:35], v[224:227]
 s_add_u32 m0, s63, 0
 v_mfma_f32_16x16x32_bf16 v[228:231], a[56:59], a[36:39], v[228:231]
 buffer_load_dwordx4 v2, s[4:7], s64 offen offset:0 sc1 lds
 v_mfma_f32_16x16x32_bf16 v[232:235], a[56:59], a[40:43], v[232:235]
 v_mfma_f32_16x16x32_bf16 v[236:239], a[56:59], a[44:47], v[236:239]
 ds_read_b64_tr_b16 a[56:57], v23 offset:49152
 ds_read_b64_tr_b16 a[58:59], v23 offset:49664
 v_mfma_f32_16x16x32_bf16 v[252:255], a[60:63], a[44:47], v[252:255]
 v_mfma_f32_16x16x32_bf16 v[248:251], a[60:63], a[40:43], v[248:251]
 buffer_load_dwordx4 v3, s[4:7], s64 offen offset:1024 sc1 lds
 v_add_u32_e64 v6, s87, v6
 v_mfma_f32_16x16x32_bf16 v[244:247], a[60:63], a[36:39], v[244:247]
 v_add_u32_e64 v7, s87, v7
 v_mfma_f32_16x16x32_bf16 v[240:243], a[60:63], a[32:35], v[240:243]
 ds_read_b64_tr_b16 a[60:61], v23 offset:51200
 ds_read_b64_tr_b16 a[62:63], v23 offset:51712
 s_waitcnt lgkmcnt(4)
 v_mfma_f32_16x16x32_bf16 a[64:67], a[16:19], a[0:3], a[64:67]
 v_mfma_f32_16x16x32_bf16 a[68:71], a[16:19], a[4:7], a[68:71]
 buffer_load_dwordx4 v2, s[4:7], s65 offen offset:2048 sc1 lds
 v_mfma_f32_16x16x32_bf16 a[72:75], a[16:19], a[8:11], a[72:75]
 v_mfma_f32_16x16x32_bf16 a[76:79], a[16:19], a[12:15], a[76:79]
 ds_read_b64_tr_b16 a[16:17], v12 offset:32768
 ds_read_b64_tr_b16 a[18:19], v12 offset:33792
 v_mfma_f32_16x16x32_bf16 a[92:95], a[20:23], a[12:15], a[92:95]
 v_mfma_f32_16x16x32_bf16 a[88:91], a[20:23], a[8:11], a[88:91]
 buffer_load_dwordx4 v3, s[4:7], s65 offen offset:3072 sc1 lds
 v_mfma_f32_16x16x32_bf16 a[84:87], a[20:23], a[4:7], a[84:87]
 v_mfma_f32_16x16x32_bf16 a[80:83], a[20:23], a[0:3], a[80:83]
 ds_read_b64_tr_b16 a[20:21], v13 offset:32768
 ds_read_b64_tr_b16 a[22:23], v13 offset:33792
 v_mfma_f32_16x16x32_bf16 a[96:99], a[24:27], a[0:3], a[96:99]
 ds_read_b128 a[32:35], v11 offset:32768
 s_add_u32 m0, s62, 0
 v_mfma_f32_16x16x32_bf16 a[100:103], a[24:27], a[4:7], a[100:103]
 buffer_load_dwordx4 v4, s[8:11], s68 offen offset:0 lds
 v_mfma_f32_16x16x32_bf16 a[104:107], a[24:27], a[8:11], a[104:107]
 v_mfma_f32_16x16x32_bf16 a[108:111], a[24:27], a[12:15], a[108:111]
 ds_read_b64_tr_b16 a[24:25], v14 offset:32768
 ds_read_b64_tr_b16 a[26:27], v14 offset:33792
 v_mfma_f32_16x16x32_bf16 a[124:127], a[28:31], a[12:15], a[124:127]
 v_mfma_f32_16x16x32_bf16 a[120:123], a[28:31], a[8:11], a[120:123]
 buffer_load_dwordx4 v4, s[8:11], s69 offen offset:1024 lds
 v_mfma_f32_16x16x32_bf16 a[116:119], a[28:31], a[4:7], a[116:119]
 v_mfma_f32_16x16x32_bf16 a[112:115], a[28:31], a[0:3], a[112:115]
 ds_read_b64_tr_b16 a[28:29], v15 offset:32768
 ds_read_b64_tr_b16 a[30:31], v15 offset:33792
 v_mfma_f32_16x16x32_bf16 a[128:131], a[48:51], a[0:3], a[128:131]
 v_mfma_f32_16x16x32_bf16 a[132:135], a[48:51], a[4:7], a[132:135]
 buffer_load_dwordx4 v5, s[8:11], s70 offen offset:2048 lds
 v_mfma_f32_16x16x32_bf16 a[136:139], a[48:51], a[8:11], a[136:139]
 ds_read_b128 a[36:39], v11 offset:34816
 v_mfma_f32_16x16x32_bf16 a[140:143], a[48:51], a[12:15], a[140:143]
 ds_read_b64_tr_b16 a[48:49], v16 offset:32768
 ds_read_b64_tr_b16 a[50:51], v16 offset:33792
 v_mfma_f32_16x16x32_bf16 a[156:159], a[52:55], a[12:15], a[156:159]
 v_mfma_f32_16x16x32_bf16 a[152:155], a[52:55], a[8:11], a[152:155]
 buffer_load_dwordx4 v5, s[8:11], s71 offen offset:3072 lds
 v_add_u32_e64 v4, s86, v4
 v_mfma_f32_16x16x32_bf16 a[148:151], a[52:55], a[4:7], a[148:151]
 v_add_u32_e64 v5, s86, v5
 v_mfma_f32_16x16x32_bf16 a[144:147], a[52:55], a[0:3], a[144:147]
 ds_read_b64_tr_b16 a[52:53], v17 offset:32768
 ds_read_b64_tr_b16 a[54:55], v17 offset:33792
 s_waitcnt lgkmcnt(5)
 v_mfma_f32_16x16x32_bf16 a[160:163], a[56:59], a[0:3], a[160:163]
 s_add_u32 m0, s63, 4096
 v_mfma_f32_16x16x32_bf16 a[164:167], a[56:59], a[4:7], a[164:167]
 buffer_load_dwordx4 v2, s[4:7], s66 offen offset:0 sc1 lds
 v_mfma_f32_16x16x32_bf16 a[168:171], a[56:59], a[8:11], a[168:171]
 v_mfma_f32_16x16x32_bf16 a[172:175], a[56:59], a[12:15], a[172:175]
 ds_read_b64_tr_b16 a[56:57], v18 offset:32768
 ds_read_b64_tr_b16 a[58:59], v18 offset:33792
 v_mfma_f32_16x16x32_bf16 a[188:191], a[60:63], a[12:15], a[188:191]
 ds_read_b128 a[40:43], v11 offset:36864
 v_mfma_f32_16x16x32_bf16 a[184:187], a[60:63], a[8:11], a[184:187]
 buffer_load_dwordx4 v3, s[4:7], s66 offen offset:1024 sc1 lds
 v_mfma_f32_16x16x32_bf16 a[180:183], a[60:63], a[4:7], a[180:183]
 v_mfma_f32_16x16x32_bf16 a[176:179], a[60:63], a[0:3], a[176:179]
 ds_read_b64_tr_b16 a[60:61], v19 offset:32768
 ds_read_b64_tr_b16 a[62:63], v19 offset:33792
 v_mfma_f32_16x16x32_bf16 a[192:195], a[16:19], a[0:3], a[192:195]
 v_mfma_f32_16x16x32_bf16 a[196:199], a[16:19], a[4:7], a[196:199]
 buffer_load_dwordx4 v2, s[4:7], s67 offen offset:2048 sc1 lds
 v_mfma_f32_16x16x32_bf16 a[200:203], a[16:19], a[8:11], a[200:203]
 v_mfma_f32_16x16x32_bf16 a[204:207], a[16:19], a[12:15], a[204:207]
 ds_read_b64_tr_b16 a[16:17], v20 offset:57344
 ds_read_b64_tr_b16 a[18:19], v20 offset:57856
 v_mfma_f32_16x16x32_bf16 a[220:223], a[20:23], a[12:15], a[220:223]
 v_mfma_f32_16x16x32_bf16 a[216:219], a[20:23], a[8:11], a[216:219]
 buffer_load_dwordx4 v3, s[4:7], s67 offen offset:3072 sc1 lds
 v_lshl_add_u32 v2, s85, 7, v2
 v_mfma_f32_16x16x32_bf16 a[212:215], a[20:23], a[4:7], a[212:215]
 ds_read_b128 a[44:47], v11 offset:38912
 v_lshl_add_u32 v3, s85, 7, v3
 v_mfma_f32_16x16x32_bf16 a[208:211], a[20:23], a[0:3], a[208:211]
 ds_read_b64_tr_b16 a[20:21], v20 offset:59392
 ds_read_b64_tr_b16 a[22:23], v20 offset:59904
 v_mfma_f32_16x16x32_bf16 v[160:163], a[24:27], a[0:3], v[160:163]
 v_mfma_f32_16x16x32_bf16 v[164:167], a[24:27], a[4:7], v[164:167]
 v_mfma_f32_16x16x32_bf16 v[168:171], a[24:27], a[8:11], v[168:171]
 buffer_store_dwordx4 v[132:135], v25, s[20:23], s78 offen offset:2048 sc1
 v_mfma_f32_16x16x32_bf16 v[172:175], a[24:27], a[12:15], v[172:175]
 v_mfma_f32_16x16x32_bf16 v[188:191], a[28:31], a[12:15], v[188:191]
 v_mfma_f32_16x16x32_bf16 v[184:187], a[28:31], a[8:11], v[184:187]
 v_mfma_f32_16x16x32_bf16 v[180:183], a[28:31], a[4:7], v[180:183]
 ds_read_b64_tr_b16 a[24:25], v21 offset:57344
 ds_read_b64_tr_b16 a[26:27], v21 offset:57856
 v_mfma_f32_16x16x32_bf16 v[176:179], a[28:31], a[0:3], v[176:179]
 ds_read_b64_tr_b16 a[28:29], v21 offset:59392
 ds_read_b64_tr_b16 a[30:31], v21 offset:59904
 s_waitcnt lgkmcnt(4)
 v_mfma_f32_16x16x32_bf16 v[192:195], a[48:51], a[0:3], v[192:195]
 v_mfma_f32_16x16x32_bf16 v[196:199], a[48:51], a[4:7], v[196:199]
 v_mfma_f32_16x16x32_bf16 v[200:203], a[48:51], a[8:11], v[200:203]
 v_mfma_f32_16x16x32_bf16 v[204:207], a[48:51], a[12:15], v[204:207]
 ds_read_b64_tr_b16 a[48:49], v22 offset:57344
 ds_read_b64_tr_b16 a[50:51], v22 offset:57856
 v_mfma_f32_16x16x32_bf16 v[220:223], a[52:55], a[12:15], v[220:223]
 v_mfma_f32_16x16x32_bf16 v[216:219], a[52:55], a[8:11], v[216:219]
 v_mfma_f32_16x16x32_bf16 v[212:215], a[52:55], a[4:7], v[212:215]
 buffer_store_dwordx4 v[148:151], v25, s[20:23], s78 offen offset:3072 sc1
 v_mfma_f32_16x16x32_bf16 v[208:211], a[52:55], a[0:3], v[208:211]
 v_mfma_f32_16x16x32_bf16 v[224:227], a[56:59], a[0:3], v[224:227]
 v_mfma_f32_16x16x32_bf16 v[228:231], a[56:59], a[4:7], v[228:231]
 v_mfma_f32_16x16x32_bf16 v[232:235], a[56:59], a[8:11], v[232:235]
 ds_read_b64_tr_b16 a[52:53], v22 offset:59392
 ds_read_b64_tr_b16 a[54:55], v22 offset:59904
 v_mfma_f32_16x16x32_bf16 v[236:239], a[56:59], a[12:15], v[236:239]
 ds_read_b64_tr_b16 a[56:57], v23 offset:57344
 ds_read_b64_tr_b16 a[58:59], v23 offset:57856
 v_mfma_f32_16x16x32_bf16 v[252:255], a[60:63], a[12:15], v[252:255]
 v_mfma_f32_16x16x32_bf16 v[248:251], a[60:63], a[8:11], v[248:251]
 v_mfma_f32_16x16x32_bf16 v[244:247], a[60:63], a[4:7], v[244:247]
 v_mfma_f32_16x16x32_bf16 v[240:243], a[60:63], a[0:3], v[240:243]
 ds_read_b64_tr_b16 a[60:61], v23 offset:59392
 ds_read_b64_tr_b16 a[62:63], v23 offset:59904
 v_mfma_f32_16x16x32_bf16 a[64:67], a[16:19], a[32:35], a[64:67]
 v_mfma_f32_16x16x32_bf16 a[68:71], a[16:19], a[36:39], a[68:71]
 v_mfma_f32_16x16x32_bf16 a[72:75], a[16:19], a[40:43], a[72:75]
 s_mov_b32 s78, 32768
 buffer_store_dwordx4 v[48:51], v24, s[20:23], s78 offen offset:0 sc1
 v_mfma_f32_16x16x32_bf16 a[76:79], a[16:19], a[44:47], a[76:79]
 v_mfma_f32_16x16x32_bf16 a[92:95], a[20:23], a[44:47], a[92:95]
 v_mfma_f32_16x16x32_bf16 a[88:91], a[20:23], a[40:43], a[88:91]
 v_mfma_f32_16x16x32_bf16 a[84:87], a[20:23], a[36:39], a[84:87]
 ds_read_b64_tr_b16 a[16:17], v12 offset:40960
 ds_read_b64_tr_b16 a[18:19], v12 offset:41984
 v_mfma_f32_16x16x32_bf16 a[80:83], a[20:23], a[32:35], a[80:83]
 ds_read_b64_tr_b16 a[20:21], v13 offset:40960
 ds_read_b64_tr_b16 a[22:23], v13 offset:41984
 s_waitcnt lgkmcnt(4)
 v_mfma_f32_16x16x32_bf16 a[96:99], a[24:27], a[32:35], a[96:99]
 v_mfma_f32_16x16x32_bf16 a[100:103], a[24:27], a[36:39], a[100:103]
 v_mfma_f32_16x16x32_bf16 a[104:107], a[24:27], a[40:43], a[104:107]
 v_mfma_f32_16x16x32_bf16 a[108:111], a[24:27], a[44:47], a[108:111]
 ds_read_b64_tr_b16 a[24:25], v14 offset:40960
 ds_read_b64_tr_b16 a[26:27], v14 offset:41984
 v_mfma_f32_16x16x32_bf16 a[124:127], a[28:31], a[44:47], a[124:127]
 v_mfma_f32_16x16x32_bf16 a[120:123], a[28:31], a[40:43], a[120:123]
 v_mfma_f32_16x16x32_bf16 a[116:119], a[28:31], a[36:39], a[116:119]
 buffer_store_dwordx4 v[80:83], v24, s[20:23], s78 offen offset:1024 sc1
 v_mfma_f32_16x16x32_bf16 a[112:115], a[28:31], a[32:35], a[112:115]
 v_mfma_f32_16x16x32_bf16 a[128:131], a[48:51], a[32:35], a[128:131]
 v_mfma_f32_16x16x32_bf16 a[132:135], a[48:51], a[36:39], a[132:135]
 v_mfma_f32_16x16x32_bf16 a[136:139], a[48:51], a[40:43], a[136:139]
 ds_read_b64_tr_b16 a[28:29], v15 offset:40960
 ds_read_b64_tr_b16 a[30:31], v15 offset:41984
 v_mfma_f32_16x16x32_bf16 a[140:143], a[48:51], a[44:47], a[140:143]
 ds_read_b64_tr_b16 a[48:49], v16 offset:40960
 ds_read_b64_tr_b16 a[50:51], v16 offset:41984
 v_mfma_f32_16x16x32_bf16 a[156:159], a[52:55], a[44:47], a[156:159]
 v_mfma_f32_16x16x32_bf16 a[152:155], a[52:55], a[40:43], a[152:155]
 v_mfma_f32_16x16x32_bf16 a[148:151], a[52:55], a[36:39], a[148:151]
 v_mfma_f32_16x16x32_bf16 a[144:147], a[52:55], a[32:35], a[144:147]
 ds_read_b64_tr_b16 a[52:53], v17 offset:40960
 ds_read_b64_tr_b16 a[54:55], v17 offset:41984
 v_mfma_f32_16x16x32_bf16 a[160:163], a[56:59], a[32:35], a[160:163]
 v_mfma_f32_16x16x32_bf16 a[164:167], a[56:59], a[36:39], a[164:167]
 v_mfma_f32_16x16x32_bf16 a[168:171], a[56:59], a[40:43], a[168:171]
 s_mov_b32 s78, 36864
 buffer_store_dwordx4 v[52:55], v24, s[20:23], s78 offen offset:0 sc1
 v_mfma_f32_16x16x32_bf16 a[172:175], a[56:59], a[44:47], a[172:175]
 v_mfma_f32_16x16x32_bf16 a[188:191], a[60:63], a[44:47], a[188:191]
 v_mfma_f32_16x16x32_bf16 a[184:187], a[60:63], a[40:43], a[184:187]
 v_mfma_f32_16x16x32_bf16 a[180:183], a[60:63], a[36:39], a[180:183]
 ds_read_b64_tr_b16 a[56:57], v18 offset:40960
 ds_read_b64_tr_b16 a[58:59], v18 offset:41984
 v_mfma_f32_16x16x32_bf16 a[176:179], a[60:63], a[32:35], a[176:179]
 ds_read_b64_tr_b16 a[60:61], v19 offset:40960
 ds_read_b64_tr_b16 a[62:63], v19 offset:41984
 s_waitcnt lgkmcnt(4)
 v_mfma_f32_16x16x32_bf16 a[192:195], a[16:19], a[32:35], a[192:195]
 v_mfma_f32_16x16x32_bf16 a[196:199], a[16:19], a[36:39], a[196:199]
 v_mfma_f32_16x16x32_bf16 a[200:203], a[16:19], a[40:43], a[200:203]
 v_mfma_f32_16x16x32_bf16 a[204:207], a[16:19], a[44:47], a[204:207]
 v_mfma_f32_16x16x32_bf16 a[220:223], a[20:23], a[44:47], a[220:223]
 v_mfma_f32_16x16x32_bf16 a[216:219], a[20:23], a[40:43], a[216:219]
 v_mfma_f32_16x16x32_bf16 a[212:215], a[20:23], a[36:39], a[212:215]
 v_mfma_f32_16x16x32_bf16 a[208:211], a[20:23], a[32:35], a[208:211]
 s_waitcnt vmcnt(5)
 s_waitcnt lgkmcnt(0)
 s_barrier
 v_mfma_f32_16x16x32_bf16 v[160:163], a[24:27], a[32:35], v[160:163]
 ds_read_b64_tr_b16 a[16:17], v20 offset:16384
 ds_read_b64_tr_b16 a[18:19], v20 offset:16896
 s_add_u32 m0, s62, 49152
 v_mfma_f32_16x16x32_bf16 v[164:167], a[24:27], a[36:39], v[164:167]
 buffer_load_dwordx4 v6, s[12:15], s72 offen offset:0 lds
 ds_read_b64_tr_b16 a[20:21], v20 offset:18432
 ds_read_b64_tr_b16 a[22:23], v20 offset:18944
 v_mfma_f32_16x16x32_bf16 v[168:171], a[24:27], a[40:43], v[168:171]
 ds_read_b128 a[0:3], v10 offset:0
 ds_read_b128 a[4:7], v10 offset:2048
 v_mfma_f32_16x16x32_bf16 v[172:175], a[24:27], a[44:47], v[172:175]
 ds_read_b64_tr_b16 a[24:25], v21 offset:16384
 ds_read_b64_tr_b16 a[26:27], v21 offset:16896
 v_mfma_f32_16x16x32_bf16 v[188:191], a[28:31], a[44:47], v[188:191]
 ds_read_b128 a[8:11], v10 offset:4096
 v_mfma_f32_16x16x32_bf16 v[184:187], a[28:31], a[40:43], v[184:187]
 buffer_load_dwordx4 v7, s[12:15], s73 offen offset:1024 lds
 v_mfma_f32_16x16x32_bf16 v[180:183], a[28:31], a[36:39], v[180:183]
 ds_read_b128 a[12:15], v10 offset:6144
 v_mfma_f32_16x16x32_bf16 v[176:179], a[28:31], a[32:35], v[176:179]
 ds_read_b64_tr_b16 a[28:29], v21 offset:18432
 ds_read_b64_tr_b16 a[30:31], v21 offset:18944
 v_mfma_f32_16x16x32_bf16 v[192:195], a[48:51], a[32:35], v[192:195]
 s_add_u32 s84, s84, 1
 s_cmp_eq_u32 s84, 10
 s_cselect_b32 s85, -9, 1
 s_cmov_b32 s84, 0
 s_add_u32 m0, s62, 51200
 v_mfma_f32_16x16x32_bf16 v[196:199], a[48:51], a[36:39], v[196:199]
 buffer_load_dwordx4 v6, s[16:19], s72 offen offset:0 lds
 s_lshl_b32 s86, s85, 19
 s_mul_i32 s87, s85, 221184
 v_mfma_f32_16x16x32_bf16 v[200:203], a[48:51], a[40:43], v[200:203]
 v_mfma_f32_16x16x32_bf16 v[204:207], a[48:51], a[44:47], v[204:207]
 ds_read_b64_tr_b16 a[48:49], v22 offset:16384
 ds_read_b64_tr_b16 a[50:51], v22 offset:16896
 v_mfma_f32_16x16x32_bf16 v[220:223], a[52:55], a[44:47], v[220:223]
 v_mfma_f32_16x16x32_bf16 v[216:219], a[52:55], a[40:43], v[216:219]
 buffer_load_dwordx4 v7, s[16:19], s73 offen offset:1024 lds
 v_mfma_f32_16x16x32_bf16 v[212:215], a[52:55], a[36:39], v[212:215]
 v_mfma_f32_16x16x32_bf16 v[208:211], a[52:55], a[32:35], v[208:211]
 ds_read_b64_tr_b16 a[52:53], v22 offset:18432
 ds_read_b64_tr_b16 a[54:55], v22 offset:18944
 v_mfma_f32_16x16x32_bf16 v[224:227], a[56:59], a[32:35], v[224:227]
 s_add_u32 m0, s63, 32768
 v_mfma_f32_16x16x32_bf16 v[228:231], a[56:59], a[36:39], v[228:231]
 buffer_load_dwordx4 v2, s[4:7], s64 offen offset:0 sc1 lds
 v_mfma_f32_16x16x32_bf16 v[232:235], a[56:59], a[40:43], v[232:235]
 v_mfma_f32_16x16x32_bf16 v[236:239], a[56:59], a[44:47], v[236:239]
 ds_read_b64_tr_b16 a[56:57], v23 offset:16384
 ds_read_b64_tr_b16 a[58:59], v23 offset:16896
 v_mfma_f32_16x16x32_bf16 v[252:255], a[60:63], a[44:47], v[252:255]
 v_mfma_f32_16x16x32_bf16 v[248:251], a[60:63], a[40:43], v[248:251]
 buffer_load_dwordx4 v3, s[4:7], s64 offen offset:1024 sc1 lds
 v_add_u32_e64 v6, s87, v6
 v_mfma_f32_16x16x32_bf16 v[244:247], a[60:63], a[36:39], v[244:247]
 v_add_u32_e64 v7, s87, v7
 v_mfma_f32_16x16x32_bf16 v[240:243], a[60:63], a[32:35], v[240:243]
 ds_read_b64_tr_b16 a[60:61], v23 offset:18432
 ds_read_b64_tr_b16 a[62:63], v23 offset:18944
 s_waitcnt lgkmcnt(4)
 v_mfma_f32_16x16x32_bf16 a[64:67], a[16:19], a[0:3], a[64:67]
 v_mfma_f32_16x16x32_bf16 a[68:71], a[16:19], a[4:7], a[68:71]
 buffer_load_dwordx4 v2, s[4:7], s65 offen offset:2048 sc1 lds
 v_mfma_f32_16x16x32_bf16 a[72:75], a[16:19], a[8:11], a[72:75]
 v_mfma_f32_16x16x32_bf16 a[76:79], a[16:19], a[12:15], a[76:79]
 ds_read_b64_tr_b16 a[16:17], v12 offset:0
 ds_read_b64_tr_b16 a[18:19], v12 offset:1024
 v_mfma_f32_16x16x32_bf16 a[92:95], a[20:23], a[12:15], a[92:95]
 v_mfma_f32_16x16x32_bf16 a[88:91], a[20:23], a[8:11], a[88:91]
 buffer_load_dwordx4 v3, s[4:7], s65 offen offset:3072 sc1 lds
 v_mfma_f32_16x16x32_bf16 a[84:87], a[20:23], a[4:7], a[84:87]
 v_mfma_f32_16x16x32_bf16 a[80:83], a[20:23], a[0:3], a[80:83]
 ds_read_b64_tr_b16 a[20:21], v13 offset:0
 ds_read_b64_tr_b16 a[22:23], v13 offset:1024
 v_mfma_f32_16x16x32_bf16 a[96:99], a[24:27], a[0:3], a[96:99]
 ds_read_b128 a[32:35], v11 offset:0
 s_add_u32 m0, s62, 32768
 v_mfma_f32_16x16x32_bf16 a[100:103], a[24:27], a[4:7], a[100:103]
 buffer_load_dwordx4 v4, s[8:11], s68 offen offset:0 lds
 v_mfma_f32_16x16x32_bf16 a[104:107], a[24:27], a[8:11], a[104:107]
 v_mfma_f32_16x16x32_bf16 a[108:111], a[24:27], a[12:15], a[108:111]
 ds_read_b64_tr_b16 a[24:25], v14 offset:0
 ds_read_b64_tr_b16 a[26:27], v14 offset:1024
 v_mfma_f32_16x16x32_bf16 a[124:127], a[28:31], a[12:15], a[124:127]
 v_mfma_f32_16x16x32_bf16 a[120:123], a[28:31], a[8:11], a[120:123]
 buffer_load_dwordx4 v4, s[8:11], s69 offen offset:1024 lds
 v_mfma_f32_16x16x32_bf16 a[116:119], a[28:31], a[4:7], a[116:119]
 v_mfma_f32_16x16x32_bf16 a[112:115], a[28:31], a[0:3], a[112:115]
 ds_read_b64_tr_b16 a[28:29], v15 offset:0
 ds_read_b64_tr_b16 a[30:31], v15 offset:1024
 v_mfma_f32_16x16x32_bf16 a[128:131], a[48:51], a[0:3], a[128:131]
 v_mfma_f32_16x16x32_bf16 a[132:135], a[48:51], a[4:7], a[132:135]
 buffer_load_dwordx4 v5, s[8:11], s70 offen offset:2048 lds
 v_mfma_f32_16x16x32_bf16 a[136:139], a[48:51], a[8:11], a[136:139]
 ds_read_b128 a[36:39], v11 offset:2048
 v_mfma_f32_16x16x32_bf16 a[140:143], a[48:51], a[12:15], a[140:143]
 ds_read_b64_tr_b16 a[48:49], v16 offset:0
 ds_read_b64_tr_b16 a[50:51], v16 offset:1024
 v_mfma_f32_16x16x32_bf16 a[156:159], a[52:55], a[12:15], a[156:159]
 v_mfma_f32_16x16x32_bf16 a[152:155], a[52:55], a[8:11], a[152:155]
 buffer_load_dwordx4 v5, s[8:11], s71 offen offset:3072 lds
 v_add_u32 v4, s86, v4
 v_mfma_f32_16x16x32_bf16 a[148:151], a[52:55], a[4:7], a[148:151]
 v_add_u32_e64 v5, s86, v5
 v_mfma_f32_16x16x32_bf16 a[144:147], a[52:55], a[0:3], a[144:147]
 ds_read_b64_tr_b16 a[52:53], v17 offset:0
 ds_read_b64_tr_b16 a[54:55], v17 offset:1024
 s_waitcnt lgkmcnt(5)
 v_mfma_f32_16x16x32_bf16 a[160:163], a[56:59], a[0:3], a[160:163]
 s_add_u32 m0, s63, 36864
 v_mfma_f32_16x16x32_bf16 a[164:167], a[56:59], a[4:7], a[164:167]
 buffer_load_dwordx4 v2, s[4:7], s66 offen offset:0 sc1 lds
 v_mfma_f32_16x16x32_bf16 a[168:171], a[56:59], a[8:11], a[168:171]
 v_mfma_f32_16x16x32_bf16 a[172:175], a[56:59], a[12:15], a[172:175]
 ds_read_b64_tr_b16 a[56:57], v18 offset:0
 ds_read_b64_tr_b16 a[58:59], v18 offset:1024
 v_mfma_f32_16x16x32_bf16 a[188:191], a[60:63], a[12:15], a[188:191]
 ds_read_b128 a[40:43], v11 offset:4096
 v_mfma_f32_16x16x32_bf16 a[184:187], a[60:63], a[8:11], a[184:187]
 buffer_load_dwordx4 v3, s[4:7], s66 offen offset:1024 sc1 lds
 v_mfma_f32_16x16x32_bf16 a[180:183], a[60:63], a[4:7], a[180:183]
 v_mfma_f32_16x16x32_bf16 a[176:179], a[60:63], a[0:3], a[176:179]
 ds_read_b64_tr_b16 a[60:61], v19 offset:0
 ds_read_b64_tr_b16 a[62:63], v19 offset:1024
 v_mfma_f32_16x16x32_bf16 a[192:195], a[16:19], a[0:3], a[192:195]
 v_mfma_f32_16x16x32_bf16 a[196:199], a[16:19], a[4:7], a[196:199]
 buffer_load_dwordx4 v2, s[4:7], s67 offen offset:2048 sc1 lds
 v_mfma_f32_16x16x32_bf16 a[200:203], a[16:19], a[8:11], a[200:203]
 v_mfma_f32_16x16x32_bf16 a[204:207], a[16:19], a[12:15], a[204:207]
 ds_read_b64_tr_b16 a[16:17], v20 offset:24576
 ds_read_b64_tr_b16 a[18:19], v20 offset:25088
 v_mfma_f32_16x16x32_bf16 a[220:223], a[20:23], a[12:15], a[220:223]
 v_mfma_f32_16x16x32_bf16 a[216:219], a[20:23], a[8:11], a[216:219]
 buffer_load_dwordx4 v3, s[4:7], s67 offen offset:3072 sc1 lds
 v_lshl_add_u32 v2, s85, 7, v2
 v_mfma_f32_16x16x32_bf16 a[212:215], a[20:23], a[4:7], a[212:215]
 ds_read_b128 a[44:47], v11 offset:6144
 v_lshl_add_u32 v3, s85, 7, v3
 v_mfma_f32_16x16x32_bf16 a[208:211], a[20:23], a[0:3], a[208:211]
 ds_read_b64_tr_b16 a[20:21], v20 offset:26624
 ds_read_b64_tr_b16 a[22:23], v20 offset:27136
 v_mfma_f32_16x16x32_bf16 v[160:163], a[24:27], a[0:3], v[160:163]
 v_mfma_f32_16x16x32_bf16 v[164:167], a[24:27], a[4:7], v[164:167]
 v_mfma_f32_16x16x32_bf16 v[168:171], a[24:27], a[8:11], v[168:171]
 buffer_store_dwordx4 v[84:87], v24, s[20:23], s78 offen offset:1024 sc1
 v_mfma_f32_16x16x32_bf16 v[172:175], a[24:27], a[12:15], v[172:175]
 v_mfma_f32_16x16x32_bf16 v[188:191], a[28:31], a[12:15], v[188:191]
 v_mfma_f32_16x16x32_bf16 v[184:187], a[28:31], a[8:11], v[184:187]
 v_mfma_f32_16x16x32_bf16 v[180:183], a[28:31], a[4:7], v[180:183]
 ds_read_b64_tr_b16 a[24:25], v21 offset:24576
 ds_read_b64_tr_b16 a[26:27], v21 offset:25088
 v_mfma_f32_16x16x32_bf16 v[176:179], a[28:31], a[0:3], v[176:179]
 ds_read_b64_tr_b16 a[28:29], v21 offset:26624
 ds_read_b64_tr_b16 a[30:31], v21 offset:27136
 s_waitcnt lgkmcnt(4)
 v_mfma_f32_16x16x32_bf16 v[192:195], a[48:51], a[0:3], v[192:195]
 v_mfma_f32_16x16x32_bf16 v[196:199], a[48:51], a[4:7], v[196:199]
 v_mfma_f32_16x16x32_bf16 v[200:203], a[48:51], a[8:11], v[200:203]
 v_mfma_f32_16x16x32_bf16 v[204:207], a[48:51], a[12:15], v[204:207]
 ds_read_b64_tr_b16 a[48:49], v22 offset:24576
 ds_read_b64_tr_b16 a[50:51], v22 offset:25088
 v_mfma_f32_16x16x32_bf16 v[220:223], a[52:55], a[12:15], v[220:223]
 v_mfma_f32_16x16x32_bf16 v[216:219], a[52:55], a[8:11], v[216:219]
 v_mfma_f32_16x16x32_bf16 v[212:215], a[52:55], a[4:7], v[212:215]
 s_mov_b32 s78, 40960
 buffer_store_dwordx4 v[56:59], v24, s[20:23], s78 offen offset:0 sc1
 v_mfma_f32_16x16x32_bf16 v[208:211], a[52:55], a[0:3], v[208:211]
 v_mfma_f32_16x16x32_bf16 v[224:227], a[56:59], a[0:3], v[224:227]
 v_mfma_f32_16x16x32_bf16 v[228:231], a[56:59], a[4:7], v[228:231]
 v_mfma_f32_16x16x32_bf16 v[232:235], a[56:59], a[8:11], v[232:235]
 ds_read_b64_tr_b16 a[52:53], v22 offset:26624
 ds_read_b64_tr_b16 a[54:55], v22 offset:27136
 v_mfma_f32_16x16x32_bf16 v[236:239], a[56:59], a[12:15], v[236:239]
 ds_read_b64_tr_b16 a[56:57], v23 offset:24576
 ds_read_b64_tr_b16 a[58:59], v23 offset:25088
 v_mfma_f32_16x16x32_bf16 v[252:255], a[60:63], a[12:15], v[252:255]
 v_mfma_f32_16x16x32_bf16 v[248:251], a[60:63], a[8:11], v[248:251]
 v_mfma_f32_16x16x32_bf16 v[244:247], a[60:63], a[4:7], v[244:247]
 v_mfma_f32_16x16x32_bf16 v[240:243], a[60:63], a[0:3], v[240:243]
 ds_read_b64_tr_b16 a[60:61], v23 offset:26624
 ds_read_b64_tr_b16 a[62:63], v23 offset:27136
 v_mfma_f32_16x16x32_bf16 a[64:67], a[16:19], a[32:35], a[64:67]
L_pg7:
 s_cbranch_execz L_hopr1
 v_mfma_f32_16x16x32_bf16 a[68:71], a[16:19], a[36:39], a[68:71]
 v_mfma_f32_16x16x32_bf16 a[72:75], a[16:19], a[40:43], a[72:75]
 buffer_store_dwordx4 v[88:91], v24, s[20:23], s78 offen offset:1024 sc1
 v_mfma_f32_16x16x32_bf16 a[76:79], a[16:19], a[44:47], a[76:79]
 v_mfma_f32_16x16x32_bf16 a[92:95], a[20:23], a[44:47], a[92:95]
 v_mfma_f32_16x16x32_bf16 a[88:91], a[20:23], a[40:43], a[88:91]
 v_mfma_f32_16x16x32_bf16 a[84:87], a[20:23], a[36:39], a[84:87]
 ds_read_b64_tr_b16 a[16:17], v12 offset:8192
 ds_read_b64_tr_b16 a[18:19], v12 offset:9216
 v_mfma_f32_16x16x32_bf16 a[80:83], a[20:23], a[32:35], a[80:83]
 ds_read_b64_tr_b16 a[20:21], v13 offset:8192
 ds_read_b64_tr_b16 a[22:23], v13 offset:9216
 s_waitcnt lgkmcnt(4)
 v_mfma_f32_16x16x32_bf16 a[96:99], a[24:27], a[32:35], a[96:99]
 v_mfma_f32_16x16x32_bf16 a[100:103], a[24:27], a[36:39], a[100:103]
 v_mfma_f32_16x16x32_bf16 a[104:107], a[24:27], a[40:43], a[104:107]
 v_mfma_f32_16x16x32_bf16 a[108:111], a[24:27], a[44:47], a[108:111]
 ds_read_b64_tr_b16 a[24:25], v14 offset:8192
 ds_read_b64_tr_b16 a[26:27], v14 offset:9216
 v_mfma_f32_16x16x32_bf16 a[124:127], a[28:31], a[44:47], a[124:127]
 v_mfma_f32_16x16x32_bf16 a[120:123], a[28:31], a[40:43], a[120:123]
 v_mfma_f32_16x16x32_bf16 a[116:119], a[28:31], a[36:39], a[116:119]
 s_mov_b32 s78, 45056
 buffer_store_dwordx4 v[60:63], v24, s[20:23], s78 offen offset:0 sc1
 v_mfma_f32_16x16x32_bf16 a[112:115], a[28:31], a[32:35], a[112:115]
 v_mfma_f32_16x16x32_bf16 a[128:131], a[48:51], a[32:35], a[128:131]
 v_mfma_f32_16x16x32_bf16 a[132:135], a[48:51], a[36:39], a[132:135]
 v_mfma_f32_16x16x32_bf16 a[136:139], a[48:51], a[40:43], a[136:139]
 ds_read_b64_tr_b16 a[28:29], v15 offset:8192
 ds_read_b64_tr_b16 a[30:31], v15 offset:9216
 v_mfma_f32_16x16x32_bf16 a[140:143], a[48:51], a[44:47], a[140:143]
 ds_read_b64_tr_b16 a[48:49], v16 offset:8192
 ds_read_b64_tr_b16 a[50:51], v16 offset:9216
 v_mfma_f32_16x16x32_bf16 a[156:159], a[52:55], a[44:47], a[156:159]
 v_mfma_f32_16x16x32_bf16 a[152:155], a[52:55], a[40:43], a[152:155]
 v_mfma_f32_16x16x32_bf16 a[148:151], a[52:55], a[36:39], a[148:151]
 v_mfma_f32_16x16x32_bf16 a[144:147], a[52:55], a[32:35], a[144:147]
 ds_read_b64_tr_b16 a[52:53], v17 offset:8192
 ds_read_b64_tr_b16 a[54:55], v17 offset:9216
 v_mfma_f32_16x16x32_bf16 a[160:163], a[56:59], a[32:35], a[160:163]
 v_mfma_f32_16x16x32_bf16 a[164:167], a[56:59], a[36:39], a[164:167]
 v_mfma_f32_16x16x32_bf16 a[168:171], a[56:59], a[40:43], a[168:171]
 buffer_store_dwordx4 v[92:95], v24, s[20:23], s78 offen offset:1024 sc1
 v_mfma_f32_16x16x32_bf16 a[172:175], a[56:59], a[44:47], a[172:175]
 v_mfma_f32_16x16x32_bf16 a[188:191], a[60:63], a[44:47], a[188:191]
 v_mfma_f32_16x16x32_bf16 a[184:187], a[60:63], a[40:43], a[184:187]
 v_mfma_f32_16x16x32_bf16 a[180:183], a[60:63], a[36:39], a[180:183]
 ds_read_b64_tr_b16 a[56:57], v18 offset:8192
 ds_read_b64_tr_b16 a[58:59], v18 offset:9216
 v_mfma_f32_16x16x32_bf16 a[176:179], a[60:63], a[32:35], a[176:179]
 ds_read_b64_tr_b16 a[60:61], v19 offset:8192
 ds_read_b64_tr_b16 a[62:63], v19 offset:9216
 s_waitcnt lgkmcnt(4)
 v_mfma_f32_16x16x32_bf16 a[192:195], a[16:19], a[32:35], a[192:195]
 v_mfma_f32_16x16x32_bf16 a[196:199], a[16:19], a[36:39], a[196:199]
 v_mfma_f32_16x16x32_bf16 a[200:203], a[16:19], a[40:43], a[200:203]
 v_mfma_f32_16x16x32_bf16 a[204:207], a[16:19], a[44:47], a[204:207]
 v_mfma_f32_16x16x32_bf16 a[220:223], a[20:23], a[44:47], a[220:223]
 v_mfma_f32_16x16x32_bf16 a[216:219], a[20:23], a[40:43], a[216:219]
 v_mfma_f32_16x16x32_bf16 a[212:215], a[20:23], a[36:39], a[212:215]
 v_mfma_f32_16x16x32_bf16 a[208:211], a[20:23], a[32:35], a[208:211]
 s_waitcnt vmcnt(5)
 s_waitcnt lgkmcnt(0)
 s_barrier
 v_mfma_f32_16x16x32_bf16 v[160:163], a[24:27], a[32:35], v[160:163]
 ds_read_b64_tr_b16 a[16:17], v20 offset:49152
 ds_read_b64_tr_b16 a[18:19], v20 offset:49664
 s_add_u32 m0, s62, 16384
 v_mfma_f32_16x16x32_bf16 v[164:167], a[24:27], a[36:39], v[164:167]
 buffer_load_dwordx4 v6, s[12:15], s72 offen offset:0 lds
 ds_read_b64_tr_b16 a[20:21], v20 offset:51200
 ds_read_b64_tr_b16 a[22:23], v20 offset:51712
 v_mfma_f32_16x16x32_bf16 v[168:171], a[24:27], a[40:43], v[168:171]
 ds_read_b128 a[0:3], v10 offset:32768
 ds_read_b128 a[4:7], v10 offset:34816
 v_mfma_f32_16x16x32_bf16 v[172:175], a[24:27], a[44:47], v[172:175]
 ds_read_b64_tr_b16 a[24:25], v21 offset:49152
 ds_read_b64_tr_b16 a[26:27], v21 offset:49664
 v_mfma_f32_16x16x32_bf16 v[188:191], a[28:31], a[44:47], v[188:191]
 ds_read_b128 a[8:11], v10 offset:36864
 v_mfma_f32_16x16x32_bf16 v[184:187], a[28:31], a[40:43], v[184:187]
 buffer_load_dwordx4 v7, s[12:15], s73 offen offset:1024 lds
 v_mfma_f32_16x16x32_bf16 v[180:183], a[28:31], a[36:39], v[180:183]
 ds_read_b128 a[12:15], v10 offset:38912
 v_mfma_f32_16x16x32_bf16 v[176:179], a[28:31], a[32:35], v[176:179]
 ds_read_b64_tr_b16 a[28:29], v21 offset:51200
 ds_read_b64_tr_b16 a[30:31], v21 offset:51712
 v_mfma_f32_16x16x32_bf16 v[192:195], a[48:51], a[32:35], v[192:195]
 s_add_u32 s84, s84, 1
 s_cmp_eq_u32 s84, 10
 s_cselect_b32 s85, -9, 1
 s_cmov_b32 s84, 0
 s_add_u32 m0, s62, 18432
 v_mfma_f32_16x16x32_bf16 v[196:199], a[48:51], a[36:39], v[196:199]
 buffer_load_dwordx4 v6, s[16:19], s72 offen offset:0 lds
 s_lshl_b32 s86, s85, 19
 s_mul_i32 s87, s85, 221184
 v_mfma_f32_16x16x32_bf16 v[200:203], a[48:51], a[40:43], v[200:203]
 v_mfma_f32_16x16x32_bf16 v[204:207], a[48:51], a[44:47], v[204:207]
 ds_read_b64_tr_b16 a[48:49], v22 offset:49152
 ds_read_b64_tr_b16 a[50:51], v22 offset:49664
 v_mfma_f32_16x16x32_bf16 v[220:223], a[52:55], a[44:47], v[220:223]
 v_mfma_f32_16x16x32_bf16 v[216:219], a[52:55], a[40:43], v[216:219]
 buffer_load_dwordx4 v7, s[16:19], s73 offen offset:1024 lds
 v_mfma_f32_16x16x32_bf16 v[212:215], a[52:55], a[36:39], v[212:215]
 v_mfma_f32_16x16x32_bf16 v[208:211], a[52:55], a[32:35], v[208:211]
 ds_read_b64_tr_b16 a[52:53], v22 offset:51200
 ds_read_b64_tr_b16 a[54:55], v22 offset:51712
 v_mfma_f32_16x16x32_bf16 v[224:227], a[56:59], a[32:35], v[224:227]
 s_add_u32 m0, s63, 0
 v_mfma_f32_16x16x32_bf16 v[228:231], a[56:59], a[36:39], v[228:231]
 buffer_load_dwordx4 v2, s[4:7], s64 offen offset:0 sc1 lds
 v_mfma_f32_16x16x32_bf16 v[232:235], a[56:59], a[40:43], v[232:235]
 v_mfma_f32_16x16x32_bf16 v[236:239], a[56:59], a[44:47], v[236:239]
 ds_read_b64_tr_b16 a[56:57], v23 offset:49152
 ds_read_b64_tr_b16 a[58:59], v23 offset:49664
 v_mfma_f32_16x16x32_bf16 v[252:255], a[60:63], a[44:47], v[252:255]
 v_mfma_f32_16x16x32_bf16 v[248:251], a[60:63], a[40:43], v[248:251]
 buffer_load_dwordx4 v3, s[4:7], s64 offen offset:1024 sc1 lds
 v_add_u32_e64 v6, s87, v6
 v_mfma_f32_16x16x32_bf16 v[244:247], a[60:63], a[36:39], v[244:247]
 v_add_u32_e64 v7, s87, v7
 v_mfma_f32_16x16x32_bf16 v[240:243], a[60:63], a[32:35], v[240:243]
 ds_read_b64_tr_b16 a[60:61], v23 offset:51200
 ds_read_b64_tr_b16 a[62:63], v23 offset:51712
 s_waitcnt lgkmcnt(4)
 v_mfma_f32_16x16x32_bf16 a[64:67], a[16:19], a[0:3], a[64:67]
 v_mfma_f32_16x16x32_bf16 a[68:71], a[16:19], a[4:7], a[68:71]
 buffer_load_dwordx4 v2, s[4:7], s65 offen offset:2048 sc1 lds
 v_mfma_f32_16x16x32_bf16 a[72:75], a[16:19], a[8:11], a[72:75]
 v_mfma_f32_16x16x32_bf16 a[76:79], a[16:19], a[12:15], a[76:79]
 ds_read_b64_tr_b16 a[16:17], v12 offset:32768
 ds_read_b64_tr_b16 a[18:19], v12 offset:33792
 v_mfma_f32_16x16x32_bf16 a[92:95], a[20:23], a[12:15], a[92:95]
 v_mfma_f32_16x16x32_bf16 a[88:91], a[20:23], a[8:11], a[88:91]
 buffer_load_dwordx4 v3, s[4:7], s65 offen offset:3072 sc1 lds
 v_mfma_f32_16x16x32_bf16 a[84:87], a[20:23], a[4:7], a[84:87]
 v_mfma_f32_16x16x32_bf16 a[80:83], a[20:23], a[0:3], a[80:83]
 ds_read_b64_tr_b16 a[20:21], v13 offset:32768
 ds_read_b64_tr_b16 a[22:23], v13 offset:33792
 v_mfma_f32_16x16x32_bf16 a[96:99], a[24:27], a[0:3], a[96:99]
 ds_read_b128 a[32:35], v11 offset:32768
 s_add_u32 m0, s62, 0
 v_mfma_f32_16x16x32_bf16 a[100:103], a[24:27], a[4:7], a[100:103]
 buffer_load_dwordx4 v4, s[8:11], s68 offen offset:0 lds
 v_mfma_f32_16x16x32_bf16 a[104:107], a[24:27], a[8:11], a[104:107]
 v_mfma_f32_16x16x32_bf16 a[108:111], a[24:27], a[12:15], a[108:111]
 ds_read_b64_tr_b16 a[24:25], v14 offset:32768
 ds_read_b64_tr_b16 a[26:27], v14 offset:33792
 v_mfma_f32_16x16x32_bf16 a[124:127], a[28:31], a[12:15], a[124:127]
 v_mfma_f32_16x16x32_bf16 a[120:123], a[28:31], a[8:11], a[120:123]
 buffer_load_dwordx4 v4, s[8:11], s69 offen offset:1024 lds
 v_mfma_f32_16x16x32_bf16 a[116:119], a[28:31], a[4:7], a[116:119]
 v_mfma_f32_16x16x32_bf16 a[112:115], a[28:31], a[0:3], a[112:115]
 ds_read_b64_tr_b16 a[28:29], v15 offset:32768
 ds_read_b64_tr_b16 a[30:31], v15 offset:33792
 v_mfma_f32_16x16x32_bf16 a[128:131], a[48:51], a[0:3], a[128:131]
 v_mfma_f32_16x16x32_bf16 a[132:135], a[48:51], a[4:7], a[132:135]
 buffer_load_dwordx4 v5, s[8:11], s70 offen offset:2048 lds
 v_mfma_f32_16x16x32_bf16 a[136:139], a[48:51], a[8:11], a[136:139]
 ds_read_b128 a[36:39], v11 offset:34816
 v_mfma_f32_16x16x32_bf16 a[140:143], a[48:51], a[12:15], a[140:143]
 ds_read_b64_tr_b16 a[48:49], v16 offset:32768
 ds_read_b64_tr_b16 a[50:51], v16 offset:33792
 v_mfma_f32_16x16x32_bf16 a[156:159], a[52:55], a[12:15], a[156:159]
 v_mfma_f32_16x16x32_bf16 a[152:155], a[52:55], a[8:11], a[152:155]
 buffer_load_dwordx4 v5, s[8:11], s71 offen offset:3072 lds
 v_add_u32_e64 v4, s86, v4
 v_mfma_f32_16x16x32_bf16 a[148:151], a[52:55], a[4:7], a[148:151]
 v_add_u32_e64 v5, s86, v5
 v_mfma_f32_16x16x32_bf16 a[144:147], a[52:55], a[0:3], a[144:147]
 ds_read_b64_tr_b16 a[52:53], v17 offset:32768
 ds_read_b64_tr_b16 a[54:55], v17 offset:33792
 s_waitcnt lgkmcnt(5)
 v_mfma_f32_16x16x32_bf16 a[160:163], a[56:59], a[0:3], a[160:163]
 s_add_u32 m0, s63, 4096
 v_mfma_f32_16x16x32_bf16 a[164:167], a[56:59], a[4:7], a[164:167]
 buffer_load_dwordx4 v2, s[4:7], s66 offen offset:0 sc1 lds
 v_mfma_f32_16x16x32_bf16 a[168:171], a[56:59], a[8:11], a[168:171]
 v_mfma_f32_16x16x32_bf16 a[172:175], a[56:59], a[12:15], a[172:175]
 ds_read_b64_tr_b16 a[56:57], v18 offset:32768
 ds_read_b64_tr_b16 a[58:59], v18 offset:33792
 v_mfma_f32_16x16x32_bf16 a[188:191], a[60:63], a[12:15], a[188:191]
 ds_read_b128 a[40:43], v11 offset:36864
 v_mfma_f32_16x16x32_bf16 a[184:187], a[60:63], a[8:11], a[184:187]
 buffer_load_dwordx4 v3, s[4:7], s66 offen offset:1024 sc1 lds
 v_mfma_f32_16x16x32_bf16 a[180:183], a[60:63], a[4:7], a[180:183]
 v_mfma_f32_16x16x32_bf16 a[176:179], a[60:63], a[0:3], a[176:179]
 ds_read_b64_tr_b16 a[60:61], v19 offset:32768
 ds_read_b64_tr_b16 a[62:63], v19 offset:33792
 v_mfma_f32_16x16x32_bf16 a[192:195], a[16:19], a[0:3], a[192:195]
 v_mfma_f32_16x16x32_bf16 a[196:199], a[16:19], a[4:7], a[196:199]
 buffer_load_dwordx4 v2, s[4:7], s67 offen offset:2048 sc1 lds
 v_mfma_f32_16x16x32_bf16 a[200:203], a[16:19], a[8:11], a[200:203]
 v_mfma_f32_16x16x32_bf16 a[204:207], a[16:19], a[12:15], a[204:207]
 ds_read_b64_tr_b16 a[16:17], v20 offset:57344
 ds_read_b64_tr_b16 a[18:19], v20 offset:57856
 v_mfma_f32_16x16x32_bf16 a[220:223], a[20:23], a[12:15], a[220:223]
 v_mfma_f32_16x16x32_bf16 a[216:219], a[20:23], a[8:11], a[216:219]
 buffer_load_dwordx4 v3, s[4:7], s67 offen offset:3072 sc1 lds
 v_lshl_add_u32 v2, s85, 7, v2
 v_mfma_f32_16x16x32_bf16 a[212:215], a[20:23], a[4:7], a[212:215]
 ds_read_b128 a[44:47], v11 offset:38912
 v_lshl_add_u32 v3, s85, 7, v3
 v_mfma_f32_16x16x32_bf16 a[208:211], a[20:23], a[0:3], a[208:211]
 ds_read_b64_tr_b16 a[20:21], v20 offset:59392
 ds_read_b64_tr_b16 a[22:23], v20 offset:59904
 v_mfma_f32_16x16x32_bf16 v[160:163], a[24:27], a[0:3], v[160:163]
 v_mfma_f32_16x16x32_bf16 v[164:167], a[24:27], a[4:7], v[164:167]
 v_mfma_f32_16x16x32_bf16 v[168:171], a[24:27], a[8:11], v[168:171]
 s_mov_b32 s78, 49152
 buffer_store_dwordx4 v[104:107], v25, s[20:23], s78 offen offset:0 sc1
 v_mfma_f32_16x16x32_bf16 v[172:175], a[24:27], a[12:15], v[172:175]
 v_mfma_f32_16x16x32_bf16 v[188:191], a[28:31], a[12:15], v[188:191]
 v_mfma_f32_16x16x32_bf16 v[184:187], a[28:31], a[8:11], v[184:187]
 v_mfma_f32_16x16x32_bf16 v[180:183], a[28:31], a[4:7], v[180:183]
 ds_read_b64_tr_b16 a[24:25], v21 offset:57344
 ds_read_b64_tr_b16 a[26:27], v21 offset:57856
 v_mfma_f32_16x16x32_bf16 v[176:179], a[28:31], a[0:3], v[176:179]
 ds_read_b64_tr_b16 a[28:29], v21 offset:59392
 ds_read_b64_tr_b16 a[30:31], v21 offset:59904
 s_waitcnt lgkmcnt(4)
 v_mfma_f32_16x16x32_bf16 v[192:195], a[48:51], a[0:3], v[192:195]
 v_mfma_f32_16x16x32_bf16 v[196:199], a[48:51], a[4:7], v[196:199]
 v_mfma_f32_16x16x32_bf16 v[200:203], a[48:51], a[8:11], v[200:203]
 v_mfma_f32_16x16x32_bf16 v[204:207], a[48:51], a[12:15], v[204:207]
 ds_read_b64_tr_b16 a[48:49], v22 offset:57344
 ds_read_b64_tr_b16 a[50:51], v22 offset:57856
 v_mfma_f32_16x16x32_bf16 v[220:223], a[52:55], a[12:15], v[220:223]
 v_mfma_f32_16x16x32_bf16 v[216:219], a[52:55], a[8:11], v[216:219]
 v_mfma_f32_16x16x32_bf16 v[212:215], a[52:55], a[4:7], v[212:215]
 v_mfma_f32_16x16x32_bf16 v[208:211], a[52:55], a[0:3], v[208:211]
 ds_read_b64_tr_b16 a[52:53], v22 offset:59392
 ds_read_b64_tr_b16 a[54:55], v22 offset:59904
 v_mfma_f32_16x16x32_bf16 v[224:227], a[56:59], a[0:3], v[224:227]
 v_mfma_f32_16x16x32_bf16 v[228:231], a[56:59], a[4:7], v[228:231]
 buffer_store_dwordx4 v[120:123], v25, s[20:23], s78 offen offset:1024 sc1
 v_mfma_f32_16x16x32_bf16 v[232:235], a[56:59], a[8:11], v[232:235]
 v_mfma_f32_16x16x32_bf16 v[236:239], a[56:59], a[12:15], v[236:239]
 v_mfma_f32_16x16x32_bf16 v[252:255], a[60:63], a[12:15], v[252:255]
 v_mfma_f32_16x16x32_bf16 v[248:251], a[60:63], a[8:11], v[248:251]
 ds_read_b64_tr_b16 a[56:57], v23 offset:57344
 ds_read_b64_tr_b16 a[58:59], v23 offset:57856
 v_mfma_f32_16x16x32_bf16 v[244:247], a[60:63], a[4:7], v[244:247]
 v_mfma_f32_16x16x32_bf16 v[240:243], a[60:63], a[0:3], v[240:243]
 ds_read_b64_tr_b16 a[60:61], v23 offset:59392
 ds_read_b64_tr_b16 a[62:63], v23 offset:59904
 v_mfma_f32_16x16x32_bf16 a[64:67], a[16:19], a[32:35], a[64:67]
 v_mfma_f32_16x16x32_bf16 a[68:71], a[16:19], a[36:39], a[68:71]
 v_mfma_f32_16x16x32_bf16 a[72:75], a[16:19], a[40:43], a[72:75]
 v_mfma_f32_16x16x32_bf16 a[76:79], a[16:19], a[44:47], a[76:79]
 ds_read_b64_tr_b16 a[16:17], v12 offset:40960
 ds_read_b64_tr_b16 a[18:19], v12 offset:41984
 v_mfma_f32_16x16x32_bf16 a[92:95], a[20:23], a[44:47], a[92:95]
 v_mfma_f32_16x16x32_bf16 a[88:91], a[20:23], a[40:43], a[88:91]
 v_mfma_f32_16x16x32_bf16 a[84:87], a[20:23], a[36:39], a[84:87]
 v_mfma_f32_16x16x32_bf16 a[80:83], a[20:23], a[32:35], a[80:83]
 ds_read_b64_tr_b16 a[20:21], v13 offset:40960
 ds_read_b64_tr_b16 a[22:23], v13 offset:41984
 s_waitcnt lgkmcnt(4)
 v_mfma_f32_16x16x32_bf16 a[96:99], a[24:27], a[32:35], a[96:99]
 buffer_store_dwordx4 v[136:139], v25, s[20:23], s78 offen offset:2048 sc1
 v_mfma_f32_16x16x32_bf16 a[100:103], a[24:27], a[36:39], a[100:103]
 v_mfma_f32_16x16x32_bf16 a[104:107], a[24:27], a[40:43], a[104:107]
 v_mfma_f32_16x16x32_bf16 a[108:111], a[24:27], a[44:47], a[108:111]
 v_mfma_f32_16x16x32_bf16 a[124:127], a[28:31], a[44:47], a[124:127]
 ds_read_b64_tr_b16 a[24:25], v14 offset:40960
 ds_read_b64_tr_b16 a[26:27], v14 offset:41984
 v_mfma_f32_16x16x32_bf16 a[120:123], a[28:31], a[40:43], a[120:123]
 v_mfma_f32_16x16x32_bf16 a[116:119], a[28:31], a[36:39], a[116:119]
 v_mfma_f32_16x16x32_bf16 a[112:115], a[28:31], a[32:35], a[112:115]
 ds_read_b64_tr_b16 a[28:29], v15 offset:40960
 ds_read_b64_tr_b16 a[30:31], v15 offset:41984
 v_mfma_f32_16x16x32_bf16 a[128:131], a[48:51], a[32:35], a[128:131]
 v_mfma_f32_16x16x32_bf16 a[132:135], a[48:51], a[36:39], a[132:135]
 v_mfma_f32_16x16x32_bf16 a[136:139], a[48:51], a[40:43], a[136:139]
 v_mfma_f32_16x16x32_bf16 a[140:143], a[48:51], a[44:47], a[140:143]
 ds_read_b64_tr_b16 a[48:49], v16 offset:40960
 ds_read_b64_tr_b16 a[50:51], v16 offset:41984
 v_mfma_f32_16x16x32_bf16 a[156:159], a[52:55], a[44:47], a[156:159]
 v_mfma_f32_16x16x32_bf16 a[152:155], a[52:55], a[40:43], a[152:155]
 v_mfma_f32_16x16x32_bf16 a[148:151], a[52:55], a[36:39], a[148:151]
 v_mfma_f32_16x16x32_bf16 a[144:147], a[52:55], a[32:35], a[144:147]
 buffer_store_dwordx4 v[152:155], v25, s[20:23], s78 offen offset:3072 sc1
 v_mfma_f32_16x16x32_bf16 a[160:163], a[56:59], a[32:35], a[160:163]
 v_mfma_f32_16x16x32_bf16 a[164:167], a[56:59], a[36:39], a[164:167]
 v_mfma_f32_16x16x32_bf16 a[168:171], a[56:59], a[40:43], a[168:171]
 v_mfma_f32_16x16x32_bf16 a[172:175], a[56:59], a[44:47], a[172:175]
 ds_read_b64_tr_b16 a[52:53], v17 offset:40960
 ds_read_b64_tr_b16 a[54:55], v17 offset:41984
 v_mfma_f32_16x16x32_bf16 a[188:191], a[60:63], a[44:47], a[188:191]
 ds_read_b64_tr_b16 a[56:57], v18 offset:40960
 ds_read_b64_tr_b16 a[58:59], v18 offset:41984
 v_mfma_f32_16x16x32_bf16 a[184:187], a[60:63], a[40:43], a[184:187]
 v_mfma_f32_16x16x32_bf16 a[180:183], a[60:63], a[36:39], a[180:183]
 v_mfma_f32_16x16x32_bf16 a[176:179], a[60:63], a[32:35], a[176:179]
 ds_read_b64_tr_b16 a[60:61], v19 offset:40960
 ds_read_b64_tr_b16 a[62:63], v19 offset:41984
 s_waitcnt lgkmcnt(6)
 v_mfma_f32_16x16x32_bf16 a[192:195], a[16:19], a[32:35], a[192:195]
 v_mfma_f32_16x16x32_bf16 a[196:199], a[16:19], a[36:39], a[196:199]
 v_mfma_f32_16x16x32_bf16 a[200:203], a[16:19], a[40:43], a[200:203]
 v_mfma_f32_16x16x32_bf16 a[204:207], a[16:19], a[44:47], a[204:207]
 v_mfma_f32_16x16x32_bf16 a[220:223], a[20:23], a[44:47], a[220:223]
 v_mfma_f32_16x16x32_bf16 a[216:219], a[20:23], a[40:43], a[216:219]
 v_mfma_f32_16x16x32_bf16 a[212:215], a[20:23], a[36:39], a[212:215]
 v_mfma_f32_16x16x32_bf16 a[208:211], a[20:23], a[32:35], a[208:211]
 s_waitcnt vmcnt(4)
 s_waitcnt lgkmcnt(0)
 s_barrier
 v_mfma_f32_16x16x32_bf16 v[160:163], a[24:27], a[32:35], v[160:163]
 ds_read_b64_tr_b16 a[16:17], v20 offset:16384
 ds_read_b64_tr_b16 a[18:19], v20 offset:16896
 s_add_u32 m0, s62, 49152
 v_mfma_f32_16x16x32_bf16 v[164:167], a[24:27], a[36:39], v[164:167]
 buffer_load_dwordx4 v6, s[12:15], s72 offen offset:0 lds
 ds_read_b64_tr_b16 a[20:21], v20 offset:18432
 ds_read_b64_tr_b16 a[22:23], v20 offset:18944
 v_mfma_f32_16x16x32_bf16 v[168:171], a[24:27], a[40:43], v[168:171]
 ds_read_b128 a[0:3], v10 offset:0
 ds_read_b128 a[4:7], v10 offset:2048
 v_mfma_f32_16x16x32_bf16 v[172:175], a[24:27], a[44:47], v[172:175]
 ds_read_b64_tr_b16 a[24:25], v21 offset:16384
 ds_read_b64_tr_b16 a[26:27], v21 offset:16896
 v_mfma_f32_16x16x32_bf16 v[188:191], a[28:31], a[44:47], v[188:191]
 ds_read_b128 a[8:11], v10 offset:4096
 v_mfma_f32_16x16x32_bf16 v[184:187], a[28:31], a[40:43], v[184:187]
 buffer_load_dwordx4 v7, s[12:15], s73 offen offset:1024 lds
 v_mfma_f32_16x16x32_bf16 v[180:183], a[28:31], a[36:39], v[180:183]
 ds_read_b128 a[12:15], v10 offset:6144
 v_mfma_f32_16x16x32_bf16 v[176:179], a[28:31], a[32:35], v[176:179]
 ds_read_b64_tr_b16 a[28:29], v21 offset:18432
 ds_read_b64_tr_b16 a[30:31], v21 offset:18944
 v_mfma_f32_16x16x32_bf16 v[192:195], a[48:51], a[32:35], v[192:195]
 s_add_u32 s84, s84, 1
 s_cmp_eq_u32 s84, 10
 s_cselect_b32 s85, -9, 1
 s_cmov_b32 s84, 0
 s_add_u32 m0, s62, 51200
 v_mfma_f32_16x16x32_bf16 v[196:199], a[48:51], a[36:39], v[196:199]
 buffer_load_dwordx4 v6, s[16:19], s72 offen offset:0 lds
 s_lshl_b32 s86, s85, 19
 s_mul_i32 s87, s85, 221184
 v_mfma_f32_16x16x32_bf16 v[200:203], a[48:51], a[40:43], v[200:203]
 v_mfma_f32_16x16x32_bf16 v[204:207], a[48:51], a[44:47], v[204:207]
 ds_read_b64_tr_b16 a[48:49], v22 offset:16384
 ds_read_b64_tr_b16 a[50:51], v22 offset:16896
 v_mfma_f32_16x16x32_bf16 v[220:223], a[52:55], a[44:47], v[220:223]
 v_mfma_f32_16x16x32_bf16 v[216:219], a[52:55], a[40:43], v[216:219]
 buffer_load_dwordx4 v7, s[16:19], s73 offen offset:1024 lds
 v_mfma_f32_16x16x32_bf16 v[212:215], a[52:55], a[36:39], v[212:215]
 v_mfma_f32_16x16x32_bf16 v[208:211], a[52:55], a[32:35], v[208:211]
 ds_read_b64_tr_b16 a[52:53], v22 offset:18432
 ds_read_b64_tr_b16 a[54:55], v22 offset:18944
 v_mfma_f32_16x16x32_bf16 v[224:227], a[56:59], a[32:35], v[224:227]
 s_add_u32 m0, s63, 32768
 v_mfma_f32_16x16x32_bf16 v[228:231], a[56:59], a[36:39], v[228:231]
 buffer_load_dwordx4 v2, s[4:7], s64 offen offset:0 sc1 lds
 v_mfma_f32_16x16x32_bf16 v[232:235], a[56:59], a[40:43], v[232:235]
 v_mfma_f32_16x16x32_bf16 v[236:239], a[56:59], a[44:47], v[236:239]
 ds_read_b64_tr_b16 a[56:57], v23 offset:16384
 ds_read_b64_tr_b16 a[58:59], v23 offset:16896
 v_mfma_f32_16x16x32_bf16 v[252:255], a[60:63], a[44:47], v[252:255]
 v_mfma_f32_16x16x32_bf16 v[248:251], a[60:63], a[40:43], v[248:251]
 buffer_load_dwordx4 v3, s[4:7], s64 offen offset:1024 sc1 lds
 v_add_u32_e64 v6, s87, v6
 v_mfma_f32_16x16x32_bf16 v[244:247], a[60:63], a[36:39], v[244:247]
 v_add_u32_e64 v7, s87, v7
 v_mfma_f32_16x16x32_bf16 v[240:243], a[60:63], a[32:35], v[240:243]
 ds_read_b64_tr_b16 a[60:61], v23 offset:18432
 ds_read_b64_tr_b16 a[62:63], v23 offset:18944
 s_waitcnt lgkmcnt(4)
 v_mfma_f32_16x16x32_bf16 a[64:67], a[16:19], a[0:3], a[64:67]
 v_mfma_f32_16x16x32_bf16 a[68:71], a[16:19], a[4:7], a[68:71]
 buffer_load_dwordx4 v2, s[4:7], s65 offen offset:2048 sc1 lds
 v_mfma_f32_16x16x32_bf16 a[72:75], a[16:19], a[8:11], a[72:75]
 v_mfma_f32_16x16x32_bf16 a[76:79], a[16:19], a[12:15], a[76:79]
 ds_read_b64_tr_b16 a[16:17], v12 offset:0
 ds_read_b64_tr_b16 a[18:19], v12 offset:1024
 v_mfma_f32_16x16x32_bf16 a[92:95], a[20:23], a[12:15], a[92:95]
 v_mfma_f32_16x16x32_bf16 a[88:91], a[20:23], a[8:11], a[88:91]
 buffer_load_dwordx4 v3, s[4:7], s65 offen offset:3072 sc1 lds
 v_mfma_f32_16x16x32_bf16 a[84:87], a[20:23], a[4:7], a[84:87]
 v_mfma_f32_16x16x32_bf16 a[80:83], a[20:23], a[0:3], a[80:83]
 ds_read_b64_tr_b16 a[20:21], v13 offset:0
 ds_read_b64_tr_b16 a[22:23], v13 offset:1024
 v_mfma_f32_16x16x32_bf16 a[96:99], a[24:27], a[0:3], a[96:99]
 ds_read_b128 a[32:35], v11 offset:0
 s_add_u32 m0, s62, 32768
 v_mfma_f32_16x16x32_bf16 a[100:103], a[24:27], a[4:7], a[100:103]
 buffer_load_dwordx4 v4, s[8:11], s68 offen offset:0 lds
 v_mfma_f32_16x16x32_bf16 a[104:107], a[24:27], a[8:11], a[104:107]
 v_mfma_f32_16x16x32_bf16 a[108:111], a[24:27], a[12:15], a[108:111]
 ds_read_b64_tr_b16 a[24:25], v14 offset:0
 ds_read_b64_tr_b16 a[26:27], v14 offset:1024
 v_mfma_f32_16x16x32_bf16 a[124:127], a[28:31], a[12:15], a[124:127]
 v_mfma_f32_16x16x32_bf16 a[120:123], a[28:31], a[8:11], a[120:123]
 buffer_load_dwordx4 v4, s[8:11], s69 offen offset:1024 lds
 v_mfma_f32_16x16x32_bf16 a[116:119], a[28:31], a[4:7], a[116:119]
 v_mfma_f32_16x16x32_bf16 a[112:115], a[28:31], a[0:3], a[112:115]
 ds_read_b64_tr_b16 a[28:29], v15 offset:0
 ds_read_b64_tr_b16 a[30:31], v15 offset:1024
 v_mfma_f32_16x16x32_bf16 a[128:131], a[48:51], a[0:3], a[128:131]
 v_mfma_f32_16x16x32_bf16 a[132:135], a[48:51], a[4:7], a[132:135]
 buffer_load_dwordx4 v5, s[8:11], s70 offen offset:2048 lds
 v_mfma_f32_16x16x32_bf16 a[136:139], a[48:51], a[8:11], a[136:139]
 ds_read_b128 a[36:39], v11 offset:2048
 v_mfma_f32_16x16x32_bf16 a[140:143], a[48:51], a[12:15], a[140:143]
 ds_read_b64_tr_b16 a[48:49], v16 offset:0
 ds_read_b64_tr_b16 a[50:51], v16 offset:1024
 v_mfma_f32_16x16x32_bf16 a[156:159], a[52:55], a[12:15], a[156:159]
 v_mfma_f32_16x16x32_bf16 a[152:155], a[52:55], a[8:11], a[152:155]
 buffer_load_dwordx4 v5, s[8:11], s71 offen offset:3072 lds
 v_add_u32 v4, s86, v4
 v_mfma_f32_16x16x32_bf16 a[148:151], a[52:55], a[4:7], a[148:151]
 v_add_u32_e64 v5, s86, v5
 v_mfma_f32_16x16x32_bf16 a[144:147], a[52:55], a[0:3], a[144:147]
 ds_read_b64_tr_b16 a[52:53], v17 offset:0
 ds_read_b64_tr_b16 a[54:55], v17 offset:1024
 s_waitcnt lgkmcnt(5)
 v_mfma_f32_16x16x32_bf16 a[160:163], a[56:59], a[0:3], a[160:163]
 s_add_u32 m0, s63, 36864
 v_mfma_f32_16x16x32_bf16 a[164:167], a[56:59], a[4:7], a[164:167]
 buffer_load_dwordx4 v2, s[4:7], s66 offen offset:0 sc1 lds
 v_mfma_f32_16x16x32_bf16 a[168:171], a[56:59], a[8:11], a[168:171]
 v_mfma_f32_16x16x32_bf16 a[172:175], a[56:59], a[12:15], a[172:175]
 ds_read_b64_tr_b16 a[56:57], v18 offset:0
 ds_read_b64_tr_b16 a[58:59], v18 offset:1024
 v_mfma_f32_16x16x32_bf16 a[188:191], a[60:63], a[12:15], a[188:191]
 ds_read_b128 a[40:43], v11 offset:4096
 v_mfma_f32_16x16x32_bf16 a[184:187], a[60:63], a[8:11], a[184:187]
 buffer_load_dwordx4 v3, s[4:7], s66 offen offset:1024 sc1 lds
 v_mfma_f32_16x16x32_bf16 a[180:183], a[60:63], a[4:7], a[180:183]
 v_mfma_f32_16x16x32_bf16 a[176:179], a[60:63], a[0:3], a[176:179]
 ds_read_b64_tr_b16 a[60:61], v19 offset:0
 ds_read_b64_tr_b16 a[62:63], v19 offset:1024
 v_mfma_f32_16x16x32_bf16 a[192:195], a[16:19], a[0:3], a[192:195]
 v_mfma_f32_16x16x32_bf16 a[196:199], a[16:19], a[4:7], a[196:199]
 buffer_load_dwordx4 v2, s[4:7], s67 offen offset:2048 sc1 lds
 v_mfma_f32_16x16x32_bf16 a[200:203], a[16:19], a[8:11], a[200:203]
 v_mfma_f32_16x16x32_bf16 a[204:207], a[16:19], a[12:15], a[204:207]
 ds_read_b64_tr_b16 a[16:17], v20 offset:24576
 ds_read_b64_tr_b16 a[18:19], v20 offset:25088
 v_mfma_f32_16x16x32_bf16 a[220:223], a[20:23], a[12:15], a[220:223]
 v_mfma_f32_16x16x32_bf16 a[216:219], a[20:23], a[8:11], a[216:219]
 buffer_load_dwordx4 v3, s[4:7], s67 offen offset:3072 sc1 lds
 v_lshl_add_u32 v2, s85, 7, v2
 v_mfma_f32_16x16x32_bf16 a[212:215], a[20:23], a[4:7], a[212:215]
 ds_read_b128 a[44:47], v11 offset:6144
 v_lshl_add_u32 v3, s85, 7, v3
 v_mfma_f32_16x16x32_bf16 a[208:211], a[20:23], a[0:3], a[208:211]
 ds_read_b64_tr_b16 a[20:21], v20 offset:26624
 ds_read_b64_tr_b16 a[22:23], v20 offset:27136
 v_mfma_f32_16x16x32_bf16 v[160:163], a[24:27], a[0:3], v[160:163]
 v_mfma_f32_16x16x32_bf16 v[164:167], a[24:27], a[4:7], v[164:167]
 v_mfma_f32_16x16x32_bf16 v[168:171], a[24:27], a[8:11], v[168:171]
 s_mov_b32 s78, 57344
 buffer_store_dwordx4 v[108:111], v25, s[20:23], s78 offen offset:0 sc1
 v_mfma_f32_16x16x32_bf16 v[172:175], a[24:27], a[12:15], v[172:175]
 v_mfma_f32_16x16x32_bf16 v[188:191], a[28:31], a[12:15], v[188:191]
 v_mfma_f32_16x16x32_bf16 v[184:187], a[28:31], a[8:11], v[184:187]
 v_mfma_f32_16x16x32_bf16 v[180:183], a[28:31], a[4:7], v[180:183]
 ds_read_b64_tr_b16 a[24:25], v21 offset:24576
 ds_read_b64_tr_b16 a[26:27], v21 offset:25088
 v_mfma_f32_16x16x32_bf16 v[176:179], a[28:31], a[0:3], v[176:179]
 ds_read_b64_tr_b16 a[28:29], v21 offset:26624
 ds_read_b64_tr_b16 a[30:31], v21 offset:27136
 s_waitcnt lgkmcnt(4)
 v_mfma_f32_16x16x32_bf16 v[192:195], a[48:51], a[0:3], v[192:195]
 v_mfma_f32_16x16x32_bf16 v[196:199], a[48:51], a[4:7], v[196:199]
 v_mfma_f32_16x16x32_bf16 v[200:203], a[48:51], a[8:11], v[200:203]
 v_mfma_f32_16x16x32_bf16 v[204:207], a[48:51], a[12:15], v[204:207]
 ds_read_b64_tr_b16 a[48:49], v22 offset:24576
 ds_read_b64_tr_b16 a[50:51], v22 offset:25088
 v_mfma_f32_16x16x32_bf16 v[220:223], a[52:55], a[12:15], v[220:223]
 v_mfma_f32_16x16x32_bf16 v[216:219], a[52:55], a[8:11], v[216:219]
 v_mfma_f32_16x16x32_bf16 v[212:215], a[52:55], a[4:7], v[212:215]
 v_mfma_f32_16x16x32_bf16 v[208:211], a[52:55], a[0:3], v[208:211]
 ds_read_b64_tr_b16 a[52:53], v22 offset:26624
 ds_read_b64_tr_b16 a[54:55], v22 offset:27136
 v_mfma_f32_16x16x32_bf16 v[224:227], a[56:59], a[0:3], v[224:227]
 v_mfma_f32_16x16x32_bf16 v[228:231], a[56:59], a[4:7], v[228:231]
 buffer_store_dwordx4 v[124:127], v25, s[20:23], s78 offen offset:1024 sc1
 v_mfma_f32_16x16x32_bf16 v[232:235], a[56:59], a[8:11], v[232:235]
 v_mfma_f32_16x16x32_bf16 v[236:239], a[56:59], a[12:15], v[236:239]
 v_mfma_f32_16x16x32_bf16 v[252:255], a[60:63], a[12:15], v[252:255]
 v_mfma_f32_16x16x32_bf16 v[248:251], a[60:63], a[8:11], v[248:251]
 ds_read_b64_tr_b16 a[56:57], v23 offset:24576
 ds_read_b64_tr_b16 a[58:59], v23 offset:25088
 v_mfma_f32_16x16x32_bf16 v[244:247], a[60:63], a[4:7], v[244:247]
 v_mfma_f32_16x16x32_bf16 v[240:243], a[60:63], a[0:3], v[240:243]
 ds_read_b64_tr_b16 a[60:61], v23 offset:26624
 ds_read_b64_tr_b16 a[62:63], v23 offset:27136
 v_mfma_f32_16x16x32_bf16 a[64:67], a[16:19], a[32:35], a[64:67]
 v_mfma_f32_16x16x32_bf16 a[68:71], a[16:19], a[36:39], a[68:71]
 v_mfma_f32_16x16x32_bf16 a[72:75], a[16:19], a[40:43], a[72:75]
 v_mfma_f32_16x16x32_bf16 a[76:79], a[16:19], a[44:47], a[76:79]
 ds_read_b64_tr_b16 a[16:17], v12 offset:8192
 ds_read_b64_tr_b16 a[18:19], v12 offset:9216
 v_mfma_f32_16x16x32_bf16 a[92:95], a[20:23], a[44:47], a[92:95]
 v_mfma_f32_16x16x32_bf16 a[88:91], a[20:23], a[40:43], a[88:91]
 v_mfma_f32_16x16x32_bf16 a[84:87], a[20:23], a[36:39], a[84:87]
 v_mfma_f32_16x16x32_bf16 a[80:83], a[20:23], a[32:35], a[80:83]
 ds_read_b64_tr_b16 a[20:21], v13 offset:8192
 ds_read_b64_tr_b16 a[22:23], v13 offset:9216
 s_waitcnt lgkmcnt(4)
 v_mfma_f32_16x16x32_bf16 a[96:99], a[24:27], a[32:35], a[96:99]
 buffer_store_dwordx4 v[140:143], v25, s[20:23], s78 offen offset:2048 sc1
 v_mfma_f32_16x16x32_bf16 a[100:103], a[24:27], a[36:39], a[100:103]
 v_mfma_f32_16x16x32_bf16 a[104:107], a[24:27], a[40:43], a[104:107]
 v_mfma_f32_16x16x32_bf16 a[108:111], a[24:27], a[44:47], a[108:111]
 v_mfma_f32_16x16x32_bf16 a[124:127], a[28:31], a[44:47], a[124:127]
 ds_read_b64_tr_b16 a[24:25], v14 offset:8192
 ds_read_b64_tr_b16 a[26:27], v14 offset:9216
 v_mfma_f32_16x16x32_bf16 a[120:123], a[28:31], a[40:43], a[120:123]
 v_mfma_f32_16x16x32_bf16 a[116:119], a[28:31], a[36:39], a[116:119]
 v_mfma_f32_16x16x32_bf16 a[112:115], a[28:31], a[32:35], a[112:115]
 ds_read_b64_tr_b16 a[28:29], v15 offset:8192
 ds_read_b64_tr_b16 a[30:31], v15 offset:9216
 v_mfma_f32_16x16x32_bf16 a[128:131], a[48:51], a[32:35], a[128:131]
 v_mfma_f32_16x16x32_bf16 a[132:135], a[48:51], a[36:39], a[132:135]
 v_mfma_f32_16x16x32_bf16 a[136:139], a[48:51], a[40:43], a[136:139]
 v_mfma_f32_16x16x32_bf16 a[140:143], a[48:51], a[44:47], a[140:143]
 ds_read_b64_tr_b16 a[48:49], v16 offset:8192
 ds_read_b64_tr_b16 a[50:51], v16 offset:9216
 v_mfma_f32_16x16x32_bf16 a[156:159], a[52:55], a[44:47], a[156:159]
 v_mfma_f32_16x16x32_bf16 a[152:155], a[52:55], a[40:43], a[152:155]
L_pg8:
 s_cbranch_execz L_hopr1
 v_mfma_f32_16x16x32_bf16 a[148:151], a[52:55], a[36:39], a[148:151]
 v_mfma_f32_16x16x32_bf16 a[144:147], a[52:55], a[32:35], a[144:147]
 buffer_store_dwordx4 v[156:159], v25, s[20:23], s78 offen offset:3072 sc1
 v_mfma_f32_16x16x32_bf16 a[160:163], a[56:59], a[32:35], a[160:163]
 v_mfma_f32_16x16x32_bf16 a[164:167], a[56:59], a[36:39], a[164:167]
 v_mfma_f32_16x16x32_bf16 a[168:171], a[56:59], a[40:43], a[168:171]
 v_mfma_f32_16x16x32_bf16 a[172:175], a[56:59], a[44:47], a[172:175]
 ds_read_b64_tr_b16 a[52:53], v17 offset:8192
 ds_read_b64_tr_b16 a[54:55], v17 offset:9216
 v_mfma_f32_16x16x32_bf16 a[188:191], a[60:63], a[44:47], a[188:191]
 ds_read_b64_tr_b16 a[56:57], v18 offset:8192
 ds_read_b64_tr_b16 a[58:59], v18 offset:9216
 v_mfma_f32_16x16x32_bf16 a[184:187], a[60:63], a[40:43], a[184:187]
 v_mfma_f32_16x16x32_bf16 a[180:183], a[60:63], a[36:39], a[180:183]
 v_mfma_f32_16x16x32_bf16 a[176:179], a[60:63], a[32:35], a[176:179]
 ds_read_b64_tr_b16 a[60:61], v19 offset:8192
 ds_read_b64_tr_b16 a[62:63], v19 offset:9216
 s_waitcnt lgkmcnt(6)
 v_mfma_f32_16x16x32_bf16 a[192:195], a[16:19], a[32:35], a[192:195]
 v_mfma_f32_16x16x32_bf16 a[196:199], a[16:19], a[36:39], a[196:199]
 v_mfma_f32_16x16x32_bf16 a[200:203], a[16:19], a[40:43], a[200:203]
 v_mfma_f32_16x16x32_bf16 a[204:207], a[16:19], a[44:47], a[204:207]
 v_mfma_f32_16x16x32_bf16 a[220:223], a[20:23], a[44:47], a[220:223]
 v_mfma_f32_16x16x32_bf16 a[216:219], a[20:23], a[40:43], a[216:219]
 v_mfma_f32_16x16x32_bf16 a[212:215], a[20:23], a[36:39], a[212:215]
 v_mfma_f32_16x16x32_bf16 a[208:211], a[20:23], a[32:35], a[208:211]
 s_waitcnt vmcnt(4)
 s_waitcnt lgkmcnt(0)
 s_barrier
 v_mfma_f32_16x16x32_bf16 v[160:163], a[24:27], a[32:35], v[160:163]
 ds_read_b64_tr_b16 a[16:17], v20 offset:49152
 ds_read_b64_tr_b16 a[18:19], v20 offset:49664
 s_add_u32 m0, s62, 16384
 v_mfma_f32_16x16x32_bf16 v[164:167], a[24:27], a[36:39], v[164:167]
 buffer_load_dwordx4 v6, s[12:15], s72 offen offset:0 lds
 ds_read_b64_tr_b16 a[20:21], v20 offset:51200
 ds_read_b64_tr_b16 a[22:23], v20 offset:51712
 v_mfma_f32_16x16x32_bf16 v[168:171], a[24:27], a[40:43], v[168:171]
 ds_read_b128 a[0:3], v10 offset:32768
 ds_read_b128 a[4:7], v10 offset:34816
 v_mfma_f32_16x16x32_bf16 v[172:175], a[24:27], a[44:47], v[172:175]
 ds_read_b64_tr_b16 a[24:25], v21 offset:49152
 ds_read_b64_tr_b16 a[26:27], v21 offset:49664
 v_mfma_f32_16x16x32_bf16 v[188:191], a[28:31], a[44:47], v[188:191]
 ds_read_b128 a[8:11], v10 offset:36864
 v_mfma_f32_16x16x32_bf16 v[184:187], a[28:31], a[40:43], v[184:187]
 buffer_load_dwordx4 v7, s[12:15], s73 offen offset:1024 lds
 v_mfma_f32_16x16x32_bf16 v[180:183], a[28:31], a[36:39], v[180:183]
 ds_read_b128 a[12:15], v10 offset:38912
 v_mfma_f32_16x16x32_bf16 v[176:179], a[28:31], a[32:35], v[176:179]
 ds_read_b64_tr_b16 a[28:29], v21 offset:51200
 ds_read_b64_tr_b16 a[30:31], v21 offset:51712
 v_mfma_f32_16x16x32_bf16 v[192:195], a[48:51], a[32:35], v[192:195]
 s_add_u32 s84, s84, 1
 s_cmp_eq_u32 s84, 10
 s_cselect_b32 s85, -9, 1
 s_cmov_b32 s84, 0
 s_add_u32 m0, s62, 18432
 v_mfma_f32_16x16x32_bf16 v[196:199], a[48:51], a[36:39], v[196:199]
 buffer_load_dwordx4 v6, s[16:19], s72 offen offset:0 lds
 s_lshl_b32 s86, s85, 19
 s_mul_i32 s87, s85, 221184
 v_mfma_f32_16x16x32_bf16 v[200:203], a[48:51], a[40:43], v[200:203]
 v_mfma_f32_16x16x32_bf16 v[204:207], a[48:51], a[44:47], v[204:207]
 ds_read_b64_tr_b16 a[48:49], v22 offset:49152
 ds_read_b64_tr_b16 a[50:51], v22 offset:49664
 v_mfma_f32_16x16x32_bf16 v[220:223], a[52:55], a[44:47], v[220:223]
 v_mfma_f32_16x16x32_bf16 v[216:219], a[52:55], a[40:43], v[216:219]
 buffer_load_dwordx4 v7, s[16:19], s73 offen offset:1024 lds
 v_mfma_f32_16x16x32_bf16 v[212:215], a[52:55], a[36:39], v[212:215]
 v_mfma_f32_16x16x32_bf16 v[208:211], a[52:55], a[32:35], v[208:211]
 ds_read_b64_tr_b16 a[52:53], v22 offset:51200
 ds_read_b64_tr_b16 a[54:55], v22 offset:51712
 v_mfma_f32_16x16x32_bf16 v[224:227], a[56:59], a[32:35], v[224:227]
 s_add_u32 m0, s63, 0
 v_mfma_f32_16x16x32_bf16 v[228:231], a[56:59], a[36:39], v[228:231]
 buffer_load_dwordx4 v2, s[4:7], s64 offen offset:0 sc1 lds
 v_mfma_f32_16x16x32_bf16 v[232:235], a[56:59], a[40:43], v[232:235]
 v_mfma_f32_16x16x32_bf16 v[236:239], a[56:59], a[44:47], v[236:239]
 ds_read_b64_tr_b16 a[56:57], v23 offset:49152
 ds_read_b64_tr_b16 a[58:59], v23 offset:49664
 v_mfma_f32_16x16x32_bf16 v[252:255], a[60:63], a[44:47], v[252:255]
 v_mfma_f32_16x16x32_bf16 v[248:251], a[60:63], a[40:43], v[248:251]
 buffer_load_dwordx4 v3, s[4:7], s64 offen offset:1024 sc1 lds
 v_add_u32_e64 v6, s87, v6
 v_mfma_f32_16x16x32_bf16 v[244:247], a[60:63], a[36:39], v[244:247]
 v_add_u32_e64 v7, s87, v7
 v_mfma_f32_16x16x32_bf16 v[240:243], a[60:63], a[32:35], v[240:243]
 ds_read_b64_tr_b16 a[60:61], v23 offset:51200
 ds_read_b64_tr_b16 a[62:63], v23 offset:51712
 s_waitcnt lgkmcnt(4)
 v_mfma_f32_16x16x32_bf16 a[64:67], a[16:19], a[0:3], a[64:67]
 v_mfma_f32_16x16x32_bf16 a[68:71], a[16:19], a[4:7], a[68:71]
 buffer_load_dwordx4 v2, s[4:7], s65 offen offset:2048 sc1 lds
 v_mfma_f32_16x16x32_bf16 a[72:75], a[16:19], a[8:11], a[72:75]
 v_mfma_f32_16x16x32_bf16 a[76:79], a[16:19], a[12:15], a[76:79]
 ds_read_b64_tr_b16 a[16:17], v12 offset:32768
 ds_read_b64_tr_b16 a[18:19], v12 offset:33792
 v_mfma_f32_16x16x32_bf16 a[92:95], a[20:23], a[12:15], a[92:95]
 v_mfma_f32_16x16x32_bf16 a[88:91], a[20:23], a[8:11], a[88:91]
 buffer_load_dwordx4 v3, s[4:7], s65 offen offset:3072 sc1 lds
 v_accvgpr_read_b32 v32, a64
 v_mfma_f32_16x16x32_bf16 a[84:87], a[20:23], a[4:7], a[84:87]
 v_accvgpr_read_b32 v33, a65
 v_mfma_f32_16x16x32_bf16 a[80:83], a[20:23], a[0:3], a[80:83]
 ds_read_b64_tr_b16 a[20:21], v13 offset:32768
 ds_read_b64_tr_b16 a[22:23], v13 offset:33792
 v_mfma_f32_16x16x32_bf16 a[96:99], a[24:27], a[0:3], a[96:99]
 ds_read_b128 a[32:35], v11 offset:32768
 s_add_u32 m0, s62, 0
 v_mfma_f32_16x16x32_bf16 a[100:103], a[24:27], a[4:7], a[100:103]
 buffer_load_dwordx4 v4, s[8:11], s68 offen offset:0 lds
 v_accvgpr_read_b32 v34, a66
 v_mfma_f32_16x16x32_bf16 a[104:107], a[24:27], a[8:11], a[104:107]
 v_accvgpr_read_b32 v35, a67
 v_mfma_f32_16x16x32_bf16 a[108:111], a[24:27], a[12:15], a[108:111]
 ds_read_b64_tr_b16 a[24:25], v14 offset:32768
 ds_read_b64_tr_b16 a[26:27], v14 offset:33792
 v_mfma_f32_16x16x32_bf16 a[124:127], a[28:31], a[12:15], a[124:127]
 v_accvgpr_read_b32 v36, a68
 v_mfma_f32_16x16x32_bf16 a[120:123], a[28:31], a[8:11], a[120:123]
 buffer_load_dwordx4 v4, s[8:11], s69 offen offset:1024 lds
 v_accvgpr_read_b32 v37, a69
 v_mfma_f32_16x16x32_bf16 a[116:119], a[28:31], a[4:7], a[116:119]
 v_accvgpr_read_b32 v38, a70
 v_mfma_f32_16x16x32_bf16 a[112:115], a[28:31], a[0:3], a[112:115]
 ds_read_b64_tr_b16 a[28:29], v15 offset:32768
 ds_read_b64_tr_b16 a[30:31], v15 offset:33792
 v_mfma_f32_16x16x32_bf16 a[128:131], a[48:51], a[0:3], a[128:131]
 v_accvgpr_read_b32 v39, a71
 v_mfma_f32_16x16x32_bf16 a[132:135], a[48:51], a[4:7], a[132:135]
 buffer_load_dwordx4 v5, s[8:11], s70 offen offset:2048 lds
 v_accvgpr_read_b32 v40, a72
 v_mfma_f32_16x16x32_bf16 a[136:139], a[48:51], a[8:11], a[136:139]
 ds_read_b128 a[36:39], v11 offset:34816
 v_accvgpr_read_b32 v41, a73
 v_mfma_f32_16x16x32_bf16 a[140:143], a[48:51], a[12:15], a[140:143]
 ds_read_b64_tr_b16 a[48:49], v16 offset:32768
 ds_read_b64_tr_b16 a[50:51], v16 offset:33792
 v_mfma_f32_16x16x32_bf16 a[156:159], a[52:55], a[12:15], a[156:159]
 v_accvgpr_read_b32 v42, a74
 v_mfma_f32_16x16x32_bf16 a[152:155], a[52:55], a[8:11], a[152:155]
 buffer_load_dwordx4 v5, s[8:11], s71 offen offset:3072 lds
 v_add_u32_e64 v4, s86, v4
 v_mfma_f32_16x16x32_bf16 a[148:151], a[52:55], a[4:7], a[148:151]
 v_add_u32_e64 v5, s86, v5
 v_accvgpr_read_b32 v43, a75
 v_mfma_f32_16x16x32_bf16 a[144:147], a[52:55], a[0:3], a[144:147]
 ds_read_b64_tr_b16 a[52:53], v17 offset:32768
 ds_read_b64_tr_b16 a[54:55], v17 offset:33792
 s_waitcnt lgkmcnt(5)
 v_mfma_f32_16x16x32_bf16 a[160:163], a[56:59], a[0:3], a[160:163]
 s_add_u32 m0, s63, 4096
 v_accvgpr_read_b32 v44, a76
 v_mfma_f32_16x16x32_bf16 a[164:167], a[56:59], a[4:7], a[164:167]
 buffer_load_dwordx4 v2, s[4:7], s66 offen offset:0 sc1 lds
 v_accvgpr_read_b32 v45, a77
 v_mfma_f32_16x16x32_bf16 a[168:171], a[56:59], a[8:11], a[168:171]
 v_accvgpr_read_b32 v46, a78
 v_mfma_f32_16x16x32_bf16 a[172:175], a[56:59], a[12:15], a[172:175]
 ds_read_b64_tr_b16 a[56:57], v18 offset:32768
 ds_read_b64_tr_b16 a[58:59], v18 offset:33792
 v_mfma_f32_16x16x32_bf16 a[188:191], a[60:63], a[12:15], a[188:191]
 ds_read_b128 a[40:43], v11 offset:36864
 v_accvgpr_read_b32 v47, a79
 v_mfma_f32_16x16x32_bf16 a[184:187], a[60:63], a[8:11], a[184:187]
 buffer_load_dwordx4 v3, s[4:7], s66 offen offset:1024 sc1 lds
 v_accvgpr_read_b32 v60, a92
 v_mfma_f32_16x16x32_bf16 a[180:183], a[60:63], a[4:7], a[180:183]
 v_accvgpr_read_b32 v61, a93
 v_mfma_f32_16x16x32_bf16 a[176:179], a[60:63], a[0:3], a[176:179]
 ds_read_b64_tr_b16 a[60:61], v19 offset:32768
 ds_read_b64_tr_b16 a[62:63], v19 offset:33792
 v_mfma_f32_16x16x32_bf16 a[192:195], a[16:19], a[0:3], a[192:195]
 v_accvgpr_read_b32 v62, a94
 v_mfma_f32_16x16x32_bf16 a[196:199], a[16:19], a[4:7], a[196:199]
 buffer_load_dwordx4 v2, s[4:7], s67 offen offset:2048 sc1 lds
 v_accvgpr_read_b32 v63, a95
 v_mfma_f32_16x16x32_bf16 a[200:203], a[16:19], a[8:11], a[200:203]
 v_accvgpr_read_b32 v56, a88
 v_mfma_f32_16x16x32_bf16 a[204:207], a[16:19], a[12:15], a[204:207]
 ds_read_b64_tr_b16 a[16:17], v20 offset:57344
 ds_read_b64_tr_b16 a[18:19], v20 offset:57856
 v_mfma_f32_16x16x32_bf16 a[220:223], a[20:23], a[12:15], a[220:223]
 v_accvgpr_read_b32 v57, a89
 v_mfma_f32_16x16x32_bf16 a[216:219], a[20:23], a[8:11], a[216:219]
 buffer_load_dwordx4 v3, s[4:7], s67 offen offset:3072 sc1 lds
 v_lshl_add_u32 v2, s85, 7, v2
 v_mfma_f32_16x16x32_bf16 a[212:215], a[20:23], a[4:7], a[212:215]
 ds_read_b128 a[44:47], v11 offset:38912
 v_lshl_add_u32 v3, s85, 7, v3
 v_mfma_f32_16x16x32_bf16 a[208:211], a[20:23], a[0:3], a[208:211]
 ds_read_b64_tr_b16 a[20:21], v20 offset:59392
 ds_read_b64_tr_b16 a[22:23], v20 offset:59904
 v_mfma_f32_16x16x32_bf16 v[160:163], a[24:27], a[0:3], v[160:163]
 v_accvgpr_read_b32 v58, a90
 v_mfma_f32_16x16x32_bf16 v[164:167], a[24:27], a[4:7], v[164:167]
 v_accvgpr_read_b32 v59, a91
 v_mfma_f32_16x16x32_bf16 v[168:171], a[24:27], a[8:11], v[168:171]
 buffer_store_dwordx4 a[224:227], v9, s[80:83], 0 offen offset:0 sc1
 v_accvgpr_read_b32 v52, a84
 v_mfma_f32_16x16x32_bf16 v[172:175], a[24:27], a[12:15], v[172:175]
 v_accvgpr_read_b32 v53, a85
 v_mfma_f32_16x16x32_bf16 v[188:191], a[28:31], a[12:15], v[188:191]
 v_accvgpr_read_b32 v54, a86
 v_mfma_f32_16x16x32_bf16 v[184:187], a[28:31], a[8:11], v[184:187]
 v_accvgpr_read_b32 v55, a87
 v_mfma_f32_16x16x32_bf16 v[180:183], a[28:31], a[4:7], v[180:183]
 ds_read_b64_tr_b16 a[24:25], v21 offset:57344
 ds_read_b64_tr_b16 a[26:27], v21 offset:57856
 v_mfma_f32_16x16x32_bf16 v[176:179], a[28:31], a[0:3], v[176:179]
 ds_read_b64_tr_b16 a[28:29], v21 offset:59392
 ds_read_b64_tr_b16 a[30:31], v21 offset:59904
 s_waitcnt lgkmcnt(4)
 v_mfma_f32_16x16x32_bf16 v[192:195], a[48:51], a[0:3], v[192:195]
 v_accvgpr_read_b32 v48, a80
 v_mfma_f32_16x16x32_bf16 v[196:199], a[48:51], a[4:7], v[196:199]
 v_accvgpr_read_b32 v49, a81
 v_mfma_f32_16x16x32_bf16 v[200:203], a[48:51], a[8:11], v[200:203]
 v_accvgpr_read_b32 v50, a82
 v_mfma_f32_16x16x32_bf16 v[204:207], a[48:51], a[12:15], v[204:207]
 ds_read_b64_tr_b16 a[48:49], v22 offset:57344
 ds_read_b64_tr_b16 a[50:51], v22 offset:57856
 v_mfma_f32_16x16x32_bf16 v[220:223], a[52:55], a[12:15], v[220:223]
 v_accvgpr_read_b32 v51, a83
 v_mfma_f32_16x16x32_bf16 v[216:219], a[52:55], a[8:11], v[216:219]
 v_mfma_f32_16x16x32_bf16 v[212:215], a[52:55], a[4:7], v[212:215]
 v_mfma_f32_16x16x32_bf16 v[208:211], a[52:55], a[0:3], v[208:211]
 ds_read_b64_tr_b16 a[52:53], v22 offset:59392
 ds_read_b64_tr_b16 a[54:55], v22 offset:59904
 v_mfma_f32_16x16x32_bf16 v[224:227], a[56:59], a[0:3], v[224:227]
 v_mfma_f32_16x16x32_bf16 v[228:231], a[56:59], a[4:7], v[228:231]
 buffer_store_dwordx4 a[228:231], v9, s[80:83], 0 offen offset:1024 sc1
 v_mfma_f32_16x16x32_bf16 v[232:235], a[56:59], a[8:11], v[232:235]
 v_mfma_f32_16x16x32_bf16 v[236:239], a[56:59], a[12:15], v[236:239]
 v_mfma_f32_16x16x32_bf16 v[252:255], a[60:63], a[12:15], v[252:255]
 v_mfma_f32_16x16x32_bf16 v[248:251], a[60:63], a[8:11], v[248:251]
 ds_read_b64_tr_b16 a[56:57], v23 offset:57344
 ds_read_b64_tr_b16 a[58:59], v23 offset:57856
 v_mfma_f32_16x16x32_bf16 v[244:247], a[60:63], a[4:7], v[244:247]
 v_mfma_f32_16x16x32_bf16 v[240:243], a[60:63], a[0:3], v[240:243]
 ds_read_b64_tr_b16 a[60:61], v23 offset:59392
 ds_read_b64_tr_b16 a[62:63], v23 offset:59904
 v_mfma_f32_16x16x32_bf16 v[32:35], a[16:19], a[32:35], v[32:35]
 v_mfma_f32_16x16x32_bf16 v[36:39], a[16:19], a[36:39], v[36:39]
 v_mfma_f32_16x16x32_bf16 v[40:43], a[16:19], a[40:43], v[40:43]
 v_mfma_f32_16x16x32_bf16 v[44:47], a[16:19], a[44:47], v[44:47]
 ds_read_b64_tr_b16 a[16:17], v12 offset:40960
 ds_read_b64_tr_b16 a[18:19], v12 offset:41984
 v_mfma_f32_16x16x32_bf16 v[60:63], a[20:23], a[44:47], v[60:63]
 v_mfma_f32_16x16x32_bf16 v[56:59], a[20:23], a[40:43], v[56:59]
 v_mfma_f32_16x16x32_bf16 v[52:55], a[20:23], a[36:39], v[52:55]
 v_mfma_f32_16x16x32_bf16 v[48:51], a[20:23], a[32:35], v[48:51]
 ds_read_b64_tr_b16 a[20:21], v13 offset:40960
 ds_read_b64_tr_b16 a[22:23], v13 offset:41984
 s_waitcnt lgkmcnt(4)
 v_mfma_f32_16x16x32_bf16 a[96:99], a[24:27], a[32:35], a[96:99]
 buffer_store_dwordx4 a[232:235], v9, s[80:83], 0 offen offset:2048 sc1
 v_mfma_f32_16x16x32_bf16 a[100:103], a[24:27], a[36:39], a[100:103]
 v_mfma_f32_16x16x32_bf16 a[104:107], a[24:27], a[40:43], a[104:107]
 v_mfma_f32_16x16x32_bf16 a[108:111], a[24:27], a[44:47], a[108:111]
 v_mfma_f32_16x16x32_bf16 a[124:127], a[28:31], a[44:47], a[124:127]
 ds_read_b64_tr_b16 a[24:25], v14 offset:40960
 ds_read_b64_tr_b16 a[26:27], v14 offset:41984
 v_mfma_f32_16x16x32_bf16 a[120:123], a[28:31], a[40:43], a[120:123]
 v_accvgpr_read_b32 v64, a96
 v_mfma_f32_16x16x32_bf16 a[116:119], a[28:31], a[36:39], a[116:119]
 v_accvgpr_read_b32 v65, a97
 v_mfma_f32_16x16x32_bf16 a[112:115], a[28:31], a[32:35], a[112:115]
 ds_read_b64_tr_b16 a[28:29], v15 offset:40960
 ds_read_b64_tr_b16 a[30:31], v15 offset:41984
 v_mfma_f32_16x16x32_bf16 a[128:131], a[48:51], a[32:35], a[128:131]
 v_accvgpr_read_b32 v66, a98
 v_mfma_f32_16x16x32_bf16 a[132:135], a[48:51], a[36:39], a[132:135]
 v_accvgpr_read_b32 v67, a99
 v_mfma_f32_16x16x32_bf16 a[136:139], a[48:51], a[40:43], a[136:139]
 v_accvgpr_read_b32 v68, a100
 v_mfma_f32_16x16x32_bf16 a[140:143], a[48:51], a[44:47], a[140:143]
 ds_read_b64_tr_b16 a[48:49], v16 offset:40960
 ds_read_b64_tr_b16 a[50:51], v16 offset:41984
 v_mfma_f32_16x16x32_bf16 a[156:159], a[52:55], a[44:47], a[156:159]
 v_accvgpr_read_b32 v69, a101
 v_mfma_f32_16x16x32_bf16 a[152:155], a[52:55], a[40:43], a[152:155]
 v_accvgpr_read_b32 v70, a102
 v_mfma_f32_16x16x32_bf16 a[148:151], a[52:55], a[36:39], a[148:151]
 v_accvgpr_read_b32 v71, a103
 v_mfma_f32_16x16x32_bf16 a[144:147], a[52:55], a[32:35], a[144:147]
 buffer_store_dwordx4 a[236:239], v9, s[80:83], 0 offen offset:3072 sc1
 v_accvgpr_read_b32 v72, a104
 v_mfma_f32_16x16x32_bf16 a[160:163], a[56:59], a[32:35], a[160:163]
 v_accvgpr_read_b32 v73, a105
 v_mfma_f32_16x16x32_bf16 a[164:167], a[56:59], a[36:39], a[164:167]
 v_accvgpr_read_b32 v74, a106
 v_mfma_f32_16x16x32_bf16 a[168:171], a[56:59], a[40:43], a[168:171]
 v_accvgpr_read_b32 v75, a107
 v_mfma_f32_16x16x32_bf16 a[172:175], a[56:59], a[44:47], a[172:175]
 ds_read_b64_tr_b16 a[52:53], v17 offset:40960
 ds_read_b64_tr_b16 a[54:55], v17 offset:41984
 v_mfma_f32_16x16x32_bf16 a[188:191], a[60:63], a[44:47], a[188:191]
 ds_read_b64_tr_b16 a[56:57], v18 offset:40960
 ds_read_b64_tr_b16 a[58:59], v18 offset:41984
 v_mfma_f32_16x16x32_bf16 a[184:187], a[60:63], a[40:43], a[184:187]
 v_accvgpr_read_b32 v76, a108
 v_mfma_f32_16x16x32_bf16 a[180:183], a[60:63], a[36:39], a[180:183]
 v_accvgpr_read_b32 v77, a109
 v_mfma_f32_16x16x32_bf16 a[176:179], a[60:63], a[32:35], a[176:179]
 ds_read_b64_tr_b16 a[60:61], v19 offset:40960
 ds_read_b64_tr_b16 a[62:63], v19 offset:41984
 s_waitcnt lgkmcnt(6)
 v_mfma_f32_16x16x32_bf16 a[192:195], a[16:19], a[32:35], a[192:195]
 v_accvgpr_read_b32 v78, a110
 v_mfma_f32_16x16x32_bf16 a[196:199], a[16:19], a[36:39], a[196:199]
 v_accvgpr_read_b32 v79, a111
 v_mfma_f32_16x16x32_bf16 a[200:203], a[16:19], a[40:43], a[200:203]
 v_accvgpr_read_b32 v92, a124
 v_mfma_f32_16x16x32_bf16 a[204:207], a[16:19], a[44:47], a[204:207]
 v_accvgpr_read_b32 v93, a125
 v_mfma_f32_16x16x32_bf16 a[220:223], a[20:23], a[44:47], a[220:223]
 v_accvgpr_read_b32 v94, a126
 v_mfma_f32_16x16x32_bf16 a[216:219], a[20:23], a[40:43], a[216:219]
 v_accvgpr_read_b32 v95, a127
 v_mfma_f32_16x16x32_bf16 a[212:215], a[20:23], a[36:39], a[212:215]
 v_accvgpr_read_b32 v88, a120
 v_mfma_f32_16x16x32_bf16 a[208:211], a[20:23], a[32:35], a[208:211]
 s_waitcnt vmcnt(20)
 s_waitcnt vmcnt(4)
 s_waitcnt lgkmcnt(0)
 s_barrier
 v_mfma_f32_16x16x32_bf16 v[160:163], a[24:27], a[32:35], v[160:163]
 ds_read_b64_tr_b16 a[16:17], v20 offset:16384
 ds_read_b64_tr_b16 a[18:19], v20 offset:16896
 s_add_u32 m0, s62, 49152
 v_mfma_f32_16x16x32_bf16 v[164:167], a[24:27], a[36:39], v[164:167]
 buffer_load_dwordx4 v6, s[12:15], s72 offen offset:0 lds
 ds_read_b64_tr_b16 a[20:21], v20 offset:18432
 ds_read_b64_tr_b16 a[22:23], v20 offset:18944
 v_mfma_f32_16x16x32_bf16 v[168:171], a[24:27], a[40:43], v[168:171]
 ds_read_b128 a[0:3], v10 offset:0
 ds_read_b128 a[4:7], v10 offset:2048
 v_mfma_f32_16x16x32_bf16 v[172:175], a[24:27], a[44:47], v[172:175]
 ds_read_b64_tr_b16 a[24:25], v21 offset:16384
 ds_read_b64_tr_b16 a[26:27], v21 offset:16896
 v_mfma_f32_16x16x32_bf16 v[188:191], a[28:31], a[44:47], v[188:191]
 ds_read_b128 a[8:11], v10 offset:4096
 v_add_u32_e64 v29, 2, v0
 v_mfma_f32_16x16x32_bf16 v[184:187], a[28:31], a[40:43], v[184:187]
 buffer_load_dwordx4 v7, s[12:15], s73 offen offset:1024 lds
 buffer_store_dword v29, v26, s[24:27], 0 offen sc1
 v_mfma_f32_16x16x32_bf16 v[180:183], a[28:31], a[36:39], v[180:183]
 ds_read_b128 a[12:15], v10 offset:6144
 v_accvgpr_read_b32 v89, a121
 v_mfma_f32_16x16x32_bf16 v[176:179], a[28:31], a[32:35], v[176:179]
 ds_read_b64_tr_b16 a[28:29], v21 offset:18432
 ds_read_b64_tr_b16 a[30:31], v21 offset:18944
 v_mfma_f32_16x16x32_bf16 v[192:195], a[48:51], a[32:35], v[192:195]
 s_add_u32 m0, s62, 51200
 v_accvgpr_read_b32 v90, a122
 v_mfma_f32_16x16x32_bf16 v[196:199], a[48:51], a[36:39], v[196:199]
 buffer_load_dwordx4 v6, s[16:19], s72 offen offset:0 lds
 v_accvgpr_read_b32 v91, a123
 v_mfma_f32_16x16x32_bf16 v[200:203], a[48:51], a[40:43], v[200:203]
 v_accvgpr_read_b32 v84, a116
 v_mfma_f32_16x16x32_bf16 v[204:207], a[48:51], a[44:47], v[204:207]
 ds_read_b64_tr_b16 a[48:49], v22 offset:16384
 ds_read_b64_tr_b16 a[50:51], v22 offset:16896
 v_mfma_f32_16x16x32_bf16 v[220:223], a[52:55], a[44:47], v[220:223]
 v_accvgpr_read_b32 v85, a117
 v_mfma_f32_16x16x32_bf16 v[216:219], a[52:55], a[40:43], v[216:219]
 buffer_load_dwordx4 v7, s[16:19], s73 offen offset:1024 lds
 v_accvgpr_read_b32 v86, a118
 v_mfma_f32_16x16x32_bf16 v[212:215], a[52:55], a[36:39], v[212:215]
 v_accvgpr_read_b32 v87, a119
 v_mfma_f32_16x16x32_bf16 v[208:211], a[52:55], a[32:35], v[208:211]
 ds_read_b64_tr_b16 a[52:53], v22 offset:18432
 ds_read_b64_tr_b16 a[54:55], v22 offset:18944
 v_mfma_f32_16x16x32_bf16 v[224:227], a[56:59], a[32:35], v[224:227]
 s_add_u32 m0, s63, 32768
 v_accvgpr_read_b32 v80, a112
 v_mfma_f32_16x16x32_bf16 v[228:231], a[56:59], a[36:39], v[228:231]
 buffer_load_dwordx4 v2, s[4:7], s64 offen offset:0 sc1 lds
 v_accvgpr_read_b32 v81, a113
 v_mfma_f32_16x16x32_bf16 v[232:235], a[56:59], a[40:43], v[232:235]
 v_accvgpr_read_b32 v82, a114
 v_mfma_f32_16x16x32_bf16 v[236:239], a[56:59], a[44:47], v[236:239]
 ds_read_b64_tr_b16 a[56:57], v23 offset:16384
 ds_read_b64_tr_b16 a[58:59], v23 offset:16896
 v_mfma_f32_16x16x32_bf16 v[252:255], a[60:63], a[44:47], v[252:255]
 v_accvgpr_read_b32 v83, a115
 v_mfma_f32_16x16x32_bf16 v[248:251], a[60:63], a[40:43], v[248:251]
 buffer_load_dwordx4 v3, s[4:7], s64 offen offset:1024 sc1 lds
 v_mfma_f32_16x16x32_bf16 v[244:247], a[60:63], a[36:39], v[244:247]
 v_mfma_f32_16x16x32_bf16 v[240:243], a[60:63], a[32:35], v[240:243]
 ds_read_b64_tr_b16 a[60:61], v23 offset:18432
 ds_read_b64_tr_b16 a[62:63], v23 offset:18944
 s_waitcnt lgkmcnt(4)
 v_mfma_f32_16x16x32_bf16 v[32:35], a[16:19], a[0:3], v[32:35]
 v_mfma_f32_16x16x32_bf16 v[36:39], a[16:19], a[4:7], v[36:39]
 buffer_load_dwordx4 v2, s[4:7], s65 offen offset:2048 sc1 lds
 v_mfma_f32_16x16x32_bf16 v[40:43], a[16:19], a[8:11], v[40:43]
 v_mfma_f32_16x16x32_bf16 v[44:47], a[16:19], a[12:15], v[44:47]
 ds_read_b64_tr_b16 a[16:17], v12 offset:0
 ds_read_b64_tr_b16 a[18:19], v12 offset:1024
 v_mfma_f32_16x16x32_bf16 v[60:63], a[20:23], a[12:15], v[60:63]
 v_mfma_f32_16x16x32_bf16 v[56:59], a[20:23], a[8:11], v[56:59]
 buffer_load_dwordx4 v3, s[4:7], s65 offen offset:3072 sc1 lds
 v_mfma_f32_16x16x32_bf16 v[52:55], a[20:23], a[4:7], v[52:55]
 v_mfma_f32_16x16x32_bf16 v[48:51], a[20:23], a[0:3], v[48:51]
 ds_read_b64_tr_b16 a[20:21], v13 offset:0
 ds_read_b64_tr_b16 a[22:23], v13 offset:1024
 v_mfma_f32_16x16x32_bf16 v[64:67], a[24:27], a[0:3], v[64:67]
 ds_read_b128 a[32:35], v11 offset:0
 s_add_u32 m0, s62, 32768
 v_mfma_f32_16x16x32_bf16 v[68:71], a[24:27], a[4:7], v[68:71]
 buffer_load_dwordx4 v4, s[8:11], s68 offen offset:0 lds
 v_mfma_f32_16x16x32_bf16 v[72:75], a[24:27], a[8:11], v[72:75]
 v_mfma_f32_16x16x32_bf16 v[76:79], a[24:27], a[12:15], v[76:79]
 ds_read_b64_tr_b16 a[24:25], v14 offset:0
 ds_read_b64_tr_b16 a[26:27], v14 offset:1024
 v_mfma_f32_16x16x32_bf16 v[92:95], a[28:31], a[12:15], v[92:95]
 v_mfma_f32_16x16x32_bf16 v[88:91], a[28:31], a[8:11], v[88:91]
 buffer_load_dwordx4 v4, s[8:11], s69 offen offset:1024 lds
 v_mfma_f32_16x16x32_bf16 v[84:87], a[28:31], a[4:7], v[84:87]
 v_mfma_f32_16x16x32_bf16 v[80:83], a[28:31], a[0:3], v[80:83]
 ds_read_b64_tr_b16 a[28:29], v15 offset:0
 ds_read_b64_tr_b16 a[30:31], v15 offset:1024
 v_mfma_f32_16x16x32_bf16 a[128:131], a[48:51], a[0:3], a[128:131]
 v_mfma_f32_16x16x32_bf16 a[132:135], a[48:51], a[4:7], a[132:135]
 buffer_load_dwordx4 v5, s[8:11], s70 offen offset:2048 lds
 v_mfma_f32_16x16x32_bf16 a[136:139], a[48:51], a[8:11], a[136:139]
 ds_read_b128 a[36:39], v11 offset:2048
 v_mfma_f32_16x16x32_bf16 a[140:143], a[48:51], a[12:15], a[140:143]
 ds_read_b64_tr_b16 a[48:49], v16 offset:0
 ds_read_b64_tr_b16 a[50:51], v16 offset:1024
 v_mfma_f32_16x16x32_bf16 a[156:159], a[52:55], a[12:15], a[156:159]
 v_mfma_f32_16x16x32_bf16 a[152:155], a[52:55], a[8:11], a[152:155]
 buffer_load_dwordx4 v5, s[8:11], s71 offen offset:3072 lds
 v_accvgpr_read_b32 v96, a128
 v_mfma_f32_16x16x32_bf16 a[148:151], a[52:55], a[4:7], a[148:151]
 v_accvgpr_read_b32 v97, a129
 v_mfma_f32_16x16x32_bf16 a[144:147], a[52:55], a[0:3], a[144:147]
 ds_read_b64_tr_b16 a[52:53], v17 offset:0
 ds_read_b64_tr_b16 a[54:55], v17 offset:1024
 s_waitcnt lgkmcnt(5)
 v_mfma_f32_16x16x32_bf16 a[160:163], a[56:59], a[0:3], a[160:163]
 s_add_u32 m0, s63, 36864
 v_accvgpr_read_b32 v98, a130
 v_mfma_f32_16x16x32_bf16 a[164:167], a[56:59], a[4:7], a[164:167]
 buffer_load_dwordx4 v2, s[4:7], s66 offen offset:0 sc1 lds
 v_accvgpr_read_b32 v99, a131
 v_mfma_f32_16x16x32_bf16 a[168:171], a[56:59], a[8:11], a[168:171]
 v_accvgpr_read_b32 v100, a132
 v_mfma_f32_16x16x32_bf16 a[172:175], a[56:59], a[12:15], a[172:175]
 ds_read_b64_tr_b16 a[56:57], v18 offset:0
 ds_read_b64_tr_b16 a[58:59], v18 offset:1024
 v_mfma_f32_16x16x32_bf16 a[188:191], a[60:63], a[12:15], a[188:191]
 ds_read_b128 a[40:43], v11 offset:4096
 v_accvgpr_read_b32 v101, a133
 v_mfma_f32_16x16x32_bf16 a[184:187], a[60:63], a[8:11], a[184:187]
 buffer_load_dwordx4 v3, s[4:7], s66 offen offset:1024 sc1 lds
 v_accvgpr_read_b32 v102, a134
 v_mfma_f32_16x16x32_bf16 a[180:183], a[60:63], a[4:7], a[180:183]
 v_accvgpr_read_b32 v103, a135
 v_mfma_f32_16x16x32_bf16 a[176:179], a[60:63], a[0:3], a[176:179]
 ds_read_b64_tr_b16 a[60:61], v19 offset:0
 ds_read_b64_tr_b16 a[62:63], v19 offset:1024
 v_mfma_f32_16x16x32_bf16 a[192:195], a[16:19], a[0:3], a[192:195]
 v_accvgpr_read_b32 v104, a136
 v_mfma_f32_16x16x32_bf16 a[196:199], a[16:19], a[4:7], a[196:199]
 buffer_load_dwordx4 v2, s[4:7], s67 offen offset:2048 sc1 lds
 v_accvgpr_read_b32 v105, a137
 v_mfma_f32_16x16x32_bf16 a[200:203], a[16:19], a[8:11], a[200:203]
 v_accvgpr_read_b32 v106, a138
 v_mfma_f32_16x16x32_bf16 a[204:207], a[16:19], a[12:15], a[204:207]
 ds_read_b64_tr_b16 a[16:17], v20 offset:24576
 ds_read_b64_tr_b16 a[18:19], v20 offset:25088
 v_mfma_f32_16x16x32_bf16 a[220:223], a[20:23], a[12:15], a[220:223]
 v_accvgpr_read_b32 v107, a139
 v_mfma_f32_16x16x32_bf16 a[216:219], a[20:23], a[8:11], a[216:219]
 buffer_load_dwordx4 v3, s[4:7], s67 offen offset:3072 sc1 lds
 v_accvgpr_read_b32 v108, a140
 v_mfma_f32_16x16x32_bf16 a[212:215], a[20:23], a[4:7], a[212:215]
 ds_read_b128 a[44:47], v11 offset:6144
 v_accvgpr_read_b32 v109, a141
 v_mfma_f32_16x16x32_bf16 a[208:211], a[20:23], a[0:3], a[208:211]
 ds_read_b64_tr_b16 a[20:21], v20 offset:26624
 ds_read_b64_tr_b16 a[22:23], v20 offset:27136
 v_mfma_f32_16x16x32_bf16 v[160:163], a[24:27], a[0:3], v[160:163]
 v_accvgpr_read_b32 v110, a142
 v_mfma_f32_16x16x32_bf16 v[164:167], a[24:27], a[4:7], v[164:167]
 v_accvgpr_read_b32 v111, a143
 v_mfma_f32_16x16x32_bf16 v[168:171], a[24:27], a[8:11], v[168:171]
 buffer_store_dwordx4 a[240:243], v9, s[80:83], s75 offen offset:0 sc1
 v_accvgpr_read_b32 v124, a156
 v_mfma_f32_16x16x32_bf16 v[172:175], a[24:27], a[12:15], v[172:175]
 v_accvgpr_read_b32 v125, a157
 v_mfma_f32_16x16x32_bf16 v[188:191], a[28:31], a[12:15], v[188:191]
 s_lshl_b32 s76, s59, 20
 v_accvgpr_read_b32 v126, a158
 v_mfma_f32_16x16x32_bf16 v[184:187], a[28:31], a[8:11], v[184:187]
 s_add_u32 s4, s56, s76
 s_addc_u32 s5, s57, 0
 v_mfma_f32_16x16x32_bf16 v[180:183], a[28:31], a[4:7], v[180:183]
 ds_read_b64_tr_b16 a[24:25], v21 offset:24576
 ds_read_b64_tr_b16 a[26:27], v21 offset:25088
 v_mfma_f32_16x16x32_bf16 v[176:179], a[28:31], a[0:3], v[176:179]
 ds_read_b64_tr_b16 a[28:29], v21 offset:26624
 ds_read_b64_tr_b16 a[30:31], v21 offset:27136
 s_waitcnt lgkmcnt(4)
 v_mfma_f32_16x16x32_bf16 v[192:195], a[48:51], a[0:3], v[192:195]
 s_mov_b32 s6, 0x100000
 s_mov_b32 s7, 0x00020000
 v_mfma_f32_16x16x32_bf16 v[196:199], a[48:51], a[4:7], v[196:199]
 s_lshl_b32 s64, s58, 13
 s_add_u32 s65, s64, 0x8000
 v_mfma_f32_16x16x32_bf16 v[200:203], a[48:51], a[8:11], v[200:203]
 s_lshl_b32 s3, s60, 16
 s_add_u32 s66, s64, s3
 v_mfma_f32_16x16x32_bf16 v[204:207], a[48:51], a[12:15], v[204:207]
 ds_read_b64_tr_b16 a[48:49], v22 offset:24576
 ds_read_b64_tr_b16 a[50:51], v22 offset:25088
 v_mfma_f32_16x16x32_bf16 v[220:223], a[52:55], a[12:15], v[220:223]
 s_add_u32 s66, s66, 0x18000
 s_add_u32 s67, s66, 0x10000
 v_mfma_f32_16x16x32_bf16 v[216:219], a[52:55], a[8:11], v[216:219]
 v_lshlrev_b32 v2, 4, v1
 v_add_u32 v3, 0x1000, v2
L_pg9:
 s_cbranch_execz L_hopr1
 v_mfma_f32_16x16x32_bf16 v[212:215], a[52:55], a[4:7], v[212:215]
 v_accvgpr_read_b32 v127, a159
 v_mfma_f32_16x16x32_bf16 v[208:211], a[52:55], a[0:3], v[208:211]
 ds_read_b64_tr_b16 a[52:53], v22 offset:26624
 ds_read_b64_tr_b16 a[54:55], v22 offset:27136
 v_mfma_f32_16x16x32_bf16 v[224:227], a[56:59], a[0:3], v[224:227]
 v_accvgpr_read_b32 v120, a152
 v_mfma_f32_16x16x32_bf16 v[228:231], a[56:59], a[4:7], v[228:231]
 buffer_store_dwordx4 a[244:247], v9, s[80:83], s75 offen offset:1024 sc1
 v_accvgpr_read_b32 v121, a153
 v_mfma_f32_16x16x32_bf16 v[232:235], a[56:59], a[8:11], v[232:235]
 v_accvgpr_read_b32 v122, a154
 v_mfma_f32_16x16x32_bf16 v[236:239], a[56:59], a[12:15], v[236:239]
 v_accvgpr_read_b32 v123, a155
 v_mfma_f32_16x16x32_bf16 v[252:255], a[60:63], a[12:15], v[252:255]
 v_accvgpr_read_b32 v116, a148
 v_mfma_f32_16x16x32_bf16 v[248:251], a[60:63], a[8:11], v[248:251]
 ds_read_b64_tr_b16 a[56:57], v23 offset:24576
 ds_read_b64_tr_b16 a[58:59], v23 offset:25088
 v_mfma_f32_16x16x32_bf16 v[244:247], a[60:63], a[4:7], v[244:247]
 v_accvgpr_read_b32 v117, a149
 v_mfma_f32_16x16x32_bf16 v[240:243], a[60:63], a[0:3], v[240:243]
 ds_read_b64_tr_b16 a[60:61], v23 offset:26624
 ds_read_b64_tr_b16 a[62:63], v23 offset:27136
 v_mfma_f32_16x16x32_bf16 v[32:35], a[16:19], a[32:35], v[32:35]
 v_accvgpr_read_b32 v118, a150
 v_mfma_f32_16x16x32_bf16 v[36:39], a[16:19], a[36:39], v[36:39]
 v_accvgpr_read_b32 v119, a151
 v_mfma_f32_16x16x32_bf16 v[40:43], a[16:19], a[40:43], v[40:43]
 v_accvgpr_read_b32 v112, a144
 v_mfma_f32_16x16x32_bf16 v[44:47], a[16:19], a[44:47], v[44:47]
 ds_read_b64_tr_b16 a[16:17], v12 offset:8192
 ds_read_b64_tr_b16 a[18:19], v12 offset:9216
 v_mfma_f32_16x16x32_bf16 v[60:63], a[20:23], a[44:47], v[60:63]
 v_accvgpr_read_b32 v113, a145
 v_mfma_f32_16x16x32_bf16 v[56:59], a[20:23], a[40:43], v[56:59]
 v_accvgpr_read_b32 v114, a146
 v_mfma_f32_16x16x32_bf16 v[52:55], a[20:23], a[36:39], v[52:55]
 v_accvgpr_read_b32 v115, a147
 v_mfma_f32_16x16x32_bf16 v[48:51], a[20:23], a[32:35], v[48:51]
 ds_read_b64_tr_b16 a[20:21], v13 offset:8192
 ds_read_b64_tr_b16 a[22:23], v13 offset:9216
 s_waitcnt lgkmcnt(4)
 v_mfma_f32_16x16x32_bf16 v[64:67], a[24:27], a[32:35], v[64:67]
 buffer_store_dwordx4 a[248:251], v9, s[80:83], s75 offen offset:2048 sc1
 v_mfma_f32_16x16x32_bf16 v[68:71], a[24:27], a[36:39], v[68:71]
 v_mfma_f32_16x16x32_bf16 v[72:75], a[24:27], a[40:43], v[72:75]
 v_mfma_f32_16x16x32_bf16 v[76:79], a[24:27], a[44:47], v[76:79]
 v_mfma_f32_16x16x32_bf16 v[92:95], a[28:31], a[44:47], v[92:95]
 ds_read_b64_tr_b16 a[24:25], v14 offset:8192
 ds_read_b64_tr_b16 a[26:27], v14 offset:9216
 v_mfma_f32_16x16x32_bf16 v[88:91], a[28:31], a[40:43], v[88:91]
 v_mfma_f32_16x16x32_bf16 v[84:87], a[28:31], a[36:39], v[84:87]
 v_mfma_f32_16x16x32_bf16 v[80:83], a[28:31], a[32:35], v[80:83]
 ds_read_b64_tr_b16 a[28:29], v15 offset:8192
 ds_read_b64_tr_b16 a[30:31], v15 offset:9216
 v_mfma_f32_16x16x32_bf16 v[96:99], a[48:51], a[32:35], v[96:99]
 s_and_b32 s3, s2, 31
 v_and_b32 v27, 7, v1
 v_mfma_f32_16x16x32_bf16 v[100:103], a[48:51], a[36:39], v[100:103]
 v_lshlrev_b32_e64 v27, 5, v27
 v_add_lshl_u32 v27, s3, v27, 7
 v_mfma_f32_16x16x32_bf16 v[104:107], a[48:51], a[40:43], v[104:107]
 buffer_load_dword v28, v27, s[24:27], 0 offen sc1
 v_mfma_f32_16x16x32_bf16 v[108:111], a[48:51], a[44:47], v[108:111]
 ds_read_b64_tr_b16 a[48:49], v16 offset:8192
 ds_read_b64_tr_b16 a[50:51], v16 offset:9216
 v_mfma_f32_16x16x32_bf16 v[124:127], a[52:55], a[44:47], v[124:127]
 v_mfma_f32_16x16x32_bf16 v[120:123], a[52:55], a[40:43], v[120:123]
 v_mfma_f32_16x16x32_bf16 v[116:119], a[52:55], a[36:39], v[116:119]
 v_mfma_f32_16x16x32_bf16 v[112:115], a[52:55], a[32:35], v[112:115]
 buffer_store_dwordx4 a[252:255], v9, s[80:83], s75 offen offset:3072 sc1
 v_mfma_f32_16x16x32_bf16 a[160:163], a[56:59], a[32:35], a[160:163]
 v_mfma_f32_16x16x32_bf16 a[164:167], a[56:59], a[36:39], a[164:167]
 v_mfma_f32_16x16x32_bf16 a[168:171], a[56:59], a[40:43], a[168:171]
 v_mfma_f32_16x16x32_bf16 a[172:175], a[56:59], a[44:47], a[172:175]
 ds_read_b64_tr_b16 a[52:53], v17 offset:8192
 ds_read_b64_tr_b16 a[54:55], v17 offset:9216
 v_mfma_f32_16x16x32_bf16 a[188:191], a[60:63], a[44:47], a[188:191]
 ds_read_b64_tr_b16 a[56:57], v18 offset:8192
 ds_read_b64_tr_b16 a[58:59], v18 offset:9216
 v_mfma_f32_16x16x32_bf16 a[184:187], a[60:63], a[40:43], a[184:187]
 v_accvgpr_read_b32 v128, a160
 v_mfma_f32_16x16x32_bf16 a[180:183], a[60:63], a[36:39], a[180:183]
 v_accvgpr_read_b32 v129, a161
 v_mfma_f32_16x16x32_bf16 a[176:179], a[60:63], a[32:35], a[176:179]
 ds_read_b64_tr_b16 a[60:61], v19 offset:8192
 ds_read_b64_tr_b16 a[62:63], v19 offset:9216
 s_waitcnt lgkmcnt(6)
 v_mfma_f32_16x16x32_bf16 a[192:195], a[16:19], a[32:35], a[192:195]
 v_accvgpr_read_b32 v130, a162
 v_mfma_f32_16x16x32_bf16 a[196:199], a[16:19], a[36:39], a[196:199]
 v_accvgpr_read_b32 v131, a163
 v_mfma_f32_16x16x32_bf16 a[200:203], a[16:19], a[40:43], a[200:203]
 v_accvgpr_read_b32 v132, a164
 v_mfma_f32_16x16x32_bf16 a[204:207], a[16:19], a[44:47], a[204:207]
 v_accvgpr_read_b32 v133, a165
 v_mfma_f32_16x16x32_bf16 a[220:223], a[20:23], a[44:47], a[220:223]
 v_accvgpr_read_b32 v134, a166
 v_mfma_f32_16x16x32_bf16 a[216:219], a[20:23], a[40:43], a[216:219]
 v_accvgpr_read_b32 v135, a167
 v_mfma_f32_16x16x32_bf16 a[212:215], a[20:23], a[36:39], a[212:215]
 v_accvgpr_read_b32 v136, a168
 v_mfma_f32_16x16x32_bf16 a[208:211], a[20:23], a[32:35], a[208:211]
 s_waitcnt vmcnt(5)
 s_waitcnt lgkmcnt(0)
 s_barrier
 v_mfma_f32_16x16x32_bf16 v[160:163], a[24:27], a[32:35], v[160:163]
 ds_read_b64_tr_b16 a[16:17], v20 offset:49152
 ds_read_b64_tr_b16 a[18:19], v20 offset:49664
 v_mfma_f32_16x16x32_bf16 v[164:167], a[24:27], a[36:39], v[164:167]
 ds_read_b64_tr_b16 a[20:21], v20 offset:51200
 ds_read_b64_tr_b16 a[22:23], v20 offset:51712
 v_mfma_f32_16x16x32_bf16 v[168:171], a[24:27], a[40:43], v[168:171]
 ds_read_b128 a[0:3], v10 offset:32768
 ds_read_b128 a[4:7], v10 offset:34816
 v_mfma_f32_16x16x32_bf16 v[172:175], a[24:27], a[44:47], v[172:175]
 ds_read_b64_tr_b16 a[24:25], v21 offset:49152
 ds_read_b64_tr_b16 a[26:27], v21 offset:49664
 v_mfma_f32_16x16x32_bf16 v[188:191], a[28:31], a[44:47], v[188:191]
 ds_read_b128 a[8:11], v10 offset:36864
 v_accvgpr_read_b32 v137, a169
 v_mfma_f32_16x16x32_bf16 v[184:187], a[28:31], a[40:43], v[184:187]
 v_accvgpr_read_b32 v138, a170
 v_mfma_f32_16x16x32_bf16 v[180:183], a[28:31], a[36:39], v[180:183]
 ds_read_b128 a[12:15], v10 offset:38912
 v_accvgpr_read_b32 v139, a171
 v_mfma_f32_16x16x32_bf16 v[176:179], a[28:31], a[32:35], v[176:179]
 ds_read_b64_tr_b16 a[28:29], v21 offset:51200
 ds_read_b64_tr_b16 a[30:31], v21 offset:51712
 v_mfma_f32_16x16x32_bf16 v[192:195], a[48:51], a[32:35], v[192:195]
 v_accvgpr_read_b32 v140, a172
 v_mfma_f32_16x16x32_bf16 v[196:199], a[48:51], a[36:39], v[196:199]
 v_accvgpr_read_b32 v141, a173
 v_mfma_f32_16x16x32_bf16 v[200:203], a[48:51], a[40:43], v[200:203]
 v_accvgpr_read_b32 v142, a174
 v_mfma_f32_16x16x32_bf16 v[204:207], a[48:51], a[44:47], v[204:207]
 ds_read_b64_tr_b16 a[48:49], v22 offset:49152
 ds_read_b64_tr_b16 a[50:51], v22 offset:49664
 v_mfma_f32_16x16x32_bf16 v[220:223], a[52:55], a[44:47], v[220:223]
 v_accvgpr_read_b32 v143, a175
 v_mfma_f32_16x16x32_bf16 v[216:219], a[52:55], a[40:43], v[216:219]
 v_accvgpr_read_b32 v156, a188
 v_mfma_f32_16x16x32_bf16 v[212:215], a[52:55], a[36:39], v[212:215]
 v_accvgpr_read_b32 v157, a189
 v_mfma_f32_16x16x32_bf16 v[208:211], a[52:55], a[32:35], v[208:211]
 ds_read_b64_tr_b16 a[52:53], v22 offset:51200
 ds_read_b64_tr_b16 a[54:55], v22 offset:51712
 v_mfma_f32_16x16x32_bf16 v[224:227], a[56:59], a[32:35], v[224:227]
 v_accvgpr_read_b32 v158, a190
 v_mfma_f32_16x16x32_bf16 v[228:231], a[56:59], a[36:39], v[228:231]
 v_accvgpr_read_b32 v159, a191
 v_mfma_f32_16x16x32_bf16 v[232:235], a[56:59], a[40:43], v[232:235]
 v_accvgpr_read_b32 v152, a184
 v_mfma_f32_16x16x32_bf16 v[236:239], a[56:59], a[44:47], v[236:239]
 ds_read_b64_tr_b16 a[56:57], v23 offset:49152
 ds_read_b64_tr_b16 a[58:59], v23 offset:49664
 v_mfma_f32_16x16x32_bf16 v[252:255], a[60:63], a[44:47], v[252:255]
 v_accvgpr_read_b32 v153, a185
 v_mfma_f32_16x16x32_bf16 v[248:251], a[60:63], a[40:43], v[248:251]
 v_accvgpr_read_b32 v154, a186
 v_mfma_f32_16x16x32_bf16 v[244:247], a[60:63], a[36:39], v[244:247]
 v_accvgpr_read_b32 v155, a187
 v_mfma_f32_16x16x32_bf16 v[240:243], a[60:63], a[32:35], v[240:243]
 ds_read_b64_tr_b16 a[60:61], v23 offset:51200
 ds_read_b64_tr_b16 a[62:63], v23 offset:51712
 s_waitcnt lgkmcnt(4)
 v_mfma_f32_16x16x32_bf16 v[32:35], a[16:19], a[0:3], v[32:35]
 v_accvgpr_read_b32 v148, a180
 v_mfma_f32_16x16x32_bf16 v[36:39], a[16:19], a[4:7], v[36:39]
 v_accvgpr_read_b32 v149, a181
 v_mfma_f32_16x16x32_bf16 v[40:43], a[16:19], a[8:11], v[40:43]
 v_accvgpr_read_b32 v150, a182
 v_mfma_f32_16x16x32_bf16 v[44:47], a[16:19], a[12:15], v[44:47]
 ds_read_b64_tr_b16 a[16:17], v12 offset:32768
 ds_read_b64_tr_b16 a[18:19], v12 offset:33792
 v_mfma_f32_16x16x32_bf16 v[60:63], a[20:23], a[12:15], v[60:63]
 v_accvgpr_read_b32 v151, a183
 v_mfma_f32_16x16x32_bf16 v[56:59], a[20:23], a[8:11], v[56:59]
 v_accvgpr_read_b32 v144, a176
 v_mfma_f32_16x16x32_bf16 v[52:55], a[20:23], a[4:7], v[52:55]
 v_accvgpr_read_b32 v145, a177
 v_mfma_f32_16x16x32_bf16 v[48:51], a[20:23], a[0:3], v[48:51]
 ds_read_b64_tr_b16 a[20:21], v13 offset:32768
 ds_read_b64_tr_b16 a[22:23], v13 offset:33792
 v_mfma_f32_16x16x32_bf16 v[64:67], a[24:27], a[0:3], v[64:67]
 ds_read_b128 a[32:35], v11 offset:32768
 v_accvgpr_read_b32 v146, a178
 v_mfma_f32_16x16x32_bf16 v[68:71], a[24:27], a[4:7], v[68:71]
 v_accvgpr_read_b32 v147, a179
 v_mfma_f32_16x16x32_bf16 v[72:75], a[24:27], a[8:11], v[72:75]
 v_mfma_f32_16x16x32_bf16 v[76:79], a[24:27], a[12:15], v[76:79]
 ds_read_b64_tr_b16 a[24:25], v14 offset:32768
 ds_read_b64_tr_b16 a[26:27], v14 offset:33792
 v_mfma_f32_16x16x32_bf16 v[92:95], a[28:31], a[12:15], v[92:95]
 v_mfma_f32_16x16x32_bf16 v[88:91], a[28:31], a[8:11], v[88:91]
 v_mfma_f32_16x16x32_bf16 v[84:87], a[28:31], a[4:7], v[84:87]
 v_mfma_f32_16x16x32_bf16 v[80:83], a[28:31], a[0:3], v[80:83]
 ds_read_b64_tr_b16 a[28:29], v15 offset:32768
 ds_read_b64_tr_b16 a[30:31], v15 offset:33792
 v_mfma_f32_16x16x32_bf16 v[96:99], a[48:51], a[0:3], v[96:99]
 v_mfma_f32_16x16x32_bf16 v[100:103], a[48:51], a[4:7], v[100:103]
 v_mfma_f32_16x16x32_bf16 v[104:107], a[48:51], a[8:11], v[104:107]
 ds_read_b128 a[36:39], v11 offset:34816
 v_mfma_f32_16x16x32_bf16 v[108:111], a[48:51], a[12:15], v[108:111]
 ds_read_b64_tr_b16 a[48:49], v16 offset:32768
 ds_read_b64_tr_b16 a[50:51], v16 offset:33792
 v_mfma_f32_16x16x32_bf16 v[124:127], a[52:55], a[12:15], v[124:127]
 v_mfma_f32_16x16x32_bf16 v[120:123], a[52:55], a[8:11], v[120:123]
 v_mfma_f32_16x16x32_bf16 v[116:119], a[52:55], a[4:7], v[116:119]
 v_mfma_f32_16x16x32_bf16 v[112:115], a[52:55], a[0:3], v[112:115]
 ds_read_b64_tr_b16 a[52:53], v17 offset:32768
 ds_read_b64_tr_b16 a[54:55], v17 offset:33792
 s_waitcnt lgkmcnt(5)
 v_mfma_f32_16x16x32_bf16 v[128:131], a[56:59], a[0:3], v[128:131]
 v_mfma_f32_16x16x32_bf16 v[132:135], a[56:59], a[4:7], v[132:135]
 v_mfma_f32_16x16x32_bf16 v[136:139], a[56:59], a[8:11], v[136:139]
 v_mfma_f32_16x16x32_bf16 v[140:143], a[56:59], a[12:15], v[140:143]
 ds_read_b64_tr_b16 a[56:57], v18 offset:32768
 ds_read_b64_tr_b16 a[58:59], v18 offset:33792
 v_mfma_f32_16x16x32_bf16 v[156:159], a[60:63], a[12:15], v[156:159]
 ds_read_b128 a[40:43], v11 offset:36864
 v_mfma_f32_16x16x32_bf16 v[152:155], a[60:63], a[8:11], v[152:155]
 v_mfma_f32_16x16x32_bf16 v[148:151], a[60:63], a[4:7], v[148:151]
 v_mfma_f32_16x16x32_bf16 v[144:147], a[60:63], a[0:3], v[144:147]
 ds_read_b64_tr_b16 a[60:61], v19 offset:32768
 ds_read_b64_tr_b16 a[62:63], v19 offset:33792
 v_mfma_f32_16x16x32_bf16 a[192:195], a[16:19], a[0:3], a[192:195]
 v_mfma_f32_16x16x32_bf16 a[196:199], a[16:19], a[4:7], a[196:199]
 v_mfma_f32_16x16x32_bf16 a[200:203], a[16:19], a[8:11], a[200:203]
 v_mfma_f32_16x16x32_bf16 a[204:207], a[16:19], a[12:15], a[204:207]
 ds_read_b64_tr_b16 a[16:17], v20 offset:57344
 ds_read_b64_tr_b16 a[18:19], v20 offset:57856
 v_mfma_f32_16x16x32_bf16 a[220:223], a[20:23], a[12:15], a[220:223]
 v_mfma_f32_16x16x32_bf16 a[216:219], a[20:23], a[8:11], a[216:219]
 v_mfma_f32_16x16x32_bf16 a[212:215], a[20:23], a[4:7], a[212:215]
 ds_read_b128 a[44:47], v11 offset:38912
 v_mfma_f32_16x16x32_bf16 a[208:211], a[20:23], a[0:3], a[208:211]
 ds_read_b64_tr_b16 a[20:21], v20 offset:59392
 ds_read_b64_tr_b16 a[22:23], v20 offset:59904
 v_mfma_f32_16x16x32_bf16 v[160:163], a[24:27], a[0:3], v[160:163]
 s_waitcnt vmcnt(0)
 s_barrier
 v_add_u32_e64 v29, 3, v0
 buffer_store_dword v29, v26, s[24:27], 0 offen sc1
 v_mfma_f32_16x16x32_bf16 v[164:167], a[24:27], a[4:7], v[164:167]
 v_mfma_f32_16x16x32_bf16 v[168:171], a[24:27], a[8:11], v[168:171]
 v_mfma_f32_16x16x32_bf16 v[172:175], a[24:27], a[12:15], v[172:175]
 ds_read_b64_tr_b16 a[24:25], v21 offset:57344
 ds_read_b64_tr_b16 a[26:27], v21 offset:57856
 v_mfma_f32_16x16x32_bf16 v[188:191], a[28:31], a[12:15], v[188:191]
 s_mov_b64 exec, 0
 s_cmp_eq_u32 s58, 0
 s_cbranch_scc1 L_pg10
 s_cmp_eq_u32 s58, 1
 s_cbranch_scc1 L_pg11
 s_cmp_eq_u32 s58, 2
 s_cbranch_scc1 L_hopr2
 s_branch L_hopr2
L_hopr2:
 s_mov_b64 exec, -1
 v_sub_u32 v28, v28, v0
 v_subrev_u32 v28, 2, v28
 v_cmp_ge_u32 vcc, 10, v28
 s_mov_b32 s79, 0
 s_cmp_eq_u64 vcc, -1
 s_cbranch_scc0 L_pl2
L_pd2:
 v_mfma_f32_16x16x32_bf16 v[184:187], a[28:31], a[8:11], v[184:187]
 v_mfma_f32_16x16x32_bf16 v[180:183], a[28:31], a[4:7], v[180:183]
 s_add_u32 m0, s63, -65536
 v_mfma_f32_16x16x32_bf16 v[176:179], a[28:31], a[0:3], v[176:179]
 buffer_load_dwordx4 v2, s[4:7], s64 offen offset:0 sc1 lds
 ds_read_b64_tr_b16 a[28:29], v21 offset:59392
 ds_read_b64_tr_b16 a[30:31], v21 offset:59904
 s_waitcnt lgkmcnt(4)
 v_mfma_f32_16x16x32_bf16 v[192:195], a[48:51], a[0:3], v[192:195]
 s_add_u32 s20, s56, 0x2400000
 s_addc_u32 s21, s57, 0
 v_mfma_f32_16x16x32_bf16 v[196:199], a[48:51], a[4:7], v[196:199]
 s_mov_b32 s22, 0x0
 s_mov_b32 s23, 0x00020000
 v_mfma_f32_16x16x32_bf16 v[200:203], a[48:51], a[8:11], v[200:203]
 s_cmp_lt_u32 s74, 27
 s_cselect_b32 s22, 0x6c0000, 0
 v_mfma_f32_16x16x32_bf16 v[204:207], a[48:51], a[12:15], v[204:207]
 buffer_load_dwordx4 v2, s[4:7], s64 offen offset:1024 sc1 lds
 ds_read_b64_tr_b16 a[48:49], v22 offset:57344
 ds_read_b64_tr_b16 a[50:51], v22 offset:57856
 v_mfma_f32_16x16x32_bf16 v[220:223], a[52:55], a[12:15], v[220:223]
 s_lshl_b32 s3, s58, 1
 s_lshl_b32 s72, s60, 3
 v_mfma_f32_16x16x32_bf16 v[216:219], a[52:55], a[8:11], v[216:219]
 s_sub_u32 s73, 120, s72
 s_add_u32 s72, s72, s3
 v_mfma_f32_16x16x32_bf16 v[212:215], a[52:55], a[4:7], v[212:215]
 s_add_u32 s73, s73, s3
 s_mul_i32 s72, s72, 55296
 v_mfma_f32_16x16x32_bf16 v[208:211], a[52:55], a[0:3], v[208:211]
 buffer_load_dwordx4 v2, s[4:7], s64 offen offset:2048 sc1 lds
 ds_read_b64_tr_b16 a[52:53], v22 offset:59392
 ds_read_b64_tr_b16 a[54:55], v22 offset:59904
 v_mfma_f32_16x16x32_bf16 v[224:227], a[56:59], a[0:3], v[224:227]
 s_mul_i32 s73, s73, 55296
 s_lshl_b32 s3, s74, 11
 v_mfma_f32_16x16x32_bf16 v[228:231], a[56:59], a[4:7], v[228:231]
 s_add_u32 s72, s72, s3
 s_add_u32 s73, s73, s3
 v_mfma_f32_16x16x32_bf16 v[232:235], a[56:59], a[8:11], v[232:235]
 v_add_u32 v5, 55296, v2
 s_mov_b32 s28, 0x3e0293ee
 v_mfma_f32_16x16x32_bf16 v[236:239], a[56:59], a[12:15], v[236:239]
 buffer_load_dwordx4 v2, s[4:7], s64 offen offset:3072 sc1 lds
 ds_read_b64_tr_b16 a[56:57], v23 offset:57344
 ds_read_b64_tr_b16 a[58:59], v23 offset:57856
 v_mfma_f32_16x16x32_bf16 v[252:255], a[60:63], a[12:15], v[252:255]
 s_mov_b32 s29, s28
 s_mov_b32 s76, 0xbdd2d3e8
 v_mfma_f32_16x16x32_bf16 v[248:251], a[60:63], a[8:11], v[248:251]
 s_mov_b32 s77, s76
 v_mov_b32 v28, 0xc0135761
 v_mfma_f32_16x16x32_bf16 v[244:247], a[60:63], a[4:7], v[244:247]
 s_add_u32 m0, s63, -61440
 s_add_u32 s3, s63, 0x10000
 v_mfma_f32_16x16x32_bf16 v[240:243], a[60:63], a[0:3], v[240:243]
 buffer_load_dwordx4 v3, s[4:7], s64 offen offset:0 sc1 lds
 ds_read_b64_tr_b16 a[60:61], v23 offset:59392
 ds_read_b64_tr_b16 a[62:63], v23 offset:59904
 v_mfma_f32_16x16x32_bf16 v[32:35], a[16:19], a[32:35], v[32:35]
 v_add_u32_e64 v29, s3, v2
 v_xor_b32 v30, 0x2000, v29
 v_mfma_f32_16x16x32_bf16 v[36:39], a[16:19], a[36:39], v[36:39]
 v_add_u32 v6, 0x4000, v2
 v_add_u32 v7, 0x8000, v2
 v_mfma_f32_16x16x32_bf16 v[40:43], a[16:19], a[40:43], v[40:43]
 v_add_u32 v24, 0xc000, v2
 v_mov_b32_e64 v4, v2
 v_mfma_f32_16x16x32_bf16 v[44:47], a[16:19], a[44:47], v[44:47]
 buffer_load_dwordx4 v3, s[4:7], s64 offen offset:1024 sc1 lds
 ds_read_b64_tr_b16 a[16:17], v12 offset:40960
 ds_read_b64_tr_b16 a[18:19], v12 offset:41984
 v_mfma_f32_16x16x32_bf16 v[60:63], a[20:23], a[44:47], v[60:63]
 v_mov_b32 v25, 0xf149f2ca
 v_lshrrev_b32_e64 v8, 4, v1
 v_mfma_f32_16x16x32_bf16 v[56:59], a[20:23], a[40:43], v[56:59]
 v_and_b32 v9, 15, v1
 v_lshlrev_b32 v10, 8, v8
 v_mfma_f32_16x16x32_bf16 v[52:55], a[20:23], a[36:39], v[52:55]
 v_lshlrev_b32 v8, 2, v8
 v_sub_u32 v8, v8, v9
 v_mfma_f32_16x16x32_bf16 v[48:51], a[20:23], a[32:35], v[48:51]
 buffer_load_dwordx4 v3, s[4:7], s64 offen offset:2048 sc1 lds
 ds_read_b64_tr_b16 a[20:21], v13 offset:40960
 ds_read_b64_tr_b16 a[22:23], v13 offset:41984
 s_waitcnt lgkmcnt(4)
 v_mfma_f32_16x16x32_bf16 v[64:67], a[24:27], a[32:35], v[64:67]
 v_mov_b32 v9, 0x3f803f80
 v_cmp_ge_i32 s[84:85], 0, v8
 v_mfma_f32_16x16x32_bf16 v[68:71], a[24:27], a[36:39], v[68:71]
 v_cmp_ge_i32 s[86:87], -1, v8
 v_cmp_ge_i32 s[92:93], -2, v8
 v_mfma_f32_16x16x32_bf16 v[72:75], a[24:27], a[40:43], v[72:75]
 v_cmp_ge_i32 s[94:95], -3, v8
 v_accvgpr_write_b32 a136, v9
 v_mfma_f32_16x16x32_bf16 v[76:79], a[24:27], a[44:47], v[76:79]
 buffer_load_dwordx4 v3, s[4:7], s64 offen offset:3072 sc1 lds
 ds_read_b64_tr_b16 a[24:25], v14 offset:40960
 ds_read_b64_tr_b16 a[26:27], v14 offset:41984
 v_mfma_f32_16x16x32_bf16 v[92:95], a[28:31], a[44:47], v[92:95]
 v_accvgpr_write_b32 a137, v9
 v_accvgpr_write_b32 a138, v9
 v_mfma_f32_16x16x32_bf16 v[88:91], a[28:31], a[40:43], v[88:91]
 v_accvgpr_write_b32 a139, v9
 v_mfma_f32_16x16x32_bf16 v[84:87], a[28:31], a[36:39], v[84:87]
 s_add_u32 m0, s63, 0
 v_mfma_f32_16x16x32_bf16 v[80:83], a[28:31], a[32:35], v[80:83]
 buffer_load_dwordx4 v2, s[4:7], s65 offen offset:0 sc1 lds
 ds_read_b64_tr_b16 a[28:29], v15 offset:40960
 ds_read_b64_tr_b16 a[30:31], v15 offset:41984
 v_mfma_f32_16x16x32_bf16 v[96:99], a[48:51], a[32:35], v[96:99]
 v_mfma_f32_16x16x32_bf16 v[100:103], a[48:51], a[36:39], v[100:103]
 v_mfma_f32_16x16x32_bf16 v[104:107], a[48:51], a[40:43], v[104:107]
 v_mfma_f32_16x16x32_bf16 v[108:111], a[48:51], a[44:47], v[108:111]
 buffer_load_dwordx4 v2, s[4:7], s65 offen offset:1024 sc1 lds
 ds_read_b64_tr_b16 a[48:49], v16 offset:40960
 ds_read_b64_tr_b16 a[50:51], v16 offset:41984
 v_mfma_f32_16x16x32_bf16 v[124:127], a[52:55], a[44:47], v[124:127]
 v_mfma_f32_16x16x32_bf16 v[120:123], a[52:55], a[40:43], v[120:123]
 v_mfma_f32_16x16x32_bf16 v[116:119], a[52:55], a[36:39], v[116:119]
 v_mfma_f32_16x16x32_bf16 v[112:115], a[52:55], a[32:35], v[112:115]
 buffer_load_dwordx4 v2, s[4:7], s65 offen offset:2048 sc1 lds
 ds_read_b64_tr_b16 a[52:53], v17 offset:40960
 ds_read_b64_tr_b16 a[54:55], v17 offset:41984
 v_mfma_f32_16x16x32_bf16 v[128:131], a[56:59], a[32:35], v[128:131]
 v_mfma_f32_16x16x32_bf16 v[132:135], a[56:59], a[36:39], v[132:135]
 v_mfma_f32_16x16x32_bf16 v[136:139], a[56:59], a[40:43], v[136:139]
 v_mfma_f32_16x16x32_bf16 v[140:143], a[56:59], a[44:47], v[140:143]
 buffer_load_dwordx4 v2, s[4:7], s65 offen offset:3072 sc1 lds
 ds_read_b64_tr_b16 a[56:57], v18 offset:40960
 ds_read_b64_tr_b16 a[58:59], v18 offset:41984
 v_mfma_f32_16x16x32_bf16 v[156:159], a[60:63], a[44:47], v[156:159]
 v_mfma_f32_16x16x32_bf16 v[152:155], a[60:63], a[40:43], v[152:155]
 v_mfma_f32_16x16x32_bf16 v[148:151], a[60:63], a[36:39], v[148:151]
 s_add_u32 m0, s63, 4096
 v_mfma_f32_16x16x32_bf16 v[144:147], a[60:63], a[32:35], v[144:147]
 buffer_load_dwordx4 v3, s[4:7], s65 offen offset:0 sc1 lds
 ds_read_b64_tr_b16 a[60:61], v19 offset:40960
 ds_read_b64_tr_b16 a[62:63], v19 offset:41984
 s_waitcnt lgkmcnt(4)
 v_mfma_f32_16x16x32_bf16 a[192:195], a[16:19], a[32:35], a[192:195]
 v_mfma_f32_16x16x32_bf16 a[196:199], a[16:19], a[36:39], a[196:199]
 v_mfma_f32_16x16x32_bf16 a[200:203], a[16:19], a[40:43], a[200:203]
 v_mfma_f32_16x16x32_bf16 a[204:207], a[16:19], a[44:47], a[204:207]
 buffer_load_dwordx4 v3, s[4:7], s65 offen offset:1024 sc1 lds
 v_mfma_f32_16x16x32_bf16 a[220:223], a[20:23], a[44:47], a[220:223]
 v_mfma_f32_16x16x32_bf16 a[216:219], a[20:23], a[40:43], a[216:219]
 v_mfma_f32_16x16x32_bf16 a[212:215], a[20:23], a[36:39], a[212:215]
 v_mfma_f32_16x16x32_bf16 a[208:211], a[20:23], a[32:35], a[208:211]
 buffer_load_dwordx4 v3, s[4:7], s65 offen offset:2048 sc1 lds
 v_mfma_f32_16x16x32_bf16 v[160:163], a[24:27], a[32:35], v[160:163]
 v_mfma_f32_16x16x32_bf16 v[164:167], a[24:27], a[36:39], v[164:167]
 v_mfma_f32_16x16x32_bf16 v[168:171], a[24:27], a[40:43], v[168:171]
 v_mfma_f32_16x16x32_bf16 v[172:175], a[24:27], a[44:47], v[172:175]
 buffer_load_dwordx4 v3, s[4:7], s65 offen offset:3072 sc1 lds
 v_mfma_f32_16x16x32_bf16 v[188:191], a[28:31], a[44:47], v[188:191]
 v_mfma_f32_16x16x32_bf16 v[184:187], a[28:31], a[40:43], v[184:187]
 v_mfma_f32_16x16x32_bf16 v[180:183], a[28:31], a[36:39], v[180:183]
 v_mfma_f32_16x16x32_bf16 v[176:179], a[28:31], a[32:35], v[176:179]
 v_mfma_f32_16x16x32_bf16 v[192:195], a[48:51], a[32:35], v[192:195]
 v_mfma_f32_16x16x32_bf16 v[196:199], a[48:51], a[36:39], v[196:199]
 v_mfma_f32_16x16x32_bf16 v[200:203], a[48:51], a[40:43], v[200:203]
 v_mfma_f32_16x16x32_bf16 v[204:207], a[48:51], a[44:47], v[204:207]
 v_mfma_f32_16x16x32_bf16 v[220:223], a[52:55], a[44:47], v[220:223]
 v_mfma_f32_16x16x32_bf16 v[216:219], a[52:55], a[40:43], v[216:219]
 v_mfma_f32_16x16x32_bf16 v[212:215], a[52:55], a[36:39], v[212:215]
 v_mfma_f32_16x16x32_bf16 v[208:211], a[52:55], a[32:35], v[208:211]
 s_waitcnt lgkmcnt(0)
 v_mfma_f32_16x16x32_bf16 v[224:227], a[56:59], a[32:35], v[224:227]
 v_mfma_f32_16x16x32_bf16 v[228:231], a[56:59], a[36:39], v[228:231]
 v_mfma_f32_16x16x32_bf16 v[232:235], a[56:59], a[40:43], v[232:235]
 v_mfma_f32_16x16x32_bf16 v[236:239], a[56:59], a[44:47], v[236:239]
 v_mfma_f32_16x16x32_bf16 v[252:255], a[60:63], a[44:47], v[252:255]
 v_mfma_f32_16x16x32_bf16 v[248:251], a[60:63], a[40:43], v[248:251]
 v_mfma_f32_16x16x32_bf16 v[244:247], a[60:63], a[36:39], v[244:247]
 v_mfma_f32_16x16x32_bf16 v[240:243], a[60:63], a[32:35], v[240:243]
 v_pk_mul_f32 v[168:169], s[28:29], v[168:169]
 v_pk_mul_f32 v[170:171], s[28:29], v[170:171]
 v_pk_mul_f32 v[184:185], s[28:29], v[184:185]
 v_pk_mul_f32 v[186:187], s[28:29], v[186:187]
 v_cvt_pk_bf16_f32 v168, v168, v169
 v_cvt_pk_bf16_f32 v169, v170, v171
 v_cvt_pk_bf16_f32 v170, v184, v185
 v_cvt_pk_bf16_f32 v171, v186, v187
 ds_write_b128 v29, v[168:171] offset:1024
 v_pk_mul_f32 v[172:173], s[28:29], v[172:173]
 v_pk_mul_f32 v[174:175], s[28:29], v[174:175]
 v_pk_mul_f32 v[188:189], s[28:29], v[188:189]
 v_pk_mul_f32 v[190:191], s[28:29], v[190:191]
 v_cvt_pk_bf16_f32 v172, v172, v173
 v_cvt_pk_bf16_f32 v173, v174, v175
 v_cvt_pk_bf16_f32 v174, v188, v189
 v_cvt_pk_bf16_f32 v175, v190, v191
 ds_write_b128 v29, v[172:175] offset:5120
 v_pk_mul_f32 v[200:201], s[28:29], v[200:201]
 v_pk_mul_f32 v[202:203], s[28:29], v[202:203]
 v_pk_mul_f32 v[216:217], s[28:29], v[216:217]
 v_pk_mul_f32 v[218:219], s[28:29], v[218:219]
 v_cvt_pk_bf16_f32 v200, v200, v201
 v_cvt_pk_bf16_f32 v201, v202, v203
 v_cvt_pk_bf16_f32 v202, v216, v217
 v_cvt_pk_bf16_f32 v203, v218, v219
 ds_write_b128 v29, v[200:203] offset:2048
 v_pk_mul_f32 v[204:205], s[28:29], v[204:205]
 v_pk_mul_f32 v[206:207], s[28:29], v[206:207]
 v_pk_mul_f32 v[220:221], s[28:29], v[220:221]
 v_pk_mul_f32 v[222:223], s[28:29], v[222:223]
 v_cvt_pk_bf16_f32 v204, v204, v205
 v_cvt_pk_bf16_f32 v205, v206, v207
 v_cvt_pk_bf16_f32 v206, v220, v221
 v_cvt_pk_bf16_f32 v207, v222, v223
 ds_write_b128 v29, v[204:207] offset:6144
 v_pk_mul_f32 v[232:233], s[28:29], v[232:233]
 v_pk_mul_f32 v[234:235], s[28:29], v[234:235]
 v_pk_mul_f32 v[248:249], s[28:29], v[248:249]
 v_pk_mul_f32 v[250:251], s[28:29], v[250:251]
 v_cvt_pk_bf16_f32 v232, v232, v233
 v_cvt_pk_bf16_f32 v233, v234, v235
 v_cvt_pk_bf16_f32 v234, v248, v249
 v_cvt_pk_bf16_f32 v235, v250, v251
 ds_write_b128 v29, v[232:235] offset:3072
 v_pk_mul_f32 v[236:237], s[28:29], v[236:237]
 v_pk_mul_f32 v[238:239], s[28:29], v[238:239]
 v_pk_mul_f32 v[252:253], s[28:29], v[252:253]
 v_pk_mul_f32 v[254:255], s[28:29], v[254:255]
 v_cvt_pk_bf16_f32 v236, v236, v237
 v_cvt_pk_bf16_f32 v237, v238, v239
 v_cvt_pk_bf16_f32 v238, v252, v253
 v_cvt_pk_bf16_f32 v239, v254, v255
 ds_write_b128 v29, v[236:239] offset:7168
 v_accvgpr_read_b32 v184, a200
 v_accvgpr_read_b32 v185, a201
 v_accvgpr_read_b32 v186, a202
 v_accvgpr_read_b32 v187, a203
 v_accvgpr_read_b32 v188, a216
 v_accvgpr_read_b32 v189, a217
 v_accvgpr_read_b32 v190, a218
 v_accvgpr_read_b32 v191, a219
 v_pk_mul_f32 v[184:185], s[28:29], v[184:185]
 v_pk_mul_f32 v[186:187], s[28:29], v[186:187]
 v_pk_mul_f32 v[188:189], s[28:29], v[188:189]
 v_pk_mul_f32 v[190:191], s[28:29], v[190:191]
 v_cvt_pk_bf16_f32 v184, v184, v185
 v_cvt_pk_bf16_f32 v185, v186, v187
 v_cvt_pk_bf16_f32 v186, v188, v189
 v_cvt_pk_bf16_f32 v187, v190, v191
 ds_write_b128 v29, v[184:187] offset:0
 v_accvgpr_read_b32 v216, a204
 v_accvgpr_read_b32 v217, a205
 v_accvgpr_read_b32 v218, a206
 v_accvgpr_read_b32 v219, a207
 v_accvgpr_read_b32 v220, a220
 v_accvgpr_read_b32 v221, a221
 v_accvgpr_read_b32 v222, a222
 v_accvgpr_read_b32 v223, a223
 v_pk_mul_f32 v[216:217], s[28:29], v[216:217]
 v_pk_mul_f32 v[218:219], s[28:29], v[218:219]
 v_pk_mul_f32 v[220:221], s[28:29], v[220:221]
 v_pk_mul_f32 v[222:223], s[28:29], v[222:223]
 v_cvt_pk_bf16_f32 v216, v216, v217
 v_cvt_pk_bf16_f32 v217, v218, v219
 v_cvt_pk_bf16_f32 v218, v220, v221
 v_cvt_pk_bf16_f32 v219, v222, v223
 ds_write_b128 v29, v[216:219] offset:4096
 v_pk_mul_f32 v[248:249], v[32:33], v[32:33]
 v_pk_mul_f32 v[250:251], v[34:35], v[34:35]
 v_pk_mul_f32 v[252:253], v[64:65], v[64:65]
 v_pk_mul_f32 v[254:255], v[66:67], v[66:67]
L_pg10:
 s_cbranch_execz L_hopr2
 v_pk_fma_f32 v[248:249], v[248:249], s[76:77], v[28:29] op_sel_hi:[1,1,0]
 v_pk_fma_f32 v[250:251], v[250:251], s[76:77], v[28:29] op_sel_hi:[1,1,0]
 v_pk_fma_f32 v[252:253], v[252:253], s[76:77], v[28:29] op_sel_hi:[1,1,0]
 v_pk_fma_f32 v[254:255], v[254:255], s[76:77], v[28:29] op_sel_hi:[1,1,0]
 v_pk_mul_f32 v[248:249], v[248:249], v[32:33]
 v_pk_mul_f32 v[250:251], v[250:251], v[34:35]
 v_pk_mul_f32 v[252:253], v[252:253], v[64:65]
 v_pk_mul_f32 v[254:255], v[254:255], v[66:67]
 v_exp_f32 v248, v248
 s_lshl_b32 s3, s58, 12
 v_exp_f32 v249, v249
 s_add_u32 s64, s3, 0x8000
 v_exp_f32_e64 v250, v250
 s_add_u32 s65, s3, 0x10000
 v_exp_f32_e64 v251, v251
 s_mov_b32 s67, 0x8000
 v_exp_f32_e64 v252, v252
 s_mov_b32 s68, 0x10000
 v_exp_f32 v253, v253
 s_and_b32 s69, s58, 1
 v_exp_f32 v254, v254
 s_lshl_b32 s69, s69, 15
 v_exp_f32_e64 v255, v255
 s_add_u32 s69, s69, 0x10000
 v_pk_mul_f32 v[48:49], v[32:33], v[48:49]
 v_pk_mul_f32 v[50:51], v[34:35], v[50:51]
 v_pk_mul_f32 v[80:81], v[64:65], v[80:81]
 v_pk_mul_f32 v[82:83], v[66:67], v[82:83]
 v_pk_add_f32 v[248:249], v[248:249], 1.0 op_sel_hi:[1,0]
 v_pk_add_f32 v[250:251], v[250:251], 1.0 op_sel_hi:[1,0]
 v_pk_add_f32 v[252:253], v[252:253], 1.0 op_sel_hi:[1,0]
 v_pk_add_f32 v[254:255], v[254:255], 1.0 op_sel_hi:[1,0]
 v_rcp_f32 v248, v248
 s_lshl_b32 s70, s60, 2
 v_rcp_f32 v249, v249
 s_add_u32 s70, s70, s58
 v_rcp_f32 v250, v250
 s_lshl_b32 s66, s60, 1
 v_rcp_f32 v251, v251
 s_sub_u32 s3, 16, s60
 v_rcp_f32 v252, v252
 s_lshl_b32 s6, s3, 16
 v_rcp_f32 v253, v253
 s_lshr_b32 s3, s58, 1
 v_rcp_f32 v254, v254
 s_lshl_b32 s3, s3, 5
 v_rcp_f32 v255, v255
 s_add_u32 s3, s3, s59
 v_pk_mul_f32 v[48:49], v[48:49], v[248:249]
 v_pk_mul_f32 v[50:51], v[50:51], v[250:251]
 v_pk_mul_f32 v[80:81], v[80:81], v[252:253]
 v_pk_mul_f32 v[82:83], v[82:83], v[254:255]
 v_cvt_pk_bf16_f32 v32, v48, v49
 v_cvt_pk_bf16_f32 v33, v50, v51
 v_cvt_pk_bf16_f32 v34, v80, v81
 v_cvt_pk_bf16_f32 v35, v82, v83
 buffer_store_dwordx4 v[32:35], v2, s[20:23], s72 offen offset:0 sc1
 v_pk_mul_f32 v[184:185], v[36:37], v[36:37]
 v_pk_mul_f32 v[186:187], v[38:39], v[38:39]
 v_pk_mul_f32 v[188:189], v[68:69], v[68:69]
 v_pk_mul_f32 v[190:191], v[70:71], v[70:71]
 v_pk_fma_f32 v[184:185], v[184:185], s[76:77], v[28:29] op_sel_hi:[1,1,0]
 v_pk_fma_f32 v[186:187], v[186:187], s[76:77], v[28:29] op_sel_hi:[1,1,0]
 v_pk_fma_f32 v[188:189], v[188:189], s[76:77], v[28:29] op_sel_hi:[1,1,0]
 v_pk_fma_f32 v[190:191], v[190:191], s[76:77], v[28:29] op_sel_hi:[1,1,0]
 v_pk_mul_f32 v[184:185], v[184:185], v[36:37]
 v_pk_mul_f32 v[186:187], v[186:187], v[38:39]
 v_pk_mul_f32 v[188:189], v[188:189], v[68:69]
 v_pk_mul_f32 v[190:191], v[190:191], v[70:71]
 v_exp_f32 v184, v184
 s_lshl_b32 s3, s3, 14
 v_exp_f32 v185, v185
 s_lshl_b32 s91, s60, 20
 v_exp_f32_e64 v186, v186
 s_sub_u32 s96, 0xf00000, s91
 v_exp_f32 v187, v187
 s_add_u32 s91, s91, s3
 v_exp_f32 v188, v188
 s_add_u32 s96, s96, s3
 v_exp_f32 v189, v189
 s_and_b32 s3, s58, 1
 v_exp_f32 v190, v190
 s_lshl_b32 s3, s3, 11
 v_exp_f32 v191, v191
 s_add_u32 s91, s91, s3
 v_pk_mul_f32 v[52:53], v[36:37], v[52:53]
 v_pk_mul_f32 v[54:55], v[38:39], v[54:55]
 v_pk_mul_f32 v[84:85], v[68:69], v[84:85]
 v_pk_mul_f32 v[86:87], v[70:71], v[86:87]
 v_pk_add_f32 v[184:185], v[184:185], 1.0 op_sel_hi:[1,0]
 v_pk_add_f32 v[186:187], v[186:187], 1.0 op_sel_hi:[1,0]
 v_pk_add_f32 v[188:189], v[188:189], 1.0 op_sel_hi:[1,0]
 v_pk_add_f32 v[190:191], v[190:191], 1.0 op_sel_hi:[1,0]
 v_rcp_f32_e64 v184, v184
 s_xor_b32 s3, s3, 0x800
 v_rcp_f32 v185, v185
 s_add_u32 s96, s96, s3
 v_rcp_f32 v186, v186
 s_lshl_b32 s62, s58, 12
 v_rcp_f32 v187, v187
 s_lshl_b32 s88, s60, 16
 v_rcp_f32 v188, v188
 s_add_u32 s88, s88, s62
 v_rcp_f32_e64 v189, v189
 s_add_u32 s88, s88, 0x10000
 v_rcp_f32 v190, v190
 v_rcp_f32 v191, v191
 v_pk_mul_f32 v[52:53], v[52:53], v[184:185]
 v_pk_mul_f32 v[54:55], v[54:55], v[186:187]
 v_pk_mul_f32 v[84:85], v[84:85], v[188:189]
 v_pk_mul_f32 v[86:87], v[86:87], v[190:191]
 v_cvt_pk_bf16_f32 v36, v52, v53
 v_cvt_pk_bf16_f32 v37, v54, v55
 v_cvt_pk_bf16_f32 v38, v84, v85
 v_cvt_pk_bf16_f32 v39, v86, v87
 buffer_store_dwordx4 v[36:39], v5, s[20:23], s72 offen offset:0 sc1
 v_pk_mul_f32 v[216:217], v[40:41], v[40:41]
 v_pk_mul_f32 v[218:219], v[42:43], v[42:43]
 v_pk_mul_f32 v[220:221], v[72:73], v[72:73]
 v_pk_mul_f32 v[222:223], v[74:75], v[74:75]
 v_pk_fma_f32 v[216:217], v[216:217], s[76:77], v[28:29] op_sel_hi:[1,1,0]
 v_pk_fma_f32 v[218:219], v[218:219], s[76:77], v[28:29] op_sel_hi:[1,1,0]
 v_pk_fma_f32 v[220:221], v[220:221], s[76:77], v[28:29] op_sel_hi:[1,1,0]
 v_pk_fma_f32 v[222:223], v[222:223], s[76:77], v[28:29] op_sel_hi:[1,1,0]
 v_pk_mul_f32 v[216:217], v[216:217], v[40:41]
 v_pk_mul_f32 v[218:219], v[218:219], v[42:43]
 v_pk_mul_f32 v[220:221], v[220:221], v[72:73]
 v_pk_mul_f32 v[222:223], v[222:223], v[74:75]
 v_exp_f32 v216, v216
 v_exp_f32 v217, v217
 v_exp_f32 v218, v218
 v_exp_f32 v219, v219
 v_exp_f32 v220, v220
 v_exp_f32 v221, v221
 v_exp_f32 v222, v222
 v_exp_f32 v223, v223
 v_pk_mul_f32 v[56:57], v[40:41], v[56:57]
 v_pk_mul_f32 v[58:59], v[42:43], v[58:59]
 v_pk_mul_f32 v[88:89], v[72:73], v[88:89]
 v_pk_mul_f32 v[90:91], v[74:75], v[90:91]
 v_pk_add_f32 v[216:217], v[216:217], 1.0 op_sel_hi:[1,0]
 v_pk_add_f32 v[218:219], v[218:219], 1.0 op_sel_hi:[1,0]
 v_pk_add_f32 v[220:221], v[220:221], 1.0 op_sel_hi:[1,0]
 v_pk_add_f32 v[222:223], v[222:223], 1.0 op_sel_hi:[1,0]
 v_rcp_f32 v216, v216
 v_rcp_f32 v217, v217
 v_rcp_f32 v218, v218
 v_rcp_f32 v219, v219
 v_rcp_f32 v220, v220
 v_rcp_f32 v221, v221
 v_rcp_f32 v222, v222
 v_rcp_f32 v223, v223
 v_pk_mul_f32 v[56:57], v[56:57], v[216:217]
 v_pk_mul_f32 v[58:59], v[58:59], v[218:219]
 v_pk_mul_f32 v[88:89], v[88:89], v[220:221]
 v_pk_mul_f32 v[90:91], v[90:91], v[222:223]
 v_cvt_pk_bf16_f32 v40, v56, v57
 v_cvt_pk_bf16_f32 v41, v58, v59
 v_cvt_pk_bf16_f32 v42, v88, v89
 v_cvt_pk_bf16_f32 v43, v90, v91
 buffer_store_dwordx4 v[40:43], v2, s[20:23], s73 offen offset:0 sc1
 v_pk_mul_f32 v[248:249], v[44:45], v[44:45]
 v_pk_mul_f32 v[250:251], v[46:47], v[46:47]
 v_pk_mul_f32 v[252:253], v[76:77], v[76:77]
 v_pk_mul_f32 v[254:255], v[78:79], v[78:79]
 v_pk_fma_f32 v[248:249], v[248:249], s[76:77], v[28:29] op_sel_hi:[1,1,0]
 v_pk_fma_f32 v[250:251], v[250:251], s[76:77], v[28:29] op_sel_hi:[1,1,0]
 v_pk_fma_f32 v[252:253], v[252:253], s[76:77], v[28:29] op_sel_hi:[1,1,0]
 v_pk_fma_f32 v[254:255], v[254:255], s[76:77], v[28:29] op_sel_hi:[1,1,0]
 v_pk_mul_f32 v[248:249], v[248:249], v[44:45]
 v_pk_mul_f32 v[250:251], v[250:251], v[46:47]
 v_pk_mul_f32 v[252:253], v[252:253], v[76:77]
 v_pk_mul_f32 v[254:255], v[254:255], v[78:79]
 v_exp_f32 v248, v248
 v_exp_f32 v249, v249
 v_exp_f32 v250, v250
 v_exp_f32 v251, v251
 v_exp_f32 v252, v252
 v_exp_f32 v253, v253
 v_exp_f32 v254, v254
 v_exp_f32 v255, v255
 v_pk_mul_f32 v[60:61], v[44:45], v[60:61]
 v_pk_mul_f32 v[62:63], v[46:47], v[62:63]
 v_pk_mul_f32 v[92:93], v[76:77], v[92:93]
 v_pk_mul_f32 v[94:95], v[78:79], v[94:95]
 v_pk_add_f32 v[248:249], v[248:249], 1.0 op_sel_hi:[1,0]
 v_pk_add_f32 v[250:251], v[250:251], 1.0 op_sel_hi:[1,0]
 v_pk_add_f32 v[252:253], v[252:253], 1.0 op_sel_hi:[1,0]
 v_pk_add_f32 v[254:255], v[254:255], 1.0 op_sel_hi:[1,0]
 v_rcp_f32 v248, v248
 v_rcp_f32 v249, v249
 v_rcp_f32 v250, v250
 v_rcp_f32 v251, v251
 v_rcp_f32 v252, v252
 v_rcp_f32 v253, v253
 v_rcp_f32 v254, v254
 v_rcp_f32 v255, v255
 v_pk_mul_f32 v[60:61], v[60:61], v[248:249]
 v_pk_mul_f32 v[62:63], v[62:63], v[250:251]
 v_pk_mul_f32 v[92:93], v[92:93], v[252:253]
 v_pk_mul_f32 v[94:95], v[94:95], v[254:255]
 v_cvt_pk_bf16_f32 v44, v60, v61
 v_cvt_pk_bf16_f32 v45, v62, v63
 v_cvt_pk_bf16_f32 v46, v92, v93
 v_cvt_pk_bf16_f32 v47, v94, v95
 buffer_store_dwordx4 v[44:47], v5, s[20:23], s73 offen offset:0 sc1
 v_pk_mul_f32 v[184:185], v[96:97], v[96:97]
 v_pk_mul_f32 v[186:187], v[98:99], v[98:99]
 v_pk_mul_f32 v[188:189], v[128:129], v[128:129]
 v_pk_mul_f32 v[190:191], v[130:131], v[130:131]
 v_pk_fma_f32 v[184:185], v[184:185], s[76:77], v[28:29] op_sel_hi:[1,1,0]
 v_pk_fma_f32 v[186:187], v[186:187], s[76:77], v[28:29] op_sel_hi:[1,1,0]
 v_pk_fma_f32 v[188:189], v[188:189], s[76:77], v[28:29] op_sel_hi:[1,1,0]
 v_pk_fma_f32 v[190:191], v[190:191], s[76:77], v[28:29] op_sel_hi:[1,1,0]
 v_pk_mul_f32 v[184:185], v[184:185], v[96:97]
 v_pk_mul_f32 v[186:187], v[186:187], v[98:99]
 v_pk_mul_f32 v[188:189], v[188:189], v[128:129]
 v_pk_mul_f32 v[190:191], v[190:191], v[130:131]
 v_exp_f32 v184, v184
 v_exp_f32 v185, v185
 v_exp_f32 v186, v186
 v_exp_f32 v187, v187
 v_exp_f32 v188, v188
 v_exp_f32 v189, v189
 v_exp_f32 v190, v190
 v_exp_f32 v191, v191
 v_pk_mul_f32 v[112:113], v[96:97], v[112:113]
 v_pk_mul_f32 v[114:115], v[98:99], v[114:115]
 v_pk_mul_f32 v[144:145], v[128:129], v[144:145]
 v_pk_mul_f32 v[146:147], v[130:131], v[146:147]
 v_pk_add_f32 v[184:185], v[184:185], 1.0 op_sel_hi:[1,0]
 v_pk_add_f32 v[186:187], v[186:187], 1.0 op_sel_hi:[1,0]
 v_pk_add_f32 v[188:189], v[188:189], 1.0 op_sel_hi:[1,0]
 v_pk_add_f32 v[190:191], v[190:191], 1.0 op_sel_hi:[1,0]
 v_rcp_f32 v184, v184
 v_rcp_f32 v185, v185
 v_rcp_f32 v186, v186
 v_rcp_f32 v187, v187
 v_rcp_f32 v188, v188
 v_rcp_f32 v189, v189
 v_rcp_f32 v190, v190
 v_rcp_f32 v191, v191
 v_pk_mul_f32 v[112:113], v[112:113], v[184:185]
 v_pk_mul_f32 v[114:115], v[114:115], v[186:187]
 v_pk_mul_f32 v[144:145], v[144:145], v[188:189]
 v_pk_mul_f32 v[146:147], v[146:147], v[190:191]
 v_cvt_pk_bf16_f32 v96, v112, v113
 v_cvt_pk_bf16_f32 v97, v114, v115
 v_cvt_pk_bf16_f32 v98, v144, v145
 v_cvt_pk_bf16_f32 v99, v146, v147
 buffer_store_dwordx4 v[96:99], v2, s[20:23], s72 offen offset:1024 sc1
 v_pk_mul_f32 v[216:217], v[100:101], v[100:101]
 v_pk_mul_f32 v[218:219], v[102:103], v[102:103]
 v_pk_mul_f32 v[220:221], v[132:133], v[132:133]
 v_pk_mul_f32 v[222:223], v[134:135], v[134:135]
 v_pk_fma_f32 v[216:217], v[216:217], s[76:77], v[28:29] op_sel_hi:[1,1,0]
 v_pk_fma_f32 v[218:219], v[218:219], s[76:77], v[28:29] op_sel_hi:[1,1,0]
 v_pk_fma_f32 v[220:221], v[220:221], s[76:77], v[28:29] op_sel_hi:[1,1,0]
 v_pk_fma_f32 v[222:223], v[222:223], s[76:77], v[28:29] op_sel_hi:[1,1,0]
 v_pk_mul_f32 v[216:217], v[216:217], v[100:101]
 v_pk_mul_f32 v[218:219], v[218:219], v[102:103]
 v_pk_mul_f32 v[220:221], v[220:221], v[132:133]
 v_pk_mul_f32 v[222:223], v[222:223], v[134:135]
 v_exp_f32 v216, v216
 v_exp_f32 v217, v217
 v_exp_f32 v218, v218
 v_exp_f32 v219, v219
 v_exp_f32 v220, v220
 v_exp_f32 v221, v221
 v_exp_f32 v222, v222
 v_exp_f32 v223, v223
 v_pk_mul_f32 v[116:117], v[100:101], v[116:117]
 v_pk_mul_f32 v[118:119], v[102:103], v[118:119]
 v_pk_mul_f32 v[148:149], v[132:133], v[148:149]
 v_pk_mul_f32 v[150:151], v[134:135], v[150:151]
 v_pk_add_f32 v[216:217], v[216:217], 1.0 op_sel_hi:[1,0]
 v_pk_add_f32 v[218:219], v[218:219], 1.0 op_sel_hi:[1,0]
 v_pk_add_f32 v[220:221], v[220:221], 1.0 op_sel_hi:[1,0]
 v_pk_add_f32 v[222:223], v[222:223], 1.0 op_sel_hi:[1,0]
 v_rcp_f32 v216, v216
 v_rcp_f32 v217, v217
 v_rcp_f32 v218, v218
 v_rcp_f32 v219, v219
 v_rcp_f32 v220, v220
 v_rcp_f32 v221, v221
 v_rcp_f32 v222, v222
 v_rcp_f32 v223, v223
 v_pk_mul_f32 v[116:117], v[116:117], v[216:217]
 v_pk_mul_f32 v[118:119], v[118:119], v[218:219]
 v_pk_mul_f32 v[148:149], v[148:149], v[220:221]
 v_pk_mul_f32 v[150:151], v[150:151], v[222:223]
 v_cvt_pk_bf16_f32 v100, v116, v117
 v_cvt_pk_bf16_f32 v101, v118, v119
 v_cvt_pk_bf16_f32 v102, v148, v149
 v_cvt_pk_bf16_f32 v103, v150, v151
 buffer_store_dwordx4 v[100:103], v5, s[20:23], s72 offen offset:1024 sc1
 v_pk_mul_f32 v[248:249], v[104:105], v[104:105]
 v_pk_mul_f32 v[250:251], v[106:107], v[106:107]
 v_pk_mul_f32 v[252:253], v[136:137], v[136:137]
 v_pk_mul_f32 v[254:255], v[138:139], v[138:139]
 v_pk_fma_f32 v[248:249], v[248:249], s[76:77], v[28:29] op_sel_hi:[1,1,0]
 v_pk_fma_f32 v[250:251], v[250:251], s[76:77], v[28:29] op_sel_hi:[1,1,0]
 v_pk_fma_f32 v[252:253], v[252:253], s[76:77], v[28:29] op_sel_hi:[1,1,0]
 v_pk_fma_f32 v[254:255], v[254:255], s[76:77], v[28:29] op_sel_hi:[1,1,0]
 v_pk_mul_f32 v[248:249], v[248:249], v[104:105]
 v_pk_mul_f32 v[250:251], v[250:251], v[106:107]
 v_pk_mul_f32 v[252:253], v[252:253], v[136:137]
 v_pk_mul_f32 v[254:255], v[254:255], v[138:139]
 v_exp_f32 v248, v248
 v_exp_f32 v249, v249
 v_exp_f32 v250, v250
 v_exp_f32 v251, v251
 v_exp_f32 v252, v252
 v_exp_f32 v253, v253
 v_exp_f32 v254, v254
 v_exp_f32 v255, v255
 v_pk_mul_f32 v[120:121], v[104:105], v[120:121]
 v_pk_mul_f32 v[122:123], v[106:107], v[122:123]
 v_pk_mul_f32 v[152:153], v[136:137], v[152:153]
 v_pk_mul_f32 v[154:155], v[138:139], v[154:155]
 v_pk_add_f32 v[248:249], v[248:249], 1.0 op_sel_hi:[1,0]
 v_pk_add_f32 v[250:251], v[250:251], 1.0 op_sel_hi:[1,0]
 v_pk_add_f32 v[252:253], v[252:253], 1.0 op_sel_hi:[1,0]
 v_pk_add_f32 v[254:255], v[254:255], 1.0 op_sel_hi:[1,0]
 v_rcp_f32 v248, v248
 v_rcp_f32 v249, v249
 v_rcp_f32 v250, v250
 v_rcp_f32 v251, v251
 v_rcp_f32 v252, v252
 v_rcp_f32 v253, v253
 v_rcp_f32 v254, v254
 v_rcp_f32 v255, v255
 v_pk_mul_f32 v[120:121], v[120:121], v[248:249]
 v_pk_mul_f32 v[122:123], v[122:123], v[250:251]
 v_pk_mul_f32 v[152:153], v[152:153], v[252:253]
 v_pk_mul_f32 v[154:155], v[154:155], v[254:255]
 v_cvt_pk_bf16_f32 v104, v120, v121
 v_cvt_pk_bf16_f32 v105, v122, v123
 v_cvt_pk_bf16_f32 v106, v152, v153
 v_cvt_pk_bf16_f32 v107, v154, v155
 buffer_store_dwordx4 v[104:107], v2, s[20:23], s73 offen offset:1024 sc1
 v_pk_mul_f32 v[184:185], v[108:109], v[108:109]
 v_pk_mul_f32 v[186:187], v[110:111], v[110:111]
 v_pk_mul_f32 v[188:189], v[140:141], v[140:141]
 v_pk_mul_f32 v[190:191], v[142:143], v[142:143]
 v_pk_fma_f32 v[184:185], v[184:185], s[76:77], v[28:29] op_sel_hi:[1,1,0]
 v_pk_fma_f32 v[186:187], v[186:187], s[76:77], v[28:29] op_sel_hi:[1,1,0]
 v_pk_fma_f32 v[188:189], v[188:189], s[76:77], v[28:29] op_sel_hi:[1,1,0]
 v_pk_fma_f32 v[190:191], v[190:191], s[76:77], v[28:29] op_sel_hi:[1,1,0]
 v_pk_mul_f32 v[184:185], v[184:185], v[108:109]
 v_pk_mul_f32 v[186:187], v[186:187], v[110:111]
 v_pk_mul_f32 v[188:189], v[188:189], v[140:141]
 v_pk_mul_f32 v[190:191], v[190:191], v[142:143]
 v_exp_f32 v184, v184
 v_exp_f32 v185, v185
 v_exp_f32 v186, v186
 v_exp_f32 v187, v187
 v_exp_f32 v188, v188
 v_exp_f32 v189, v189
 v_exp_f32 v190, v190
 v_exp_f32 v191, v191
 v_pk_mul_f32 v[124:125], v[108:109], v[124:125]
 v_pk_mul_f32 v[126:127], v[110:111], v[126:127]
 v_pk_mul_f32 v[156:157], v[140:141], v[156:157]
 v_pk_mul_f32 v[158:159], v[142:143], v[158:159]
 v_pk_add_f32 v[184:185], v[184:185], 1.0 op_sel_hi:[1,0]
 v_pk_add_f32 v[186:187], v[186:187], 1.0 op_sel_hi:[1,0]
 v_pk_add_f32 v[188:189], v[188:189], 1.0 op_sel_hi:[1,0]
 v_pk_add_f32 v[190:191], v[190:191], 1.0 op_sel_hi:[1,0]
 v_rcp_f32 v184, v184
 v_rcp_f32 v185, v185
 v_rcp_f32 v186, v186
 v_rcp_f32 v187, v187
 v_rcp_f32 v188, v188
 v_rcp_f32 v189, v189
 v_rcp_f32 v190, v190
 v_rcp_f32 v191, v191
 v_pk_mul_f32 v[124:125], v[124:125], v[184:185]
 v_pk_mul_f32 v[126:127], v[126:127], v[186:187]
 v_pk_mul_f32 v[156:157], v[156:157], v[188:189]
 v_pk_mul_f32 v[158:159], v[158:159], v[190:191]
 v_cvt_pk_bf16_f32 v108, v124, v125
 v_cvt_pk_bf16_f32 v109, v126, v127
 v_cvt_pk_bf16_f32 v110, v156, v157
 v_cvt_pk_bf16_f32 v111, v158, v159
 buffer_store_dwordx4 v[108:111], v5, s[20:23], s73 offen offset:1024 sc1
 v_pk_mul_f32 v[160:161], s[28:29], v[160:161]
 v_pk_mul_f32 v[162:163], s[28:29], v[162:163]
 v_pk_mul_f32 v[176:177], s[28:29], v[176:177]
 v_pk_mul_f32 v[178:179], s[28:29], v[178:179]
 v_cvt_pk_bf16_f32 v36, v160, v161
 v_cvt_pk_bf16_f32 v37, v162, v163
 v_cvt_pk_bf16_f32 v38, v176, v177
 v_cvt_pk_bf16_f32 v39, v178, v179
 v_pk_mul_f32 v[164:165], s[28:29], v[164:165]
 v_pk_mul_f32 v[166:167], s[28:29], v[166:167]
 v_pk_mul_f32 v[180:181], s[28:29], v[180:181]
 v_pk_mul_f32 v[182:183], s[28:29], v[182:183]
 v_cvt_pk_bf16_f32 v52, v164, v165
 v_cvt_pk_bf16_f32 v53, v166, v167
 v_cvt_pk_bf16_f32 v54, v180, v181
 v_cvt_pk_bf16_f32 v55, v182, v183
 v_pk_mul_f32 v[192:193], s[28:29], v[192:193]
 v_pk_mul_f32 v[194:195], s[28:29], v[194:195]
 v_pk_mul_f32 v[208:209], s[28:29], v[208:209]
 v_pk_mul_f32 v[210:211], s[28:29], v[210:211]
 v_cvt_pk_bf16_f32 v40, v192, v193
 v_cvt_pk_bf16_f32 v41, v194, v195
 v_cvt_pk_bf16_f32 v42, v208, v209
 v_cvt_pk_bf16_f32 v43, v210, v211
 v_pk_mul_f32 v[196:197], s[28:29], v[196:197]
 v_pk_mul_f32 v[198:199], s[28:29], v[198:199]
 v_pk_mul_f32 v[212:213], s[28:29], v[212:213]
 v_pk_mul_f32 v[214:215], s[28:29], v[214:215]
 v_cvt_pk_bf16_f32 v56, v196, v197
 v_cvt_pk_bf16_f32 v57, v198, v199
 v_cvt_pk_bf16_f32 v58, v212, v213
 v_cvt_pk_bf16_f32 v59, v214, v215
 v_pk_mul_f32 v[224:225], s[28:29], v[224:225]
 v_pk_mul_f32 v[226:227], s[28:29], v[226:227]
 v_pk_mul_f32 v[240:241], s[28:29], v[240:241]
 v_pk_mul_f32 v[242:243], s[28:29], v[242:243]
 v_cvt_pk_bf16_f32 v44, v224, v225
 v_cvt_pk_bf16_f32 v45, v226, v227
 v_cvt_pk_bf16_f32 v46, v240, v241
 v_cvt_pk_bf16_f32 v47, v242, v243
 v_pk_mul_f32 v[228:229], s[28:29], v[228:229]
 v_pk_mul_f32 v[230:231], s[28:29], v[230:231]
 v_pk_mul_f32 v[244:245], s[28:29], v[244:245]
 v_pk_mul_f32 v[246:247], s[28:29], v[246:247]
 v_cvt_pk_bf16_f32 v60, v228, v229
 v_cvt_pk_bf16_f32 v61, v230, v231
 v_cvt_pk_bf16_f32 v62, v244, v245
 v_cvt_pk_bf16_f32 v63, v246, v247
 v_accvgpr_read_b32 v248, a192
 v_accvgpr_read_b32 v249, a193
 v_accvgpr_read_b32 v250, a194
 v_accvgpr_read_b32 v251, a195
 v_accvgpr_read_b32 v252, a208
 v_accvgpr_read_b32 v253, a209
 v_accvgpr_read_b32 v254, a210
 v_accvgpr_read_b32 v255, a211
 v_pk_mul_f32 v[248:249], s[28:29], v[248:249]
 v_pk_mul_f32 v[250:251], s[28:29], v[250:251]
 v_pk_mul_f32 v[252:253], s[28:29], v[252:253]
 v_pk_mul_f32 v[254:255], s[28:29], v[254:255]
 v_cvt_pk_bf16_f32 v32, v248, v249
 v_cvt_pk_bf16_f32 v33, v250, v251
 v_cvt_pk_bf16_f32 v34, v252, v253
 v_cvt_pk_bf16_f32 v35, v254, v255
 v_accvgpr_read_b32 v184, a196
 v_accvgpr_read_b32 v185, a197
 v_accvgpr_read_b32 v186, a198
 v_accvgpr_read_b32 v187, a199
 v_accvgpr_read_b32 v188, a212
 v_accvgpr_read_b32 v189, a213
 v_accvgpr_read_b32 v190, a214
 v_accvgpr_read_b32 v191, a215
 v_pk_mul_f32 v[184:185], s[28:29], v[184:185]
 v_pk_mul_f32 v[186:187], s[28:29], v[186:187]
 v_pk_mul_f32 v[188:189], s[28:29], v[188:189]
 v_pk_mul_f32 v[190:191], s[28:29], v[190:191]
 v_cvt_pk_bf16_f32 v48, v184, v185
 v_cvt_pk_bf16_f32 v49, v186, v187
 v_cvt_pk_bf16_f32 v50, v188, v189
 v_cvt_pk_bf16_f32 v51, v190, v191
 s_mov_b64 s[72:73], 0
 s_add_u32 s20, s56, 0x2c00000
 s_addc_u32 s21, s57, 0
 s_mov_b32 s22, 0x1000000
 s_mov_b32 s23, 0x00020000
 s_waitcnt vmcnt(8)
 s_waitcnt lgkmcnt(0)
 s_barrier
 ds_read_b128 v[96:99], v10 offset:0
 ds_read_b128 v[100:103], v10 offset:1024
 ds_read_b128 v[104:107], v10 offset:2048
 ds_read_b128 v[108:111], v10 offset:3072
 ds_read_b128 a[32:35], v29 offset:0
 ds_read_b128 a[36:39], v29 offset:1024
 ds_read_b128 a[40:43], v29 offset:2048
 ds_read_b128 a[44:47], v29 offset:3072
 ds_read_b128 a[48:51], v29 offset:4096
 ds_read_b128 a[52:55], v29 offset:5120
 ds_read_b128 a[56:59], v29 offset:6144
 ds_read_b128 a[60:63], v29 offset:7168
 s_waitcnt lgkmcnt(11)
 v_xor_b32 v96, 0x80008000, v96
 v_xor_b32 v97, 0x80008000, v97
 v_xor_b32 v98, 0x80008000, v98
 v_xor_b32 v99, 0x80008000, v99
 s_waitcnt lgkmcnt(10)
 v_xor_b32 v100, 0x80008000, v100
 v_xor_b32 v101, 0x80008000, v101
 v_xor_b32 v102, 0x80008000, v102
 v_xor_b32 v103, 0x80008000, v103
 s_waitcnt lgkmcnt(9)
 v_xor_b32 v104, 0x80008000, v104
 v_xor_b32 v105, 0x80008000, v105
 v_xor_b32 v106, 0x80008000, v106
 v_xor_b32 v107, 0x80008000, v107
 s_waitcnt lgkmcnt(8)
 v_xor_b32 v108, 0x80008000, v108
 v_xor_b32 v109, 0x80008000, v109
 v_xor_b32 v110, 0x80008000, v110
 v_xor_b32 v111, 0x80008000, v111
 ds_read_b128 a[224:227], v30 offset:0
 ds_read_b128 a[228:231], v30 offset:1024
 ds_read_b128 a[232:235], v30 offset:2048
 ds_read_b128 a[236:239], v30 offset:3072
 ds_read_b128 a[240:243], v30 offset:4096
 ds_read_b128 a[244:247], v30 offset:5120
 ds_read_b128 a[248:251], v30 offset:6144
 ds_read_b128 a[252:255], v30 offset:7168
 v_mfma_f32_16x16x32_bf16 v[144:147], v[96:99], v[32:35], 0
 ds_read_b128 a[0:3], v4 offset:0
 s_add_u32 m0, s62, 0x8000
 v_mfma_f32_16x16x32_bf16 v[152:155], v[96:99], v[48:51], 0
 ds_read_b128 a[16:19], v4 offset:4096
 buffer_load_dwordx4 v7, s[4:7], s88 offen offset:0 sc1 lds
 v_mfma_f32_16x16x32_bf16 v[144:147], v[100:103], v[36:39], v[144:147]
 ds_read_b128 a[4:7], v4 offset:1024
 v_mfma_f32_16x16x32_bf16 v[152:155], v[100:103], v[52:55], v[152:155]
 ds_read_b128 a[20:23], v4 offset:5120
 v_mfma_f32_16x16x32_bf16 v[144:147], v[104:107], v[40:43], v[144:147]
 ds_read_b128 a[8:11], v4 offset:2048
 buffer_load_dwordx4 v7, s[4:7], s88 offen offset:1024 sc1 lds
 v_mfma_f32_16x16x32_bf16 v[152:155], v[104:107], v[56:59], v[152:155]
 ds_read_b128 a[24:27], v4 offset:6144
 v_mfma_f32_16x16x32_bf16 v[144:147], v[108:111], v[44:47], v[144:147]
 ds_read_b128 a[12:15], v4 offset:3072
 v_mfma_f32_16x16x32_bf16 v[152:155], v[108:111], v[60:63], v[152:155]
 ds_read_b128 a[28:31], v4 offset:7168
 buffer_load_dwordx4 v7, s[4:7], s88 offen offset:2048 sc1 lds
 s_waitcnt lgkmcnt(8)
 v_mfma_f32_16x16x32_bf16 v[160:163], v[96:99], a[32:35], 0
 v_mfma_f32_16x16x32_bf16 v[168:171], v[96:99], a[48:51], 0
 v_mfma_f32_16x16x32_bf16 v[160:163], v[100:103], a[36:39], v[160:163]
 buffer_load_dwordx4 v7, s[4:7], s88 offen offset:3072 sc1 lds
 v_mfma_f32_16x16x32_bf16 v[168:171], v[100:103], a[52:55], v[168:171]
 v_mfma_f32_16x16x32_bf16 v[160:163], v[104:107], a[40:43], v[160:163]
 v_mov_b64 v[148:149], v[144:145]
 v_mov_b64 v[150:151], v[146:147]
 s_add_u32 m0, s62, 0xc000
 v_mfma_f32_16x16x32_bf16 v[168:171], v[104:107], a[56:59], v[168:171]
 buffer_load_dwordx4 v24, s[4:7], s88 offen offset:0 sc1 lds
 v_mfma_f32_16x16x32_bf16 v[160:163], v[108:111], a[44:47], v[160:163]
 v_mov_b64 v[156:157], v[152:153]
 v_mov_b64 v[158:159], v[154:155]
 v_mfma_f32_16x16x32_bf16 v[168:171], v[108:111], a[60:63], v[168:171]
 v_mfma_f32_16x16x32_bf16 v[8:11], v[96:99], a[224:227], 0
 buffer_load_dwordx4 v24, s[4:7], s88 offen offset:1024 sc1 lds
 v_mfma_f32_16x16x32_bf16 v[16:19], v[96:99], a[240:243], 0
 v_mfma_f32_16x16x32_bf16 v[8:11], v[100:103], a[228:231], v[8:11]
 v_mfma_f32_16x16x32_bf16 v[16:19], v[100:103], a[244:247], v[16:19]
 buffer_load_dwordx4 v24, s[4:7], s88 offen offset:2048 sc1 lds
 v_mfma_f32_16x16x32_bf16 v[8:11], v[104:107], a[232:235], v[8:11]
 v_mov_b64 v[164:165], v[160:161]
 v_mov_b64 v[166:167], v[162:163]
 v_mfma_f32_16x16x32_bf16 v[16:19], v[104:107], a[248:251], v[16:19]
 v_mfma_f32_16x16x32_bf16 v[8:11], v[108:111], a[236:239], v[8:11]
 v_mov_b64 v[172:173], v[168:169]
 v_mov_b64 v[174:175], v[170:171]
 buffer_load_dwordx4 v24, s[4:7], s88 offen offset:3072 sc1 lds
 v_mfma_f32_16x16x32_bf16 v[16:19], v[108:111], a[252:255], v[16:19]
 s_nop 3
 v_mov_b64 v[12:13], v[8:9]
 v_mov_b64 v[14:15], v[10:11]
 s_nop 1
 v_mov_b64 v[20:21], v[16:17]
 v_mov_b64 v[22:23], v[18:19]
 s_sub_u32 s70, s70, 1
 s_cbranch_scc1 L_hdp
L_hdrp:
 s_waitcnt lgkmcnt(0)
 v_mfma_f32_16x16x32_bf16 v[64:67], a[0:3], v[32:35], v[144:147]
 s_and_b32 s75, s2, 7
 s_bfe_u32 s76, s2, 0x20003
 v_mfma_f32_16x16x32_bf16 v[72:75], a[0:3], v[48:51], v[152:155]
 s_and_b32 s3, s2, 1
 s_lshl_b32 s46, s76, 1
 v_mfma_f32_16x16x32_bf16 v[80:83], a[0:3], a[32:35], v[160:163]
 s_add_u32 s46, s46, s3
 s_and_b32 s3, s2, 6
 v_mfma_f32_16x16x32_bf16 v[88:91], a[0:3], a[48:51], v[168:171]
 ds_read_b128 a[0:3], v4 offset:8192
 s_lshl_b32 s44, s60, 3
 v_mfma_f32_16x16x32_bf16 v[92:95], a[16:19], a[48:51], v[172:175]
 s_sub_u32 s45, 120, s44
 s_add_u32 s44, s44, s3
 v_mfma_f32_16x16x32_bf16 v[84:87], a[16:19], a[32:35], v[164:167]
 s_xor_b32 s3, s3, 2
 s_add_u32 s45, s45, s3
 v_mfma_f32_16x16x32_bf16 v[76:79], a[16:19], v[48:51], v[156:159]
 s_cmp_lt_u32 s58, 2
 s_cselect_b32 s34, s44, s45
 v_mfma_f32_16x16x32_bf16 v[68:71], a[16:19], v[32:35], v[148:151]
 ds_read_b128 a[16:19], v4 offset:12288
 s_and_b32 s3, s58, 1
 v_mfma_f32_16x16x32_bf16 v[64:67], a[4:7], v[36:39], v[64:67]
 s_add_u32 s34, s34, s3
 s_mul_i32 s34, s34, 55296
 v_mfma_f32_16x16x32_bf16 v[72:75], a[4:7], v[52:55], v[72:75]
 s_mul_i32 s77, s46, 5
 s_lshl_b32 s3, s58, 2
L_pg11:
 s_cbranch_execz L_hopr2
 v_mfma_f32_16x16x32_bf16 v[80:83], a[4:7], a[36:39], v[80:83]
 s_add_u32 s77, s77, s3
 s_mul_i32 s39, s58, 52
 v_mfma_f32_16x16x32_bf16 v[88:91], a[4:7], a[52:55], v[88:91]
 ds_read_b128 a[4:7], v4 offset:9216
 s_add_u32 s3, s39, 0
 v_mfma_f32_16x16x32_bf16 v[92:95], a[20:23], a[52:55], v[92:95]
 s_lshr_b32 s3, s3, 6
 s_mul_i32 s3, s3, 35
 v_mfma_f32_16x16x32_bf16 v[84:87], a[20:23], a[36:39], v[84:87]
 s_add_u32 s3, s3, s77
 s_lshl_b32 s35, s3, 10
 v_mfma_f32_16x16x32_bf16 v[76:79], a[20:23], v[52:55], v[76:79]
 s_add_u32 s3, s39, 13
 s_lshr_b32 s3, s3, 6
 v_mfma_f32_16x16x32_bf16 v[68:71], a[20:23], v[36:39], v[68:71]
 ds_read_b128 a[20:23], v4 offset:13312
 s_mul_i32 s3, s3, 35
 v_mfma_f32_16x16x32_bf16 v[64:67], a[8:11], v[40:43], v[64:67]
 s_add_u32 s3, s3, s77
 s_lshl_b32 s36, s3, 10
 v_mfma_f32_16x16x32_bf16 v[72:75], a[8:11], v[56:59], v[72:75]
 s_add_u32 s3, s39, 26
 s_lshr_b32 s3, s3, 6
 v_mfma_f32_16x16x32_bf16 v[80:83], a[8:11], a[40:43], v[80:83]
 s_mul_i32 s3, s3, 35
 s_add_u32 s3, s3, s77
 v_mfma_f32_16x16x32_bf16 v[88:91], a[8:11], a[56:59], v[88:91]
 ds_read_b128 a[8:11], v4 offset:10240
 s_lshl_b32 s37, s3, 10
 v_mfma_f32_16x16x32_bf16 v[92:95], a[24:27], a[56:59], v[92:95]
 s_add_u32 s3, s39, 39
 s_lshr_b32 s3, s3, 6
 v_mfma_f32_16x16x32_bf16 v[84:87], a[24:27], a[40:43], v[84:87]
 s_mul_i32 s3, s3, 35
 s_add_u32 s3, s3, s77
 v_mfma_f32_16x16x32_bf16 v[76:79], a[24:27], v[56:59], v[76:79]
 s_lshl_b32 s38, s3, 10
 s_lshl_b32 s39, s58, 12
 v_mfma_f32_16x16x32_bf16 v[68:71], a[24:27], v[40:43], v[68:71]
 ds_read_b128 a[24:27], v4 offset:14336
 s_add_u32 s39, s39, 0x20000
 v_mfma_f32_16x16x32_bf16 v[64:67], a[12:15], v[44:47], v[64:67]
 v_mfma_f32_16x16x32_bf16 v[72:75], a[12:15], v[60:63], v[72:75]
 v_mfma_f32_16x16x32_bf16 v[80:83], a[12:15], a[44:47], v[80:83]
 v_mfma_f32_16x16x32_bf16 v[88:91], a[12:15], a[60:63], v[88:91]
 ds_read_b128 a[12:15], v4 offset:11264
 v_mfma_f32_16x16x32_bf16 v[92:95], a[28:31], a[60:63], v[92:95]
 s_nop 2
 v_exp_f32 v64, v64
 v_mfma_f32_16x16x32_bf16 v[84:87], a[28:31], a[44:47], v[84:87]
 v_exp_f32_e64 v65, v65
 v_mfma_f32_16x16x32_bf16 v[76:79], a[28:31], v[60:63], v[76:79]
 v_exp_f32_e64 v66, v66
 v_mfma_f32_16x16x32_bf16 v[68:71], a[28:31], v[44:47], v[68:71]
 ds_read_b128 a[28:31], v4 offset:15360
 v_exp_f32 v67, v67
 v_exp_f32 v72, v72
 v_exp_f32 v73, v73
 v_exp_f32 v74, v74
 v_exp_f32 v75, v75
 v_exp_f32 v80, v80
 v_exp_f32 v81, v81
 v_exp_f32 v82, v82
 v_exp_f32 v83, v83
 v_exp_f32 v88, v88
 v_exp_f32 v89, v89
 v_exp_f32 v90, v90
 v_exp_f32 v91, v91
 v_exp_f32 v92, v92
 v_exp_f32 v93, v93
 v_exp_f32 v94, v94
 v_exp_f32 v95, v95
 v_exp_f32 v84, v84
 v_exp_f32 v85, v85
 v_exp_f32 v86, v86
 v_exp_f32 v87, v87
 v_exp_f32 v76, v76
 v_exp_f32 v77, v77
 v_exp_f32 v78, v78
 v_mov_b32 v5, v4
 v_xor_b32 v4, s68, v4
 s_sub_u32 s70, s70, 1
 s_cbranch_scc1 L_hdfD1
L_hdrfD1:
 s_mov_b64 exec, 0
 s_cmp_eq_u32 s58, 0
 s_cbranch_scc1 L_pg12
 s_cmp_eq_u32 s58, 1
 s_cbranch_scc1 L_pg13
 s_cmp_eq_u32 s58, 2
 s_cbranch_scc1 L_pg14
 s_branch L_hopr3
L_hopr3:
 s_mov_b64 exec, -1
 s_waitcnt vmcnt(8)
 s_waitcnt lgkmcnt(0)
 s_barrier
 v_add_u32_e64 v29, 4, v0
 buffer_store_dword v29, v26, s[24:27], 0 offen sc1
 v_mfma_f32_16x16x32_bf16 v[96:99], a[0:3], v[32:35], v[144:147]
 v_exp_f32_e64 v79, v79
 v_mfma_f32_16x16x32_bf16 v[104:107], a[0:3], v[48:51], v[152:155]
 s_xor_b32 s65, s65, 0x10000
 s_add_u32 s64, s64, s67
 v_mfma_f32_16x16x32_bf16 v[112:115], a[0:3], a[32:35], v[160:163]
 s_mov_b32 m0, s65
 ds_read_b128 a[192:195], v5 offset:16384
 v_mfma_f32_16x16x32_bf16 v[120:123], a[0:3], a[48:51], v[168:171]
 buffer_load_dwordx4 v2, s[4:7], s64 offen offset:0 sc1 lds
 ds_read_b128 a[0:3], v4 offset:0
 v_mfma_f32_16x16x32_bf16 v[124:127], a[16:19], a[48:51], v[172:175]
 v_exp_f32_e64 v68, v68
 v_mfma_f32_16x16x32_bf16 v[116:119], a[16:19], a[32:35], v[164:167]
 v_exp_f32_e64 v69, v69
 v_mfma_f32_16x16x32_bf16 v[108:111], a[16:19], v[48:51], v[156:159]
 v_exp_f32_e64 v70, v70
 v_mfma_f32_16x16x32_bf16 v[100:103], a[16:19], v[32:35], v[148:151]
 buffer_load_dwordx4 v2, s[4:7], s64 offen offset:1024 sc1 lds
 ds_read_b128 a[16:19], v4 offset:4096
 v_mfma_f32_16x16x32_bf16 v[96:99], a[4:7], v[36:39], v[96:99]
 v_exp_f32_e64 v71, v71
 v_mfma_f32_16x16x32_bf16 v[104:107], a[4:7], v[52:55], v[104:107]
 ds_read_b128 a[196:199], v5 offset:17408
 ds_read_b128 a[200:203], v5 offset:18432
 v_mfma_f32_16x16x32_bf16 v[112:115], a[4:7], a[36:39], v[112:115]
 ds_read_b128 a[204:207], v5 offset:19456
 ds_read_b128 a[208:211], v5 offset:20480
 v_mfma_f32_16x16x32_bf16 v[120:123], a[4:7], a[52:55], v[120:123]
 buffer_load_dwordx4 v2, s[4:7], s64 offen offset:2048 sc1 lds
 ds_read_b128 a[4:7], v4 offset:1024
 v_mfma_f32_16x16x32_bf16 v[124:127], a[20:23], a[52:55], v[124:127]
 ds_read_b128 a[212:215], v5 offset:21504
 ds_read_b128 a[216:219], v5 offset:22528
 v_mfma_f32_16x16x32_bf16 v[116:119], a[20:23], a[36:39], v[116:119]
 ds_read_b128 a[220:223], v5 offset:23552
 s_lshl_b32 s3, s58, 6
 v_mfma_f32_16x16x32_bf16 v[108:111], a[20:23], v[52:55], v[108:111]
 v_add_lshl_u32 v27, s3, v1, 7
 v_mov_b32 v248, v2
 v_mfma_f32_16x16x32_bf16 v[100:103], a[20:23], v[36:39], v[100:103]
 buffer_load_dwordx4 v2, s[4:7], s64 offen offset:3072 sc1 lds
 ds_read_b128 a[20:23], v4 offset:5120
 v_mfma_f32_16x16x32_bf16 v[96:99], a[8:11], v[40:43], v[96:99]
 s_add_u32 m0, s62, 0x18000
 s_add_u32 s88, s88, 0x10000
 v_mfma_f32_16x16x32_bf16 v[104:107], a[8:11], v[56:59], v[104:107]
 v_add_u32 v249, 0x20000, v2
 v_mfma_f32_16x16x32_bf16 v[112:115], a[8:11], a[40:43], v[112:115]
 v_cvt_pk_bf16_f32 v128, v64, v65
 v_cvt_pk_bf16_f32 v129, v66, v67
 v_mfma_f32_16x16x32_bf16 v[120:123], a[8:11], a[56:59], v[120:123]
 buffer_load_dwordx4 v7, s[4:7], s88 offen offset:0 sc1 lds
 ds_read_b128 a[8:11], v4 offset:2048
 v_mfma_f32_16x16x32_bf16 v[124:127], a[24:27], a[56:59], v[124:127]
 v_cvt_pk_bf16_f32 v130, v68, v69
 v_cvt_pk_bf16_f32 v131, v70, v71
 v_mfma_f32_16x16x32_bf16 v[116:119], a[24:27], a[40:43], v[116:119]
 v_cvt_pk_bf16_f32 v132, v72, v73
 v_cvt_pk_bf16_f32 v133, v74, v75
 v_mfma_f32_16x16x32_bf16 v[108:111], a[24:27], v[56:59], v[108:111]
 v_cvt_pk_bf16_f32 v134, v76, v77
 v_cvt_pk_bf16_f32 v135, v78, v79
 v_mfma_f32_16x16x32_bf16 v[100:103], a[24:27], v[40:43], v[100:103]
 buffer_load_dwordx4 v7, s[4:7], s88 offen offset:1024 sc1 lds
 ds_read_b128 a[24:27], v4 offset:6144
 v_mfma_f32_16x16x32_bf16 v[96:99], a[12:15], v[44:47], v[96:99]
 v_cvt_pk_bf16_f32 v136, v80, v81
 v_cvt_pk_bf16_f32 v137, v82, v83
 v_mfma_f32_16x16x32_bf16 v[104:107], a[12:15], v[60:63], v[104:107]
 v_cvt_pk_bf16_f32 v138, v84, v85
 v_cvt_pk_bf16_f32 v139, v86, v87
 v_mfma_f32_16x16x32_bf16 v[112:115], a[12:15], a[44:47], v[112:115]
 v_cvt_pk_bf16_f32 v140, v88, v89
 v_cvt_pk_bf16_f32 v141, v90, v91
 v_mfma_f32_16x16x32_bf16 v[120:123], a[12:15], a[60:63], v[120:123]
 buffer_load_dwordx4 v7, s[4:7], s88 offen offset:2048 sc1 lds
 ds_read_b128 a[12:15], v4 offset:3072
 v_mfma_f32_16x16x32_bf16 v[124:127], a[28:31], a[60:63], v[124:127]
 v_cvt_pk_bf16_f32 v142, v92, v93
 v_cvt_pk_bf16_f32 v143, v94, v95
 v_mfma_f32_16x16x32_bf16 v[116:119], a[28:31], a[44:47], v[116:119]
 v_exp_f32_e64 v96, v96
 v_mfma_f32_16x16x32_bf16 v[108:111], a[28:31], v[60:63], v[108:111]
 v_exp_f32_e64 v97, v97
 v_mfma_f32_16x16x32_bf16 v[100:103], a[28:31], v[44:47], v[100:103]
 buffer_load_dwordx4 v7, s[4:7], s88 offen offset:3072 sc1 lds
 ds_read_b128 a[28:31], v4 offset:7168
 v_mfma_f32_16x16x32_bf16 v[240:243], a[136:139], v[128:131], 0
 v_exp_f32_e64 v98, v98
 v_mfma_f32_16x16x32_bf16 v[244:247], a[136:139], v[132:135], 0
 v_exp_f32_e64 v99, v99
 v_mfma_f32_16x16x32_bf16 a[128:131], a[136:139], v[136:139], 0
 v_exp_f32_e64 v104, v104
 v_mfma_f32_16x16x32_bf16 a[132:135], a[136:139], v[140:143], 0
 v_exp_f32 v105, v105
 s_waitcnt lgkmcnt(1)
 v_mfma_f32_16x16x32_bf16 a[72:75], a[192:195], v[140:143], 0
 v_exp_f32_e64 v106, v106
 v_mfma_f32_16x16x32_bf16 a[64:67], a[192:195], v[136:139], 0
 v_exp_f32_e64 v107, v107
 v_mfma_f32_16x16x32_bf16 v[184:187], a[192:195], v[132:135], 0
 v_exp_f32_e64 v112, v112
 v_mfma_f32_16x16x32_bf16 v[176:179], a[192:195], v[128:131], 0
 v_exp_f32_e64 v113, v113
 v_mfma_f32_16x16x32_bf16 v[180:183], a[196:199], v[128:131], 0
 v_exp_f32_e64 v114, v114
 v_mfma_f32_16x16x32_bf16 v[188:191], a[196:199], v[132:135], 0
 v_exp_f32_e64 v115, v115
 v_mfma_f32_16x16x32_bf16 a[68:71], a[196:199], v[136:139], 0
 v_exp_f32_e64 v120, v120
 v_mfma_f32_16x16x32_bf16 a[76:79], a[196:199], v[140:143], 0
 v_exp_f32_e64 v121, v121
 v_mfma_f32_16x16x32_bf16 a[88:91], a[200:203], v[140:143], 0
 v_exp_f32_e64 v122, v122
 v_mfma_f32_16x16x32_bf16 a[80:83], a[200:203], v[136:139], 0
 v_exp_f32_e64 v123, v123
 v_mfma_f32_16x16x32_bf16 v[200:203], a[200:203], v[132:135], 0
 v_exp_f32_e64 v124, v124
 v_mfma_f32_16x16x32_bf16 v[192:195], a[200:203], v[128:131], 0
 v_exp_f32_e64 v125, v125
 v_mfma_f32_16x16x32_bf16 v[196:199], a[204:207], v[128:131], 0
 v_exp_f32_e64 v126, v126
 v_mfma_f32_16x16x32_bf16 v[204:207], a[204:207], v[132:135], 0
 v_exp_f32_e64 v127, v127
 v_mfma_f32_16x16x32_bf16 a[84:87], a[204:207], v[136:139], 0
 v_exp_f32_e64 v116, v116
 v_mfma_f32_16x16x32_bf16 a[92:95], a[204:207], v[140:143], 0
 v_exp_f32_e64 v117, v117
 v_mfma_f32_16x16x32_bf16 a[104:107], a[208:211], v[140:143], 0
 v_exp_f32_e64 v118, v118
 v_mfma_f32_16x16x32_bf16 a[96:99], a[208:211], v[136:139], 0
 v_exp_f32_e64 v119, v119
 v_mfma_f32_16x16x32_bf16 v[216:219], a[208:211], v[132:135], 0
 v_exp_f32_e64 v108, v108
 v_mfma_f32_16x16x32_bf16 v[208:211], a[208:211], v[128:131], 0
 v_exp_f32_e64 v109, v109
 v_mfma_f32_16x16x32_bf16 v[212:215], a[212:215], v[128:131], 0
 v_exp_f32_e64 v110, v110
 v_mfma_f32_16x16x32_bf16 v[220:223], a[212:215], v[132:135], 0
 v_exp_f32_e64 v111, v111
 v_mfma_f32_16x16x32_bf16 a[100:103], a[212:215], v[136:139], 0
 v_exp_f32_e64 v100, v100
 v_mfma_f32_16x16x32_bf16 a[108:111], a[212:215], v[140:143], 0
 v_exp_f32_e64 v101, v101
 v_mfma_f32_16x16x32_bf16 a[120:123], a[216:219], v[140:143], 0
 v_exp_f32_e64 v102, v102
 v_mfma_f32_16x16x32_bf16 a[112:115], a[216:219], v[136:139], 0
 v_exp_f32_e64 v103, v103
 v_mfma_f32_16x16x32_bf16 v[232:235], a[216:219], v[132:135], 0
 s_add_u32 s8, s56, 0x2400000
 s_addc_u32 s9, s57, 0
 v_mfma_f32_16x16x32_bf16 v[224:227], a[216:219], v[128:131], 0
 s_mov_b32 s10, 0x6c0000
 s_mov_b32 s11, 0x00020000
 v_mfma_f32_16x16x32_bf16 v[228:231], a[220:223], v[128:131], 0
 s_add_u32 s12, s56, 0x4100000
 s_addc_u32 s13, s57, 0
 v_mfma_f32_16x16x32_bf16 v[236:239], a[220:223], v[132:135], 0
 s_mov_b32 s14, 0x21c000
 s_mov_b32 s15, 0x00020000
 v_mfma_f32_16x16x32_bf16 a[116:119], a[220:223], v[136:139], 0
 buffer_load_dword v28, v27, s[24:27], 0 offen sc1
 v_mfma_f32_16x16x32_bf16 a[124:127], a[220:223], v[140:143], 0
 s_cmp_eq_u32 s60, 0
 s_cmov_b32 s67, 0x10000
 s_cmov_b32 s68, s69
 s_sub_u32 s70, s70, 1
 s_cbranch_scc1 L_hdsD0
L_hdrsD0:
 v_mfma_f32_16x16x32_bf16 v[64:67], a[0:3], v[32:35], v[144:147]
 ds_read_b128 a[192:195], v5 offset:24576
 v_cvt_pk_bf16_f32 v128, v96, v97
 v_mfma_f32_16x16x32_bf16 v[72:75], a[0:3], v[48:51], v[152:155]
 v_cvt_pk_bf16_f32 v129, v98, v99
 ds_read_b128 a[196:199], v5 offset:25600
 v_mfma_f32_16x16x32_bf16 v[80:83], a[0:3], a[32:35], v[160:163]
 v_cvt_pk_bf16_f32 v130, v100, v101
 v_cvt_pk_bf16_f32 v131, v102, v103
 v_mfma_f32_16x16x32_bf16 v[88:91], a[0:3], a[48:51], v[168:171]
 ds_read_b128 a[0:3], v4 offset:8192
 ds_read_b128 a[200:203], v5 offset:26624
 v_mfma_f32_16x16x32_bf16 v[92:95], a[16:19], a[48:51], v[172:175]
 v_cvt_pk_bf16_f32 v132, v104, v105
 v_cvt_pk_bf16_f32 v133, v106, v107
 v_mfma_f32_16x16x32_bf16 v[84:87], a[16:19], a[32:35], v[164:167]
 ds_read_b128 a[204:207], v5 offset:27648
 v_cvt_pk_bf16_f32 v134, v108, v109
 v_mfma_f32_16x16x32_bf16 v[76:79], a[16:19], v[48:51], v[156:159]
 v_cvt_pk_bf16_f32 v135, v110, v111
 ds_read_b128 a[208:211], v5 offset:28672
 v_mfma_f32_16x16x32_bf16 v[68:71], a[16:19], v[32:35], v[148:151]
 ds_read_b128 a[16:19], v4 offset:12288
 v_cvt_pk_bf16_f32 v136, v112, v113
 v_mfma_f32_16x16x32_bf16 v[64:67], a[4:7], v[36:39], v[64:67]
 v_cvt_pk_bf16_f32 v137, v114, v115
 ds_read_b128 a[212:215], v5 offset:29696
 v_mfma_f32_16x16x32_bf16 v[72:75], a[4:7], v[52:55], v[72:75]
 v_cvt_pk_bf16_f32 v138, v116, v117
 v_cvt_pk_bf16_f32 v139, v118, v119
 v_mfma_f32_16x16x32_bf16 v[80:83], a[4:7], a[36:39], v[80:83]
 ds_read_b128 a[216:219], v5 offset:30720
 v_cvt_pk_bf16_f32 v140, v120, v121
 v_mfma_f32_16x16x32_bf16 v[88:91], a[4:7], a[52:55], v[88:91]
 ds_read_b128 a[4:7], v4 offset:9216
 v_cvt_pk_bf16_f32 v141, v122, v123
 v_mfma_f32_16x16x32_bf16 v[92:95], a[20:23], a[52:55], v[92:95]
 ds_read_b128 a[220:223], v5 offset:31744
 v_cvt_pk_bf16_f32 v142, v124, v125
 v_mfma_f32_16x16x32_bf16 v[84:87], a[20:23], a[36:39], v[84:87]
 v_cvt_pk_bf16_f32 v143, v126, v127
 v_accvgpr_write_b32 a140, 0
 v_mfma_f32_16x16x32_bf16 v[76:79], a[20:23], v[52:55], v[76:79]
 v_accvgpr_write_b32 a141, 0
 v_accvgpr_write_b32 a142, 0
 v_mfma_f32_16x16x32_bf16 v[68:71], a[20:23], v[36:39], v[68:71]
 ds_read_b128 a[20:23], v4 offset:13312
 v_accvgpr_write_b32 a143, 0
 v_mfma_f32_16x16x32_bf16 v[64:67], a[8:11], v[40:43], v[64:67]
 v_accvgpr_write_b32 a144, 0
 v_accvgpr_write_b32 a145, 0
 v_mfma_f32_16x16x32_bf16 v[72:75], a[8:11], v[56:59], v[72:75]
 v_accvgpr_write_b32 a146, 0
 v_accvgpr_write_b32 a147, 0
 v_mfma_f32_16x16x32_bf16 v[80:83], a[8:11], a[40:43], v[80:83]
 v_accvgpr_write_b32 a148, 0
 v_accvgpr_write_b32 a149, 0
 v_mfma_f32_16x16x32_bf16 v[88:91], a[8:11], a[56:59], v[88:91]
 ds_read_b128 a[8:11], v4 offset:10240
 v_accvgpr_write_b32 a150, 0
 v_mfma_f32_16x16x32_bf16 v[92:95], a[24:27], a[56:59], v[92:95]
 v_accvgpr_write_b32 a151, 0
 v_accvgpr_write_b32 a152, 0
 v_mfma_f32_16x16x32_bf16 v[84:87], a[24:27], a[40:43], v[84:87]
 v_accvgpr_write_b32 a153, 0
 v_accvgpr_write_b32 a154, 0
 v_mfma_f32_16x16x32_bf16 v[76:79], a[24:27], v[56:59], v[76:79]
 v_accvgpr_write_b32 a155, 0
 v_accvgpr_write_b32 a156, 0
 v_mfma_f32_16x16x32_bf16 v[68:71], a[24:27], v[40:43], v[68:71]
 ds_read_b128 a[24:27], v4 offset:14336
 v_accvgpr_write_b32 a157, 0
 v_mfma_f32_16x16x32_bf16 v[64:67], a[12:15], v[44:47], v[64:67]
 v_accvgpr_write_b32 a158, 0
 v_accvgpr_write_b32 a159, 0
 v_mfma_f32_16x16x32_bf16 v[72:75], a[12:15], v[60:63], v[72:75]
 v_mfma_f32_16x16x32_bf16 v[80:83], a[12:15], a[44:47], v[80:83]
 v_mfma_f32_16x16x32_bf16 v[88:91], a[12:15], a[60:63], v[88:91]
 ds_read_b128 a[12:15], v4 offset:11264
 s_waitcnt lgkmcnt(2)
 v_mfma_f32_16x16x32_bf16 v[92:95], a[28:31], a[60:63], v[92:95]
 v_mfma_f32_16x16x32_bf16 v[84:87], a[28:31], a[44:47], v[84:87]
 v_exp_f32 v64, v64
 v_mfma_f32_16x16x32_bf16 v[76:79], a[28:31], v[60:63], v[76:79]
 v_exp_f32_e64 v65, v65
 v_mfma_f32_16x16x32_bf16 v[68:71], a[28:31], v[44:47], v[68:71]
 ds_read_b128 a[28:31], v4 offset:15360
 v_mfma_f32_16x16x32_bf16 v[240:243], a[136:139], v[128:131], v[240:243]
 v_exp_f32_e64 v66, v66
 v_mfma_f32_16x16x32_bf16 v[244:247], a[136:139], v[132:135], v[244:247]
 v_exp_f32_e64 v67, v67
 v_mfma_f32_16x16x32_bf16 a[128:131], a[136:139], v[136:139], a[128:131]
 v_exp_f32_e64 v72, v72
 v_mfma_f32_16x16x32_bf16 a[132:135], a[136:139], v[140:143], a[132:135]
 v_exp_f32_e64 v73, v73
 v_mfma_f32_16x16x32_bf16 a[72:75], a[192:195], v[140:143], a[72:75]
 v_exp_f32_e64 v74, v74
 v_mfma_f32_16x16x32_bf16 a[64:67], a[192:195], v[136:139], a[64:67]
 v_exp_f32_e64 v75, v75
 v_mfma_f32_16x16x32_bf16 v[184:187], a[192:195], v[132:135], v[184:187]
 s_waitcnt vmcnt(0)
 v_sub_u32 v28, v28, v0
 v_subrev_u32 v28, 3, v28
 v_cmp_ge_u32 vcc, 9, v28
 s_mov_b32 s79, 0
 s_cmp_eq_u64 vcc, -1
 s_cbranch_scc0 L_pl3
L_pd3:
 v_mfma_f32_16x16x32_bf16 v[176:179], a[192:195], v[128:131], v[176:179]
 s_waitcnt lgkmcnt(0)
 s_barrier
 v_mfma_f32_16x16x32_bf16 v[180:183], a[196:199], v[128:131], v[180:183]
 s_mov_b32 m0, s39
 s_add_u32 s89, s89, 1
 v_mfma_f32_16x16x32_bf16 v[188:191], a[196:199], v[132:135], v[188:191]
 buffer_load_dwordx4 v248, s[12:15], s35 offen offset:0 sc1 lds
 v_mov_b32 v29, s89
 v_mfma_f32_16x16x32_bf16 a[68:71], a[196:199], v[136:139], a[68:71]
 v_exp_f32_e64 v80, v80
 v_mfma_f32_16x16x32_bf16 a[76:79], a[196:199], v[140:143], a[76:79]
 v_exp_f32_e64 v81, v81
 v_mfma_f32_16x16x32_bf16 a[88:91], a[200:203], v[140:143], a[88:91]
 v_exp_f32_e64 v82, v82
 v_mfma_f32_16x16x32_bf16 a[80:83], a[200:203], v[136:139], a[80:83]
 buffer_load_dwordx4 v248, s[12:15], s36 offen offset:1024 sc1 lds
 v_add_u32 v30, 0x8000, v26
 v_mfma_f32_16x16x32_bf16 v[200:203], a[200:203], v[132:135], v[200:203]
 v_exp_f32_e64 v83, v83
 v_mfma_f32_16x16x32_bf16 v[192:195], a[200:203], v[128:131], v[192:195]
 v_exp_f32_e64 v88, v88
 v_mfma_f32_16x16x32_bf16 v[196:199], a[204:207], v[128:131], v[196:199]
 v_exp_f32_e64 v89, v89
 v_mfma_f32_16x16x32_bf16 v[204:207], a[204:207], v[132:135], v[204:207]
 buffer_load_dwordx4 v248, s[12:15], s37 offen offset:2048 sc1 lds
 buffer_store_dword v29, v30, s[24:27], 0 offen sc1
 v_mfma_f32_16x16x32_bf16 a[84:87], a[204:207], v[136:139], a[84:87]
 v_exp_f32_e64 v90, v90
 v_mfma_f32_16x16x32_bf16 a[92:95], a[204:207], v[140:143], a[92:95]
 v_exp_f32_e64 v91, v91
 v_mfma_f32_16x16x32_bf16 a[104:107], a[208:211], v[140:143], a[104:107]
 v_exp_f32_e64 v92, v92
 v_mfma_f32_16x16x32_bf16 a[96:99], a[208:211], v[136:139], a[96:99]
 buffer_load_dwordx4 v248, s[12:15], s38 offen offset:3072 sc1 lds
 s_xor_b32 s39, s39, 0x4000
 v_mfma_f32_16x16x32_bf16 v[216:219], a[208:211], v[132:135], v[216:219]
 v_add_u32 v248, 122880, v248
 s_add_u32 m0, s65, 0x4000
 v_mfma_f32_16x16x32_bf16 v[208:211], a[208:211], v[128:131], v[208:211]
 v_exp_f32_e64 v93, v93
 v_mfma_f32_16x16x32_bf16 v[212:215], a[212:215], v[128:131], v[212:215]
 v_exp_f32_e64 v94, v94
 v_mfma_f32_16x16x32_bf16 v[220:223], a[212:215], v[132:135], v[220:223]
 buffer_load_dwordx4 v6, s[4:7], s64 offen offset:0 sc1 lds
 s_lshl_b32 s3, s2, 5
 v_mfma_f32_16x16x32_bf16 a[100:103], a[212:215], v[136:139], a[100:103]
 v_exp_f32 v95, v95
 v_mfma_f32_16x16x32_bf16 a[108:111], a[212:215], v[140:143], a[108:111]
 v_exp_f32_e64 v84, v84
 v_mfma_f32_16x16x32_bf16 a[120:123], a[216:219], v[140:143], a[120:123]
 v_exp_f32_e64 v85, v85
 v_mfma_f32_16x16x32_bf16 a[112:115], a[216:219], v[136:139], a[112:115]
 buffer_load_dwordx4 v6, s[4:7], s64 offen offset:1024 sc1 lds
 s_add_u32 s3, s3, s58
 v_mfma_f32_16x16x32_bf16 v[232:235], a[216:219], v[132:135], v[232:235]
 v_exp_f32 v86, v86
 v_mfma_f32_16x16x32_bf16 v[224:227], a[216:219], v[128:131], v[224:227]
 v_exp_f32_e64 v87, v87
 v_mfma_f32_16x16x32_bf16 v[228:231], a[220:223], v[128:131], v[228:231]
 v_exp_f32_e64 v76, v76
 v_mfma_f32_16x16x32_bf16 v[236:239], a[220:223], v[132:135], v[236:239]
 buffer_load_dwordx4 v6, s[4:7], s64 offen offset:2048 sc1 lds
 s_lshl_b32 s3, s3, 2
 v_mfma_f32_16x16x32_bf16 a[116:119], a[220:223], v[136:139], a[116:119]
 v_mov_b32 v5, v4
 v_xor_b32_e64 v4, s68, v4
 v_mfma_f32_16x16x32_bf16 a[124:127], a[220:223], v[140:143], a[124:127]
 s_sub_u32 s70, s70, 1
 s_cbranch_scc1 L_hdsD1
L_hdrsD1:
 v_mfma_f32_16x16x32_bf16 v[96:99], a[0:3], v[32:35], v[144:147]
 v_exp_f32_e64 v77, v77
 v_mfma_f32_16x16x32_bf16 v[104:107], a[0:3], v[48:51], v[152:155]
 buffer_load_dwordx4 v6, s[4:7], s64 offen offset:3072 sc1 lds
 s_xor_b32 s65, s65, 0x10000
 v_mfma_f32_16x16x32_bf16 v[112:115], a[0:3], a[32:35], v[160:163]
 s_add_u32 s64, s64, s67
 s_mov_b32 m0, s65
 v_mfma_f32_16x16x32_bf16 v[120:123], a[0:3], a[48:51], v[168:171]
 ds_read_b128 a[0:3], v4 offset:0
 ds_read_b128 a[192:195], v5 offset:16384
 v_mfma_f32_16x16x32_bf16 v[124:127], a[16:19], a[48:51], v[172:175]
 v_exp_f32_e64 v78, v78
 v_mfma_f32_16x16x32_bf16 v[116:119], a[16:19], a[32:35], v[164:167]
 buffer_load_dwordx4 v2, s[4:7], s64 offen offset:0 sc1 lds
 ds_read_b128 a[196:199], v5 offset:17408
 v_mfma_f32_16x16x32_bf16 v[108:111], a[16:19], v[48:51], v[156:159]
 v_exp_f32_e64 v79, v79
 v_mfma_f32_16x16x32_bf16 v[100:103], a[16:19], v[32:35], v[148:151]
 ds_read_b128 a[16:19], v4 offset:4096
 ds_read_b128 a[200:203], v5 offset:18432
 v_mfma_f32_16x16x32_bf16 v[96:99], a[4:7], v[36:39], v[96:99]
 v_exp_f32_e64 v68, v68
 v_mfma_f32_16x16x32_bf16 v[104:107], a[4:7], v[52:55], v[104:107]
 buffer_load_dwordx4 v2, s[4:7], s64 offen offset:1024 sc1 lds
 ds_read_b128 a[204:207], v5 offset:19456
 v_mfma_f32_16x16x32_bf16 v[112:115], a[4:7], a[36:39], v[112:115]
 v_exp_f32_e64 v69, v69
 v_mfma_f32_16x16x32_bf16 v[120:123], a[4:7], a[52:55], v[120:123]
 ds_read_b128 a[4:7], v4 offset:1024
 ds_read_b128 a[208:211], v5 offset:20480
 v_mfma_f32_16x16x32_bf16 v[124:127], a[20:23], a[52:55], v[124:127]
 v_exp_f32 v70, v70
 s_add_u32 s3, s3, 16
 v_mov_b32 v26, 0x7fff0000
 v_writelane_b32 v26, s3, 0
 s_lshl_b32 s3, s60, 5
 v_and_b32 v27, 31, v1
 v_add_lshl_u32 v27, s3, v27, 7
 v_mfma_f32_16x16x32_bf16 v[116:119], a[20:23], a[36:39], v[116:119]
 buffer_load_dwordx4 v2, s[4:7], s64 offen offset:2048 sc1 lds
 ds_read_b128 a[212:215], v5 offset:21504
 buffer_load_dword v28, v27, s[24:27], 0 offen sc1
 v_mfma_f32_16x16x32_bf16 v[108:111], a[20:23], v[52:55], v[108:111]
 v_exp_f32_e64 v71, v71
 v_mfma_f32_16x16x32_bf16 v[100:103], a[20:23], v[36:39], v[100:103]
 ds_read_b128 a[20:23], v4 offset:5120
 ds_read_b128 a[216:219], v5 offset:22528
 v_mfma_f32_16x16x32_bf16 v[96:99], a[8:11], v[40:43], v[96:99]
 ds_read_b128 a[220:223], v5 offset:23552
 v_mfma_f32_16x16x32_bf16 v[104:107], a[8:11], v[56:59], v[104:107]
 buffer_load_dwordx4 v2, s[4:7], s64 offen offset:3072 sc1 lds
 v_mfma_f32_16x16x32_bf16 v[112:115], a[8:11], a[40:43], v[112:115]
 v_mfma_f32_16x16x32_bf16 v[120:123], a[8:11], a[56:59], v[120:123]
 ds_read_b128 a[8:11], v4 offset:2048
 v_mfma_f32_16x16x32_bf16 v[124:127], a[24:27], a[56:59], v[124:127]
 v_cvt_pk_bf16_f32 v128, v64, v65
 v_cvt_pk_bf16_f32 v129, v66, v67
 v_mfma_f32_16x16x32_bf16 v[116:119], a[24:27], a[40:43], v[116:119]
 v_cvt_pk_bf16_f32 v130, v68, v69
 v_cvt_pk_bf16_f32 v131, v70, v71
 v_mfma_f32_16x16x32_bf16 v[108:111], a[24:27], v[56:59], v[108:111]
 v_cvt_pk_bf16_f32 v132, v72, v73
 v_cvt_pk_bf16_f32 v133, v74, v75
 v_mfma_f32_16x16x32_bf16 v[100:103], a[24:27], v[40:43], v[100:103]
 v_cvt_pk_bf16_f32 v134, v76, v77
 ds_read_b128 a[24:27], v4 offset:6144
 v_mfma_f32_16x16x32_bf16 v[96:99], a[12:15], v[44:47], v[96:99]
 v_cvt_pk_bf16_f32 v135, v78, v79
 v_cvt_pk_bf16_f32 v136, v80, v81
 v_mfma_f32_16x16x32_bf16 v[104:107], a[12:15], v[60:63], v[104:107]
 v_cvt_pk_bf16_f32 v137, v82, v83
 v_cvt_pk_bf16_f32 v138, v84, v85
 v_mfma_f32_16x16x32_bf16 v[112:115], a[12:15], a[44:47], v[112:115]
 v_cvt_pk_bf16_f32 v139, v86, v87
 v_cvt_pk_bf16_f32 v140, v88, v89
 v_mfma_f32_16x16x32_bf16 v[120:123], a[12:15], a[60:63], v[120:123]
 v_cvt_pk_bf16_f32 v141, v90, v91
 ds_read_b128 a[12:15], v4 offset:3072
 v_mfma_f32_16x16x32_bf16 v[124:127], a[28:31], a[60:63], v[124:127]
 v_cvt_pk_bf16_f32 v142, v92, v93
 v_cvt_pk_bf16_f32 v143, v94, v95
 v_mfma_f32_16x16x32_bf16 v[116:119], a[28:31], a[44:47], v[116:119]
 v_exp_f32_e64 v96, v96
 v_mfma_f32_16x16x32_bf16 v[108:111], a[28:31], v[60:63], v[108:111]
 v_exp_f32_e64 v97, v97
 v_mfma_f32_16x16x32_bf16 v[100:103], a[28:31], v[44:47], v[100:103]
 ds_read_b128 a[28:31], v4 offset:7168
 v_mfma_f32_16x16x32_bf16 v[240:243], a[136:139], v[128:131], v[240:243]
 v_exp_f32_e64 v98, v98
 v_mfma_f32_16x16x32_bf16 v[244:247], a[136:139], v[132:135], v[244:247]
 v_exp_f32_e64 v99, v99
 v_mfma_f32_16x16x32_bf16 a[128:131], a[136:139], v[136:139], a[128:131]
 v_exp_f32_e64 v104, v104
 v_mfma_f32_16x16x32_bf16 a[132:135], a[136:139], v[140:143], a[132:135]
 v_exp_f32 v105, v105
 s_waitcnt lgkmcnt(1)
 v_mfma_f32_16x16x32_bf16 a[72:75], a[192:195], v[140:143], a[72:75]
 v_exp_f32_e64 v106, v106
 v_mfma_f32_16x16x32_bf16 a[64:67], a[192:195], v[136:139], a[64:67]
 v_exp_f32_e64 v107, v107
 v_mfma_f32_16x16x32_bf16 v[184:187], a[192:195], v[132:135], v[184:187]
 v_exp_f32_e64 v112, v112
 v_mfma_f32_16x16x32_bf16 v[176:179], a[192:195], v[128:131], v[176:179]
 v_exp_f32_e64 v113, v113
 v_mfma_f32_16x16x32_bf16 v[180:183], a[196:199], v[128:131], v[180:183]
 v_exp_f32_e64 v114, v114
 v_mfma_f32_16x16x32_bf16 v[188:191], a[196:199], v[132:135], v[188:191]
 v_exp_f32_e64 v115, v115
 v_mfma_f32_16x16x32_bf16 a[68:71], a[196:199], v[136:139], a[68:71]
 v_exp_f32_e64 v120, v120
 v_mfma_f32_16x16x32_bf16 a[76:79], a[196:199], v[140:143], a[76:79]
 v_exp_f32_e64 v121, v121
 v_mfma_f32_16x16x32_bf16 a[88:91], a[200:203], v[140:143], a[88:91]
 v_exp_f32_e64 v122, v122
 v_mfma_f32_16x16x32_bf16 a[80:83], a[200:203], v[136:139], a[80:83]
 v_exp_f32_e64 v123, v123
 v_mfma_f32_16x16x32_bf16 v[200:203], a[200:203], v[132:135], v[200:203]
 v_exp_f32_e64 v124, v124
 v_mfma_f32_16x16x32_bf16 v[192:195], a[200:203], v[128:131], v[192:195]
 v_exp_f32_e64 v125, v125
L_pg12:
 s_cbranch_execz L_hopr3
 v_mfma_f32_16x16x32_bf16 v[196:199], a[204:207], v[128:131], v[196:199]
 v_exp_f32 v126, v126
 v_mfma_f32_16x16x32_bf16 v[204:207], a[204:207], v[132:135], v[204:207]
 v_exp_f32_e64 v127, v127
 v_mfma_f32_16x16x32_bf16 a[84:87], a[204:207], v[136:139], a[84:87]
 v_exp_f32_e64 v116, v116
 v_mfma_f32_16x16x32_bf16 a[92:95], a[204:207], v[140:143], a[92:95]
 v_exp_f32_e64 v117, v117
 v_mfma_f32_16x16x32_bf16 a[104:107], a[208:211], v[140:143], a[104:107]
 v_exp_f32_e64 v118, v118
 v_mfma_f32_16x16x32_bf16 a[96:99], a[208:211], v[136:139], a[96:99]
 v_exp_f32_e64 v119, v119
 v_mfma_f32_16x16x32_bf16 v[216:219], a[208:211], v[132:135], v[216:219]
 v_exp_f32_e64 v108, v108
 v_mfma_f32_16x16x32_bf16 v[208:211], a[208:211], v[128:131], v[208:211]
 s_waitcnt vmcnt(1)
 v_sub_u32 v28, v28, v0
 v_subrev_u32 v28, 4, v28
 v_cmp_ge_u32 vcc, 8, v28
 s_mov_b32 s79, 0
 s_cmp_eq_u64 vcc, -1
 s_cbranch_scc0 L_pl4
L_pd4:
 v_mfma_f32_16x16x32_bf16 v[212:215], a[212:215], v[128:131], v[212:215]
 buffer_load_dwordx4 a[160:163], v2, s[8:11], s34 offen offset:0 sc1
 v_mfma_f32_16x16x32_bf16 v[220:223], a[212:215], v[132:135], v[220:223]
 v_exp_f32 v109, v109
 v_mfma_f32_16x16x32_bf16 a[100:103], a[212:215], v[136:139], a[100:103]
 v_exp_f32_e64 v110, v110
 v_mfma_f32_16x16x32_bf16 a[108:111], a[212:215], v[140:143], a[108:111]
 v_exp_f32_e64 v111, v111
 v_mfma_f32_16x16x32_bf16 a[120:123], a[216:219], v[140:143], a[120:123]
 buffer_load_dwordx4 a[164:167], v2, s[8:11], s34 offen offset:1024 sc1
 v_mfma_f32_16x16x32_bf16 a[112:115], a[216:219], v[136:139], a[112:115]
 v_exp_f32_e64 v100, v100
 v_mfma_f32_16x16x32_bf16 v[232:235], a[216:219], v[132:135], v[232:235]
 v_exp_f32_e64 v101, v101
 v_mfma_f32_16x16x32_bf16 v[224:227], a[216:219], v[128:131], v[224:227]
 v_exp_f32_e64 v102, v102
 v_mfma_f32_16x16x32_bf16 v[228:231], a[220:223], v[128:131], v[228:231]
 v_exp_f32_e64 v103, v103
 v_mfma_f32_16x16x32_bf16 v[236:239], a[220:223], v[132:135], v[236:239]
 v_mfma_f32_16x16x32_bf16 a[116:119], a[220:223], v[136:139], a[116:119]
 v_mfma_f32_16x16x32_bf16 a[124:127], a[220:223], v[140:143], a[124:127]
 s_waitcnt lgkmcnt(0)
 s_sub_u32 s66, s66, 2
 s_cbranch_scc1 L_entS
L_topD:
 s_sub_u32 s70, s70, 1
 s_cbranch_scc1 L_hdlD0
L_hdrlD0:
 v_mfma_f32_16x16x32_bf16 v[64:67], a[0:3], v[32:35], v[144:147]
 ds_read_b128 a[192:195], v5 offset:24576
 v_cvt_pk_bf16_f32 v128, v96, v97
 v_mfma_f32_16x16x32_bf16 v[72:75], a[0:3], v[48:51], v[152:155]
 v_cvt_pk_bf16_f32 v129, v98, v99
 ds_read_b128 a[196:199], v5 offset:25600
 v_mfma_f32_16x16x32_bf16 v[80:83], a[0:3], a[32:35], v[160:163]
 v_cvt_pk_bf16_f32 v130, v100, v101
 v_cvt_pk_bf16_f32 v131, v102, v103
 v_mfma_f32_16x16x32_bf16 v[88:91], a[0:3], a[48:51], v[168:171]
 ds_read_b128 a[0:3], v4 offset:8192
 ds_read_b128 a[200:203], v5 offset:26624
 v_mfma_f32_16x16x32_bf16 v[92:95], a[16:19], a[48:51], v[172:175]
 v_cvt_pk_bf16_f32 v132, v104, v105
 v_cvt_pk_bf16_f32 v133, v106, v107
 v_mfma_f32_16x16x32_bf16 v[84:87], a[16:19], a[32:35], v[164:167]
 ds_read_b128 a[204:207], v5 offset:27648
 v_cvt_pk_bf16_f32 v134, v108, v109
 v_mfma_f32_16x16x32_bf16 v[76:79], a[16:19], v[48:51], v[156:159]
 v_cvt_pk_bf16_f32 v135, v110, v111
 ds_read_b128 a[208:211], v5 offset:28672
 v_mfma_f32_16x16x32_bf16 v[68:71], a[16:19], v[32:35], v[148:151]
 ds_read_b128 a[16:19], v4 offset:12288
 v_cvt_pk_bf16_f32 v136, v112, v113
 v_mfma_f32_16x16x32_bf16 v[64:67], a[4:7], v[36:39], v[64:67]
 v_cvt_pk_bf16_f32 v137, v114, v115
 ds_read_b128 a[212:215], v5 offset:29696
 v_mfma_f32_16x16x32_bf16 v[72:75], a[4:7], v[52:55], v[72:75]
 v_cvt_pk_bf16_f32 v138, v116, v117
 v_cvt_pk_bf16_f32 v139, v118, v119
 v_mfma_f32_16x16x32_bf16 v[80:83], a[4:7], a[36:39], v[80:83]
 ds_read_b128 a[216:219], v5 offset:30720
 v_cvt_pk_bf16_f32 v140, v120, v121
 v_mfma_f32_16x16x32_bf16 v[88:91], a[4:7], a[52:55], v[88:91]
 ds_read_b128 a[4:7], v4 offset:9216
 v_cvt_pk_bf16_f32 v141, v122, v123
 v_mfma_f32_16x16x32_bf16 v[92:95], a[20:23], a[52:55], v[92:95]
 ds_read_b128 a[220:223], v5 offset:31744
 v_cvt_pk_bf16_f32 v142, v124, v125
 v_mfma_f32_16x16x32_bf16 v[84:87], a[20:23], a[36:39], v[84:87]
 v_cvt_pk_bf16_f32 v143, v126, v127
 buffer_load_dwordx4 a[168:171], v2, s[8:11], s34 offen offset:2048 sc1
 v_mfma_f32_16x16x32_bf16 v[76:79], a[20:23], v[52:55], v[76:79]
 s_add_u32 s34, s34, 3072
 v_mfma_f32_16x16x32_bf16 v[68:71], a[20:23], v[36:39], v[68:71]
 ds_read_b128 a[20:23], v4 offset:13312
 v_mfma_f32_16x16x32_bf16 v[64:67], a[8:11], v[40:43], v[64:67]
 v_mfma_f32_16x16x32_bf16 v[72:75], a[8:11], v[56:59], v[72:75]
 v_mfma_f32_16x16x32_bf16 v[80:83], a[8:11], a[40:43], v[80:83]
 v_mfma_f32_16x16x32_bf16 v[88:91], a[8:11], a[56:59], v[88:91]
 ds_read_b128 a[8:11], v4 offset:10240
 v_mfma_f32_16x16x32_bf16 v[92:95], a[24:27], a[56:59], v[92:95]
 v_mfma_f32_16x16x32_bf16 v[84:87], a[24:27], a[40:43], v[84:87]
 v_mfma_f32_16x16x32_bf16 v[76:79], a[24:27], v[56:59], v[76:79]
 v_mfma_f32_16x16x32_bf16 v[68:71], a[24:27], v[40:43], v[68:71]
 ds_read_b128 a[24:27], v4 offset:14336
 v_mfma_f32_16x16x32_bf16 v[64:67], a[12:15], v[44:47], v[64:67]
 v_mfma_f32_16x16x32_bf16 v[72:75], a[12:15], v[60:63], v[72:75]
 v_mfma_f32_16x16x32_bf16 v[80:83], a[12:15], a[44:47], v[80:83]
 v_mfma_f32_16x16x32_bf16 v[88:91], a[12:15], a[60:63], v[88:91]
 ds_read_b128 a[12:15], v4 offset:11264
 v_mfma_f32_16x16x32_bf16 v[92:95], a[28:31], a[60:63], v[92:95]
 v_mfma_f32_16x16x32_bf16 v[84:87], a[28:31], a[44:47], v[84:87]
 s_nop 1
 v_exp_f32_e64 v64, v64
 v_mfma_f32_16x16x32_bf16 v[76:79], a[28:31], v[60:63], v[76:79]
 v_exp_f32_e64 v65, v65
 v_mfma_f32_16x16x32_bf16 v[68:71], a[28:31], v[44:47], v[68:71]
 ds_read_b128 a[28:31], v4 offset:15360
 v_mfma_f32_16x16x32_bf16 v[240:243], a[136:139], v[128:131], v[240:243]
 v_exp_f32_e64 v66, v66
 v_mfma_f32_16x16x32_bf16 v[244:247], a[136:139], v[132:135], v[244:247]
 v_exp_f32_e64 v67, v67
 v_mfma_f32_16x16x32_bf16 a[128:131], a[136:139], v[136:139], a[128:131]
 v_exp_f32_e64 v72, v72
 v_mfma_f32_16x16x32_bf16 a[132:135], a[136:139], v[140:143], a[132:135]
 v_exp_f32 v73, v73
 s_waitcnt lgkmcnt(1)
 v_mfma_f32_16x16x32_bf16 a[72:75], a[192:195], v[140:143], a[72:75]
 v_exp_f32_e64 v74, v74
 v_mfma_f32_16x16x32_bf16 a[64:67], a[192:195], v[136:139], a[64:67]
 v_exp_f32_e64 v75, v75
 v_mfma_f32_16x16x32_bf16 v[184:187], a[192:195], v[132:135], v[184:187]
 v_exp_f32_e64 v80, v80
 v_mfma_f32_16x16x32_bf16 v[176:179], a[192:195], v[128:131], v[176:179]
 s_waitcnt vmcnt(3)
 s_waitcnt lgkmcnt(0)
 s_barrier
 v_mfma_f32_16x16x32_bf16 v[180:183], a[196:199], v[128:131], v[180:183]
 ds_read_b128 a[172:175], v249 offset:0
 s_mov_b32 m0, s39
 v_mfma_f32_16x16x32_bf16 v[188:191], a[196:199], v[132:135], v[188:191]
 buffer_load_dwordx4 v248, s[12:15], s35 offen offset:0 sc1 lds
 ds_read_b128 a[176:179], v249 offset:1024
 v_mfma_f32_16x16x32_bf16 a[68:71], a[196:199], v[136:139], a[68:71]
 v_exp_f32_e64 v81, v81
 v_mfma_f32_16x16x32_bf16 a[76:79], a[196:199], v[140:143], a[76:79]
 v_exp_f32_e64 v82, v82
 v_mfma_f32_16x16x32_bf16 a[88:91], a[200:203], v[140:143], a[88:91]
 v_exp_f32_e64 v83, v83
 v_mfma_f32_16x16x32_bf16 a[80:83], a[200:203], v[136:139], a[80:83]
 buffer_load_dwordx4 v248, s[12:15], s36 offen offset:1024 sc1 lds
 v_mfma_f32_16x16x32_bf16 v[200:203], a[200:203], v[132:135], v[200:203]
 v_exp_f32_e64 v88, v88
 v_mfma_f32_16x16x32_bf16 v[192:195], a[200:203], v[128:131], v[192:195]
 v_exp_f32 v89, v89
 s_waitcnt vmcnt(4) lgkmcnt(1)
 v_mfma_f32_16x16x32_bf16 a[140:143], a[172:175], a[160:163], a[140:143]
 ds_read_b128 a[180:183], v249 offset:2048
 v_mfma_f32_16x16x32_bf16 v[196:199], a[204:207], v[128:131], v[196:199]
 buffer_load_dwordx4 v248, s[12:15], s37 offen offset:2048 sc1 lds
 v_mfma_f32_16x16x32_bf16 v[204:207], a[204:207], v[132:135], v[204:207]
 v_exp_f32_e64 v90, v90
 v_mfma_f32_16x16x32_bf16 a[84:87], a[204:207], v[136:139], a[84:87]
 v_exp_f32_e64 v91, v91
 v_mfma_f32_16x16x32_bf16 a[92:95], a[204:207], v[140:143], a[92:95]
 v_exp_f32_e64 v92, v92
 v_mfma_f32_16x16x32_bf16 a[104:107], a[208:211], v[140:143], a[104:107]
 buffer_load_dwordx4 v248, s[12:15], s38 offen offset:3072 sc1 lds
 s_xor_b32 s39, s39, 0x4000
 v_mfma_f32_16x16x32_bf16 a[96:99], a[208:211], v[136:139], a[96:99]
 v_add_u32 v248, 122880, v248
 s_add_u32 m0, s65, 0x4000
 s_waitcnt lgkmcnt(1)
 v_mfma_f32_16x16x32_bf16 a[144:147], a[176:179], a[160:163], a[144:147]
 ds_read_b128 a[184:187], v249 offset:3072
 v_mfma_f32_16x16x32_bf16 v[216:219], a[208:211], v[132:135], v[216:219]
 v_exp_f32 v93, v93
 v_mfma_f32_16x16x32_bf16 v[208:211], a[208:211], v[128:131], v[208:211]
 buffer_load_dwordx4 v6, s[4:7], s64 offen offset:0 sc1 lds
 v_mfma_f32_16x16x32_bf16 v[212:215], a[212:215], v[128:131], v[212:215]
 v_exp_f32_e64 v94, v94
 v_mfma_f32_16x16x32_bf16 v[220:223], a[212:215], v[132:135], v[220:223]
 v_exp_f32_e64 v95, v95
 v_mfma_f32_16x16x32_bf16 a[100:103], a[212:215], v[136:139], a[100:103]
 v_exp_f32_e64 v84, v84
 v_mfma_f32_16x16x32_bf16 a[108:111], a[212:215], v[140:143], a[108:111]
 v_exp_f32 v85, v85
 s_waitcnt lgkmcnt(1)
 v_mfma_f32_16x16x32_bf16 a[148:151], a[180:183], a[160:163], a[148:151]
 buffer_load_dwordx4 v6, s[4:7], s64 offen offset:1024 sc1 lds
 ds_read_b128 a[188:191], v249 offset:4096
 v_mfma_f32_16x16x32_bf16 a[120:123], a[216:219], v[140:143], a[120:123]
 v_exp_f32_e64 v86, v86
 v_mfma_f32_16x16x32_bf16 a[112:115], a[216:219], v[136:139], a[112:115]
 v_exp_f32_e64 v87, v87
 v_mfma_f32_16x16x32_bf16 v[232:235], a[216:219], v[132:135], v[232:235]
 v_exp_f32_e64 v76, v76
 v_mfma_f32_16x16x32_bf16 v[224:227], a[216:219], v[128:131], v[224:227]
 buffer_load_dwordx4 v6, s[4:7], s64 offen offset:2048 sc1 lds
 v_mfma_f32_16x16x32_bf16 v[228:231], a[220:223], v[128:131], v[228:231]
 v_exp_f32_e64 v77, v77
 v_mfma_f32_16x16x32_bf16 v[236:239], a[220:223], v[132:135], v[236:239]
 v_exp_f32 v78, v78
 s_waitcnt lgkmcnt(1)
 v_mfma_f32_16x16x32_bf16 a[152:155], a[184:187], a[160:163], a[152:155]
 ds_read_b128 a[172:175], v249 offset:5120
 v_mfma_f32_16x16x32_bf16 a[116:119], a[220:223], v[136:139], a[116:119]
 v_mov_b32 v5, v4
 v_xor_b32 v4, s68, v4
 v_mfma_f32_16x16x32_bf16 a[124:127], a[220:223], v[140:143], a[124:127]
 s_sub_u32 s70, s70, 1
 s_cbranch_scc1 L_hdlD1
L_hdrlD1:
 v_mfma_f32_16x16x32_bf16 v[96:99], a[0:3], v[32:35], v[144:147]
 buffer_load_dwordx4 v6, s[4:7], s64 offen offset:3072 sc1 lds
 s_xor_b32 s65, s65, 0x10000
 v_mfma_f32_16x16x32_bf16 v[104:107], a[0:3], v[48:51], v[152:155]
 s_add_u32 s64, s64, s67
 s_mov_b32 m0, s65
 v_mfma_f32_16x16x32_bf16 v[112:115], a[0:3], a[32:35], v[160:163]
 v_exp_f32_e64 v79, v79
 v_mfma_f32_16x16x32_bf16 v[120:123], a[0:3], a[48:51], v[168:171]
 ds_read_b128 a[0:3], v4 offset:0
 ds_read_b128 a[192:195], v5 offset:16384
 s_waitcnt lgkmcnt(3)
 v_mfma_f32_16x16x32_bf16 a[156:159], a[188:191], a[160:163], a[156:159]
 buffer_load_dwordx4 v2, s[4:7], s64 offen offset:0 sc1 lds
 ds_read_b128 a[176:179], v249 offset:6144
 v_mfma_f32_16x16x32_bf16 v[124:127], a[16:19], a[48:51], v[172:175]
 v_exp_f32 v68, v68
 v_mfma_f32_16x16x32_bf16 v[116:119], a[16:19], a[32:35], v[164:167]
 v_exp_f32_e64 v69, v69
 v_mfma_f32_16x16x32_bf16 v[108:111], a[16:19], v[48:51], v[156:159]
 v_exp_f32_e64 v70, v70
 v_mfma_f32_16x16x32_bf16 v[100:103], a[16:19], v[32:35], v[148:151]
 buffer_load_dwordx4 v2, s[4:7], s64 offen offset:1024 sc1 lds
 ds_read_b128 a[16:19], v4 offset:4096
 v_mfma_f32_16x16x32_bf16 v[96:99], a[4:7], v[36:39], v[96:99]
 v_exp_f32_e64 v71, v71
 v_mfma_f32_16x16x32_bf16 v[104:107], a[4:7], v[52:55], v[104:107]
 ds_read_b128 a[196:199], v5 offset:17408
 ds_read_b128 a[200:203], v5 offset:18432
 s_waitcnt vmcnt(11) lgkmcnt(6)
 v_mfma_f32_16x16x32_bf16 a[140:143], a[172:175], a[164:167], a[140:143]
 ds_read_b128 a[180:183], v249 offset:7168
 ds_read_b128 a[204:207], v5 offset:19456
 v_mfma_f32_16x16x32_bf16 v[112:115], a[4:7], a[36:39], v[112:115]
 ds_read_b128 a[208:211], v5 offset:20480
 ds_read_b128 a[212:215], v5 offset:21504
 v_mfma_f32_16x16x32_bf16 v[120:123], a[4:7], a[52:55], v[120:123]
 buffer_load_dwordx4 v2, s[4:7], s64 offen offset:2048 sc1 lds
 ds_read_b128 a[4:7], v4 offset:1024
 v_mfma_f32_16x16x32_bf16 v[124:127], a[20:23], a[52:55], v[124:127]
 ds_read_b128 a[216:219], v5 offset:22528
 ds_read_b128 a[220:223], v5 offset:23552
 v_mfma_f32_16x16x32_bf16 v[116:119], a[20:23], a[36:39], v[116:119]
 v_mfma_f32_16x16x32_bf16 v[108:111], a[20:23], v[52:55], v[108:111]
 v_mfma_f32_16x16x32_bf16 v[100:103], a[20:23], v[36:39], v[100:103]
 buffer_load_dwordx4 v2, s[4:7], s64 offen offset:3072 sc1 lds
 ds_read_b128 a[20:23], v4 offset:5120
 s_waitcnt lgkmcnt(10)
 v_mfma_f32_16x16x32_bf16 a[144:147], a[176:179], a[164:167], a[144:147]
 ds_read_b128 a[184:187], v249 offset:8192
 v_mfma_f32_16x16x32_bf16 v[96:99], a[8:11], v[40:43], v[96:99]
 v_mfma_f32_16x16x32_bf16 v[104:107], a[8:11], v[56:59], v[104:107]
 v_mfma_f32_16x16x32_bf16 v[112:115], a[8:11], a[40:43], v[112:115]
 v_mfma_f32_16x16x32_bf16 v[120:123], a[8:11], a[56:59], v[120:123]
 buffer_load_dwordx4 a[160:163], v2, s[8:11], s34 offen offset:0 sc1
 ds_read_b128 a[8:11], v4 offset:2048
 v_mfma_f32_16x16x32_bf16 v[124:127], a[24:27], a[56:59], v[124:127]
 v_mfma_f32_16x16x32_bf16 v[116:119], a[24:27], a[40:43], v[116:119]
 v_cvt_pk_bf16_f32 v128, v64, v65
 v_cvt_pk_bf16_f32 v129, v66, v67
 s_waitcnt lgkmcnt(3)
 v_mfma_f32_16x16x32_bf16 a[148:151], a[180:183], a[164:167], a[148:151]
 v_cvt_pk_bf16_f32 v130, v68, v69
 ds_read_b128 a[188:191], v249 offset:9216
 v_mfma_f32_16x16x32_bf16 v[108:111], a[24:27], v[56:59], v[108:111]
 v_cvt_pk_bf16_f32 v131, v70, v71
 v_cvt_pk_bf16_f32 v132, v72, v73
 v_mfma_f32_16x16x32_bf16 v[100:103], a[24:27], v[40:43], v[100:103]
 v_cvt_pk_bf16_f32 v133, v74, v75
 ds_read_b128 a[24:27], v4 offset:6144
 v_mfma_f32_16x16x32_bf16 v[96:99], a[12:15], v[44:47], v[96:99]
 v_cvt_pk_bf16_f32 v134, v76, v77
 v_cvt_pk_bf16_f32 v135, v78, v79
 v_mfma_f32_16x16x32_bf16 v[104:107], a[12:15], v[60:63], v[104:107]
 v_cvt_pk_bf16_f32 v136, v80, v81
 v_cvt_pk_bf16_f32 v137, v82, v83
 v_mfma_f32_16x16x32_bf16 v[112:115], a[12:15], a[44:47], v[112:115]
 v_cvt_pk_bf16_f32 v138, v84, v85
 v_cvt_pk_bf16_f32 v139, v86, v87
 v_mfma_f32_16x16x32_bf16 v[120:123], a[12:15], a[60:63], v[120:123]
 v_cvt_pk_bf16_f32 v140, v88, v89
 ds_read_b128 a[12:15], v4 offset:3072
 s_waitcnt lgkmcnt(3)
 v_mfma_f32_16x16x32_bf16 a[152:155], a[184:187], a[164:167], a[152:155]
 v_cvt_pk_bf16_f32 v141, v90, v91
 ds_read_b128 a[172:175], v249 offset:10240
 v_mfma_f32_16x16x32_bf16 v[124:127], a[28:31], a[60:63], v[124:127]
 v_cvt_pk_bf16_f32 v142, v92, v93
 v_cvt_pk_bf16_f32 v143, v94, v95
 v_mfma_f32_16x16x32_bf16 v[116:119], a[28:31], a[44:47], v[116:119]
 v_exp_f32_e64 v96, v96
 v_mfma_f32_16x16x32_bf16 v[108:111], a[28:31], v[60:63], v[108:111]
 v_exp_f32_e64 v97, v97
 v_mfma_f32_16x16x32_bf16 v[100:103], a[28:31], v[44:47], v[100:103]
 ds_read_b128 a[28:31], v4 offset:7168
 v_mfma_f32_16x16x32_bf16 v[240:243], a[136:139], v[128:131], v[240:243]
 v_exp_f32_e64 v98, v98
 v_mfma_f32_16x16x32_bf16 v[244:247], a[136:139], v[132:135], v[244:247]
 v_exp_f32 v99, v99
 s_waitcnt lgkmcnt(3)
 v_mfma_f32_16x16x32_bf16 a[156:159], a[188:191], a[164:167], a[156:159]
 buffer_load_dwordx4 a[164:167], v2, s[8:11], s34 offen offset:1024 sc1
 ds_read_b128 a[176:179], v249 offset:11264
 v_mfma_f32_16x16x32_bf16 a[128:131], a[136:139], v[136:139], a[128:131]
 v_exp_f32_e64 v104, v104
 v_mfma_f32_16x16x32_bf16 a[132:135], a[136:139], v[140:143], a[132:135]
 v_exp_f32_e64 v105, v105
 v_mfma_f32_16x16x32_bf16 a[72:75], a[192:195], v[140:143], a[72:75]
 v_exp_f32_e64 v106, v106
 v_mfma_f32_16x16x32_bf16 a[64:67], a[192:195], v[136:139], a[64:67]
 v_exp_f32_e64 v107, v107
 v_mfma_f32_16x16x32_bf16 v[184:187], a[192:195], v[132:135], v[184:187]
 v_exp_f32_e64 v112, v112
 v_mfma_f32_16x16x32_bf16 v[176:179], a[192:195], v[128:131], v[176:179]
 v_exp_f32 v113, v113
 s_waitcnt vmcnt(14) lgkmcnt(1)
 v_mfma_f32_16x16x32_bf16 a[140:143], a[172:175], a[168:171], a[140:143]
 ds_read_b128 a[180:183], v249 offset:12288
 v_mfma_f32_16x16x32_bf16 v[180:183], a[196:199], v[128:131], v[180:183]
 v_exp_f32_e64 v114, v114
 v_mfma_f32_16x16x32_bf16 v[188:191], a[196:199], v[132:135], v[188:191]
 v_exp_f32_e64 v115, v115
 v_mfma_f32_16x16x32_bf16 a[68:71], a[196:199], v[136:139], a[68:71]
 v_exp_f32_e64 v120, v120
 v_mfma_f32_16x16x32_bf16 a[76:79], a[196:199], v[140:143], a[76:79]
 v_exp_f32_e64 v121, v121
 v_mfma_f32_16x16x32_bf16 a[88:91], a[200:203], v[140:143], a[88:91]
 v_exp_f32_e64 v122, v122
 v_mfma_f32_16x16x32_bf16 a[80:83], a[200:203], v[136:139], a[80:83]
 v_exp_f32 v123, v123
 s_waitcnt lgkmcnt(1)
 v_mfma_f32_16x16x32_bf16 a[144:147], a[176:179], a[168:171], a[144:147]
 ds_read_b128 a[184:187], v249 offset:13312
 v_mfma_f32_16x16x32_bf16 v[200:203], a[200:203], v[132:135], v[200:203]
 v_exp_f32_e64 v124, v124
 v_mfma_f32_16x16x32_bf16 v[192:195], a[200:203], v[128:131], v[192:195]
 v_exp_f32_e64 v125, v125
 v_mfma_f32_16x16x32_bf16 v[196:199], a[204:207], v[128:131], v[196:199]
 v_exp_f32_e64 v126, v126
 v_mfma_f32_16x16x32_bf16 v[204:207], a[204:207], v[132:135], v[204:207]
 v_exp_f32_e64 v127, v127
 v_mfma_f32_16x16x32_bf16 a[84:87], a[204:207], v[136:139], a[84:87]
 v_exp_f32_e64 v116, v116
 v_mfma_f32_16x16x32_bf16 a[92:95], a[204:207], v[140:143], a[92:95]
 v_exp_f32 v117, v117
 s_waitcnt lgkmcnt(1)
 v_mfma_f32_16x16x32_bf16 a[148:151], a[180:183], a[168:171], a[148:151]
 ds_read_b128 a[188:191], v249 offset:14336
 v_mfma_f32_16x16x32_bf16 a[104:107], a[208:211], v[140:143], a[104:107]
 v_exp_f32_e64 v118, v118
 v_mfma_f32_16x16x32_bf16 a[96:99], a[208:211], v[136:139], a[96:99]
 v_exp_f32_e64 v119, v119
 v_mfma_f32_16x16x32_bf16 v[216:219], a[208:211], v[132:135], v[216:219]
 v_exp_f32_e64 v108, v108
 v_mfma_f32_16x16x32_bf16 v[208:211], a[208:211], v[128:131], v[208:211]
 v_exp_f32_e64 v109, v109
 v_mfma_f32_16x16x32_bf16 v[212:215], a[212:215], v[128:131], v[212:215]
 v_exp_f32_e64 v110, v110
 v_mfma_f32_16x16x32_bf16 v[220:223], a[212:215], v[132:135], v[220:223]
 v_exp_f32 v111, v111
 s_waitcnt lgkmcnt(1)
 v_mfma_f32_16x16x32_bf16 a[152:155], a[184:187], a[168:171], a[152:155]
 v_xor_b32 v249, 0x4000, v249
 v_mfma_f32_16x16x32_bf16 a[100:103], a[212:215], v[136:139], a[100:103]
 v_exp_f32_e64 v100, v100
 v_mfma_f32_16x16x32_bf16 a[108:111], a[212:215], v[140:143], a[108:111]
 v_exp_f32_e64 v101, v101
 v_mfma_f32_16x16x32_bf16 a[120:123], a[216:219], v[140:143], a[120:123]
 v_exp_f32_e64 v102, v102
 v_mfma_f32_16x16x32_bf16 a[112:115], a[216:219], v[136:139], a[112:115]
 v_exp_f32_e64 v103, v103
 v_mfma_f32_16x16x32_bf16 v[232:235], a[216:219], v[132:135], v[232:235]
 v_mfma_f32_16x16x32_bf16 v[224:227], a[216:219], v[128:131], v[224:227]
 s_waitcnt lgkmcnt(0)
 v_mfma_f32_16x16x32_bf16 a[156:159], a[188:191], a[168:171], a[156:159]
 v_mfma_f32_16x16x32_bf16 v[228:231], a[220:223], v[128:131], v[228:231]
 v_mfma_f32_16x16x32_bf16 v[236:239], a[220:223], v[132:135], v[236:239]
 v_mfma_f32_16x16x32_bf16 a[116:119], a[220:223], v[136:139], a[116:119]
 v_mfma_f32_16x16x32_bf16 a[124:127], a[220:223], v[140:143], a[124:127]
 s_sub_u32 s66, s66, 1
 s_cbranch_scc0 L_topD
 s_cmp_eq_u32 s67, 0x8000
 s_mov_b32 s67, 0x10000
 s_mov_b32 s68, s69
 s_mov_b32 s66, 0
 s_cbranch_scc1 L_topD
L_entS:
 s_mov_b32 s71, 1
 s_lshl_b32 s3, s60, 1
 s_sub_u32 s66, 13, s3
 s_cbranch_scc1 L_postS
L_topS:
 v_mfma_f32_16x16x32_bf16 v[64:67], a[0:3], a[224:227], v[8:11]
 ds_read_b128 a[192:195], v5 offset:24576
 v_cvt_pk_bf16_f32 v128, v96, v97
 v_mfma_f32_16x16x32_bf16 v[72:75], a[0:3], a[240:243], v[16:19]
 v_cvt_pk_bf16_f32 v129, v98, v99
 ds_read_b128 a[196:199], v5 offset:25600
 v_mfma_f32_16x16x32_bf16 v[80:83], a[0:3], a[32:35], v[160:163]
 v_cvt_pk_bf16_f32 v130, v100, v101
 v_cvt_pk_bf16_f32 v131, v102, v103
 v_mfma_f32_16x16x32_bf16 v[88:91], a[0:3], a[48:51], v[168:171]
 ds_read_b128 a[0:3], v4 offset:8192
 ds_read_b128 a[200:203], v5 offset:26624
 v_mfma_f32_16x16x32_bf16 v[92:95], a[16:19], a[48:51], v[172:175]
 v_cvt_pk_bf16_f32 v132, v104, v105
 v_cvt_pk_bf16_f32 v133, v106, v107
 v_mfma_f32_16x16x32_bf16 v[84:87], a[16:19], a[32:35], v[164:167]
 ds_read_b128 a[204:207], v5 offset:27648
 v_cvt_pk_bf16_f32 v134, v108, v109
 v_mfma_f32_16x16x32_bf16 v[76:79], a[16:19], a[240:243], v[20:23]
 v_cvt_pk_bf16_f32 v135, v110, v111
 ds_read_b128 a[208:211], v5 offset:28672
 v_mfma_f32_16x16x32_bf16 v[68:71], a[16:19], a[224:227], v[12:15]
 ds_read_b128 a[16:19], v4 offset:12288
 v_cvt_pk_bf16_f32 v136, v112, v113
 v_mfma_f32_16x16x32_bf16 v[64:67], a[4:7], a[228:231], v[64:67]
 v_cvt_pk_bf16_f32 v137, v114, v115
 ds_read_b128 a[212:215], v5 offset:29696
 v_mfma_f32_16x16x32_bf16 v[72:75], a[4:7], a[244:247], v[72:75]
 v_cvt_pk_bf16_f32 v138, v116, v117
 v_cvt_pk_bf16_f32 v139, v118, v119
 v_mfma_f32_16x16x32_bf16 v[80:83], a[4:7], a[36:39], v[80:83]
 ds_read_b128 a[216:219], v5 offset:30720
 v_cvt_pk_bf16_f32 v140, v120, v121
 v_mfma_f32_16x16x32_bf16 v[88:91], a[4:7], a[52:55], v[88:91]
 ds_read_b128 a[4:7], v4 offset:9216
 v_cvt_pk_bf16_f32 v141, v122, v123
 v_mfma_f32_16x16x32_bf16 v[92:95], a[20:23], a[52:55], v[92:95]
 ds_read_b128 a[220:223], v5 offset:31744
 v_cvt_pk_bf16_f32 v142, v124, v125
 v_mfma_f32_16x16x32_bf16 v[84:87], a[20:23], a[36:39], v[84:87]
 v_cvt_pk_bf16_f32 v143, v126, v127
 buffer_load_dwordx4 a[168:171], v2, s[8:11], s34 offen offset:2048 sc1
 v_mfma_f32_16x16x32_bf16 v[76:79], a[20:23], a[244:247], v[76:79]
 s_add_u32 s34, s34, 3072
 v_mfma_f32_16x16x32_bf16 v[68:71], a[20:23], a[228:231], v[68:71]
 ds_read_b128 a[20:23], v4 offset:13312
 v_mfma_f32_16x16x32_bf16 v[64:67], a[8:11], a[232:235], v[64:67]
 v_mfma_f32_16x16x32_bf16 v[72:75], a[8:11], a[248:251], v[72:75]
 v_mfma_f32_16x16x32_bf16 v[80:83], a[8:11], a[40:43], v[80:83]
 v_mfma_f32_16x16x32_bf16 v[88:91], a[8:11], a[56:59], v[88:91]
 ds_read_b128 a[8:11], v4 offset:10240
 v_mfma_f32_16x16x32_bf16 v[92:95], a[24:27], a[56:59], v[92:95]
 v_mfma_f32_16x16x32_bf16 v[84:87], a[24:27], a[40:43], v[84:87]
 v_mfma_f32_16x16x32_bf16 v[76:79], a[24:27], a[248:251], v[76:79]
 v_mfma_f32_16x16x32_bf16 v[68:71], a[24:27], a[232:235], v[68:71]
 ds_read_b128 a[24:27], v4 offset:14336
 v_mfma_f32_16x16x32_bf16 v[64:67], a[12:15], a[236:239], v[64:67]
 v_mfma_f32_16x16x32_bf16 v[72:75], a[12:15], a[252:255], v[72:75]
 v_mfma_f32_16x16x32_bf16 v[80:83], a[12:15], a[44:47], v[80:83]
 v_mfma_f32_16x16x32_bf16 v[88:91], a[12:15], a[60:63], v[88:91]
 ds_read_b128 a[12:15], v4 offset:11264
 v_mfma_f32_16x16x32_bf16 v[92:95], a[28:31], a[60:63], v[92:95]
 v_mfma_f32_16x16x32_bf16 v[84:87], a[28:31], a[44:47], v[84:87]
 s_nop 1
 v_exp_f32 v64, v64
 v_mfma_f32_16x16x32_bf16 v[76:79], a[28:31], a[252:255], v[76:79]
 v_exp_f32_e64 v65, v65
 v_mfma_f32_16x16x32_bf16 v[68:71], a[28:31], a[236:239], v[68:71]
 ds_read_b128 a[28:31], v4 offset:15360
 v_mfma_f32_16x16x32_bf16 v[240:243], a[136:139], v[128:131], v[240:243]
 v_exp_f32_e64 v66, v66
 v_mfma_f32_16x16x32_bf16 v[244:247], a[136:139], v[132:135], v[244:247]
 v_exp_f32_e64 v67, v67
 v_mfma_f32_16x16x32_bf16 a[128:131], a[136:139], v[136:139], a[128:131]
 v_exp_f32_e64 v72, v72
 v_mfma_f32_16x16x32_bf16 a[132:135], a[136:139], v[140:143], a[132:135]
 v_exp_f32 v73, v73
 s_waitcnt lgkmcnt(1)
 v_mfma_f32_16x16x32_bf16 a[72:75], a[192:195], v[140:143], a[72:75]
 v_exp_f32_e64 v74, v74
 v_mfma_f32_16x16x32_bf16 a[64:67], a[192:195], v[136:139], a[64:67]
 v_exp_f32_e64 v75, v75
 v_mfma_f32_16x16x32_bf16 v[184:187], a[192:195], v[132:135], v[184:187]
 v_exp_f32_e64 v80, v80
 v_mfma_f32_16x16x32_bf16 v[176:179], a[192:195], v[128:131], v[176:179]
 s_waitcnt vmcnt(3)
 s_waitcnt lgkmcnt(0)
 s_barrier
 v_mfma_f32_16x16x32_bf16 v[180:183], a[196:199], v[128:131], v[180:183]
 ds_read_b128 a[172:175], v249 offset:0
 s_mov_b32 m0, s39
 v_mfma_f32_16x16x32_bf16 v[188:191], a[196:199], v[132:135], v[188:191]
 buffer_load_dwordx4 v248, s[12:15], s35 offen offset:0 sc1 lds
 ds_read_b128 a[176:179], v249 offset:1024
 v_mfma_f32_16x16x32_bf16 a[68:71], a[196:199], v[136:139], a[68:71]
 v_exp_f32_e64 v81, v81
 v_mfma_f32_16x16x32_bf16 a[76:79], a[196:199], v[140:143], a[76:79]
 v_exp_f32_e64 v82, v82
 v_mfma_f32_16x16x32_bf16 a[88:91], a[200:203], v[140:143], a[88:91]
 v_exp_f32_e64 v83, v83
 v_mfma_f32_16x16x32_bf16 a[80:83], a[200:203], v[136:139], a[80:83]
 buffer_load_dwordx4 v248, s[12:15], s36 offen offset:1024 sc1 lds
 v_mfma_f32_16x16x32_bf16 v[200:203], a[200:203], v[132:135], v[200:203]
 v_exp_f32_e64 v88, v88
 v_mfma_f32_16x16x32_bf16 v[192:195], a[200:203], v[128:131], v[192:195]
 v_exp_f32 v89, v89
 s_waitcnt vmcnt(4) lgkmcnt(1)
 v_mfma_f32_16x16x32_bf16 a[140:143], a[172:175], a[160:163], a[140:143]
 ds_read_b128 a[180:183], v249 offset:2048
 v_mfma_f32_16x16x32_bf16 v[196:199], a[204:207], v[128:131], v[196:199]
 buffer_load_dwordx4 v248, s[12:15], s37 offen offset:2048 sc1 lds
 v_mfma_f32_16x16x32_bf16 v[204:207], a[204:207], v[132:135], v[204:207]
 v_exp_f32_e64 v90, v90
 v_mfma_f32_16x16x32_bf16 a[84:87], a[204:207], v[136:139], a[84:87]
 v_exp_f32_e64 v91, v91
 v_mfma_f32_16x16x32_bf16 a[92:95], a[204:207], v[140:143], a[92:95]
 v_exp_f32_e64 v92, v92
 v_mfma_f32_16x16x32_bf16 a[104:107], a[208:211], v[140:143], a[104:107]
 buffer_load_dwordx4 v248, s[12:15], s38 offen offset:3072 sc1 lds
 s_xor_b32 s39, s39, 0x4000
 v_mfma_f32_16x16x32_bf16 a[96:99], a[208:211], v[136:139], a[96:99]
 v_add_u32 v248, 122880, v248
 s_add_u32 m0, s65, 0x4000
 s_waitcnt lgkmcnt(1)
 v_mfma_f32_16x16x32_bf16 a[144:147], a[176:179], a[160:163], a[144:147]
 ds_read_b128 a[184:187], v249 offset:3072
 v_mfma_f32_16x16x32_bf16 v[216:219], a[208:211], v[132:135], v[216:219]
 v_exp_f32 v93, v93
 v_mfma_f32_16x16x32_bf16 v[208:211], a[208:211], v[128:131], v[208:211]
 buffer_load_dwordx4 v6, s[4:7], s64 offen offset:0 sc1 lds
 v_mfma_f32_16x16x32_bf16 v[212:215], a[212:215], v[128:131], v[212:215]
 v_exp_f32_e64 v94, v94
 v_mfma_f32_16x16x32_bf16 v[220:223], a[212:215], v[132:135], v[220:223]
 v_exp_f32_e64 v95, v95
 v_mfma_f32_16x16x32_bf16 a[100:103], a[212:215], v[136:139], a[100:103]
 v_exp_f32_e64 v84, v84
 v_mfma_f32_16x16x32_bf16 a[108:111], a[212:215], v[140:143], a[108:111]
 v_exp_f32 v85, v85
 s_waitcnt lgkmcnt(1)
 v_mfma_f32_16x16x32_bf16 a[148:151], a[180:183], a[160:163], a[148:151]
 buffer_load_dwordx4 v6, s[4:7], s64 offen offset:1024 sc1 lds
 ds_read_b128 a[188:191], v249 offset:4096
 v_mfma_f32_16x16x32_bf16 a[120:123], a[216:219], v[140:143], a[120:123]
 v_exp_f32_e64 v86, v86
 v_mfma_f32_16x16x32_bf16 a[112:115], a[216:219], v[136:139], a[112:115]
 v_exp_f32_e64 v87, v87
 v_mfma_f32_16x16x32_bf16 v[232:235], a[216:219], v[132:135], v[232:235]
 v_exp_f32_e64 v76, v76
L_pg13:
 s_cbranch_execz L_hopr3
 v_mfma_f32_16x16x32_bf16 v[224:227], a[216:219], v[128:131], v[224:227]
 buffer_load_dwordx4 v6, s[4:7], s64 offen offset:2048 sc1 lds
 v_mfma_f32_16x16x32_bf16 v[228:231], a[220:223], v[128:131], v[228:231]
 v_exp_f32 v77, v77
 v_mfma_f32_16x16x32_bf16 v[236:239], a[220:223], v[132:135], v[236:239]
 v_exp_f32 v78, v78
 s_waitcnt lgkmcnt(1)
 v_mfma_f32_16x16x32_bf16 a[152:155], a[184:187], a[160:163], a[152:155]
 ds_read_b128 a[172:175], v249 offset:5120
 v_mfma_f32_16x16x32_bf16 a[116:119], a[220:223], v[136:139], a[116:119]
 v_mov_b32_e64 v5, v4
 v_xor_b32 v4, 0x10000, v4
 v_mfma_f32_16x16x32_bf16 a[124:127], a[220:223], v[140:143], a[124:127]
 s_cmp_lg_u32 s71, 0
 s_cbranch_scc1 L_hmid
L_hmidr:
 v_mfma_f32_16x16x32_bf16 v[96:99], a[0:3], a[224:227], v[8:11]
 buffer_load_dwordx4 v6, s[4:7], s64 offen offset:3072 sc1 lds
 s_add_u32 m0, s65, 0xc000
 v_mfma_f32_16x16x32_bf16 v[104:107], a[0:3], a[240:243], v[16:19]
 v_exp_f32_e64 v79, v79
 v_mfma_f32_16x16x32_bf16 v[112:115], a[0:3], a[32:35], v[160:163]
 v_exp_f32_e64 v68, v68
 v_mfma_f32_16x16x32_bf16 v[120:123], a[0:3], a[48:51], v[168:171]
 ds_read_b128 a[0:3], v4 offset:0
 ds_read_b128 a[192:195], v5 offset:16384
 s_waitcnt lgkmcnt(3)
 v_mfma_f32_16x16x32_bf16 a[156:159], a[188:191], a[160:163], a[156:159]
 buffer_load_dwordx4 v24, s[4:7], s64 offen offset:0 sc1 lds
 ds_read_b128 a[176:179], v249 offset:6144
 v_mfma_f32_16x16x32_bf16 v[124:127], a[16:19], a[48:51], v[172:175]
 v_exp_f32 v69, v69
 v_mfma_f32_16x16x32_bf16 v[116:119], a[16:19], a[32:35], v[164:167]
 v_exp_f32_e64 v70, v70
 v_mfma_f32_16x16x32_bf16 v[108:111], a[16:19], a[240:243], v[20:23]
 v_exp_f32_e64 v71, v71
 v_mfma_f32_16x16x32_bf16 v[100:103], a[16:19], a[224:227], v[12:15]
 buffer_load_dwordx4 v24, s[4:7], s64 offen offset:1024 sc1 lds
 ds_read_b128 a[16:19], v4 offset:4096
 v_mfma_f32_16x16x32_bf16 v[96:99], a[4:7], a[228:231], v[96:99]
 ds_read_b128 a[196:199], v5 offset:17408
 ds_read_b128 a[200:203], v5 offset:18432
 v_mfma_f32_16x16x32_bf16 v[104:107], a[4:7], a[244:247], v[104:107]
 ds_read_b128 a[204:207], v5 offset:19456
 ds_read_b128 a[208:211], v5 offset:20480
 s_waitcnt vmcnt(11) lgkmcnt(8)
 v_mfma_f32_16x16x32_bf16 a[140:143], a[172:175], a[164:167], a[140:143]
 ds_read_b128 a[180:183], v249 offset:7168
 ds_read_b128 a[212:215], v5 offset:21504
 v_mfma_f32_16x16x32_bf16 v[112:115], a[4:7], a[36:39], v[112:115]
 ds_read_b128 a[216:219], v5 offset:22528
 ds_read_b128 a[220:223], v5 offset:23552
 v_mfma_f32_16x16x32_bf16 v[120:123], a[4:7], a[52:55], v[120:123]
 buffer_load_dwordx4 v24, s[4:7], s64 offen offset:2048 sc1 lds
 ds_read_b128 a[4:7], v4 offset:1024
 v_mfma_f32_16x16x32_bf16 v[124:127], a[20:23], a[52:55], v[124:127]
 v_mfma_f32_16x16x32_bf16 v[116:119], a[20:23], a[36:39], v[116:119]
 v_mfma_f32_16x16x32_bf16 v[108:111], a[20:23], a[244:247], v[108:111]
 v_mfma_f32_16x16x32_bf16 v[100:103], a[20:23], a[228:231], v[100:103]
 buffer_load_dwordx4 v24, s[4:7], s64 offen offset:3072 sc1 lds
 ds_read_b128 a[20:23], v4 offset:5120
 s_waitcnt lgkmcnt(8)
 v_mfma_f32_16x16x32_bf16 a[144:147], a[176:179], a[164:167], a[144:147]
 ds_read_b128 a[184:187], v249 offset:8192
 s_xor_b32 s65, s65, 0x10000
 v_mfma_f32_16x16x32_bf16 v[96:99], a[8:11], a[232:235], v[96:99]
 s_add_u32 s64, s64, 0x10000
 s_mov_b32 m0, s65
 v_mfma_f32_16x16x32_bf16 v[104:107], a[8:11], a[248:251], v[104:107]
 v_mfma_f32_16x16x32_bf16 v[112:115], a[8:11], a[40:43], v[112:115]
 v_mfma_f32_16x16x32_bf16 v[120:123], a[8:11], a[56:59], v[120:123]
 buffer_load_dwordx4 v2, s[4:7], s64 offen offset:0 sc1 lds
 ds_read_b128 a[8:11], v4 offset:2048
 v_mfma_f32_16x16x32_bf16 v[124:127], a[24:27], a[56:59], v[124:127]
 v_cvt_pk_bf16_f32 v128, v64, v65
 v_cvt_pk_bf16_f32 v129, v66, v67
 v_mfma_f32_16x16x32_bf16 v[116:119], a[24:27], a[40:43], v[116:119]
 v_cvt_pk_bf16_f32 v130, v68, v69
 v_cvt_pk_bf16_f32 v131, v70, v71
 s_waitcnt lgkmcnt(3)
 v_mfma_f32_16x16x32_bf16 a[148:151], a[180:183], a[164:167], a[148:151]
 v_cvt_pk_bf16_f32 v132, v72, v73
 ds_read_b128 a[188:191], v249 offset:9216
 v_mfma_f32_16x16x32_bf16 v[108:111], a[24:27], a[248:251], v[108:111]
 v_cvt_pk_bf16_f32 v133, v74, v75
 v_cvt_pk_bf16_f32 v134, v76, v77
 v_mfma_f32_16x16x32_bf16 v[100:103], a[24:27], a[232:235], v[100:103]
 buffer_load_dwordx4 v2, s[4:7], s64 offen offset:1024 sc1 lds
 ds_read_b128 a[24:27], v4 offset:6144
 v_mfma_f32_16x16x32_bf16 v[96:99], a[12:15], a[236:239], v[96:99]
 v_cvt_pk_bf16_f32 v135, v78, v79
 v_cvt_pk_bf16_f32 v136, v80, v81
 v_mfma_f32_16x16x32_bf16 v[104:107], a[12:15], a[252:255], v[104:107]
 v_cvt_pk_bf16_f32 v137, v82, v83
 v_cvt_pk_bf16_f32 v138, v84, v85
 v_mfma_f32_16x16x32_bf16 v[112:115], a[12:15], a[44:47], v[112:115]
 v_cvt_pk_bf16_f32 v139, v86, v87
 v_cvt_pk_bf16_f32 v140, v88, v89
 v_mfma_f32_16x16x32_bf16 v[120:123], a[12:15], a[60:63], v[120:123]
 buffer_load_dwordx4 v2, s[4:7], s64 offen offset:2048 sc1 lds
 ds_read_b128 a[12:15], v4 offset:3072
 s_waitcnt lgkmcnt(3)
 v_mfma_f32_16x16x32_bf16 a[152:155], a[184:187], a[164:167], a[152:155]
 v_cvt_pk_bf16_f32 v141, v90, v91
 ds_read_b128 a[172:175], v249 offset:10240
 v_mfma_f32_16x16x32_bf16 v[124:127], a[28:31], a[60:63], v[124:127]
 v_cvt_pk_bf16_f32 v142, v92, v93
 v_cvt_pk_bf16_f32 v143, v94, v95
 v_mfma_f32_16x16x32_bf16 v[116:119], a[28:31], a[44:47], v[116:119]
 v_exp_f32 v96, v96
 v_mfma_f32_16x16x32_bf16 v[108:111], a[28:31], a[252:255], v[108:111]
 v_exp_f32_e64 v97, v97
 v_mfma_f32_16x16x32_bf16 v[100:103], a[28:31], a[236:239], v[100:103]
 buffer_load_dwordx4 v2, s[4:7], s64 offen offset:3072 sc1 lds
 ds_read_b128 a[28:31], v4 offset:7168
 v_mfma_f32_16x16x32_bf16 v[240:243], a[136:139], v[128:131], v[240:243]
 s_add_u32 m0, s65, 0x8000
 v_mfma_f32_16x16x32_bf16 v[244:247], a[136:139], v[132:135], v[244:247]
 v_exp_f32 v98, v98
 s_waitcnt lgkmcnt(3)
 v_mfma_f32_16x16x32_bf16 a[156:159], a[188:191], a[164:167], a[156:159]
 ds_read_b128 a[176:179], v249 offset:11264
 v_mfma_f32_16x16x32_bf16 a[128:131], a[136:139], v[136:139], a[128:131]
 buffer_load_dwordx4 v7, s[4:7], s64 offen offset:0 sc1 lds
 v_mfma_f32_16x16x32_bf16 a[132:135], a[136:139], v[140:143], a[132:135]
 v_exp_f32_e64 v99, v99
 v_mfma_f32_16x16x32_bf16 a[72:75], a[192:195], v[140:143], a[72:75]
 v_exp_f32_e64 v104, v104
 v_mfma_f32_16x16x32_bf16 a[64:67], a[192:195], v[136:139], a[64:67]
 v_exp_f32_e64 v105, v105
 v_mfma_f32_16x16x32_bf16 v[184:187], a[192:195], v[132:135], v[184:187]
 buffer_load_dwordx4 v7, s[4:7], s64 offen offset:1024 sc1 lds
 v_mfma_f32_16x16x32_bf16 v[176:179], a[192:195], v[128:131], v[176:179]
 v_exp_f32 v106, v106
 s_waitcnt vmcnt(18) lgkmcnt(1)
 v_mfma_f32_16x16x32_bf16 a[140:143], a[172:175], a[168:171], a[140:143]
 ds_read_b128 a[180:183], v249 offset:12288
 v_mfma_f32_16x16x32_bf16 v[180:183], a[196:199], v[128:131], v[180:183]
 v_exp_f32_e64 v107, v107
 v_mfma_f32_16x16x32_bf16 v[188:191], a[196:199], v[132:135], v[188:191]
 buffer_load_dwordx4 v7, s[4:7], s64 offen offset:2048 sc1 lds
 v_mfma_f32_16x16x32_bf16 a[68:71], a[196:199], v[136:139], a[68:71]
 v_exp_f32_e64 v112, v112
 v_mfma_f32_16x16x32_bf16 a[76:79], a[196:199], v[140:143], a[76:79]
 v_exp_f32_e64 v113, v113
 v_mfma_f32_16x16x32_bf16 a[88:91], a[200:203], v[140:143], a[88:91]
 v_exp_f32_e64 v114, v114
 v_mfma_f32_16x16x32_bf16 a[80:83], a[200:203], v[136:139], a[80:83]
 v_exp_f32 v115, v115
 s_waitcnt lgkmcnt(1)
 v_mfma_f32_16x16x32_bf16 a[144:147], a[176:179], a[168:171], a[144:147]
 buffer_load_dwordx4 v7, s[4:7], s64 offen offset:3072 sc1 lds
 ds_read_b128 a[184:187], v249 offset:13312
 v_mfma_f32_16x16x32_bf16 v[200:203], a[200:203], v[132:135], v[200:203]
 v_exp_f32_e64 v120, v120
 v_mfma_f32_16x16x32_bf16 v[192:195], a[200:203], v[128:131], v[192:195]
 v_exp_f32_e64 v121, v121
 v_mfma_f32_16x16x32_bf16 v[196:199], a[204:207], v[128:131], v[196:199]
 v_exp_f32_e64 v122, v122
 v_mfma_f32_16x16x32_bf16 v[204:207], a[204:207], v[132:135], v[204:207]
 buffer_load_dwordx4 a[160:163], v2, s[8:11], s34 offen offset:0 sc1
 v_mfma_f32_16x16x32_bf16 a[84:87], a[204:207], v[136:139], a[84:87]
 v_exp_f32_e64 v123, v123
 v_mfma_f32_16x16x32_bf16 a[92:95], a[204:207], v[140:143], a[92:95]
 v_exp_f32 v124, v124
 s_waitcnt lgkmcnt(1)
 v_mfma_f32_16x16x32_bf16 a[148:151], a[180:183], a[168:171], a[148:151]
 ds_read_b128 a[188:191], v249 offset:14336
 v_mfma_f32_16x16x32_bf16 a[104:107], a[208:211], v[140:143], a[104:107]
 buffer_load_dwordx4 a[164:167], v2, s[8:11], s34 offen offset:1024 sc1
 v_mfma_f32_16x16x32_bf16 a[96:99], a[208:211], v[136:139], a[96:99]
 v_exp_f32_e64 v125, v125
 v_mfma_f32_16x16x32_bf16 v[216:219], a[208:211], v[132:135], v[216:219]
 v_exp_f32_e64 v126, v126
 v_mfma_f32_16x16x32_bf16 v[208:211], a[208:211], v[128:131], v[208:211]
 v_exp_f32_e64 v127, v127
 v_mfma_f32_16x16x32_bf16 v[212:215], a[212:215], v[128:131], v[212:215]
 v_exp_f32_e64 v116, v116
 v_mfma_f32_16x16x32_bf16 v[220:223], a[212:215], v[132:135], v[220:223]
 v_exp_f32 v117, v117
 s_waitcnt lgkmcnt(1)
 v_mfma_f32_16x16x32_bf16 a[152:155], a[184:187], a[168:171], a[152:155]
 v_xor_b32 v249, 0x4000, v249
 v_mfma_f32_16x16x32_bf16 a[100:103], a[212:215], v[136:139], a[100:103]
 v_exp_f32_e64 v118, v118
 v_mfma_f32_16x16x32_bf16 a[108:111], a[212:215], v[140:143], a[108:111]
 v_exp_f32_e64 v119, v119
 v_mfma_f32_16x16x32_bf16 a[120:123], a[216:219], v[140:143], a[120:123]
 v_exp_f32_e64 v108, v108
 v_mfma_f32_16x16x32_bf16 a[112:115], a[216:219], v[136:139], a[112:115]
 v_exp_f32_e64 v109, v109
 v_mfma_f32_16x16x32_bf16 v[232:235], a[216:219], v[132:135], v[232:235]
 v_exp_f32_e64 v110, v110
 v_mfma_f32_16x16x32_bf16 v[224:227], a[216:219], v[128:131], v[224:227]
 v_exp_f32 v111, v111
 s_waitcnt lgkmcnt(0)
 v_mfma_f32_16x16x32_bf16 a[156:159], a[188:191], a[168:171], a[156:159]
 v_exp_f32_e64 v100, v100
 v_mfma_f32_16x16x32_bf16 v[228:231], a[220:223], v[128:131], v[228:231]
 v_exp_f32_e64 v101, v101
 v_mfma_f32_16x16x32_bf16 v[236:239], a[220:223], v[132:135], v[236:239]
 v_exp_f32_e64 v102, v102
 v_mfma_f32_16x16x32_bf16 a[116:119], a[220:223], v[136:139], a[116:119]
 v_exp_f32_e64 v103, v103
 v_mfma_f32_16x16x32_bf16 a[124:127], a[220:223], v[140:143], a[124:127]
 s_sub_u32 s66, s66, 1
 s_cbranch_scc0 L_topS
L_postS:
 s_or_b32 s71, s71, 2
 s_cmp_eq_u32 s58, 2
 s_cbranch_scc0 L_hs0
L_topL:
 s_cmp_eq_u32 s60, 7
 s_cselect_b32 s3, 5, 6
 v_add_u32 v29, s3, v0
 buffer_store_dword v29, v26, s[24:27], 0 offen sc1
 s_mov_b32 s28, s32
 s_mov_b32 s29, s33
 s_mov_b32 s30, 0x280000
 s_mov_b32 s31, 0x00020000
 s_cmp_lt_u32 s58, 2
 s_cselect_b32 s51, s44, s45
 s_and_b32 s54, s58, 1
 s_add_u32 s51, s51, s54
 s_lshl_b32 s51, s51, 7
 s_add_u32 s51, s51, s46
 s_mul_i32 s51, s51, 160
 v_and_b32_e64 v254, 15, v1
 v_mul_u32_u24 v254, 1280, v254
 v_lshrrev_b32_e64 v255, 4, v1
 v_mad_u32_u24 v254, v255, 52, v254
 buffer_load_dword v255, v254, s[28:31], s51 offen
 s_andn2_b32 s51, s2, 24
 s_lshl_b32 s51, s51, 5
 s_add_u32 s51, s51, s58
 s_lshl_b32 s51, s51, 2
 s_add_u32 s51, s51, 16
 v_and_b32 v27, 3, v1
 v_lshl_add_u32 v27, v27, 10, s51
 v_mfma_f32_16x16x32_bf16 v[64:67], a[0:3], a[224:227], v[8:11]
 ds_read_b128 a[192:195], v5 offset:24576
 v_cvt_pk_bf16_f32 v128, v96, v97
 v_mfma_f32_16x16x32_bf16 v[72:75], a[0:3], a[240:243], v[16:19]
 v_cvt_pk_bf16_f32 v129, v98, v99
 ds_read_b128 a[196:199], v5 offset:25600
 v_mfma_f32_16x16x32_bf16 v[80:83], a[0:3], a[32:35], v[160:163]
 v_cvt_pk_bf16_f32 v130, v100, v101
 v_cvt_pk_bf16_f32 v131, v102, v103
 v_mfma_f32_16x16x32_bf16 v[88:91], a[0:3], a[48:51], v[168:171]
 ds_read_b128 a[0:3], v4 offset:8192
 ds_read_b128 a[200:203], v5 offset:26624
 v_mfma_f32_16x16x32_bf16 v[92:95], a[16:19], a[48:51], v[172:175]
 v_cvt_pk_bf16_f32 v132, v104, v105
 v_cvt_pk_bf16_f32 v133, v106, v107
 v_mfma_f32_16x16x32_bf16 v[84:87], a[16:19], a[32:35], v[164:167]
 ds_read_b128 a[204:207], v5 offset:27648
 v_cvt_pk_bf16_f32 v134, v108, v109
 v_mfma_f32_16x16x32_bf16 v[76:79], a[16:19], a[240:243], v[20:23]
 v_cvt_pk_bf16_f32 v135, v110, v111
 ds_read_b128 a[208:211], v5 offset:28672
 v_mfma_f32_16x16x32_bf16 v[68:71], a[16:19], a[224:227], v[12:15]
 ds_read_b128 a[16:19], v4 offset:12288
 v_cvt_pk_bf16_f32 v136, v112, v113
 v_mfma_f32_16x16x32_bf16 v[64:67], a[4:7], a[228:231], v[64:67]
 v_cvt_pk_bf16_f32 v137, v114, v115
 ds_read_b128 a[212:215], v5 offset:29696
 v_mfma_f32_16x16x32_bf16 v[72:75], a[4:7], a[244:247], v[72:75]
 v_cvt_pk_bf16_f32 v138, v116, v117
 v_cvt_pk_bf16_f32 v139, v118, v119
 v_mfma_f32_16x16x32_bf16 v[80:83], a[4:7], a[36:39], v[80:83]
 ds_read_b128 a[216:219], v5 offset:30720
 v_cvt_pk_bf16_f32 v140, v120, v121
 v_mfma_f32_16x16x32_bf16 v[88:91], a[4:7], a[52:55], v[88:91]
 ds_read_b128 a[4:7], v4 offset:9216
 v_cvt_pk_bf16_f32 v141, v122, v123
 v_mfma_f32_16x16x32_bf16 v[92:95], a[20:23], a[52:55], v[92:95]
 ds_read_b128 a[220:223], v5 offset:31744
 v_cvt_pk_bf16_f32 v142, v124, v125
 v_mfma_f32_16x16x32_bf16 v[84:87], a[20:23], a[36:39], v[84:87]
 v_cvt_pk_bf16_f32 v143, v126, v127
 s_bfe_u32 s76, s2, 0x20003
 v_mfma_f32_16x16x32_bf16 v[76:79], a[20:23], a[244:247], v[76:79]
 s_lshl_b32 s77, s59, 2
 s_add_u32 s77, s77, s58
 v_mfma_f32_16x16x32_bf16 v[68:71], a[20:23], a[228:231], v[68:71]
 ds_read_b128 a[20:23], v4 offset:13312
 s_lshl_b32 s77, s77, 2
 v_mfma_f32_16x16x32_bf16 v[64:67], a[8:11], a[232:235], v[64:67]
 s_add_u32 s77, s77, s76
 s_mul_i32 s40, s77, 10240
 v_mfma_f32_16x16x32_bf16 v[72:75], a[8:11], a[248:251], v[72:75]
 s_add_u32 s3, s76, 1
 s_and_b32 s3, s3, 3
 v_mfma_f32_16x16x32_bf16 v[80:83], a[8:11], a[40:43], v[80:83]
 s_sub_u32 s3, s3, s76
 s_lshl_b32 s48, s3, 14
 v_mfma_f32_16x16x32_bf16 v[88:91], a[8:11], a[56:59], v[88:91]
 ds_read_b128 a[8:11], v4 offset:10240
 s_mul_i32 s3, s48, 10
 v_mfma_f32_16x16x32_bf16 v[92:95], a[24:27], a[56:59], v[92:95]
 s_add_u32 s41, s40, s3
 s_add_u32 s3, s76, 2
 v_mfma_f32_16x16x32_bf16 v[84:87], a[24:27], a[40:43], v[84:87]
 s_and_b32 s3, s3, 3
 s_sub_u32 s3, s3, s76
 v_mfma_f32_16x16x32_bf16 v[76:79], a[24:27], a[248:251], v[76:79]
 s_lshl_b32 s49, s3, 14
 s_mul_i32 s3, s49, 10
 v_mfma_f32_16x16x32_bf16 v[68:71], a[24:27], a[232:235], v[68:71]
 ds_read_b128 a[24:27], v4 offset:14336
 s_add_u32 s42, s40, s3
 v_mfma_f32_16x16x32_bf16 v[64:67], a[12:15], a[236:239], v[64:67]
 s_add_u32 s3, s76, 3
 s_and_b32 s3, s3, 3
 v_mfma_f32_16x16x32_bf16 v[72:75], a[12:15], a[252:255], v[72:75]
 s_sub_u32 s3, s3, s76
 s_lshl_b32 s50, s3, 14
 v_mfma_f32_16x16x32_bf16 v[80:83], a[12:15], a[44:47], v[80:83]
 s_mul_i32 s3, s50, 10
 s_add_u32 s43, s40, s3
 v_mfma_f32_16x16x32_bf16 v[88:91], a[12:15], a[60:63], v[88:91]
 ds_read_b128 a[12:15], v4 offset:11264
 v_mfma_f32_16x16x32_bf16 v[92:95], a[28:31], a[60:63], v[92:95]
 s_add_u32 s16, s56, 0x3c00000
 s_addc_u32 s17, s57, 0
 v_mfma_f32_16x16x32_bf16 v[84:87], a[28:31], a[44:47], v[84:87]
 s_mov_b32 s18, 0x500000
 s_mov_b32 s19, 0x00020000
 v_mfma_f32_16x16x32_bf16 v[76:79], a[28:31], a[252:255], v[76:79]
 v_add_u32 v6, 0x2000, v2
 s_mul_i32 s65, s58, 10240
 v_mfma_f32_16x16x32_bf16 v[68:71], a[28:31], a[236:239], v[68:71]
 ds_read_b128 a[28:31], v4 offset:15360
 s_lshl_b32 s64, s58, 12
 v_mfma_f32_16x16x32_bf16 v[240:243], a[136:139], v[128:131], v[240:243]
 s_lshl_b32 s67, s58, 14
 v_add_u32 v7, s67, v2
 v_mfma_f32_16x16x32_bf16 v[244:247], a[136:139], v[132:135], v[244:247]
 v_xor_b32 v24, 0x4000, v7
 s_xor_b32 s67, s67, 0x4000
 v_mfma_f32_16x16x32_bf16 a[128:131], a[136:139], v[136:139], a[128:131]
 s_add_u32 s68, s64, 147456
 v_lshl_add_u32 v250, v1, 2, s68
 v_mfma_f32_16x16x32_bf16 a[132:135], a[136:139], v[140:143], a[132:135]
 v_xor_b32 v251, 0x1000, v250
 v_lshrrev_b32 v252, 4, v1
 s_waitcnt lgkmcnt(1)
 v_mfma_f32_16x16x32_bf16 a[72:75], a[192:195], v[140:143], a[72:75]
 v_and_b32 v253, 15, v1
 v_lshlrev_b32 v253, 7, v253
 v_mfma_f32_16x16x32_bf16 a[64:67], a[192:195], v[136:139], a[64:67]
 v_lshl_add_u32 v252, v252, 12, v253
 v_mfma_f32_16x16x32_bf16 v[184:187], a[192:195], v[132:135], v[184:187]
 v_exp_f32_e64 v64, v64
 v_mfma_f32_16x16x32_bf16 v[176:179], a[192:195], v[128:131], v[176:179]
 s_waitcnt vmcnt(4)
 s_waitcnt lgkmcnt(0)
 s_barrier
 v_mfma_f32_16x16x32_bf16 v[180:183], a[196:199], v[128:131], v[180:183]
 s_add_u32 m0, s65, 65536
 v_mfma_f32_16x16x32_bf16 v[188:191], a[196:199], v[132:135], v[188:191]
 buffer_load_dwordx4 v2, s[16:19], s40 offen offset:0 sc1 lds
 v_mfma_f32_16x16x32_bf16 a[68:71], a[196:199], v[136:139], a[68:71]
 v_exp_f32 v65, v65
 v_mfma_f32_16x16x32_bf16 a[76:79], a[196:199], v[140:143], a[76:79]
 v_exp_f32_e64 v66, v66
 v_mfma_f32_16x16x32_bf16 a[88:91], a[200:203], v[140:143], a[88:91]
 v_exp_f32_e64 v67, v67
 v_mfma_f32_16x16x32_bf16 a[80:83], a[200:203], v[136:139], a[80:83]
 buffer_load_dwordx4 v2, s[16:19], s40 offen offset:1024 sc1 lds
 v_mfma_f32_16x16x32_bf16 v[200:203], a[200:203], v[132:135], v[200:203]
 v_exp_f32_e64 v72, v72
 v_mfma_f32_16x16x32_bf16 v[192:195], a[200:203], v[128:131], v[192:195]
 v_exp_f32_e64 v73, v73
 v_mfma_f32_16x16x32_bf16 v[196:199], a[204:207], v[128:131], v[196:199]
 v_exp_f32_e64 v74, v74
 v_mfma_f32_16x16x32_bf16 v[204:207], a[204:207], v[132:135], v[204:207]
 buffer_load_dwordx4 v2, s[16:19], s40 offen offset:2048 sc1 lds
 v_mfma_f32_16x16x32_bf16 a[84:87], a[204:207], v[136:139], a[84:87]
 v_exp_f32_e64 v75, v75
 v_mfma_f32_16x16x32_bf16 a[92:95], a[204:207], v[140:143], a[92:95]
 v_exp_f32_e64 v80, v80
 v_mfma_f32_16x16x32_bf16 a[104:107], a[208:211], v[140:143], a[104:107]
 v_exp_f32_e64 v81, v81
 v_mfma_f32_16x16x32_bf16 a[96:99], a[208:211], v[136:139], a[96:99]
 buffer_load_dwordx4 v2, s[16:19], s40 offen offset:3072 sc1 lds
 s_add_u32 m0, s65, 69632
 v_mfma_f32_16x16x32_bf16 v[216:219], a[208:211], v[132:135], v[216:219]
 v_exp_f32_e64 v82, v82
 v_mfma_f32_16x16x32_bf16 v[208:211], a[208:211], v[128:131], v[208:211]
 v_exp_f32_e64 v83, v83
 v_mfma_f32_16x16x32_bf16 v[212:215], a[212:215], v[128:131], v[212:215]
 v_exp_f32_e64 v88, v88
 v_mfma_f32_16x16x32_bf16 v[220:223], a[212:215], v[132:135], v[220:223]
 buffer_load_dwordx4 v3, s[16:19], s40 offen offset:0 sc1 lds
 v_mfma_f32_16x16x32_bf16 a[100:103], a[212:215], v[136:139], a[100:103]
 v_exp_f32_e64 v89, v89
 v_mfma_f32_16x16x32_bf16 a[108:111], a[212:215], v[140:143], a[108:111]
 v_exp_f32_e64 v90, v90
 v_mfma_f32_16x16x32_bf16 a[120:123], a[216:219], v[140:143], a[120:123]
 v_exp_f32_e64 v91, v91
 v_mfma_f32_16x16x32_bf16 a[112:115], a[216:219], v[136:139], a[112:115]
 buffer_load_dwordx4 v3, s[16:19], s40 offen offset:1024 sc1 lds
 v_mfma_f32_16x16x32_bf16 v[232:235], a[216:219], v[132:135], v[232:235]
 v_exp_f32_e64 v92, v92
 v_mfma_f32_16x16x32_bf16 v[224:227], a[216:219], v[128:131], v[224:227]
 v_exp_f32_e64 v93, v93
 v_mfma_f32_16x16x32_bf16 v[228:231], a[220:223], v[128:131], v[228:231]
 v_exp_f32_e64 v94, v94
 v_mfma_f32_16x16x32_bf16 v[236:239], a[220:223], v[132:135], v[236:239]
 v_exp_f32_e64 v95, v95
 v_mfma_f32_16x16x32_bf16 a[116:119], a[220:223], v[136:139], a[116:119]
 buffer_load_dwordx4 v3, s[16:19], s40 offen offset:2048 sc1 lds
 v_mov_b32_e64 v5, v4
 v_mfma_f32_16x16x32_bf16 a[124:127], a[220:223], v[140:143], a[124:127]
 s_branch L_hmid
L_hmidr2:
 v_mfma_f32_16x16x32_bf16 v[96:99], a[0:3], a[224:227], v[8:11]
 v_exp_f32 v84, v84
 v_mfma_f32_16x16x32_bf16 v[104:107], a[0:3], a[240:243], v[16:19]
 v_exp_f32_e64 v85, v85
 v_mfma_f32_16x16x32_bf16 v[112:115], a[0:3], a[32:35], v[160:163]
 buffer_load_dwordx4 v3, s[16:19], s40 offen offset:3072 sc1 lds
 s_add_u32 m0, s65, 73728
 v_mfma_f32_16x16x32_bf16 v[120:123], a[0:3], a[48:51], v[168:171]
 v_exp_f32_e64 v86, v86
 v_mfma_f32_16x16x32_bf16 v[124:127], a[16:19], a[48:51], v[172:175]
 v_exp_f32_e64 v87, v87
 v_mfma_f32_16x16x32_bf16 v[116:119], a[16:19], a[32:35], v[164:167]
 v_exp_f32_e64 v76, v76
 v_mfma_f32_16x16x32_bf16 v[108:111], a[16:19], a[240:243], v[20:23]
 buffer_load_dwordx4 v6, s[16:19], s40 offen offset:0 sc1 lds
 ds_read_b128 a[192:195], v5 offset:16384
 v_mfma_f32_16x16x32_bf16 v[100:103], a[16:19], a[224:227], v[12:15]
 v_exp_f32_e64 v77, v77
 v_mfma_f32_16x16x32_bf16 v[96:99], a[4:7], a[228:231], v[96:99]
 v_exp_f32_e64 v78, v78
 v_mfma_f32_16x16x32_bf16 v[104:107], a[4:7], a[244:247], v[104:107]
 v_exp_f32_e64 v79, v79
 v_mfma_f32_16x16x32_bf16 v[112:115], a[4:7], a[36:39], v[112:115]
 buffer_load_dwordx4 v6, s[16:19], s40 offen offset:1024 sc1 lds
 s_add_u32 m0, s65, 106496
 v_mfma_f32_16x16x32_bf16 v[120:123], a[4:7], a[52:55], v[120:123]
 v_exp_f32_e64 v68, v68
 v_mfma_f32_16x16x32_bf16 v[124:127], a[20:23], a[52:55], v[124:127]
 v_exp_f32_e64 v69, v69
 v_mfma_f32_16x16x32_bf16 v[116:119], a[20:23], a[36:39], v[116:119]
 v_exp_f32_e64 v70, v70
 buffer_load_dword v28, v27, s[24:27], 0 offen sc1
 v_mfma_f32_16x16x32_bf16 v[108:111], a[20:23], a[244:247], v[108:111]
 buffer_load_dwordx4 v2, s[16:19], s41 offen offset:0 sc1 lds
 ds_read_b128 a[196:199], v5 offset:17408
 v_mfma_f32_16x16x32_bf16 v[100:103], a[20:23], a[228:231], v[100:103]
 v_exp_f32_e64 v71, v71
 v_mfma_f32_16x16x32_bf16 v[96:99], a[8:11], a[232:235], v[96:99]
 ds_read_b128 a[200:203], v5 offset:18432
 ds_read_b128 a[204:207], v5 offset:19456
 v_mfma_f32_16x16x32_bf16 v[104:107], a[8:11], a[248:251], v[104:107]
 ds_read_b128 a[208:211], v5 offset:20480
 ds_read_b128 a[212:215], v5 offset:21504
 v_mfma_f32_16x16x32_bf16 v[112:115], a[8:11], a[40:43], v[112:115]
 buffer_load_dwordx4 v2, s[16:19], s41 offen offset:1024 sc1 lds
 ds_read_b128 a[216:219], v5 offset:22528
 v_mfma_f32_16x16x32_bf16 v[120:123], a[8:11], a[56:59], v[120:123]
 v_cvt_pk_bf16_f32 v128, v64, v65
 ds_read_b128 a[220:223], v5 offset:23552
 v_mfma_f32_16x16x32_bf16 v[124:127], a[24:27], a[56:59], v[124:127]
 v_cvt_pk_bf16_f32 v129, v66, v67
 v_cvt_pk_bf16_f32 v130, v68, v69
 v_mfma_f32_16x16x32_bf16 v[116:119], a[24:27], a[40:43], v[116:119]
 v_cvt_pk_bf16_f32 v131, v70, v71
 v_cvt_pk_bf16_f32 v132, v72, v73
 v_mfma_f32_16x16x32_bf16 v[108:111], a[24:27], a[248:251], v[108:111]
 v_cvt_pk_bf16_f32 v133, v74, v75
 buffer_load_dwordx4 v2, s[16:19], s41 offen offset:2048 sc1 lds
 v_mfma_f32_16x16x32_bf16 v[100:103], a[24:27], a[232:235], v[100:103]
 v_cvt_pk_bf16_f32 v134, v76, v77
 v_cvt_pk_bf16_f32 v135, v78, v79
 v_mfma_f32_16x16x32_bf16 v[96:99], a[12:15], a[236:239], v[96:99]
 v_cvt_pk_bf16_f32 v136, v80, v81
 v_cvt_pk_bf16_f32 v137, v82, v83
 v_mfma_f32_16x16x32_bf16 v[104:107], a[12:15], a[252:255], v[104:107]
 v_cvt_pk_bf16_f32 v138, v84, v85
 v_cvt_pk_bf16_f32 v139, v86, v87
 v_mfma_f32_16x16x32_bf16 v[112:115], a[12:15], a[44:47], v[112:115]
 buffer_load_dwordx4 v2, s[16:19], s41 offen offset:3072 sc1 lds
 s_add_u32 m0, s65, 110592
 v_mfma_f32_16x16x32_bf16 v[120:123], a[12:15], a[60:63], v[120:123]
 v_cvt_pk_bf16_f32 v140, v88, v89
 v_cvt_pk_bf16_f32 v141, v90, v91
 v_mfma_f32_16x16x32_bf16 v[124:127], a[28:31], a[60:63], v[124:127]
 v_cvt_pk_bf16_f32 v142, v92, v93
 v_cvt_pk_bf16_f32 v143, v94, v95
 v_mfma_f32_16x16x32_bf16 v[116:119], a[28:31], a[44:47], v[116:119]
 s_waitcnt vmcnt(18)
 ds_read_b128 a[160:163], v5 offset:24576
 s_waitcnt vmcnt(17)
 ds_read_b128 a[164:167], v5 offset:25600
 v_mfma_f32_16x16x32_bf16 v[108:111], a[28:31], a[252:255], v[108:111]
 buffer_load_dwordx4 v3, s[16:19], s41 offen offset:0 sc1 lds
 ds_read_b128 a[168:171], v5 offset:26624
 v_mfma_f32_16x16x32_bf16 v[100:103], a[28:31], a[236:239], v[100:103]
 ds_read_b128 a[172:175], v5 offset:27648
 ds_read_b128 a[176:179], v5 offset:28672
 ds_read_b128 a[180:183], v5 offset:29696
 ds_read_b128 a[184:187], v5 offset:30720
 ds_read_b128 a[188:191], v5 offset:31744
 v_mfma_f32_16x16x32_bf16 v[240:243], a[136:139], v[128:131], v[240:243]
 v_exp_f32_e64 v112, v112
 v_mfma_f32_16x16x32_bf16 v[244:247], a[136:139], v[132:135], v[244:247]
 v_exp_f32_e64 v113, v113
 v_mfma_f32_16x16x32_bf16 a[128:131], a[136:139], v[136:139], a[128:131]
 buffer_load_dwordx4 v3, s[16:19], s41 offen offset:1024 sc1 lds
 v_add_u32 v4, 0x10000, v2
 v_mfma_f32_16x16x32_bf16 a[132:135], a[136:139], v[140:143], a[132:135]
 v_exp_f32 v114, v114
 s_waitcnt lgkmcnt(8)
 v_mfma_f32_16x16x32_bf16 a[72:75], a[192:195], v[140:143], a[72:75]
 v_exp_f32_e64 v115, v115
 v_mfma_f32_16x16x32_bf16 a[64:67], a[192:195], v[136:139], a[64:67]
 v_exp_f32_e64 v120, v120
 v_mfma_f32_16x16x32_bf16 v[184:187], a[192:195], v[132:135], v[184:187]
 buffer_load_dwordx4 v3, s[16:19], s41 offen offset:2048 sc1 lds
 v_add_u32 v5, 0x20000, v2
 v_mfma_f32_16x16x32_bf16 v[176:179], a[192:195], v[128:131], v[176:179]
 v_exp_f32_e64 v121, v121
 v_mfma_f32_16x16x32_bf16 v[180:183], a[196:199], v[128:131], v[180:183]
 v_exp_f32_e64 v122, v122
 v_mfma_f32_16x16x32_bf16 v[188:191], a[196:199], v[132:135], v[188:191]
 v_exp_f32_e64 v123, v123
 v_mfma_f32_16x16x32_bf16 a[68:71], a[196:199], v[136:139], a[68:71]
 buffer_load_dwordx4 v3, s[16:19], s41 offen offset:3072 sc1 lds
 s_add_u32 m0, s65, 114688
 v_mfma_f32_16x16x32_bf16 a[76:79], a[196:199], v[140:143], a[76:79]
 v_exp_f32_e64 v124, v124
 v_mfma_f32_16x16x32_bf16 a[88:91], a[200:203], v[140:143], a[88:91]
 v_exp_f32_e64 v125, v125
 v_mfma_f32_16x16x32_bf16 a[80:83], a[200:203], v[136:139], a[80:83]
 v_exp_f32_e64 v126, v126
 v_mfma_f32_16x16x32_bf16 v[200:203], a[200:203], v[132:135], v[200:203]
 buffer_load_dwordx4 v6, s[16:19], s41 offen offset:0 sc1 lds
 v_mfma_f32_16x16x32_bf16 v[192:195], a[200:203], v[128:131], v[192:195]
 v_exp_f32_e64 v127, v127
 v_mfma_f32_16x16x32_bf16 v[196:199], a[204:207], v[128:131], v[196:199]
 v_exp_f32_e64 v116, v116
 v_mfma_f32_16x16x32_bf16 v[204:207], a[204:207], v[132:135], v[204:207]
 v_exp_f32_e64 v117, v117
 v_mfma_f32_16x16x32_bf16 a[84:87], a[204:207], v[136:139], a[84:87]
 buffer_load_dwordx4 v6, s[16:19], s41 offen offset:1024 sc1 lds
 s_add_u32 m0, s64, 147456
 v_mfma_f32_16x16x32_bf16 a[92:95], a[204:207], v[140:143], a[92:95]
 v_exp_f32_e64 v118, v118
 v_mfma_f32_16x16x32_bf16 a[104:107], a[208:211], v[140:143], a[104:107]
 v_exp_f32_e64 v119, v119
 v_mfma_f32_16x16x32_bf16 a[96:99], a[208:211], v[136:139], a[96:99]
 v_cvt_pk_bf16_f32 v156, v120, v121
 v_cvt_pk_bf16_f32 v157, v122, v123
 v_mfma_f32_16x16x32_bf16 v[216:219], a[208:211], v[132:135], v[216:219]
 buffer_load_dwordx4 v2, s[16:19], s42 offen offset:0 sc1 lds
L_pg14:
 s_cbranch_execz L_hopr3
 v_cvt_pk_bf16_f32 v158, v124, v125
 v_mfma_f32_16x16x32_bf16 v[208:211], a[208:211], v[128:131], v[208:211]
 v_cvt_pk_bf16_f32 v159, v126, v127
 v_cvt_pk_bf16_f32 v152, v112, v113
 v_mfma_f32_16x16x32_bf16 v[212:215], a[212:215], v[128:131], v[212:215]
 v_cvt_pk_bf16_f32 v153, v114, v115
 v_cvt_pk_bf16_f32 v154, v116, v117
 v_mfma_f32_16x16x32_bf16 v[220:223], a[212:215], v[132:135], v[220:223]
 v_cvt_pk_bf16_f32 v155, v118, v119
 v_mfma_f32_16x16x32_bf16 a[100:103], a[212:215], v[136:139], a[100:103]
 buffer_load_dwordx4 v2, s[16:19], s42 offen offset:1024 sc1 lds
 v_mfma_f32_16x16x32_bf16 a[108:111], a[212:215], v[140:143], a[108:111]
 v_exp_f32 v96, v96
 v_mfma_f32_16x16x32_bf16 a[120:123], a[216:219], v[140:143], a[120:123]
 v_exp_f32_e64 v97, v97
 v_mfma_f32_16x16x32_bf16 a[112:115], a[216:219], v[136:139], a[112:115]
 v_exp_f32_e64 v98, v98
 v_mfma_f32_16x16x32_bf16 v[232:235], a[216:219], v[132:135], v[232:235]
 buffer_load_dwordx4 v2, s[16:19], s42 offen offset:2048 sc1 lds
 v_mfma_f32_16x16x32_bf16 v[224:227], a[216:219], v[128:131], v[224:227]
 v_exp_f32_e64 v99, v99
 v_mfma_f32_16x16x32_bf16 v[228:231], a[220:223], v[128:131], v[228:231]
 v_exp_f32_e64 v100, v100
 v_mfma_f32_16x16x32_bf16 v[236:239], a[220:223], v[132:135], v[236:239]
 v_exp_f32_e64 v101, v101
 v_mfma_f32_16x16x32_bf16 a[116:119], a[220:223], v[136:139], a[116:119]
 v_exp_f32_e64 v102, v102
 v_mfma_f32_16x16x32_bf16 a[124:127], a[220:223], v[140:143], a[124:127]
 s_waitcnt vmcnt(14)
 s_waitcnt lgkmcnt(0)
 s_barrier
 v_mfma_f32_16x16x32_bf16 a[128:131], a[136:139], v[152:155], a[128:131]
 v_add_u32 v29, 6, v0
 buffer_store_dword v29, v26, s[24:27], 0 offen sc1
 v_mfma_f32_16x16x32_bf16 a[132:135], a[136:139], v[156:159], a[132:135]
 v_exp_f32_e64 v103, v103
 v_mfma_f32_16x16x32_bf16 a[72:75], a[160:163], v[156:159], a[72:75]
 v_cvt_pk_bf16_f32 v144, v96, v97
 v_cvt_pk_bf16_f32 v145, v98, v99
 v_mfma_f32_16x16x32_bf16 a[64:67], a[160:163], v[152:155], a[64:67]
 v_cvt_pk_bf16_f32 v146, v100, v101
 v_cvt_pk_bf16_f32 v147, v102, v103
 v_mfma_f32_16x16x32_bf16 a[68:71], a[164:167], v[152:155], a[68:71]
 v_exp_f32_e64 v104, v104
 v_mfma_f32_16x16x32_bf16 a[76:79], a[164:167], v[156:159], a[76:79]
 v_exp_f32_e64 v105, v105
 v_mfma_f32_16x16x32_bf16 a[88:91], a[168:171], v[156:159], a[88:91]
 s_nop 0
 ds_write_b128 v7, a[64:67] offset:0
 v_mfma_f32_16x16x32_bf16 a[80:83], a[168:171], v[152:155], a[80:83]
 v_exp_f32 v106, v106
 v_mfma_f32_16x16x32_bf16 a[84:87], a[172:175], v[152:155], a[84:87]
 v_exp_f32_e64 v107, v107
 v_mfma_f32_16x16x32_bf16 a[92:95], a[172:175], v[156:159], a[92:95]
 ds_write_b128 v7, a[72:75] offset:2048
 ds_write_b32 v251, a128 offset:3072
 v_mfma_f32_16x16x32_bf16 a[104:107], a[176:179], v[156:159], a[104:107]
 v_exp_f32_e64 v108, v108
 v_mfma_f32_16x16x32_bf16 a[96:99], a[176:179], v[152:155], a[96:99]
 v_exp_f32_e64 v109, v109
 v_mfma_f32_16x16x32_bf16 a[100:103], a[180:183], v[152:155], a[100:103]
 v_exp_f32_e64 v110, v110
 v_mfma_f32_16x16x32_bf16 a[108:111], a[180:183], v[156:159], a[108:111]
 ds_write_b128 v7, a[68:71] offset:1024
 v_mfma_f32_16x16x32_bf16 a[120:123], a[184:187], v[156:159], a[120:123]
 v_exp_f32_e64 v111, v111
 v_mfma_f32_16x16x32_bf16 a[112:115], a[184:187], v[152:155], a[112:115]
 v_cvt_pk_bf16_f32 v148, v104, v105
 v_cvt_pk_bf16_f32 v149, v106, v107
 v_mfma_f32_16x16x32_bf16 a[116:119], a[188:191], v[152:155], a[116:119]
 ds_write_b128 v7, a[76:79] offset:3072
 v_cvt_pk_bf16_f32 v150, v108, v109
 v_mfma_f32_16x16x32_bf16 a[124:127], a[188:191], v[156:159], a[124:127]
 v_cvt_pk_bf16_f32 v151, v110, v111
 v_mfma_f32_16x16x32_bf16 v[240:243], a[136:139], v[144:147], v[240:243]
 s_nop 0
 v_mfma_f32_16x16x32_bf16 v[244:247], a[136:139], v[148:151], v[244:247]
 ds_write_b32 v251, a132 offset:3328
 v_mfma_f32_16x16x32_bf16 v[184:187], a[160:163], v[148:151], v[184:187]
 ds_write_b128 v7, a[80:83] offset:4096
 ds_read_b128 a[0:3], v4 offset:0
 v_mfma_f32_16x16x32_bf16 v[176:179], a[160:163], v[144:147], v[176:179]
 v_mfma_f32_16x16x32_bf16 v[180:183], a[164:167], v[144:147], v[180:183]
 ds_read_b128 a[4:7], v4 offset:5120
 v_mfma_f32_16x16x32_bf16 v[188:191], a[164:167], v[148:151], v[188:191]
 ds_write_b128 v7, a[88:91] offset:6144
 v_mfma_f32_16x16x32_bf16 v[200:203], a[168:171], v[148:151], v[200:203]
 ds_read_b128 a[8:11], v4 offset:1024
 v_mfma_f32_16x16x32_bf16 v[192:195], a[168:171], v[144:147], v[192:195]
 v_mfma_f32_16x16x32_bf16 v[196:199], a[172:175], v[144:147], v[196:199]
 ds_read_b128 a[12:15], v4 offset:6144
 v_mfma_f32_16x16x32_bf16 v[204:207], a[172:175], v[148:151], v[204:207]
 ds_write_b128 v7, a[84:87] offset:5120
 v_mfma_f32_16x16x32_bf16 v[216:219], a[176:179], v[148:151], v[216:219]
 ds_read_b128 a[16:19], v4 offset:2048
 v_mfma_f32_16x16x32_bf16 v[208:211], a[176:179], v[144:147], v[208:211]
 v_mfma_f32_16x16x32_bf16 v[212:215], a[180:183], v[144:147], v[212:215]
 ds_write_b128 v7, a[92:95] offset:7168
 ds_read_b128 a[20:23], v4 offset:7168
 v_mfma_f32_16x16x32_bf16 v[220:223], a[180:183], v[148:151], v[220:223]
 v_mfma_f32_16x16x32_bf16 v[232:235], a[184:187], v[148:151], v[232:235]
 ds_read_b128 a[24:27], v4 offset:3072
 v_mfma_f32_16x16x32_bf16 v[224:227], a[184:187], v[144:147], v[224:227]
 v_mfma_f32_16x16x32_bf16 v[228:231], a[188:191], v[144:147], v[228:231]
 ds_write_b128 v7, a[96:99] offset:8192
 ds_read_b128 a[28:31], v4 offset:8192
 v_mfma_f32_16x16x32_bf16 v[236:239], a[188:191], v[148:151], v[236:239]
 s_waitcnt lgkmcnt(6)
 v_mfma_f32_16x16x32_bf16 v[64:67], a[0:3], v[32:35], 0
 ds_read_b128 a[32:35], v4 offset:4096
 v_mfma_f32_16x16x32_bf16 v[68:71], a[0:3], v[36:39], 0
 ds_write_b128 v7, a[104:107] offset:10240
 v_mfma_f32_16x16x32_bf16 v[108:111], a[4:7], v[36:39], 0
 ds_read_b128 a[36:39], v4 offset:9216
 v_mfma_f32_16x16x32_bf16 v[104:107], a[4:7], v[32:35], 0
 v_mfma_f32_16x16x32_bf16 v[72:75], a[8:11], v[32:35], 0
 ds_read_b128 a[40:43], v4 offset:10240
 s_mov_b64 exec, 0
 s_cmp_eq_u32 s58, 0
 s_cbranch_scc1 L_pg15
 s_cmp_eq_u32 s58, 1
 s_cbranch_scc1 L_hopr4
 s_cmp_eq_u32 s58, 2
 s_cbranch_scc1 L_hopr4
 s_branch L_hopr4
L_hopr4:
 s_mov_b64 exec, -1
 s_waitcnt vmcnt(14)
 v_sub_u32 v28, v28, v0
 v_subrev_u32 v28, 6, v28
 v_cmp_ge_u32 vcc, 6, v28
 s_mov_b32 s79, 0
 s_cmp_eq_u64 vcc, -1
 s_cbranch_scc0 L_pl5
L_pd5:
 s_add_u32 s75, s91, s48
 v_mfma_f32_16x16x32_bf16 v[76:79], a[8:11], v[36:39], 0
 ds_write_b128 v7, a[100:103] offset:9216
 buffer_load_dwordx4 a[160:163], v2, s[20:23], s75 offen offset:0 sc1
 v_mfma_f32_16x16x32_bf16 v[116:119], a[12:15], v[36:39], 0
 ds_read_b128 a[44:47], v4 offset:15360
 v_mfma_f32_16x16x32_bf16 v[112:115], a[12:15], v[32:35], 0
 s_waitcnt lgkmcnt(6)
 v_mfma_f32_16x16x32_bf16 v[80:83], a[16:19], v[32:35], 0
 ds_write_b128 v7, a[108:111] offset:11264
 ds_read_b128 a[48:51], v4 offset:11264
 v_mfma_f32_16x16x32_bf16 v[84:87], a[16:19], v[36:39], 0
 v_mfma_f32_16x16x32_bf16 v[124:127], a[20:23], v[36:39], 0
 ds_read_b128 a[52:55], v4 offset:16384
 v_mfma_f32_16x16x32_bf16 v[120:123], a[20:23], v[32:35], 0
 buffer_load_dwordx4 a[164:167], v2, s[20:23], s75 offen offset:1024 sc1
 v_mfma_f32_16x16x32_bf16 v[88:91], a[24:27], v[32:35], 0
 ds_write_b128 v7, a[112:115] offset:12288
 ds_read_b128 a[56:59], v4 offset:12288
 v_mfma_f32_16x16x32_bf16 v[92:95], a[24:27], v[36:39], 0
 v_mfma_f32_16x16x32_bf16 v[132:135], a[28:31], v[36:39], 0
 ds_read_b128 a[60:63], v4 offset:17408
 v_mfma_f32_16x16x32_bf16 v[128:131], a[28:31], v[32:35], 0
 ds_write_b128 v7, a[120:123] offset:14336
 s_waitcnt lgkmcnt(7)
 v_mfma_f32_16x16x32_bf16 v[96:99], a[32:35], v[32:35], 0
 ds_read_b128 a[0:3], v4 offset:13312
 v_mfma_f32_16x16x32_bf16 v[100:103], a[32:35], v[36:39], 0
 buffer_load_dwordx4 a[168:171], v3, s[20:23], s75 offen offset:0 sc1
 v_mfma_f32_16x16x32_bf16 v[140:143], a[36:39], v[36:39], 0
 ds_read_b128 a[4:7], v4 offset:18432
 v_mfma_f32_16x16x32_bf16 v[136:139], a[36:39], v[32:35], 0
 ds_write_b128 v7, a[116:119] offset:13312
 v_mfma_f32_16x16x32_bf16 v[64:67], a[40:43], v[40:43], v[64:67]
 ds_read_b128 a[8:11], v4 offset:14336
 v_mfma_f32_16x16x32_bf16 v[68:71], a[40:43], v[44:47], v[68:71]
 v_mfma_f32_16x16x32_bf16 v[108:111], a[44:47], v[44:47], v[108:111]
 ds_write_b128 v7, a[124:127] offset:15360
 ds_read_b128 a[12:15], v4 offset:19456
 v_mfma_f32_16x16x32_bf16 v[104:107], a[44:47], v[40:43], v[104:107]
 buffer_load_dwordx4 a[172:175], v3, s[20:23], s75 offen offset:1024 sc1
 s_waitcnt lgkmcnt(6)
 v_mfma_f32_16x16x32_bf16 v[72:75], a[48:51], v[40:43], v[72:75]
 ds_read_b128 a[16:19], v4 offset:20480
 v_mfma_f32_16x16x32_bf16 v[76:79], a[48:51], v[44:47], v[76:79]
 v_mfma_f32_16x16x32_bf16 v[116:119], a[52:55], v[44:47], v[116:119]
 ds_read_b128 a[20:23], v4 offset:25600
 v_mfma_f32_16x16x32_bf16 v[112:115], a[52:55], v[40:43], v[112:115]
 v_mfma_f32_16x16x32_bf16 v[80:83], a[56:59], v[40:43], v[80:83]
 ds_read_b128 a[24:27], v4 offset:21504
 s_add_u32 s75, s75, 0x2000
 v_mfma_f32_16x16x32_bf16 v[84:87], a[56:59], v[44:47], v[84:87]
 buffer_load_dwordx4 a[176:179], v2, s[20:23], s75 offen offset:0 sc1
 v_mfma_f32_16x16x32_bf16 v[124:127], a[60:63], v[44:47], v[124:127]
 ds_read_b128 a[28:31], v4 offset:26624
 v_mfma_f32_16x16x32_bf16 v[120:123], a[60:63], v[40:43], v[120:123]
 s_waitcnt vmcnt(9)
 s_waitcnt lgkmcnt(0)
 s_barrier
 ds_read_b32 v241, v250 offset:3072
 ds_read_b32 v245, v250 offset:3328
 v_mfma_f32_16x16x32_bf16 v[88:91], a[0:3], v[40:43], v[88:91]
 ds_read_b128 a[32:35], v4 offset:22528
 v_mfma_f32_16x16x32_bf16 v[92:95], a[0:3], v[44:47], v[92:95]
 v_mfma_f32_16x16x32_bf16 v[132:135], a[4:7], v[44:47], v[132:135]
 ds_read_b128 a[36:39], v4 offset:27648
 v_mfma_f32_16x16x32_bf16 v[128:131], a[4:7], v[40:43], v[128:131]
 buffer_load_dwordx4 a[180:183], v2, s[20:23], s75 offen offset:1024 sc1
 v_mfma_f32_16x16x32_bf16 v[96:99], a[8:11], v[40:43], v[96:99]
 ds_read_b128 a[40:43], v4 offset:23552
 v_mfma_f32_16x16x32_bf16 v[100:103], a[8:11], v[44:47], v[100:103]
 s_waitcnt lgkmcnt(4)
 v_add_f32 v240, v240, v241
 s_waitcnt lgkmcnt(3)
 v_add_f32 v244, v244, v245
 v_add_f32 v242, v240, v244
 v_cmp_gt_f32 vcc, 0x5f800000, v242
 s_cmp_eq_u64 vcc, -1
 s_cbranch_scc0 L_slowH
L_slowHr:
 v_mfma_f32_16x16x32_bf16 v[140:143], a[12:15], v[44:47], v[140:143]
 ds_read_b128 a[44:47], v4 offset:28672
 v_mov_b32_e64 v7, v252
 v_mfma_f32_16x16x32_bf16 v[136:139], a[12:15], v[40:43], v[136:139]
 ds_read_b128 v[248:251], v24 offset:2048
 ds_read_b128 v[252:255], v24 offset:3072
 v_mfma_f32_16x16x32_bf16 v[64:67], a[16:19], v[48:51], v[64:67]
 ds_read_b128 a[48:51], v4 offset:24576
 v_mfma_f32_16x16x32_bf16 v[68:71], a[16:19], v[52:55], v[68:71]
 v_rcp_f32_e64 v30, v240
 buffer_load_dwordx4 a[184:187], v3, s[20:23], s75 offen offset:0 sc1
 v_mfma_f32_16x16x32_bf16 v[108:111], a[20:23], v[52:55], v[108:111]
 ds_read_b128 a[52:55], v4 offset:29696
 v_mfma_f32_16x16x32_bf16 v[104:107], a[20:23], v[48:51], v[104:107]
 v_rcp_f32_e64 v25, v244
 v_mfma_f32_16x16x32_bf16 v[72:75], a[24:27], v[48:51], v[72:75]
 ds_read_b128 a[56:59], v4 offset:30720
 ds_read_b128 v[240:243], v24 offset:0
 v_mfma_f32_16x16x32_bf16 v[76:79], a[24:27], v[52:55], v[76:79]
 ds_read_b128 v[244:247], v24 offset:1024
 v_mfma_f32_16x16x32_bf16 v[116:119], a[28:31], v[52:55], v[116:119]
 ds_read_b128 a[60:63], v4 offset:35840
 v_mfma_f32_16x16x32_bf16 v[112:115], a[28:31], v[48:51], v[112:115]
 buffer_load_dwordx4 a[188:191], v3, s[20:23], s75 offen offset:1024 sc1
 s_waitcnt lgkmcnt(6)
 v_mfma_f32_16x16x32_bf16 v[80:83], a[32:35], v[48:51], v[80:83]
 ds_read_b128 a[0:3], v4 offset:31744
 v_mfma_f32_16x16x32_bf16 v[84:87], a[32:35], v[52:55], v[84:87]
 v_add_f32 v184, v184, v248
 v_add_f32_e64 v185, v185, v249
 v_mfma_f32_16x16x32_bf16 v[124:127], a[36:39], v[52:55], v[124:127]
 ds_read_b128 a[4:7], v4 offset:36864
 v_add_f32_e64 v186, v186, v250
 v_mfma_f32_16x16x32_bf16 v[120:123], a[36:39], v[48:51], v[120:123]
 v_add_f32 v187, v187, v251
 v_add_f32 v188, v188, v252
 v_mfma_f32_16x16x32_bf16 v[88:91], a[40:43], v[48:51], v[88:91]
 ds_read_b128 a[8:11], v4 offset:32768
 v_add_f32 v189, v189, v253
 s_mov_b32 m0, s68
 v_mfma_f32_16x16x32_bf16 v[92:95], a[40:43], v[52:55], v[92:95]
 v_add_f32 v190, v190, v254
 v_add_f32 v191, v191, v255
 buffer_load_dwordx4 v2, s[16:19], s42 offen offset:3072 sc1 lds
 v_mfma_f32_16x16x32_bf16 v[132:135], a[44:47], v[52:55], v[132:135]
 ds_read_b128 a[12:15], v4 offset:37888
 ds_read_b128 v[248:251], v24 offset:6144
 v_mfma_f32_16x16x32_bf16 v[128:131], a[44:47], v[48:51], v[128:131]
 ds_read_b128 v[252:255], v24 offset:7168
 v_mul_f32 v184, v184, v25
 s_waitcnt lgkmcnt(6)
 v_mfma_f32_16x16x32_bf16 v[96:99], a[48:51], v[48:51], v[96:99]
 ds_read_b128 a[16:19], v4 offset:33792
 v_mul_f32_e64 v185, v185, v25
 v_mfma_f32_16x16x32_bf16 v[100:103], a[48:51], v[52:55], v[100:103]
 v_mul_f32 v186, v186, v25
 v_mul_f32 v187, v187, v25
 v_mfma_f32_16x16x32_bf16 v[140:143], a[52:55], v[52:55], v[140:143]
 ds_read_b128 a[20:23], v4 offset:38912
 v_mul_f32 v188, v188, v25
 s_add_u32 s75, s91, s49
 v_mfma_f32_16x16x32_bf16 v[136:139], a[52:55], v[48:51], v[136:139]
 v_mul_f32 v189, v189, v25
 v_mul_f32 v190, v190, v25
 buffer_load_dwordx4 a[64:67], v2, s[20:23], s75 offen offset:0 sc1
 v_mfma_f32_16x16x32_bf16 v[64:67], a[56:59], v[56:59], v[64:67]
 ds_read_b128 a[24:27], v4 offset:34816
 v_mul_f32_e64 v191, v191, v25
 v_mfma_f32_16x16x32_bf16 v[68:71], a[56:59], v[60:63], v[68:71]
 v_cvt_pk_bf16_f32 v184, v184, v185
 v_cvt_pk_bf16_f32 v185, v186, v187
 v_mfma_f32_16x16x32_bf16 v[108:111], a[60:63], v[60:63], v[108:111]
 ds_read_b128 a[28:31], v4 offset:39936
 v_cvt_pk_bf16_f32 v186, v188, v189
 v_mfma_f32_16x16x32_bf16 v[104:107], a[60:63], v[56:59], v[104:107]
 v_cvt_pk_bf16_f32 v187, v190, v191
 buffer_store_dwordx4 v[184:187], v2, s[20:23], s96 offen offset:1024 sc1
 s_waitcnt lgkmcnt(4)
 v_mfma_f32_16x16x32_bf16 v[72:75], a[0:3], v[56:59], v[72:75]
 ds_read_b128 a[32:35], v4 offset:0
 v_add_f32 v176, v176, v240
 v_mfma_f32_16x16x32_bf16 v[76:79], a[0:3], v[60:63], v[76:79]
 v_add_f32 v177, v177, v241
 v_add_f32 v178, v178, v242
 buffer_load_dwordx4 a[68:71], v2, s[20:23], s75 offen offset:1024 sc1
 v_mfma_f32_16x16x32_bf16 v[116:119], a[4:7], v[60:63], v[116:119]
 ds_read_b128 a[36:39], v4 offset:5120
 v_add_f32_e64 v179, v179, v243
 v_mfma_f32_16x16x32_bf16 v[112:115], a[4:7], v[56:59], v[112:115]
 v_add_f32 v180, v180, v244
 v_add_f32 v181, v181, v245
 v_mfma_f32_16x16x32_bf16 v[80:83], a[8:11], v[56:59], v[80:83]
 ds_read_b128 a[40:43], v4 offset:1024
 v_add_f32_e64 v182, v182, v246
 v_mfma_f32_16x16x32_bf16 v[84:87], a[8:11], v[60:63], v[84:87]
 v_add_f32_e64 v183, v183, v247
 ds_read_b128 v[240:243], v24 offset:4096
 v_mfma_f32_16x16x32_bf16 v[124:127], a[12:15], v[60:63], v[124:127]
 ds_read_b128 a[44:47], v4 offset:6144
 ds_read_b128 v[244:247], v24 offset:5120
 v_mfma_f32_16x16x32_bf16 v[120:123], a[12:15], v[56:59], v[120:123]
 v_mul_f32 v176, v176, v30
 v_mul_f32 v177, v177, v30
 buffer_load_dwordx4 a[72:75], v3, s[20:23], s75 offen offset:0 sc1
 s_waitcnt lgkmcnt(6)
 v_mfma_f32_16x16x32_bf16 v[88:91], a[16:19], v[56:59], v[88:91]
 ds_read_b128 a[48:51], v4 offset:2048
 v_mul_f32 v178, v178, v30
 v_mfma_f32_16x16x32_bf16 v[92:95], a[16:19], v[60:63], v[92:95]
 v_mul_f32 v179, v179, v30
 v_mul_f32 v180, v180, v30
 v_mfma_f32_16x16x32_bf16 v[132:135], a[20:23], v[60:63], v[132:135]
 ds_read_b128 a[52:55], v4 offset:7168
 v_mul_f32_e64 v181, v181, v30
 v_mfma_f32_16x16x32_bf16 v[128:131], a[20:23], v[56:59], v[128:131]
 v_mul_f32 v182, v182, v30
 v_mul_f32 v183, v183, v30
 v_mfma_f32_16x16x32_bf16 v[96:99], a[24:27], v[56:59], v[96:99]
 ds_read_b128 a[56:59], v4 offset:3072
 v_cvt_pk_bf16_f32 v176, v176, v177
 v_mfma_f32_16x16x32_bf16 v[100:103], a[24:27], v[60:63], v[100:103]
 v_cvt_pk_bf16_f32 v177, v178, v179
 v_cvt_pk_bf16_f32 v178, v180, v181
 buffer_load_dwordx4 a[76:79], v3, s[20:23], s75 offen offset:1024 sc1
 v_mfma_f32_16x16x32_bf16 v[140:143], a[28:31], v[60:63], v[140:143]
 ds_read_b128 a[60:63], v4 offset:8192
 v_cvt_pk_bf16_f32 v179, v182, v183
 v_mfma_f32_16x16x32_bf16 v[136:139], a[28:31], v[56:59], v[136:139]
 buffer_store_dwordx4 v[176:179], v2, s[20:23], s96 offen offset:0 sc1
 v_add_f32 v200, v200, v248
 s_waitcnt lgkmcnt(4)
 v_mfma_f32_16x16x32_bf16 v[32:35], a[32:35], v[176:179], 0
 ds_read_b128 a[0:3], v4 offset:4096
 v_add_f32_e64 v201, v201, v249
 v_mfma_f32_16x16x32_bf16 v[36:39], a[32:35], v[184:187], 0
 v_add_f32 v202, v202, v250
 v_add_f32 v203, v203, v251
 v_mfma_f32_16x16x32_bf16 v[156:159], a[36:39], v[184:187], 0
 ds_read_b128 a[4:7], v4 offset:9216
 v_add_f32_e64 v204, v204, v252
 s_add_u32 s75, s75, 0x2000
 v_mfma_f32_16x16x32_bf16 v[152:155], a[36:39], v[176:179], 0
 v_add_f32 v205, v205, v253
 v_add_f32 v206, v206, v254
 buffer_load_dwordx4 a[80:83], v2, s[20:23], s75 offen offset:0 sc1
 v_mfma_f32_16x16x32_bf16 v[40:43], a[40:43], v[176:179], 0
 ds_read_b128 a[8:11], v4 offset:40960
 v_add_f32_e64 v207, v207, v255
 v_mfma_f32_16x16x32_bf16 v[44:47], a[40:43], v[184:187], 0
 ds_read_b128 v[248:251], v24 offset:10240
 ds_read_b128 v[252:255], v24 offset:11264
 v_mfma_f32_16x16x32_bf16 v[164:167], a[44:47], v[184:187], 0
 ds_read_b128 a[12:15], v4 offset:46080
 v_mul_f32_e64 v200, v200, v25
 v_mfma_f32_16x16x32_bf16 v[160:163], a[44:47], v[176:179], 0
 v_mul_f32 v201, v201, v25
 v_mul_f32 v202, v202, v25
 s_waitcnt lgkmcnt(6)
 v_mfma_f32_16x16x32_bf16 v[48:51], a[48:51], v[176:179], 0
 ds_read_b128 a[16:19], v4 offset:41984
 v_mul_f32 v203, v203, v25
 v_mfma_f32_16x16x32_bf16 v[52:55], a[48:51], v[184:187], 0
 v_mul_f32 v204, v204, v25
 v_mul_f32 v205, v205, v25
 buffer_load_dwordx4 a[84:87], v2, s[20:23], s75 offen offset:1024 sc1
 v_mfma_f32_16x16x32_bf16 v[172:175], a[52:55], v[184:187], 0
 ds_read_b128 a[20:23], v4 offset:47104
 v_mul_f32_e64 v206, v206, v25
 v_mfma_f32_16x16x32_bf16 v[168:171], a[52:55], v[176:179], 0
 v_mul_f32_e64 v207, v207, v25
 v_cvt_pk_bf16_f32 v200, v200, v201
 v_mfma_f32_16x16x32_bf16 v[56:59], a[56:59], v[176:179], 0
 ds_read_b128 a[24:27], v4 offset:43008
 v_cvt_pk_bf16_f32 v201, v202, v203
 v_mfma_f32_16x16x32_bf16 v[60:63], a[56:59], v[184:187], 0
 v_cvt_pk_bf16_f32 v202, v204, v205
 v_cvt_pk_bf16_f32 v203, v206, v207
 v_mfma_f32_16x16x32_bf16 v[12:15], a[60:63], v[184:187], 0
 ds_read_b128 a[28:31], v4 offset:48128
 buffer_store_dwordx4 v[200:203], v3, s[20:23], s96 offen offset:1024 sc1
 v_mfma_f32_16x16x32_bf16 v[8:11], a[60:63], v[176:179], 0
 v_add_f32 v192, v192, v240
 v_add_f32 v193, v193, v241
 s_waitcnt lgkmcnt(4)
 v_mfma_f32_16x16x32_bf16 v[144:147], a[0:3], v[176:179], 0
 ds_read_b128 a[32:35], v4 offset:44032
 v_add_f32 v194, v194, v242
 buffer_load_dwordx4 a[88:91], v3, s[20:23], s75 offen offset:0 sc1
 v_mfma_f32_16x16x32_bf16 v[148:151], a[0:3], v[184:187], 0
 v_add_f32 v195, v195, v243
 v_add_f32 v196, v196, v244
 v_mfma_f32_16x16x32_bf16 v[20:23], a[4:7], v[184:187], 0
 ds_read_b128 a[36:39], v4 offset:49152
 v_add_f32_e64 v197, v197, v245
 v_mfma_f32_16x16x32_bf16 v[16:19], a[4:7], v[176:179], 0
 v_add_f32 v198, v198, v246
 v_add_f32 v199, v199, v247
 s_waitcnt vmcnt(18)
 v_mfma_f32_16x16x32_bf16 v[64:67], a[8:11], a[160:163], v[64:67]
 ds_read_b128 a[40:43], v4 offset:45056
 ds_read_b128 v[240:243], v24 offset:8192
 s_waitcnt vmcnt(17)
 v_mfma_f32_16x16x32_bf16 v[68:71], a[8:11], a[164:167], v[68:71]
 ds_read_b128 v[244:247], v24 offset:9216
 v_mul_f32_e64 v192, v192, v30
 v_mfma_f32_16x16x32_bf16 v[108:111], a[12:15], a[164:167], v[108:111]
 ds_read_b128 a[44:47], v4 offset:50176
 v_mul_f32_e64 v193, v193, v30
 buffer_load_dwordx4 a[92:95], v3, s[20:23], s75 offen offset:1024 sc1
 v_mfma_f32_16x16x32_bf16 v[104:107], a[12:15], a[160:163], v[104:107]
 v_mul_f32 v194, v194, v30
 v_mul_f32 v195, v195, v30
 s_waitcnt lgkmcnt(6)
 v_mfma_f32_16x16x32_bf16 v[72:75], a[16:19], a[160:163], v[72:75]
 ds_read_b128 a[48:51], v4 offset:51200
 v_mul_f32 v196, v196, v30
 v_mfma_f32_16x16x32_bf16 v[76:79], a[16:19], a[164:167], v[76:79]
 v_mul_f32 v197, v197, v30
 v_mul_f32 v198, v198, v30
 v_mfma_f32_16x16x32_bf16 v[116:119], a[20:23], a[164:167], v[116:119]
 ds_read_b128 a[52:55], v4 offset:56320
 v_mul_f32_e64 v199, v199, v30
 v_mfma_f32_16x16x32_bf16 v[112:115], a[20:23], a[160:163], v[112:115]
 v_cvt_pk_bf16_f32 v192, v192, v193
 v_cvt_pk_bf16_f32 v193, v194, v195
 v_mfma_f32_16x16x32_bf16 v[80:83], a[24:27], a[160:163], v[80:83]
 ds_read_b128 a[56:59], v4 offset:52224
 v_cvt_pk_bf16_f32 v194, v196, v197
 v_mfma_f32_16x16x32_bf16 v[84:87], a[24:27], a[164:167], v[84:87]
 v_cvt_pk_bf16_f32 v195, v198, v199
 buffer_store_dwordx4 v[192:195], v3, s[20:23], s96 offen offset:0 sc1
 v_mfma_f32_16x16x32_bf16 v[124:127], a[28:31], a[164:167], v[124:127]
 ds_read_b128 a[60:63], v4 offset:57344
 v_add_f32 v216, v216, v248
 s_add_u32 m0, s67, 0
 v_mfma_f32_16x16x32_bf16 v[120:123], a[28:31], a[160:163], v[120:123]
 v_add_f32 v217, v217, v249
 v_add_f32 v218, v218, v250
 buffer_load_dwordx4 v3, s[16:19], s42 offen offset:0 sc1 lds
 s_waitcnt lgkmcnt(4)
 v_mfma_f32_16x16x32_bf16 v[88:91], a[32:35], a[160:163], v[88:91]
 ds_read_b128 a[0:3], v4 offset:53248
 v_add_f32 v219, v219, v251
 v_mfma_f32_16x16x32_bf16 v[92:95], a[32:35], a[164:167], v[92:95]
 v_add_f32 v220, v220, v252
 v_add_f32 v221, v221, v253
 v_mfma_f32_16x16x32_bf16 v[132:135], a[36:39], a[164:167], v[132:135]
 ds_read_b128 a[4:7], v4 offset:58368
 v_add_f32_e64 v222, v222, v254
 v_mfma_f32_16x16x32_bf16 v[128:131], a[36:39], a[160:163], v[128:131]
 v_add_f32_e64 v223, v223, v255
 ds_read_b128 v[248:251], v24 offset:14336
 v_mfma_f32_16x16x32_bf16 v[96:99], a[40:43], a[160:163], v[96:99]
 ds_read_b128 a[8:11], v4 offset:54272
 ds_read_b128 v[252:255], v24 offset:15360
 v_mfma_f32_16x16x32_bf16 v[100:103], a[40:43], a[164:167], v[100:103]
 v_mul_f32 v216, v216, v25
 v_mul_f32 v217, v217, v25
 buffer_load_dwordx4 v3, s[16:19], s42 offen offset:1024 sc1 lds
 v_mfma_f32_16x16x32_bf16 v[140:143], a[44:47], a[164:167], v[140:143]
 ds_read_b128 a[12:15], v4 offset:59392
 v_mul_f32_e64 v218, v218, v25
 v_mfma_f32_16x16x32_bf16 v[136:139], a[44:47], a[160:163], v[136:139]
 v_mul_f32 v219, v219, v25
 v_mul_f32 v220, v220, v25
 s_waitcnt vmcnt(20) lgkmcnt(6)
 v_mfma_f32_16x16x32_bf16 v[64:67], a[48:51], a[168:171], v[64:67]
 ds_read_b128 a[16:19], v4 offset:55296
 v_mul_f32 v221, v221, v25
 s_waitcnt vmcnt(19)
 v_mfma_f32_16x16x32_bf16 v[68:71], a[48:51], a[172:175], v[68:71]
 v_mul_f32 v222, v222, v25
 v_mul_f32_e64 v223, v223, v25
 v_mfma_f32_16x16x32_bf16 v[108:111], a[52:55], a[172:175], v[108:111]
 ds_read_b128 a[20:23], v4 offset:60416
 v_cvt_pk_bf16_f32 v216, v216, v217
 v_mfma_f32_16x16x32_bf16 v[104:107], a[52:55], a[168:171], v[104:107]
 v_cvt_pk_bf16_f32 v217, v218, v219
 v_cvt_pk_bf16_f32 v218, v220, v221
 buffer_load_dwordx4 v3, s[16:19], s42 offen offset:2048 sc1 lds
 v_mfma_f32_16x16x32_bf16 v[72:75], a[56:59], a[168:171], v[72:75]
 ds_read_b128 a[24:27], v4 offset:10240
 v_cvt_pk_bf16_f32 v219, v222, v223
 v_mfma_f32_16x16x32_bf16 v[76:79], a[56:59], a[172:175], v[76:79]
 s_add_u32 s77, s96, 0x2000
 buffer_store_dwordx4 v[216:219], v2, s[20:23], s77 offen offset:1024 sc1
 v_mfma_f32_16x16x32_bf16 v[116:119], a[60:63], a[172:175], v[116:119]
 ds_read_b128 a[28:31], v4 offset:15360
 v_add_f32_e64 v208, v208, v240
 v_mfma_f32_16x16x32_bf16 v[112:115], a[60:63], a[168:171], v[112:115]
 v_add_f32 v209, v209, v241
 v_add_f32 v210, v210, v242
 s_waitcnt lgkmcnt(4)
 v_mfma_f32_16x16x32_bf16 v[80:83], a[0:3], a[168:171], v[80:83]
 ds_read_b128 a[32:35], v4 offset:11264
 v_add_f32 v211, v211, v243
 v_mfma_f32_16x16x32_bf16 v[84:87], a[0:3], a[172:175], v[84:87]
 v_add_f32 v212, v212, v244
 v_add_f32 v213, v213, v245
 buffer_load_dwordx4 v3, s[16:19], s42 offen offset:3072 sc1 lds
 v_mfma_f32_16x16x32_bf16 v[124:127], a[4:7], a[172:175], v[124:127]
 ds_read_b128 a[36:39], v4 offset:16384
 v_add_f32_e64 v214, v214, v246
 v_mfma_f32_16x16x32_bf16 v[120:123], a[4:7], a[168:171], v[120:123]
 v_add_f32_e64 v215, v215, v247
 ds_read_b128 v[240:243], v24 offset:12288
 v_mfma_f32_16x16x32_bf16 v[88:91], a[8:11], a[168:171], v[88:91]
 ds_read_b128 a[40:43], v4 offset:12288
 ds_read_b128 v[244:247], v24 offset:13312
 v_mfma_f32_16x16x32_bf16 v[92:95], a[8:11], a[172:175], v[92:95]
 v_mul_f32 v208, v208, v30
 v_mul_f32 v209, v209, v30
 v_mfma_f32_16x16x32_bf16 v[132:135], a[12:15], a[172:175], v[132:135]
 ds_read_b128 a[44:47], v4 offset:17408
 v_mul_f32_e64 v210, v210, v30
 s_add_u32 m0, s67, 4096
 v_mfma_f32_16x16x32_bf16 v[128:131], a[12:15], a[168:171], v[128:131]
 v_mul_f32 v211, v211, v30
 v_mul_f32 v212, v212, v30
 buffer_load_dwordx4 v6, s[16:19], s42 offen offset:0 sc1 lds
 s_waitcnt lgkmcnt(6)
 v_mfma_f32_16x16x32_bf16 v[96:99], a[16:19], a[168:171], v[96:99]
 ds_read_b128 a[48:51], v4 offset:13312
 v_mul_f32 v213, v213, v30
 v_mfma_f32_16x16x32_bf16 v[100:103], a[16:19], a[172:175], v[100:103]
 v_mul_f32 v214, v214, v30
 v_mul_f32 v215, v215, v30
 v_mfma_f32_16x16x32_bf16 v[140:143], a[20:23], a[172:175], v[140:143]
 ds_read_b128 a[52:55], v4 offset:18432
 v_cvt_pk_bf16_f32 v208, v208, v209
 v_mfma_f32_16x16x32_bf16 v[136:139], a[20:23], a[168:171], v[136:139]
 v_cvt_pk_bf16_f32 v209, v210, v211
 v_cvt_pk_bf16_f32 v210, v212, v213
 v_mfma_f32_16x16x32_bf16 v[32:35], a[24:27], v[192:195], v[32:35]
 ds_read_b128 a[56:59], v4 offset:14336
 v_cvt_pk_bf16_f32 v211, v214, v215
 v_mfma_f32_16x16x32_bf16 v[36:39], a[24:27], v[200:203], v[36:39]
 buffer_store_dwordx4 v[208:211], v2, s[20:23], s77 offen offset:0 sc1
 v_add_f32_e64 v232, v232, v248
 v_mfma_f32_16x16x32_bf16 v[156:159], a[28:31], v[200:203], v[156:159]
 ds_read_b128 a[60:63], v4 offset:19456
 v_add_f32_e64 v233, v233, v249
 v_mfma_f32_16x16x32_bf16 v[152:155], a[28:31], v[192:195], v[152:155]
 v_add_f32 v234, v234, v250
 v_add_f32 v235, v235, v251
 buffer_load_dwordx4 v6, s[16:19], s42 offen offset:1024 sc1 lds
 s_waitcnt lgkmcnt(4)
 v_mfma_f32_16x16x32_bf16 v[40:43], a[32:35], v[192:195], v[40:43]
 ds_read_b128 a[0:3], v4 offset:61440
 v_add_f32 v236, v236, v252
 v_mfma_f32_16x16x32_bf16 v[44:47], a[32:35], v[200:203], v[44:47]
 v_add_f32 v237, v237, v253
 v_add_f32 v238, v238, v254
 v_mfma_f32_16x16x32_bf16 v[164:167], a[36:39], v[200:203], v[164:167]
 ds_read_b128 a[4:7], v5 offset:1024
 v_add_f32_e64 v239, v239, v255
 v_mfma_f32_16x16x32_bf16 v[160:163], a[36:39], v[192:195], v[160:163]
 v_mul_f32 v232, v232, v25
 v_mul_f32 v233, v233, v25
 v_mfma_f32_16x16x32_bf16 v[48:51], a[40:43], v[192:195], v[48:51]
 ds_read_b128 a[8:11], v4 offset:62464
 v_mul_f32_e64 v234, v234, v25
 s_add_u32 m0, s67, 6144
 v_mfma_f32_16x16x32_bf16 v[52:55], a[40:43], v[200:203], v[52:55]
 v_mul_f32 v235, v235, v25
 v_mul_f32 v236, v236, v25
 buffer_load_dwordx4 v2, s[16:19], s43 offen offset:0 sc1 lds
 v_mfma_f32_16x16x32_bf16 v[172:175], a[44:47], v[200:203], v[172:175]
L_pg15:
 s_cbranch_execz L_hopr4
 ds_read_b128 a[12:15], v5 offset:2048
 v_mul_f32 v237, v237, v25
 v_mfma_f32_16x16x32_bf16 v[168:171], a[44:47], v[192:195], v[168:171]
 v_mul_f32 v238, v238, v25
 v_mul_f32 v239, v239, v25
 s_waitcnt lgkmcnt(4)
 v_mfma_f32_16x16x32_bf16 v[56:59], a[48:51], v[192:195], v[56:59]
 ds_read_b128 a[16:19], v4 offset:63488
 v_cvt_pk_bf16_f32 v232, v232, v233
 v_mfma_f32_16x16x32_bf16 v[60:63], a[48:51], v[200:203], v[60:63]
 v_cvt_pk_bf16_f32 v233, v234, v235
 v_cvt_pk_bf16_f32 v234, v236, v237
 v_mfma_f32_16x16x32_bf16 v[12:15], a[52:55], v[200:203], v[12:15]
 ds_read_b128 a[20:23], v5 offset:3072
 v_cvt_pk_bf16_f32 v235, v238, v239
 v_mfma_f32_16x16x32_bf16 v[8:11], a[52:55], v[192:195], v[8:11]
 buffer_store_dwordx4 v[232:235], v3, s[20:23], s77 offen offset:1024 sc1
 v_add_f32 v224, v224, v240
 v_mfma_f32_16x16x32_bf16 v[144:147], a[56:59], v[192:195], v[144:147]
 ds_read_b128 a[24:27], v4 offset:64512
 v_add_f32_e64 v225, v225, v241
 v_mfma_f32_16x16x32_bf16 v[148:151], a[56:59], v[200:203], v[148:151]
 v_add_f32 v226, v226, v242
 v_add_f32 v227, v227, v243
 buffer_load_dwordx4 v2, s[16:19], s43 offen offset:1024 sc1 lds
 v_mfma_f32_16x16x32_bf16 v[20:23], a[60:63], v[200:203], v[20:23]
 ds_read_b128 a[28:31], v5 offset:4096
 v_add_f32_e64 v228, v228, v244
 v_mfma_f32_16x16x32_bf16 v[16:19], a[60:63], v[192:195], v[16:19]
 v_add_f32 v229, v229, v245
 v_add_f32 v230, v230, v246
 s_waitcnt vmcnt(27) lgkmcnt(4)
 v_mfma_f32_16x16x32_bf16 v[64:67], a[0:3], a[176:179], v[64:67]
 ds_read_b128 a[32:35], v5 offset:0
 v_add_f32 v231, v231, v247
 s_waitcnt vmcnt(26)
 v_mfma_f32_16x16x32_bf16 v[68:71], a[0:3], a[180:183], v[68:71]
 v_mul_f32 v224, v224, v30
 v_mul_f32_e64 v225, v225, v30
 v_mfma_f32_16x16x32_bf16 v[108:111], a[4:7], a[180:183], v[108:111]
 ds_read_b128 a[36:39], v5 offset:5120
 v_mul_f32_e64 v226, v226, v30
 v_mfma_f32_16x16x32_bf16 v[104:107], a[4:7], a[176:179], v[104:107]
 v_mul_f32 v227, v227, v30
 v_mul_f32 v228, v228, v30
 buffer_load_dwordx4 v2, s[16:19], s43 offen offset:2048 sc1 lds
 v_mfma_f32_16x16x32_bf16 v[72:75], a[8:11], a[176:179], v[72:75]
 ds_read_b128 a[40:43], v5 offset:6144
 v_mul_f32_e64 v229, v229, v30
 v_mfma_f32_16x16x32_bf16 v[76:79], a[8:11], a[180:183], v[76:79]
 v_mul_f32 v230, v230, v30
 v_mul_f32 v231, v231, v30
 v_mfma_f32_16x16x32_bf16 v[116:119], a[12:15], a[180:183], v[116:119]
 ds_read_b128 a[44:47], v5 offset:11264
 v_cvt_pk_bf16_f32 v224, v224, v225
 v_mfma_f32_16x16x32_bf16 v[112:115], a[12:15], a[176:179], v[112:115]
 v_cvt_pk_bf16_f32 v225, v226, v227
 v_cvt_pk_bf16_f32 v226, v228, v229
 s_waitcnt lgkmcnt(4)
 v_mfma_f32_16x16x32_bf16 v[80:83], a[16:19], a[176:179], v[80:83]
 ds_read_b128 a[48:51], v5 offset:7168
 v_cvt_pk_bf16_f32 v227, v230, v231
 v_mfma_f32_16x16x32_bf16 v[84:87], a[16:19], a[180:183], v[84:87]
 buffer_store_dwordx4 v[224:227], v3, s[20:23], s77 offen offset:0 sc1
 v_mfma_f32_16x16x32_bf16 v[124:127], a[20:23], a[180:183], v[124:127]
 ds_read_b128 a[52:55], v5 offset:12288
 s_andn2_b32 s74, s2, 7
 v_mfma_f32_16x16x32_bf16 v[120:123], a[20:23], a[176:179], v[120:123]
 buffer_load_dwordx4 v2, s[16:19], s43 offen offset:3072 sc1 lds
 s_add_u32 s74, s74, s58
 v_mfma_f32_16x16x32_bf16 v[88:91], a[24:27], a[176:179], v[88:91]
 ds_read_b128 a[56:59], v5 offset:8192
 s_add_u32 s74, s74, s58
 v_mfma_f32_16x16x32_bf16 v[92:95], a[24:27], a[180:183], v[92:95]
 s_mul_i32 s74, s74, 80
 s_and_b32 s47, s2, 7
 v_mfma_f32_16x16x32_bf16 v[132:135], a[28:31], a[180:183], v[132:135]
 ds_read_b128 a[60:63], v5 offset:13312
 s_add_u32 s74, s74, s47
 v_mfma_f32_16x16x32_bf16 v[128:131], a[28:31], a[176:179], v[128:131]
 s_lshl_b32 s47, s74, 10
 s_waitcnt lgkmcnt(4)
 v_mfma_f32_16x16x32_bf16 v[96:99], a[32:35], a[176:179], v[96:99]
 ds_read_b128 a[0:3], v5 offset:9216
 s_add_u32 m0, s67, 10240
 v_mfma_f32_16x16x32_bf16 v[100:103], a[32:35], a[180:183], v[100:103]
 buffer_load_dwordx4 v3, s[16:19], s43 offen offset:0 sc1 lds
 v_mfma_f32_16x16x32_bf16 v[140:143], a[36:39], a[180:183], v[140:143]
 ds_read_b128 a[4:7], v5 offset:14336
 v_mfma_f32_16x16x32_bf16 v[136:139], a[36:39], a[176:179], v[136:139]
 s_add_u32 s80, s56, 0x4800000
 s_addc_u32 s81, s57, 0
 s_waitcnt vmcnt(29)
 v_mfma_f32_16x16x32_bf16 v[64:67], a[40:43], a[184:187], v[64:67]
 ds_read_b128 a[8:11], v5 offset:10240
 s_mov_b32 s82, 0x1400000
 s_waitcnt vmcnt(28)
 v_mfma_f32_16x16x32_bf16 v[68:71], a[40:43], a[188:191], v[68:71]
 s_mov_b32 s83, 0x00020000
 v_mfma_f32_16x16x32_bf16 v[108:111], a[44:47], a[188:191], v[108:111]
 ds_read_b128 a[12:15], v5 offset:15360
 v_mfma_f32_16x16x32_bf16 v[104:107], a[44:47], a[184:187], v[104:107]
 buffer_load_dwordx4 v3, s[16:19], s43 offen offset:1024 sc1 lds
 s_waitcnt lgkmcnt(4)
 v_mfma_f32_16x16x32_bf16 v[72:75], a[48:51], a[184:187], v[72:75]
 ds_read_b128 a[16:19], v4 offset:20480
 v_mfma_f32_16x16x32_bf16 v[76:79], a[48:51], a[188:191], v[76:79]
 v_mfma_f32_16x16x32_bf16 v[116:119], a[52:55], a[188:191], v[116:119]
 ds_read_b128 a[20:23], v4 offset:25600
 v_mfma_f32_16x16x32_bf16 v[112:115], a[52:55], a[184:187], v[112:115]
 v_mfma_f32_16x16x32_bf16 v[80:83], a[56:59], a[184:187], v[80:83]
 ds_read_b128 a[24:27], v4 offset:21504
 v_mfma_f32_16x16x32_bf16 v[84:87], a[56:59], a[188:191], v[84:87]
 buffer_load_dwordx4 v3, s[16:19], s43 offen offset:2048 sc1 lds
 v_mfma_f32_16x16x32_bf16 v[124:127], a[60:63], a[188:191], v[124:127]
 ds_read_b128 a[28:31], v4 offset:26624
 v_mfma_f32_16x16x32_bf16 v[120:123], a[60:63], a[184:187], v[120:123]
 s_waitcnt lgkmcnt(4)
 v_mfma_f32_16x16x32_bf16 v[88:91], a[0:3], a[184:187], v[88:91]
 ds_read_b128 a[32:35], v4 offset:22528
 v_mfma_f32_16x16x32_bf16 v[92:95], a[0:3], a[188:191], v[92:95]
 v_mfma_f32_16x16x32_bf16 v[132:135], a[4:7], a[188:191], v[132:135]
 ds_read_b128 a[36:39], v4 offset:27648
 v_mfma_f32_16x16x32_bf16 v[128:131], a[4:7], a[184:187], v[128:131]
 buffer_load_dwordx4 v3, s[16:19], s43 offen offset:3072 sc1 lds
 v_mfma_f32_16x16x32_bf16 v[96:99], a[8:11], a[184:187], v[96:99]
 ds_read_b128 a[40:43], v4 offset:23552
 v_mfma_f32_16x16x32_bf16 v[100:103], a[8:11], a[188:191], v[100:103]
 v_mfma_f32_16x16x32_bf16 v[140:143], a[12:15], a[188:191], v[140:143]
 ds_read_b128 a[44:47], v4 offset:28672
 v_mfma_f32_16x16x32_bf16 v[136:139], a[12:15], a[184:187], v[136:139]
 s_waitcnt lgkmcnt(4)
 v_mfma_f32_16x16x32_bf16 v[32:35], a[16:19], v[208:211], v[32:35]
 ds_read_b128 a[48:51], v4 offset:24576
 s_add_u32 m0, s67, 14336
 v_mfma_f32_16x16x32_bf16 v[36:39], a[16:19], v[216:219], v[36:39]
 buffer_load_dwordx4 v6, s[16:19], s43 offen offset:0 sc1 lds
 v_mfma_f32_16x16x32_bf16 v[156:159], a[20:23], v[216:219], v[156:159]
 ds_read_b128 a[52:55], v4 offset:29696
 v_mfma_f32_16x16x32_bf16 v[152:155], a[20:23], v[208:211], v[152:155]
 v_mfma_f32_16x16x32_bf16 v[40:43], a[24:27], v[208:211], v[40:43]
 ds_read_b128 a[56:59], v4 offset:30720
 v_mfma_f32_16x16x32_bf16 v[44:47], a[24:27], v[216:219], v[44:47]
 v_mfma_f32_16x16x32_bf16 v[164:167], a[28:31], v[216:219], v[164:167]
 ds_read_b128 a[60:63], v4 offset:35840
 v_mfma_f32_16x16x32_bf16 v[160:163], a[28:31], v[208:211], v[160:163]
 buffer_load_dwordx4 v6, s[16:19], s43 offen offset:1024 sc1 lds
 s_waitcnt lgkmcnt(4)
 v_mfma_f32_16x16x32_bf16 v[48:51], a[32:35], v[208:211], v[48:51]
 ds_read_b128 a[0:3], v4 offset:31744
 s_mul_i32 s41, s2, 10
 v_mfma_f32_16x16x32_bf16 v[52:55], a[32:35], v[216:219], v[52:55]
 s_add_u32 s40, s41, s58
 s_lshl_b32 s40, s40, 13
 v_mfma_f32_16x16x32_bf16 v[172:175], a[36:39], v[216:219], v[172:175]
 ds_read_b128 a[4:7], v4 offset:36864
 s_mul_i32 s55, s46, 5
 v_mfma_f32_16x16x32_bf16 v[168:171], a[36:39], v[208:211], v[168:171]
 s_add_u32 s55, s55, s58
 s_lshl_b32 s55, s55, 5
 v_mfma_f32_16x16x32_bf16 v[56:59], a[40:43], v[208:211], v[56:59]
 ds_read_b128 a[8:11], v4 offset:32768
 s_add_u32 s75, s91, s50
 v_mfma_f32_16x16x32_bf16 v[60:63], a[40:43], v[216:219], v[60:63]
 buffer_load_dwordx4 a[96:99], v2, s[20:23], s75 offen offset:0 sc1
 s_mul_i32 s42, s44, 20480
 v_mfma_f32_16x16x32_bf16 v[12:15], a[44:47], v[216:219], v[12:15]
 ds_read_b128 a[12:15], v4 offset:37888
 s_mul_i32 s43, s45, 20480
 v_mfma_f32_16x16x32_bf16 v[8:11], a[44:47], v[208:211], v[8:11]
 s_add_u32 s42, s42, s55
 s_add_u32 s43, s43, s55
 s_waitcnt lgkmcnt(4)
 v_mfma_f32_16x16x32_bf16 v[144:147], a[48:51], v[208:211], v[144:147]
 ds_read_b128 a[16:19], v4 offset:33792
 s_add_u32 s55, s42, 32
 v_mfma_f32_16x16x32_bf16 v[148:151], a[48:51], v[216:219], v[148:151]
 s_cmp_eq_u32 s58, 3
 s_cselect_b32 s43, s55, s43
 s_cselect_b32 s55, 1, 5
 v_mfma_f32_16x16x32_bf16 v[20:23], a[52:55], v[216:219], v[20:23]
 ds_read_b128 a[20:23], v4 offset:38912
 s_lshl_b32 s55, s55, 13
 v_mfma_f32_16x16x32_bf16 v[16:19], a[52:55], v[208:211], v[16:19]
 buffer_load_dwordx4 a[100:103], v2, s[20:23], s75 offen offset:1024 sc1
 s_add_u32 s41, s40, s55
 v_mfma_f32_16x16x32_bf16 v[32:35], a[56:59], v[224:227], v[32:35]
 ds_read_b128 a[24:27], v4 offset:34816
 v_lshrrev_b32 v253, 2, v1
 v_mfma_f32_16x16x32_bf16 v[36:39], a[56:59], v[232:235], v[36:39]
 v_mul_u32_u24 v6, 1280, v253
 v_and_b32_e64 v24, 3, v1
 v_mfma_f32_16x16x32_bf16 v[156:159], a[60:63], v[232:235], v[156:159]
 ds_read_b128 a[28:31], v4 offset:39936
 v_lshl_add_u32 v6, v24, 3, v6
 v_mfma_f32_16x16x32_bf16 v[152:155], a[60:63], v[224:227], v[152:155]
 s_waitcnt vmcnt(14)
 s_barrier
 s_waitcnt lgkmcnt(4)
 v_mfma_f32_16x16x32_bf16 v[40:43], a[0:3], v[224:227], v[40:43]
 ds_read_b128 a[32:35], v5 offset:16384
 v_lshl_add_u32 v253, v24, 4, v253
 v_mfma_f32_16x16x32_bf16 v[44:47], a[0:3], v[232:235], v[44:47]
 buffer_load_dwordx4 a[104:107], v3, s[20:23], s75 offen offset:0 sc1
 v_lshlrev_b32 v253, 2, v253
 v_mfma_f32_16x16x32_bf16 v[164:167], a[4:7], v[232:235], v[164:167]
 ds_read_b128 a[36:39], v2 offset:17408
 v_add_u32 v24, 20480, v6
 v_mfma_f32_16x16x32_bf16 v[160:163], a[4:7], v[224:227], v[160:163]
 v_and_b32 v254, 15, v1
 v_lshrrev_b32 v255, 4, v1
 v_mfma_f32_16x16x32_bf16 v[48:51], a[8:11], v[224:227], v[48:51]
 ds_read_b128 a[40:43], v5 offset:17408
 v_lshl_add_u32 v254, v254, 2, v255
 v_mfma_f32_16x16x32_bf16 v[52:55], a[8:11], v[232:235], v[52:55]
 s_waitcnt vmcnt(10)
 v_add_u32 v29, 7, v0
 buffer_store_dword v29, v26, s[24:27], 0 offen sc1
 v_mfma_f32_16x16x32_bf16 v[172:175], a[12:15], v[232:235], v[172:175]
 ds_read_b128 a[44:47], v2 offset:18432
 v_lshlrev_b32_e64 v254, 2, v254
 v_mfma_f32_16x16x32_bf16 v[168:171], a[12:15], v[224:227], v[168:171]
 buffer_load_dwordx4 a[108:111], v3, s[20:23], s75 offen offset:1024 sc1
 s_mov_b32 s28, s32
 s_waitcnt lgkmcnt(4)
 v_mfma_f32_16x16x32_bf16 v[56:59], a[16:19], v[224:227], v[56:59]
 ds_read_b128 a[48:51], v5 offset:18432
 s_mov_b32 s29, s33
 v_mfma_f32_16x16x32_bf16 v[60:63], a[16:19], v[232:235], v[60:63]
 s_mov_b32 s30, 0x280000
 s_mov_b32 s31, 0x00020000
 v_mfma_f32_16x16x32_bf16 v[12:15], a[20:23], v[232:235], v[12:15]
 ds_read_b128 a[52:55], v2 offset:19456
 s_mov_b32 s4, s52
 v_mfma_f32_16x16x32_bf16 v[8:11], a[20:23], v[224:227], v[8:11]
 s_mov_b32 s5, s53
 s_mov_b32 s6, 0x280000
 v_mfma_f32_16x16x32_bf16 v[144:147], a[24:27], v[224:227], v[144:147]
 ds_read_b128 a[56:59], v5 offset:19456
 s_add_u32 s75, s75, 0x2000
 v_mfma_f32_16x16x32_bf16 v[148:151], a[24:27], v[232:235], v[148:151]
 buffer_load_dwordx4 a[112:115], v2, s[20:23], s75 offen offset:0 sc1
 s_mov_b32 s7, 0x00020000
 v_mfma_f32_16x16x32_bf16 v[20:23], a[28:31], v[232:235], v[20:23]
 ds_read_b128 a[60:63], v2 offset:20480
 v_mfma_f32_16x16x32_bf16 v[16:19], a[28:31], v[224:227], v[16:19]
 s_waitcnt lgkmcnt(4)
 v_mfma_f32_16x16x32_bf16 v[64:67], a[32:35], a[64:67], v[64:67]
 ds_read_b128 a[0:3], v2 offset:16384
 v_mfma_f32_16x16x32_bf16 v[68:71], a[32:35], a[68:71], v[68:71]
 v_mfma_f32_16x16x32_bf16 v[108:111], a[36:39], a[68:71], v[108:111]
 ds_read_b128 a[4:7], v2 offset:21504
 v_mfma_f32_16x16x32_bf16 v[104:107], a[36:39], a[64:67], v[104:107]
 buffer_load_dwordx4 a[116:119], v2, s[20:23], s75 offen offset:1024 sc1
 v_mfma_f32_16x16x32_bf16 v[72:75], a[40:43], a[64:67], v[72:75]
 ds_read_b128 a[8:11], v5 offset:20480
 v_mfma_f32_16x16x32_bf16 v[76:79], a[40:43], a[68:71], v[76:79]
 v_mfma_f32_16x16x32_bf16 v[116:119], a[44:47], a[68:71], v[116:119]
 ds_read_b128 a[12:15], v2 offset:1024
 v_mfma_f32_16x16x32_bf16 v[112:115], a[44:47], a[64:67], v[112:115]
 s_waitcnt lgkmcnt(4)
 v_mfma_f32_16x16x32_bf16 v[80:83], a[48:51], a[64:67], v[80:83]
 ds_read_b128 a[16:19], v5 offset:21504
 v_mfma_f32_16x16x32_bf16 v[84:87], a[48:51], a[68:71], v[84:87]
 buffer_load_dwordx4 a[120:123], v3, s[20:23], s75 offen offset:0 sc1
 v_mfma_f32_16x16x32_bf16 v[124:127], a[52:55], a[68:71], v[124:127]
 ds_read_b128 a[20:23], v2 offset:2048
 v_mfma_f32_16x16x32_bf16 v[120:123], a[52:55], a[64:67], v[120:123]
 v_mfma_f32_16x16x32_bf16 v[88:91], a[56:59], a[64:67], v[88:91]
 ds_read_b128 a[24:27], v5 offset:22528
 v_mfma_f32_16x16x32_bf16 v[92:95], a[56:59], a[68:71], v[92:95]
 v_mfma_f32_16x16x32_bf16 v[132:135], a[60:63], a[68:71], v[132:135]
 ds_read_b128 a[28:31], v2 offset:3072
 v_mfma_f32_16x16x32_bf16 v[128:131], a[60:63], a[64:67], v[128:131]
 buffer_load_dwordx4 a[124:127], v3, s[20:23], s75 offen offset:1024 sc1
 s_waitcnt lgkmcnt(4)
 v_mfma_f32_16x16x32_bf16 v[96:99], a[0:3], a[64:67], v[96:99]
 ds_read_b128 a[32:35], v5 offset:23552
 v_mfma_f32_16x16x32_bf16 v[100:103], a[0:3], a[68:71], v[100:103]
 v_mfma_f32_16x16x32_bf16 v[140:143], a[4:7], a[68:71], v[140:143]
 ds_read_b128 a[36:39], v2 offset:4096
 v_mfma_f32_16x16x32_bf16 v[136:139], a[4:7], a[64:67], v[136:139]
 buffer_load_dwordx2 v[240:241], v6, s[28:31], s42 offen offset:0
 v_mfma_f32_16x16x32_bf16 v[64:67], a[8:11], a[72:75], v[64:67]
 ds_read_b128 a[40:43], v2 offset:0
 v_mfma_f32_16x16x32_bf16 v[68:71], a[8:11], a[76:79], v[68:71]
 v_mfma_f32_16x16x32_bf16 v[108:111], a[12:15], a[76:79], v[108:111]
 ds_read_b128 a[44:47], v2 offset:5120
 v_mfma_f32_16x16x32_bf16 v[104:107], a[12:15], a[72:75], v[104:107]
 buffer_load_dwordx2 v[242:243], v24, s[28:31], s42 offen offset:0
 s_waitcnt lgkmcnt(4)
 v_mfma_f32_16x16x32_bf16 v[72:75], a[16:19], a[72:75], v[72:75]
 ds_read_b128 a[48:51], v5 offset:24576
 v_mfma_f32_16x16x32_bf16 v[76:79], a[16:19], a[76:79], v[76:79]
 v_mfma_f32_16x16x32_bf16 v[116:119], a[20:23], a[76:79], v[116:119]
 ds_read_b128 a[52:55], v2 offset:50176
 v_mfma_f32_16x16x32_bf16 v[112:115], a[20:23], a[72:75], v[112:115]
 buffer_load_dwordx2 v[244:245], v6, s[28:31], s43 offen offset:0
 v_mfma_f32_16x16x32_bf16 v[80:83], a[24:27], a[72:75], v[80:83]
 ds_read_b128 a[56:59], v5 offset:25600
 v_mfma_f32_16x16x32_bf16 v[84:87], a[24:27], a[76:79], v[84:87]
 buffer_load_dword v28, v27, s[24:27], 0 offen sc1
 v_mfma_f32_16x16x32_bf16 v[124:127], a[28:31], a[76:79], v[124:127]
 ds_read_b128 a[60:63], v2 offset:51200
 v_mfma_f32_16x16x32_bf16 v[120:123], a[28:31], a[72:75], v[120:123]
 buffer_load_dwordx2 v[246:247], v24, s[28:31], s43 offen offset:0
 s_waitcnt lgkmcnt(4)
 v_mfma_f32_16x16x32_bf16 v[88:91], a[32:35], a[72:75], v[88:91]
 ds_read_b128 a[0:3], v5 offset:26624
 v_mfma_f32_16x16x32_bf16 v[92:95], a[32:35], a[76:79], v[92:95]
 v_mfma_f32_16x16x32_bf16 v[132:135], a[36:39], a[76:79], v[132:135]
 ds_read_b128 a[4:7], v2 offset:52224
 v_mfma_f32_16x16x32_bf16 v[128:131], a[36:39], a[72:75], v[128:131]
 buffer_load_dwordx2 v[248:249], v6, s[28:31], s43 offen offset:96
 v_mfma_f32_16x16x32_bf16 v[96:99], a[40:43], a[72:75], v[96:99]
 ds_read_b128 a[8:11], v5 offset:27648
 v_mfma_f32_16x16x32_bf16 v[100:103], a[40:43], a[76:79], v[100:103]
 v_mfma_f32_16x16x32_bf16 v[140:143], a[44:47], a[76:79], v[140:143]
 ds_read_b128 a[12:15], v2 offset:53248
 v_mfma_f32_16x16x32_bf16 v[136:139], a[44:47], a[72:75], v[136:139]
 buffer_load_dwordx2 v[250:251], v24, s[28:31], s43 offen offset:96
 s_waitcnt lgkmcnt(4)
 v_mfma_f32_16x16x32_bf16 v[64:67], a[48:51], a[80:83], v[64:67]
 ds_read_b128 a[16:19], v2 offset:49152
 v_mfma_f32_16x16x32_bf16 v[68:71], a[48:51], a[84:87], v[68:71]
 v_mfma_f32_16x16x32_bf16 v[108:111], a[52:55], a[84:87], v[108:111]
 ds_read_b128 a[20:23], v2 offset:54272
 v_mfma_f32_16x16x32_bf16 v[104:107], a[52:55], a[80:83], v[104:107]
 v_mfma_f32_16x16x32_bf16 v[72:75], a[56:59], a[80:83], v[72:75]
 ds_read_b128 a[24:27], v5 offset:28672
 v_mfma_f32_16x16x32_bf16 v[76:79], a[56:59], a[84:87], v[76:79]
 v_mfma_f32_16x16x32_bf16 v[116:119], a[60:63], a[84:87], v[116:119]
 ds_read_b128 a[28:31], v2 offset:33792
 v_mfma_f32_16x16x32_bf16 v[112:115], a[60:63], a[80:83], v[112:115]
 s_waitcnt lgkmcnt(4)
 v_mfma_f32_16x16x32_bf16 v[80:83], a[0:3], a[80:83], v[80:83]
 ds_read_b128 a[32:35], v5 offset:29696
 v_mfma_f32_16x16x32_bf16 v[84:87], a[0:3], a[84:87], v[84:87]
 v_mfma_f32_16x16x32_bf16 v[124:127], a[4:7], a[84:87], v[124:127]
 ds_read_b128 a[36:39], v2 offset:34816
 v_mfma_f32_16x16x32_bf16 v[120:123], a[4:7], a[80:83], v[120:123]
 v_mfma_f32_16x16x32_bf16 v[88:91], a[8:11], a[80:83], v[88:91]
 ds_read_b128 a[40:43], v5 offset:30720
 v_mfma_f32_16x16x32_bf16 v[92:95], a[8:11], a[84:87], v[92:95]
 v_mfma_f32_16x16x32_bf16 v[132:135], a[12:15], a[84:87], v[132:135]
 ds_read_b128 a[44:47], v2 offset:35840
 v_mfma_f32_16x16x32_bf16 v[128:131], a[12:15], a[80:83], v[128:131]
 s_waitcnt lgkmcnt(4)
 v_mfma_f32_16x16x32_bf16 v[96:99], a[16:19], a[80:83], v[96:99]
 ds_read_b128 a[48:51], v5 offset:31744
 v_mfma_f32_16x16x32_bf16 v[100:103], a[16:19], a[84:87], v[100:103]
 v_mfma_f32_16x16x32_bf16 v[140:143], a[20:23], a[84:87], v[140:143]
 ds_read_b128 a[52:55], v2 offset:36864
 v_mfma_f32_16x16x32_bf16 v[136:139], a[20:23], a[80:83], v[136:139]
 s_mov_b64 exec, 0
 s_cmp_eq_u32 s58, 0
 s_cbranch_scc1 L_pg16
 s_cmp_eq_u32 s58, 1
 s_cbranch_scc1 L_pg17
 s_cmp_eq_u32 s58, 2
 s_cbranch_scc1 L_hopr5
 s_branch L_hopr5
L_hopr5:
 s_mov_b64 exec, -1
 s_waitcnt vmcnt(3)
 v_sub_u32 v28, v28, v0
 v_subrev_u32 v28, 7, v28
 v_cmp_ge_u32 vcc, 5, v28
 s_mov_b32 s79, 0
 s_cmp_eq_u64 vcc, -1
 s_cbranch_scc0 L_pl6
L_pd6:
 s_add_u32 s75, s96, s48
 v_mfma_f32_16x16x32_bf16 v[64:67], a[24:27], a[88:91], v[64:67]
 ds_read_b128 a[56:59], v2 offset:32768
 buffer_load_dwordx4 a[192:195], v2, s[20:23], s75 offen offset:0 sc1
 v_mfma_f32_16x16x32_bf16 v[68:71], a[24:27], a[92:95], v[68:71]
 s_mul_i32 s39, s58, 3
 s_add_u32 s39, s39, 42
 v_mfma_f32_16x16x32_bf16 v[108:111], a[28:31], a[92:95], v[108:111]
 ds_read_b128 a[60:63], v2 offset:37888
 s_add_u32 s54, s58, 0
 v_mfma_f32_16x16x32_bf16 v[104:107], a[28:31], a[88:91], v[104:107]
 s_barrier
 s_waitcnt lgkmcnt(4)
 v_mfma_f32_16x16x32_bf16 v[72:75], a[32:35], a[88:91], v[72:75]
 ds_read_b128 a[0:3], v2 offset:22528
 s_andn2_b32 s88, s2, 7
 v_mfma_f32_16x16x32_bf16 v[76:79], a[32:35], a[92:95], v[76:79]
 s_bitcmp1_b32 s54, 1
 s_cselect_b32 s35, s45, s44
 v_mfma_f32_16x16x32_bf16 v[116:119], a[36:39], a[92:95], v[116:119]
 ds_read_b128 a[4:7], v2 offset:27648
 buffer_load_dwordx4 a[196:199], v2, s[20:23], s75 offen offset:1024 sc1
 v_mfma_f32_16x16x32_bf16 v[112:115], a[36:39], a[88:91], v[112:115]
 s_and_b32 s54, s54, 1
 s_add_u32 s54, s54, s35
 v_mfma_f32_16x16x32_bf16 v[80:83], a[40:43], a[88:91], v[80:83]
 ds_read_b128 a[8:11], v2 offset:6144
 s_mul_i32 s54, s54, 54
 v_mfma_f32_16x16x32_bf16 v[84:87], a[40:43], a[92:95], v[84:87]
 s_add_u32 s54, s54, s39
 s_lshl_b32 s35, s54, 10
 v_mfma_f32_16x16x32_bf16 v[124:127], a[44:47], a[92:95], v[124:127]
 ds_read_b128 a[12:15], v2 offset:11264
 s_add_u32 s54, s58, 1
 v_mfma_f32_16x16x32_bf16 v[120:123], a[44:47], a[88:91], v[120:123]
 s_bitcmp1_b32 s54, 1
 s_cselect_b32 s36, s45, s44
 s_waitcnt lgkmcnt(4)
 v_mfma_f32_16x16x32_bf16 v[88:91], a[48:51], a[88:91], v[88:91]
 ds_read_b128 a[16:19], v2 offset:55296
 buffer_load_dwordx4 a[200:203], v3, s[20:23], s75 offen offset:0 sc1
 v_mfma_f32_16x16x32_bf16 v[92:95], a[48:51], a[92:95], v[92:95]
 s_and_b32 s54, s54, 1
 s_add_u32 s54, s54, s36
 v_mfma_f32_16x16x32_bf16 v[132:135], a[52:55], a[92:95], v[132:135]
 ds_read_b128 a[20:23], v2 offset:60416
 s_mul_i32 s54, s54, 54
 v_mfma_f32_16x16x32_bf16 v[128:131], a[52:55], a[88:91], v[128:131]
 s_add_u32 s54, s54, s39
 s_lshl_b32 s36, s54, 10
 v_mfma_f32_16x16x32_bf16 v[96:99], a[56:59], a[88:91], v[96:99]
 ds_read_b128 a[24:27], v2 offset:38912
 s_add_u32 s54, s58, 2
 v_mfma_f32_16x16x32_bf16 v[100:103], a[56:59], a[92:95], v[100:103]
 s_bitcmp1_b32 s54, 1
 s_cselect_b32 s37, s45, s44
 v_mfma_f32_16x16x32_bf16 v[140:143], a[60:63], a[92:95], v[140:143]
 ds_read_b128 a[28:31], v2 offset:44032
 buffer_load_dwordx4 a[204:207], v3, s[20:23], s75 offen offset:1024 sc1
 v_mfma_f32_16x16x32_bf16 v[136:139], a[60:63], a[88:91], v[136:139]
 s_and_b32 s54, s54, 1
 s_add_u32 s54, s54, s37
 s_waitcnt lgkmcnt(4)
 v_mfma_f32_16x16x32_bf16 v[64:67], a[0:3], a[96:99], v[64:67]
 ds_read_b128 a[32:35], v2 offset:23552
 s_mul_i32 s54, s54, 54
 v_mfma_f32_16x16x32_bf16 v[68:71], a[0:3], a[100:103], v[68:71]
 s_add_u32 s54, s54, s39
 s_lshl_b32 s37, s54, 10
 v_mfma_f32_16x16x32_bf16 v[108:111], a[4:7], a[100:103], v[108:111]
 ds_read_b128 a[36:39], v2 offset:28672
 s_add_u32 s54, s58, 3
 v_mfma_f32_16x16x32_bf16 v[104:107], a[4:7], a[96:99], v[104:107]
 s_add_u32 s75, s75, 0x2000
 s_lshl_b32 s88, s88, 7
 v_mfma_f32_16x16x32_bf16 v[64:67], a[8:11], a[104:107], v[64:67]
 ds_read_b128 a[40:43], v2 offset:7168
 buffer_load_dwordx4 a[208:211], v2, s[20:23], s75 offen offset:0 sc1
 v_mfma_f32_16x16x32_bf16 v[68:71], a[8:11], a[108:111], v[68:71]
 s_bitcmp1_b32 s54, 1
 s_cselect_b32 s38, s45, s44
 v_mfma_f32_16x16x32_bf16 v[108:111], a[12:15], a[108:111], v[108:111]
 ds_read_b128 a[44:47], v2 offset:12288
 s_and_b32 s54, s54, 1
 v_mfma_f32_16x16x32_bf16 v[104:107], a[12:15], a[104:107], v[104:107]
 s_add_u32 s54, s54, s38
 s_mul_i32 s54, s54, 54
 s_waitcnt lgkmcnt(4)
 v_mfma_f32_16x16x32_bf16 v[64:67], a[16:19], a[112:115], v[64:67]
 ds_read_b128 a[48:51], v2 offset:56320
 s_add_u32 s54, s54, s39
 v_mfma_f32_16x16x32_bf16 v[68:71], a[16:19], a[116:119], v[68:71]
 s_lshl_b32 s38, s54, 10
 s_lshl_b32 s39, s39, 3
 v_mfma_f32_16x16x32_bf16 v[108:111], a[20:23], a[116:119], v[108:111]
 ds_read_b128 a[52:55], v2 offset:61440
 buffer_load_dwordx4 a[212:215], v2, s[20:23], s75 offen offset:1024 sc1
 v_mfma_f32_16x16x32_bf16 v[104:107], a[20:23], a[112:115], v[104:107]
 s_add_u32 s39, s39, s46
 s_mul_i32 s39, s39, 5120
 v_mfma_f32_16x16x32_bf16 v[64:67], a[24:27], a[120:123], v[64:67]
 ds_read_b128 a[56:59], v2 offset:39936
 s_and_b32 s77, s2, 6
 v_mfma_f32_16x16x32_bf16 v[68:71], a[24:27], a[124:127], v[68:71]
 s_lshl_b32 s77, s77, 1
 s_add_u32 s88, s88, s77
 v_mfma_f32_16x16x32_bf16 v[108:111], a[28:31], a[124:127], v[108:111]
 ds_read_b128 a[60:63], v2 offset:45056
 s_add_u32 s88, s88, 16
 v_mfma_f32_16x16x32_bf16 v[104:107], a[28:31], a[120:123], v[104:107]
 v_and_b32 v27, 7, v1
 v_lshl_add_u32 v27, v27, 7, s88
 s_waitcnt lgkmcnt(4)
 v_mfma_f32_16x16x32_bf16 v[72:75], a[32:35], a[96:99], v[72:75]
 ds_read_b128 a[0:3], v2 offset:24576
 buffer_load_dwordx4 a[216:219], v3, s[20:23], s75 offen offset:0 sc1
 v_mfma_f32_16x16x32_bf16 v[76:79], a[32:35], a[100:103], v[76:79]
 v_cvt_pk_bf16_f32 v64, v64, v65
 v_cvt_pk_bf16_f32 v65, v66, v67
 v_mfma_f32_16x16x32_bf16 v[116:119], a[36:39], a[100:103], v[116:119]
 ds_read_b128 a[4:7], v2 offset:29696
 v_cvt_pk_bf16_f32 v66, v68, v69
 v_mfma_f32_16x16x32_bf16 v[112:115], a[36:39], a[96:99], v[112:115]
 v_cvt_pk_bf16_f32 v67, v70, v71
 s_add_u32 s76, s47, 0
 v_mfma_f32_16x16x32_bf16 v[72:75], a[40:43], a[104:107], v[72:75]
 ds_read_b128 a[8:11], v2 offset:8192
 buffer_store_dwordx4 v[64:67], v2, s[80:83], s76 offen sc1
 v_mfma_f32_16x16x32_bf16 v[76:79], a[40:43], a[108:111], v[76:79]
 v_cvt_pk_bf16_f32 v104, v104, v105
 v_cvt_pk_bf16_f32 v105, v106, v107
 v_mfma_f32_16x16x32_bf16 v[116:119], a[44:47], a[108:111], v[116:119]
 ds_read_b128 a[12:15], v2 offset:13312
 buffer_load_dwordx4 a[220:223], v3, s[20:23], s75 offen offset:1024 sc1
 v_mfma_f32_16x16x32_bf16 v[112:115], a[44:47], a[104:107], v[112:115]
 v_cvt_pk_bf16_f32 v106, v108, v109
 v_cvt_pk_bf16_f32 v107, v110, v111
 s_waitcnt lgkmcnt(4)
 v_mfma_f32_16x16x32_bf16 v[72:75], a[48:51], a[112:115], v[72:75]
 ds_read_b128 a[16:19], v2 offset:57344
 s_add_u32 s76, s47, 81920
 v_mfma_f32_16x16x32_bf16 v[76:79], a[48:51], a[116:119], v[76:79]
 buffer_store_dwordx4 v[104:107], v2, s[80:83], s76 offen sc1
 v_mfma_f32_16x16x32_bf16 v[116:119], a[52:55], a[116:119], v[116:119]
 ds_read_b128 a[20:23], v2 offset:62464
 v_mfma_f32_16x16x32_bf16 v[112:115], a[52:55], a[112:115], v[112:115]
 s_add_u32 s75, s96, s49
 v_mfma_f32_16x16x32_bf16 v[72:75], a[56:59], a[120:123], v[72:75]
 ds_read_b128 a[24:27], v2 offset:40960
 buffer_load_dwordx4 a[224:227], v2, s[20:23], s75 offen offset:0 sc1
 v_mfma_f32_16x16x32_bf16 v[76:79], a[56:59], a[124:127], v[76:79]
 v_mfma_f32_16x16x32_bf16 v[116:119], a[60:63], a[124:127], v[116:119]
 ds_read_b128 a[28:31], v2 offset:46080
 v_mfma_f32_16x16x32_bf16 v[112:115], a[60:63], a[120:123], v[112:115]
 s_waitcnt lgkmcnt(4)
 v_mfma_f32_16x16x32_bf16 v[80:83], a[0:3], a[96:99], v[80:83]
 ds_read_b128 a[32:35], v2 offset:25600
 v_mfma_f32_16x16x32_bf16 v[84:87], a[0:3], a[100:103], v[84:87]
 v_cvt_pk_bf16_f32 v72, v72, v73
 v_cvt_pk_bf16_f32 v73, v74, v75
 v_mfma_f32_16x16x32_bf16 v[124:127], a[4:7], a[100:103], v[124:127]
 ds_read_b128 a[36:39], v2 offset:30720
 buffer_load_dwordx4 a[228:231], v2, s[20:23], s75 offen offset:1024 sc1
 v_mfma_f32_16x16x32_bf16 v[120:123], a[4:7], a[96:99], v[120:123]
 v_cvt_pk_bf16_f32 v74, v76, v77
 v_cvt_pk_bf16_f32 v75, v78, v79
 v_mfma_f32_16x16x32_bf16 v[80:83], a[8:11], a[104:107], v[80:83]
 ds_read_b128 a[40:43], v2 offset:9216
 s_add_u32 s76, s47, 8192
 v_mfma_f32_16x16x32_bf16 v[84:87], a[8:11], a[108:111], v[84:87]
 buffer_store_dwordx4 v[72:75], v2, s[80:83], s76 offen sc1
 v_cvt_pk_bf16_f32 v112, v112, v113
 v_mfma_f32_16x16x32_bf16 v[124:127], a[12:15], a[108:111], v[124:127]
 ds_read_b128 a[44:47], v2 offset:14336
 v_cvt_pk_bf16_f32 v113, v114, v115
 v_mfma_f32_16x16x32_bf16 v[120:123], a[12:15], a[104:107], v[120:123]
 v_cvt_pk_bf16_f32 v114, v116, v117
 v_cvt_pk_bf16_f32 v115, v118, v119
 s_waitcnt lgkmcnt(4)
 v_mfma_f32_16x16x32_bf16 v[80:83], a[16:19], a[112:115], v[80:83]
 ds_read_b128 a[48:51], v2 offset:58368
 buffer_load_dwordx4 a[232:235], v3, s[20:23], s75 offen offset:0 sc1
 v_mfma_f32_16x16x32_bf16 v[84:87], a[16:19], a[116:119], v[84:87]
 s_add_u32 s76, s47, 90112
 buffer_store_dwordx4 v[112:115], v2, s[80:83], s76 offen sc1
 v_mfma_f32_16x16x32_bf16 v[124:127], a[20:23], a[116:119], v[124:127]
 ds_read_b128 a[52:55], v2 offset:63488
 v_mfma_f32_16x16x32_bf16 v[120:123], a[20:23], a[112:115], v[120:123]
 v_mfma_f32_16x16x32_bf16 v[80:83], a[24:27], a[120:123], v[80:83]
 ds_read_b128 a[56:59], v2 offset:41984
 v_mfma_f32_16x16x32_bf16 v[84:87], a[24:27], a[124:127], v[84:87]
 v_mfma_f32_16x16x32_bf16 v[124:127], a[28:31], a[124:127], v[124:127]
 ds_read_b128 a[60:63], v2 offset:47104
 buffer_load_dwordx4 a[236:239], v3, s[20:23], s75 offen offset:1024 sc1
 v_mfma_f32_16x16x32_bf16 v[120:123], a[28:31], a[120:123], v[120:123]
 s_waitcnt lgkmcnt(4)
 v_mfma_f32_16x16x32_bf16 v[88:91], a[32:35], a[96:99], v[88:91]
 ds_read_b128 a[0:3], v2 offset:26624
 v_mfma_f32_16x16x32_bf16 v[92:95], a[32:35], a[100:103], v[92:95]
 v_cvt_pk_bf16_f32 v80, v80, v81
 v_cvt_pk_bf16_f32 v81, v82, v83
 v_mfma_f32_16x16x32_bf16 v[132:135], a[36:39], a[100:103], v[132:135]
 ds_read_b128 a[4:7], v2 offset:31744
 v_cvt_pk_bf16_f32 v82, v84, v85
 v_mfma_f32_16x16x32_bf16 v[128:131], a[36:39], a[96:99], v[128:131]
 s_add_u32 s75, s75, 0x2000
 v_cvt_pk_bf16_f32 v83, v86, v87
 v_mfma_f32_16x16x32_bf16 v[88:91], a[40:43], a[104:107], v[88:91]
 ds_read_b128 a[8:11], v2 offset:10240
 buffer_load_dwordx4 a[240:243], v2, s[20:23], s75 offen offset:0 sc1
 v_mfma_f32_16x16x32_bf16 v[92:95], a[40:43], a[108:111], v[92:95]
 s_add_u32 s76, s47, 16384
 buffer_store_dwordx4 v[80:83], v2, s[80:83], s76 offen sc1
L_pg16:
 s_cbranch_execz L_hopr5
 v_mfma_f32_16x16x32_bf16 v[132:135], a[44:47], a[108:111], v[132:135]
 ds_read_b128 a[12:15], v2 offset:15360
 v_cvt_pk_bf16_f32 v120, v120, v121
 v_mfma_f32_16x16x32_bf16 v[128:131], a[44:47], a[104:107], v[128:131]
 v_cvt_pk_bf16_f32 v121, v122, v123
 v_cvt_pk_bf16_f32 v122, v124, v125
 s_waitcnt lgkmcnt(4)
 v_mfma_f32_16x16x32_bf16 v[88:91], a[48:51], a[112:115], v[88:91]
 ds_read_b128 a[16:19], v2 offset:59392
 v_cvt_pk_bf16_f32 v123, v126, v127
 v_mfma_f32_16x16x32_bf16 v[92:95], a[48:51], a[116:119], v[92:95]
 s_add_u32 s76, s47, 98304
 buffer_store_dwordx4 v[120:123], v2, s[80:83], s76 offen sc1
 v_mfma_f32_16x16x32_bf16 v[132:135], a[52:55], a[116:119], v[132:135]
 ds_read_b128 a[20:23], v2 offset:64512
 buffer_load_dwordx4 a[244:247], v2, s[20:23], s75 offen offset:1024 sc1
 v_mfma_f32_16x16x32_bf16 v[128:131], a[52:55], a[112:115], v[128:131]
 v_mfma_f32_16x16x32_bf16 v[88:91], a[56:59], a[120:123], v[88:91]
 ds_read_b128 a[24:27], v2 offset:43008
 v_mfma_f32_16x16x32_bf16 v[92:95], a[56:59], a[124:127], v[92:95]
 v_mfma_f32_16x16x32_bf16 v[132:135], a[60:63], a[124:127], v[132:135]
 ds_read_b128 a[28:31], v2 offset:48128
 v_mfma_f32_16x16x32_bf16 v[128:131], a[60:63], a[120:123], v[128:131]
 s_waitcnt lgkmcnt(4)
 v_mfma_f32_16x16x32_bf16 v[96:99], a[0:3], a[96:99], v[96:99]
 ds_read_b128 a[32:35], v4 offset:40960
 buffer_load_dwordx4 a[248:251], v3, s[20:23], s75 offen offset:0 sc1
 v_mfma_f32_16x16x32_bf16 v[100:103], a[0:3], a[100:103], v[100:103]
 v_cvt_pk_bf16_f32 v88, v88, v89
 v_cvt_pk_bf16_f32 v89, v90, v91
 v_mfma_f32_16x16x32_bf16 v[140:143], a[4:7], a[100:103], v[140:143]
 ds_read_b128 a[36:39], v4 offset:46080
 v_cvt_pk_bf16_f32 v90, v92, v93
 v_mfma_f32_16x16x32_bf16 v[136:139], a[4:7], a[96:99], v[136:139]
 v_cvt_pk_bf16_f32 v91, v94, v95
 s_add_u32 s76, s47, 24576
 v_mfma_f32_16x16x32_bf16 v[96:99], a[8:11], a[104:107], v[96:99]
 ds_read_b128 a[40:43], v4 offset:41984
 buffer_store_dwordx4 v[88:91], v2, s[80:83], s76 offen sc1
 v_mfma_f32_16x16x32_bf16 v[100:103], a[8:11], a[108:111], v[100:103]
 v_cvt_pk_bf16_f32 v128, v128, v129
 v_cvt_pk_bf16_f32 v129, v130, v131
 v_mfma_f32_16x16x32_bf16 v[140:143], a[12:15], a[108:111], v[140:143]
 ds_read_b128 a[44:47], v4 offset:47104
 buffer_load_dwordx4 a[252:255], v3, s[20:23], s75 offen offset:1024 sc1
 v_mfma_f32_16x16x32_bf16 v[136:139], a[12:15], a[104:107], v[136:139]
 v_cvt_pk_bf16_f32 v130, v132, v133
 v_cvt_pk_bf16_f32 v131, v134, v135
 s_waitcnt lgkmcnt(4)
 v_mfma_f32_16x16x32_bf16 v[96:99], a[16:19], a[112:115], v[96:99]
 ds_read_b128 a[48:51], v4 offset:43008
 s_add_u32 s76, s47, 106496
 v_mfma_f32_16x16x32_bf16 v[100:103], a[16:19], a[116:119], v[100:103]
 buffer_store_dwordx4 v[128:131], v2, s[80:83], s76 offen sc1
 v_mfma_f32_16x16x32_bf16 v[140:143], a[20:23], a[116:119], v[140:143]
 ds_read_b128 a[52:55], v4 offset:48128
 v_mfma_f32_16x16x32_bf16 v[136:139], a[20:23], a[112:115], v[136:139]
 s_add_u32 s75, s96, s50
 v_mfma_f32_16x16x32_bf16 v[96:99], a[24:27], a[120:123], v[96:99]
 ds_read_b128 a[56:59], v4 offset:51200
 buffer_load_dwordx4 v[180:183], v2, s[20:23], s75 offen offset:0 sc1
 v_mfma_f32_16x16x32_bf16 v[100:103], a[24:27], a[124:127], v[100:103]
 v_mfma_f32_16x16x32_bf16 v[140:143], a[28:31], a[124:127], v[140:143]
 ds_read_b128 a[60:63], v4 offset:56320
 v_mfma_f32_16x16x32_bf16 v[136:139], a[28:31], a[120:123], v[136:139]
 s_waitcnt vmcnt(24) lgkmcnt(4)
 v_mfma_f32_16x16x32_bf16 v[32:35], a[32:35], a[192:195], v[32:35]
 ds_read_b128 a[0:3], v4 offset:52224
 s_waitcnt vmcnt(23)
 v_mfma_f32_16x16x32_bf16 v[36:39], a[32:35], a[196:199], v[36:39]
 v_cvt_pk_bf16_f32 v96, v96, v97
 v_cvt_pk_bf16_f32 v97, v98, v99
 v_mfma_f32_16x16x32_bf16 v[156:159], a[36:39], a[196:199], v[156:159]
 ds_read_b128 a[4:7], v4 offset:57344
 buffer_load_dwordx4 v[188:191], v2, s[20:23], s75 offen offset:1024 sc1
 v_mfma_f32_16x16x32_bf16 v[152:155], a[36:39], a[192:195], v[152:155]
 v_cvt_pk_bf16_f32 v98, v100, v101
 v_cvt_pk_bf16_f32 v99, v102, v103
 v_mfma_f32_16x16x32_bf16 v[40:43], a[40:43], a[192:195], v[40:43]
 ds_read_b128 a[8:11], v4 offset:53248
 s_add_u32 s76, s47, 32768
 v_mfma_f32_16x16x32_bf16 v[44:47], a[40:43], a[196:199], v[44:47]
 buffer_store_dwordx4 v[96:99], v2, s[80:83], s76 offen sc1
 v_cvt_pk_bf16_f32 v136, v136, v137
 v_mfma_f32_16x16x32_bf16 v[164:167], a[44:47], a[196:199], v[164:167]
 ds_read_b128 a[12:15], v4 offset:58368
 v_cvt_pk_bf16_f32 v137, v138, v139
 v_mfma_f32_16x16x32_bf16 v[160:163], a[44:47], a[192:195], v[160:163]
 v_cvt_pk_bf16_f32 v138, v140, v141
 v_cvt_pk_bf16_f32 v139, v142, v143
 s_waitcnt lgkmcnt(4)
 v_mfma_f32_16x16x32_bf16 v[48:51], a[48:51], a[192:195], v[48:51]
 ds_read_b128 a[16:19], v4 offset:61440
 buffer_load_dwordx4 v[196:199], v3, s[20:23], s75 offen offset:0 sc1
 v_mfma_f32_16x16x32_bf16 v[52:55], a[48:51], a[196:199], v[52:55]
 s_add_u32 s76, s47, 114688
 buffer_store_dwordx4 v[136:139], v2, s[80:83], s76 offen sc1
 v_mfma_f32_16x16x32_bf16 v[172:175], a[52:55], a[196:199], v[172:175]
 ds_read_b128 a[20:23], v5 offset:1024
 v_mfma_f32_16x16x32_bf16 v[168:171], a[52:55], a[192:195], v[168:171]
 s_waitcnt vmcnt(26)
 v_mfma_f32_16x16x32_bf16 v[32:35], a[56:59], a[200:203], v[32:35]
 ds_read_b128 a[24:27], v4 offset:62464
 s_waitcnt vmcnt(25)
 v_mfma_f32_16x16x32_bf16 v[36:39], a[56:59], a[204:207], v[36:39]
 v_mfma_f32_16x16x32_bf16 v[156:159], a[60:63], a[204:207], v[156:159]
 ds_read_b128 a[28:31], v5 offset:2048
 buffer_load_dwordx4 v[204:207], v3, s[20:23], s75 offen offset:1024 sc1
 v_mfma_f32_16x16x32_bf16 v[152:155], a[60:63], a[200:203], v[152:155]
 s_waitcnt lgkmcnt(4)
 v_mfma_f32_16x16x32_bf16 v[40:43], a[0:3], a[200:203], v[40:43]
 ds_read_b128 a[32:35], v4 offset:63488
 v_mfma_f32_16x16x32_bf16 v[44:47], a[0:3], a[204:207], v[44:47]
 v_mfma_f32_16x16x32_bf16 v[164:167], a[4:7], a[204:207], v[164:167]
 ds_read_b128 a[36:39], v5 offset:3072
 v_mfma_f32_16x16x32_bf16 v[160:163], a[4:7], a[200:203], v[160:163]
 s_add_u32 s75, s75, 0x2000
 v_mfma_f32_16x16x32_bf16 v[48:51], a[8:11], a[200:203], v[48:51]
 ds_read_b128 a[40:43], v5 offset:6144
 buffer_load_dwordx4 v[212:215], v2, s[20:23], s75 offen offset:0 sc1
 v_mfma_f32_16x16x32_bf16 v[52:55], a[8:11], a[204:207], v[52:55]
 v_mfma_f32_16x16x32_bf16 v[172:175], a[12:15], a[204:207], v[172:175]
 ds_read_b128 a[44:47], v5 offset:11264
 v_mfma_f32_16x16x32_bf16 v[168:171], a[12:15], a[200:203], v[168:171]
 s_waitcnt vmcnt(26) lgkmcnt(4)
 v_mfma_f32_16x16x32_bf16 v[32:35], a[16:19], a[208:211], v[32:35]
 ds_read_b128 a[48:51], v5 offset:7168
 s_waitcnt vmcnt(25)
 v_mfma_f32_16x16x32_bf16 v[36:39], a[16:19], a[212:215], v[36:39]
 v_mfma_f32_16x16x32_bf16 v[156:159], a[20:23], a[212:215], v[156:159]
 ds_read_b128 a[52:55], v5 offset:12288
 buffer_load_dwordx4 v[220:223], v2, s[20:23], s75 offen offset:1024 sc1
 v_mfma_f32_16x16x32_bf16 v[152:155], a[20:23], a[208:211], v[152:155]
 v_mfma_f32_16x16x32_bf16 v[40:43], a[24:27], a[208:211], v[40:43]
 ds_read_b128 a[56:59], v5 offset:8192
 v_mfma_f32_16x16x32_bf16 v[44:47], a[24:27], a[212:215], v[44:47]
 v_mfma_f32_16x16x32_bf16 v[164:167], a[28:31], a[212:215], v[164:167]
 ds_read_b128 a[60:63], v5 offset:13312
 v_mfma_f32_16x16x32_bf16 v[160:163], a[28:31], a[208:211], v[160:163]
 s_waitcnt lgkmcnt(4)
 v_mfma_f32_16x16x32_bf16 v[48:51], a[32:35], a[208:211], v[48:51]
 ds_read_b128 a[0:3], v5 offset:16384
 buffer_load_dwordx4 v[228:231], v3, s[20:23], s75 offen offset:0 sc1
 v_mfma_f32_16x16x32_bf16 v[52:55], a[32:35], a[212:215], v[52:55]
 v_mfma_f32_16x16x32_bf16 v[172:175], a[36:39], a[212:215], v[172:175]
 ds_read_b128 a[4:7], v2 offset:17408
 v_mfma_f32_16x16x32_bf16 v[168:171], a[36:39], a[208:211], v[168:171]
 s_waitcnt vmcnt(26)
 v_mfma_f32_16x16x32_bf16 v[32:35], a[40:43], a[216:219], v[32:35]
 ds_read_b128 a[8:11], v5 offset:17408
 s_waitcnt vmcnt(24)
 v_mfma_f32_16x16x32_bf16 v[36:39], a[40:43], a[220:223], v[36:39]
 v_mfma_f32_16x16x32_bf16 v[156:159], a[44:47], a[220:223], v[156:159]
 ds_read_b128 a[12:15], v2 offset:18432
 buffer_load_dwordx4 v[236:239], v3, s[20:23], s75 offen offset:1024 sc1
 v_mfma_f32_16x16x32_bf16 v[152:155], a[44:47], a[216:219], v[152:155]
 s_waitcnt lgkmcnt(4)
 v_mfma_f32_16x16x32_bf16 v[40:43], a[48:51], a[216:219], v[40:43]
 ds_read_b128 a[16:19], v5 offset:18432
 v_mfma_f32_16x16x32_bf16 v[44:47], a[48:51], a[220:223], v[44:47]
 v_mfma_f32_16x16x32_bf16 v[164:167], a[52:55], a[220:223], v[164:167]
 ds_read_b128 a[20:23], v2 offset:19456
 v_mfma_f32_16x16x32_bf16 v[160:163], a[52:55], a[216:219], v[160:163]
 v_mfma_f32_16x16x32_bf16 v[48:51], a[56:59], a[216:219], v[48:51]
 ds_read_b128 a[24:27], v5 offset:20480
 buffer_load_dwordx4 a[64:67], v2, s[8:11], s35 offen offset:0 sc1
 v_mfma_f32_16x16x32_bf16 v[52:55], a[56:59], a[220:223], v[52:55]
 ds_bpermute_b32 v240, v254, v240
 v_mfma_f32_16x16x32_bf16 v[172:175], a[60:63], a[220:223], v[172:175]
 ds_read_b128 a[28:31], v2 offset:1024
 ds_bpermute_b32 v241, v254, v241
 v_mfma_f32_16x16x32_bf16 v[168:171], a[60:63], a[216:219], v[168:171]
 s_waitcnt vmcnt(24) lgkmcnt(6)
 v_mfma_f32_16x16x32_bf16 v[32:35], a[0:3], a[224:227], v[32:35]
 ds_read_b128 a[32:35], v5 offset:21504
 ds_bpermute_b32 v242, v254, v242
 s_waitcnt vmcnt(23)
 v_mfma_f32_16x16x32_bf16 v[36:39], a[0:3], a[228:231], v[36:39]
 v_mfma_f32_16x16x32_bf16 v[156:159], a[4:7], a[228:231], v[156:159]
 ds_read_b128 a[36:39], v2 offset:2048
 buffer_load_dwordx4 a[68:71], v2, s[8:11], s36 offen offset:0 sc1
 v_mfma_f32_16x16x32_bf16 v[152:155], a[4:7], a[224:227], v[152:155]
 ds_bpermute_b32 v243, v254, v243
 v_mfma_f32_16x16x32_bf16 v[40:43], a[8:11], a[224:227], v[40:43]
 ds_read_b128 a[40:43], v5 offset:22528
 ds_bpermute_b32 v244, v254, v244
 v_mfma_f32_16x16x32_bf16 v[44:47], a[8:11], a[228:231], v[44:47]
 v_mfma_f32_16x16x32_bf16 v[164:167], a[12:15], a[228:231], v[164:167]
 ds_read_b128 a[44:47], v2 offset:3072
 ds_bpermute_b32 v245, v254, v245
 v_mfma_f32_16x16x32_bf16 v[160:163], a[12:15], a[224:227], v[160:163]
 s_waitcnt lgkmcnt(8)
 v_mfma_f32_16x16x32_bf16 v[48:51], a[16:19], a[224:227], v[48:51]
 ds_read_b128 a[48:51], v5 offset:24576
 buffer_load_dwordx4 a[72:75], v2, s[8:11], s37 offen offset:0 sc1
 v_mfma_f32_16x16x32_bf16 v[52:55], a[16:19], a[228:231], v[52:55]
 ds_bpermute_b32 v246, v254, v246
 v_mfma_f32_16x16x32_bf16 v[172:175], a[20:23], a[228:231], v[172:175]
 ds_read_b128 a[52:55], v2 offset:50176
 ds_bpermute_b32 v247, v254, v247
 v_mfma_f32_16x16x32_bf16 v[168:171], a[20:23], a[224:227], v[168:171]
 s_waitcnt vmcnt(23)
 v_mfma_f32_16x16x32_bf16 v[32:35], a[24:27], a[232:235], v[32:35]
 ds_read_b128 a[56:59], v5 offset:25600
 ds_bpermute_b32 v248, v254, v248
 s_waitcnt vmcnt(21)
 v_mfma_f32_16x16x32_bf16 v[36:39], a[24:27], a[236:239], v[36:39]
 v_mfma_f32_16x16x32_bf16 v[156:159], a[28:31], a[236:239], v[156:159]
 ds_read_b128 a[60:63], v2 offset:51200
 buffer_load_dwordx4 a[76:79], v2, s[8:11], s38 offen offset:0 sc1
 v_mfma_f32_16x16x32_bf16 v[152:155], a[28:31], a[232:235], v[152:155]
 ds_bpermute_b32 v249, v254, v249
 s_waitcnt lgkmcnt(8)
 v_mfma_f32_16x16x32_bf16 v[40:43], a[32:35], a[232:235], v[40:43]
 ds_read_b128 a[0:3], v5 offset:26624
 ds_bpermute_b32 v250, v254, v250
 v_mfma_f32_16x16x32_bf16 v[44:47], a[32:35], a[236:239], v[44:47]
 v_mfma_f32_16x16x32_bf16 v[164:167], a[36:39], a[236:239], v[164:167]
 ds_read_b128 a[4:7], v2 offset:52224
 ds_bpermute_b32 v251, v254, v251
 v_mfma_f32_16x16x32_bf16 v[160:163], a[36:39], a[232:235], v[160:163]
 v_mfma_f32_16x16x32_bf16 v[48:51], a[40:43], a[232:235], v[48:51]
 ds_read_b128 a[8:11], v5 offset:28672
 buffer_load_dwordx4 a[80:83], v2, s[12:15], s39 offen offset:0 sc1
 v_mfma_f32_16x16x32_bf16 v[52:55], a[40:43], a[236:239], v[52:55]
 v_mfma_f32_16x16x32_bf16 v[172:175], a[44:47], a[236:239], v[172:175]
 ds_read_b128 a[12:15], v2 offset:33792
 v_mfma_f32_16x16x32_bf16 v[168:171], a[44:47], a[232:235], v[168:171]
 s_waitcnt vmcnt(22) lgkmcnt(6)
 v_mfma_f32_16x16x32_bf16 v[32:35], a[48:51], a[240:243], v[32:35]
 ds_read_b128 a[16:19], v5 offset:29696
 s_waitcnt vmcnt(19)
 v_mfma_f32_16x16x32_bf16 v[36:39], a[48:51], a[244:247], v[36:39]
 v_mfma_f32_16x16x32_bf16 v[156:159], a[52:55], a[244:247], v[156:159]
 ds_read_b128 a[20:23], v2 offset:34816
 buffer_load_dwordx4 a[84:87], v2, s[12:15], s39 offen offset:1024 sc1
 v_mfma_f32_16x16x32_bf16 v[152:155], a[52:55], a[240:243], v[152:155]
 v_mfma_f32_16x16x32_bf16 v[40:43], a[56:59], a[240:243], v[40:43]
 ds_read_b128 a[24:27], v5 offset:30720
 v_mfma_f32_16x16x32_bf16 v[44:47], a[56:59], a[244:247], v[44:47]
 v_mfma_f32_16x16x32_bf16 v[164:167], a[60:63], a[244:247], v[164:167]
 ds_read_b128 a[28:31], v2 offset:35840
 v_mfma_f32_16x16x32_bf16 v[160:163], a[60:63], a[240:243], v[160:163]
 s_waitcnt lgkmcnt(4)
 v_mfma_f32_16x16x32_bf16 v[48:51], a[0:3], a[240:243], v[48:51]
 ds_read_b128 a[32:35], v2 offset:22528
 buffer_load_dwordx4 a[88:91], v2, s[12:15], s39 offen offset:2048 sc1
 v_mfma_f32_16x16x32_bf16 v[52:55], a[0:3], a[244:247], v[52:55]
 v_mfma_f32_16x16x32_bf16 v[172:175], a[4:7], a[244:247], v[172:175]
 ds_read_b128 a[36:39], v2 offset:27648
 v_mfma_f32_16x16x32_bf16 v[168:171], a[4:7], a[240:243], v[168:171]
 s_waitcnt vmcnt(20)
 v_mfma_f32_16x16x32_bf16 v[32:35], a[8:11], a[248:251], v[32:35]
 ds_read_b128 a[40:43], v2 offset:6144
 s_waitcnt vmcnt(18)
 v_mfma_f32_16x16x32_bf16 v[36:39], a[8:11], a[252:255], v[36:39]
 v_mfma_f32_16x16x32_bf16 v[156:159], a[12:15], a[252:255], v[156:159]
 ds_read_b128 a[44:47], v2 offset:11264
 buffer_load_dwordx4 a[92:95], v2, s[12:15], s39 offen offset:3072 sc1
 v_mfma_f32_16x16x32_bf16 v[152:155], a[12:15], a[248:251], v[152:155]
 s_waitcnt lgkmcnt(4)
 v_mfma_f32_16x16x32_bf16 v[40:43], a[16:19], a[248:251], v[40:43]
 ds_read_b128 a[48:51], v2 offset:55296
 v_mfma_f32_16x16x32_bf16 v[44:47], a[16:19], a[252:255], v[44:47]
 s_waitcnt vmcnt(13)
 v_add_u32 v29, 8, v0
 buffer_store_dword v29, v26, s[24:27], 0 offen sc1
 v_mfma_f32_16x16x32_bf16 v[164:167], a[20:23], a[252:255], v[164:167]
 ds_read_b128 a[52:55], v2 offset:60416
 s_add_u32 s62, s58, 0
 v_mfma_f32_16x16x32_bf16 v[160:163], a[20:23], a[248:251], v[160:163]
 s_and_b32 s62, s62, 3
 s_mul_i32 s62, s62, 20
 v_mfma_f32_16x16x32_bf16 v[48:51], a[24:27], a[248:251], v[48:51]
 ds_read_b128 a[56:59], v2 offset:38912
 buffer_load_dwordx4 a[96:99], v3, s[12:15], s39 offen offset:0 sc1
 v_mfma_f32_16x16x32_bf16 v[52:55], a[24:27], a[252:255], v[52:55]
 s_add_u32 s62, s62, s58
 s_lshl_b32 s62, s62, 10
 v_mfma_f32_16x16x32_bf16 v[172:175], a[28:31], a[252:255], v[172:175]
 ds_read_b128 a[60:63], v2 offset:44032
 v_add_u32 v136, s62, v2
 v_mfma_f32_16x16x32_bf16 v[168:171], a[28:31], a[248:251], v[168:171]
 s_add_u32 s62, s58, 1
 s_and_b32 s62, s62, 3
 s_waitcnt lgkmcnt(4)
 v_mfma_f32_16x16x32_bf16 v[32:35], a[32:35], v[180:183], v[32:35]
 ds_read_b128 a[0:3], v2 offset:23552
 s_mul_i32 s62, s62, 20
 v_mfma_f32_16x16x32_bf16 v[36:39], a[32:35], v[188:191], v[36:39]
 s_add_u32 s39, s39, 40960
 s_add_u32 s62, s62, s58
 v_mfma_f32_16x16x32_bf16 v[156:159], a[36:39], v[188:191], v[156:159]
 ds_read_b128 a[4:7], v2 offset:28672
 buffer_load_dwordx4 a[100:103], v2, s[8:11], s35 offen offset:1024 sc1
 v_mfma_f32_16x16x32_bf16 v[152:155], a[36:39], v[180:183], v[152:155]
 s_lshl_b32 s62, s62, 10
 v_add_u32_e64 v137, s62, v2
 v_mfma_f32_16x16x32_bf16 v[32:35], a[40:43], v[196:199], v[32:35]
 ds_read_b128 a[8:11], v2 offset:7168
 s_add_u32 s62, s58, 2
 s_waitcnt vmcnt(15)
 v_mfma_f32_16x16x32_bf16 v[36:39], a[40:43], v[204:207], v[36:39]
 s_and_b32 s62, s62, 3
 s_mul_i32 s62, s62, 20
 v_mfma_f32_16x16x32_bf16 v[156:159], a[44:47], v[204:207], v[156:159]
 ds_read_b128 a[12:15], v2 offset:12288
 s_add_u32 s62, s62, s58
 v_mfma_f32_16x16x32_bf16 v[152:155], a[44:47], v[196:199], v[152:155]
 s_lshl_b32 s62, s62, 10
 v_add_u32 v138, s62, v2
 s_waitcnt vmcnt(14) lgkmcnt(4)
 v_mfma_f32_16x16x32_bf16 v[32:35], a[48:51], v[212:215], v[32:35]
 ds_read_b128 a[16:19], v2 offset:56320
 buffer_load_dwordx4 a[104:107], v2, s[8:11], s36 offen offset:1024 sc1
 s_waitcnt vmcnt(14)
 v_mfma_f32_16x16x32_bf16 v[36:39], a[48:51], v[220:223], v[36:39]
 s_add_u32 s62, s58, 3
 s_and_b32 s62, s62, 3
 v_mfma_f32_16x16x32_bf16 v[156:159], a[52:55], v[220:223], v[156:159]
 ds_read_b128 a[20:23], v2 offset:61440
 s_mul_i32 s62, s62, 20
 v_mfma_f32_16x16x32_bf16 v[152:155], a[52:55], v[212:215], v[152:155]
 s_add_u32 s62, s62, s58
 s_lshl_b32 s62, s62, 10
 s_waitcnt vmcnt(13)
 v_mfma_f32_16x16x32_bf16 v[32:35], a[56:59], v[228:231], v[32:35]
 ds_read_b128 a[24:27], v2 offset:39936
 v_add_u32 v139, s62, v2
 s_waitcnt vmcnt(12)
 v_mfma_f32_16x16x32_bf16 v[36:39], a[56:59], v[236:239], v[36:39]
 s_lshl_b32 s62, s58, 12
 v_add_u32_e64 v25, s62, v2
 v_mfma_f32_16x16x32_bf16 v[156:159], a[60:63], v[236:239], v[156:159]
 ds_read_b128 a[28:31], v2 offset:45056
 buffer_load_dwordx4 a[108:111], v2, s[8:11], s37 offen offset:1024 sc1
 v_mfma_f32_16x16x32_bf16 v[152:155], a[60:63], v[228:231], v[152:155]
 s_cmp_eq_u32 s58, 3
 s_cselect_b32 s62, 4, 40
 s_waitcnt lgkmcnt(4)
 v_mfma_f32_16x16x32_bf16 v[40:43], a[0:3], v[180:183], v[40:43]
 ds_read_b128 a[32:35], v2 offset:24576
 s_lshl_b32 s62, s62, 10
 v_mfma_f32_16x16x32_bf16 v[44:47], a[0:3], v[188:191], v[44:47]
 v_cvt_pk_bf16_f32 v32, v32, v33
 v_cvt_pk_bf16_f32 v33, v34, v35
 v_mfma_f32_16x16x32_bf16 v[164:167], a[4:7], v[188:191], v[164:167]
 ds_read_b128 a[36:39], v2 offset:29696
 v_cvt_pk_bf16_f32 v34, v36, v37
 v_mfma_f32_16x16x32_bf16 v[160:163], a[4:7], v[180:183], v[160:163]
 v_cvt_pk_bf16_f32 v35, v38, v39
 s_add_u32 s76, s47, 40960
 v_mfma_f32_16x16x32_bf16 v[40:43], a[8:11], v[196:199], v[40:43]
 ds_read_b128 a[40:43], v2 offset:8192
 buffer_store_dwordx4 v[32:35], v2, s[80:83], s76 offen sc1
 v_mfma_f32_16x16x32_bf16 v[44:47], a[8:11], v[204:207], v[44:47]
 v_cvt_pk_bf16_f32 v152, v152, v153
 v_cvt_pk_bf16_f32 v153, v154, v155
 v_mfma_f32_16x16x32_bf16 v[164:167], a[12:15], v[204:207], v[164:167]
 ds_read_b128 a[44:47], v2 offset:13312
 v_cvt_pk_bf16_f32 v154, v156, v157
 buffer_load_dwordx4 a[112:115], v2, s[8:11], s38 offen offset:1024 sc1
 v_mfma_f32_16x16x32_bf16 v[160:163], a[12:15], v[196:199], v[160:163]
 v_cvt_pk_bf16_f32 v155, v158, v159
 s_add_u32 s76, s47, 122880
 s_waitcnt lgkmcnt(4)
 v_mfma_f32_16x16x32_bf16 v[40:43], a[16:19], v[212:215], v[40:43]
 ds_read_b128 a[48:51], v2 offset:57344
 buffer_store_dwordx4 v[152:155], v2, s[80:83], s76 offen sc1
 v_mfma_f32_16x16x32_bf16 v[44:47], a[16:19], v[220:223], v[44:47]
 v_add_u32 v252, s62, v25
 v_lshrrev_b32_e64 v140, 4, v1
 v_mfma_f32_16x16x32_bf16 v[164:167], a[20:23], v[220:223], v[164:167]
 ds_read_b128 a[52:55], v2 offset:62464
 v_bfe_u32 v141, v1, 1, 3
 v_mfma_f32_16x16x32_bf16 v[160:163], a[20:23], v[212:215], v[160:163]
 v_lshlrev_b32 v140, 1, v140
 v_sub_u32 v141, v141, v140
 v_mfma_f32_16x16x32_bf16 v[40:43], a[24:27], v[228:231], v[40:43]
 ds_read_b128 a[56:59], v2 offset:40960
 buffer_load_dwordx4 a[116:119], v2, s[12:15], s39 offen offset:0 sc1
 v_mfma_f32_16x16x32_bf16 v[44:47], a[24:27], v[236:239], v[44:47]
 v_and_b32 v140, 1, v1
 v_lshlrev_b32 v140, 4, v140
 v_mfma_f32_16x16x32_bf16 v[164:167], a[28:31], v[236:239], v[164:167]
 ds_read_b128 a[60:63], v2 offset:46080
 s_movk_i32 s62, 0x3f80
 v_mfma_f32_16x16x32_bf16 v[160:163], a[28:31], v[228:231], v[160:163]
 v_lshlrev_b32 v140, v140, s62
 s_waitcnt lgkmcnt(4)
 v_mfma_f32_16x16x32_bf16 v[48:51], a[32:35], v[180:183], v[48:51]
 ds_read_b128 a[0:3], v4 offset:44032
 v_mfma_f32_16x16x32_bf16 v[52:55], a[32:35], v[188:191], v[52:55]
 v_cvt_pk_bf16_f32 v40, v40, v41
 v_cvt_pk_bf16_f32 v41, v42, v43
 v_mfma_f32_16x16x32_bf16 v[172:175], a[36:39], v[188:191], v[172:175]
 ds_read_b128 a[4:7], v4 offset:49152
 v_cvt_pk_bf16_f32 v42, v44, v45
 buffer_load_dwordx4 a[120:123], v2, s[12:15], s39 offen offset:1024 sc1
 v_mfma_f32_16x16x32_bf16 v[168:171], a[36:39], v[180:183], v[168:171]
 v_cvt_pk_bf16_f32 v43, v46, v47
 s_add_u32 s76, s47, 49152
 v_mfma_f32_16x16x32_bf16 v[48:51], a[40:43], v[196:199], v[48:51]
 ds_read_b128 a[8:11], v4 offset:54272
 buffer_store_dwordx4 v[40:43], v2, s[80:83], s76 offen sc1
 v_mfma_f32_16x16x32_bf16 v[52:55], a[40:43], v[204:207], v[52:55]
 v_cvt_pk_bf16_f32 v160, v160, v161
 v_cvt_pk_bf16_f32 v161, v162, v163
 v_mfma_f32_16x16x32_bf16 v[172:175], a[44:47], v[204:207], v[172:175]
 ds_read_b128 a[12:15], v4 offset:59392
 v_cvt_pk_bf16_f32 v162, v164, v165
 v_mfma_f32_16x16x32_bf16 v[168:171], a[44:47], v[196:199], v[168:171]
 v_cvt_pk_bf16_f32 v163, v166, v167
 s_add_u32 s76, s47, 131072
 s_waitcnt lgkmcnt(4)
 v_mfma_f32_16x16x32_bf16 v[48:51], a[48:51], v[212:215], v[48:51]
 ds_read_b128 a[16:19], v4 offset:64512
 buffer_store_dwordx4 v[160:163], v2, s[80:83], s76 offen sc1
 v_mfma_f32_16x16x32_bf16 v[52:55], a[48:51], v[220:223], v[52:55]
 v_cmp_eq_u32 vcc, 0, v141
 s_nop 1
 v_cndmask_b32 v142, 0, v140, vcc
 v_mfma_f32_16x16x32_bf16 v[172:175], a[52:55], v[220:223], v[172:175]
 ds_read_b128 a[20:23], v5 offset:4096
 buffer_load_dwordx4 a[124:127], v2, s[12:15], s39 offen offset:2048 sc1
 v_mfma_f32_16x16x32_bf16 v[168:171], a[52:55], v[212:215], v[168:171]
 v_cmp_eq_u32 vcc, 1, v141
 s_nop 1
 v_cndmask_b32 v143, 0, v140, vcc
 v_mfma_f32_16x16x32_bf16 v[48:51], a[56:59], v[228:231], v[48:51]
 ds_read_b128 a[24:27], v5 offset:9216
 v_mov_b64 v[140:141], 0
 v_mfma_f32_16x16x32_bf16 v[52:55], a[56:59], v[236:239], v[52:55]
 v_mfma_f32_16x16x32_bf16 v[172:175], a[60:63], v[236:239], v[172:175]
 ds_read_b128 a[28:31], v5 offset:14336
 v_mfma_f32_16x16x32_bf16 v[168:171], a[60:63], v[228:231], v[168:171]
 s_waitcnt lgkmcnt(4)
 v_mfma_f32_16x16x32_bf16 v[56:59], a[0:3], a[192:195], v[56:59]
 ds_read_b128 a[32:35], v5 offset:19456
 buffer_load_dwordx4 a[160:163], v2, s[12:15], s39 offen offset:3072 sc1
 v_mfma_f32_16x16x32_bf16 v[60:63], a[0:3], a[196:199], v[60:63]
 v_cvt_pk_bf16_f32 v48, v48, v49
 v_cvt_pk_bf16_f32 v49, v50, v51
 v_mfma_f32_16x16x32_bf16 v[12:15], a[4:7], a[196:199], v[12:15]
 ds_read_b128 a[36:39], v2 offset:20480
 v_cvt_pk_bf16_f32 v50, v52, v53
 v_mfma_f32_16x16x32_bf16 v[8:11], a[4:7], a[192:195], v[8:11]
 v_cvt_pk_bf16_f32 v51, v54, v55
 s_add_u32 s76, s47, 57344
 v_mfma_f32_16x16x32_bf16 v[56:59], a[8:11], a[200:203], v[56:59]
 ds_read_b128 a[40:43], v5 offset:23552
 buffer_store_dwordx4 v[48:51], v2, s[80:83], s76 offen sc1
 v_mfma_f32_16x16x32_bf16 v[60:63], a[8:11], a[204:207], v[60:63]
 v_cvt_pk_bf16_f32 v168, v168, v169
 v_cvt_pk_bf16_f32 v169, v170, v171
 v_mfma_f32_16x16x32_bf16 v[12:15], a[12:15], a[204:207], v[12:15]
 ds_read_b128 a[44:47], v2 offset:4096
 v_cvt_pk_bf16_f32 v170, v172, v173
 buffer_load_dwordx4 a[164:167], v3, s[12:15], s39 offen offset:0 sc1
 v_mfma_f32_16x16x32_bf16 v[8:11], a[12:15], a[200:203], v[8:11]
 v_cvt_pk_bf16_f32 v171, v174, v175
 s_add_u32 s76, s47, 139264
 s_waitcnt lgkmcnt(4)
 v_mfma_f32_16x16x32_bf16 v[56:59], a[16:19], a[208:211], v[56:59]
 ds_read_b128 a[48:51], v5 offset:27648
 buffer_store_dwordx4 v[168:171], v2, s[80:83], s76 offen sc1
 v_mfma_f32_16x16x32_bf16 v[60:63], a[16:19], a[212:215], v[60:63]
 v_mfma_f32_16x16x32_bf16 v[12:15], a[20:23], a[212:215], v[12:15]
 ds_read_b128 a[52:55], v2 offset:53248
 v_mfma_f32_16x16x32_bf16 v[8:11], a[20:23], a[208:211], v[8:11]
 s_add_u32 s39, s39, 40960
 v_mfma_f32_16x16x32_bf16 v[56:59], a[24:27], a[216:219], v[56:59]
 ds_read_b128 a[56:59], v5 offset:31744
 buffer_load_dwordx4 a[168:171], v2, s[8:11], s35 offen offset:2048 sc1
 v_mfma_f32_16x16x32_bf16 v[60:63], a[24:27], a[220:223], v[60:63]
 v_mfma_f32_16x16x32_bf16 v[12:15], a[28:31], a[220:223], v[12:15]
 ds_read_b128 a[60:63], v2 offset:36864
 v_mfma_f32_16x16x32_bf16 v[8:11], a[28:31], a[216:219], v[8:11]
 s_waitcnt lgkmcnt(4)
 v_mfma_f32_16x16x32_bf16 v[56:59], a[32:35], a[224:227], v[56:59]
 ds_read_b128 a[0:3], v2 offset:25600
 v_mfma_f32_16x16x32_bf16 v[60:63], a[32:35], a[228:231], v[60:63]
 v_mfma_f32_16x16x32_bf16 v[12:15], a[36:39], a[228:231], v[12:15]
 ds_read_b128 a[4:7], v2 offset:30720
 buffer_load_dwordx4 a[172:175], v2, s[8:11], s36 offen offset:2048 sc1
 v_mfma_f32_16x16x32_bf16 v[8:11], a[36:39], a[224:227], v[8:11]
 v_mfma_f32_16x16x32_bf16 v[56:59], a[40:43], a[232:235], v[56:59]
 ds_read_b128 a[8:11], v2 offset:9216
 v_mfma_f32_16x16x32_bf16 v[60:63], a[40:43], a[236:239], v[60:63]
 v_mfma_f32_16x16x32_bf16 v[12:15], a[44:47], a[236:239], v[12:15]
 ds_read_b128 a[12:15], v2 offset:14336
 v_mfma_f32_16x16x32_bf16 v[8:11], a[44:47], a[232:235], v[8:11]
 s_waitcnt lgkmcnt(4)
 v_mfma_f32_16x16x32_bf16 v[56:59], a[48:51], a[240:243], v[56:59]
 ds_read_b128 a[16:19], v2 offset:58368
 buffer_load_dwordx4 a[176:179], v2, s[8:11], s37 offen offset:2048 sc1
 v_mfma_f32_16x16x32_bf16 v[60:63], a[48:51], a[244:247], v[60:63]
 v_mfma_f32_16x16x32_bf16 v[12:15], a[52:55], a[244:247], v[12:15]
 ds_read_b128 a[20:23], v2 offset:63488
 v_mfma_f32_16x16x32_bf16 v[8:11], a[52:55], a[240:243], v[8:11]
 v_mfma_f32_16x16x32_bf16 v[56:59], a[56:59], a[248:251], v[56:59]
 ds_read_b128 a[24:27], v2 offset:41984
 v_mfma_f32_16x16x32_bf16 v[60:63], a[56:59], a[252:255], v[60:63]
 v_mfma_f32_16x16x32_bf16 v[12:15], a[60:63], a[252:255], v[12:15]
 ds_read_b128 a[28:31], v2 offset:47104
 buffer_load_dwordx4 a[180:183], v2, s[8:11], s38 offen offset:2048 sc1
 v_mfma_f32_16x16x32_bf16 v[8:11], a[60:63], a[248:251], v[8:11]
 s_waitcnt lgkmcnt(4)
 v_mfma_f32_16x16x32_bf16 v[56:59], a[0:3], v[180:183], v[56:59]
 ds_read_b128 a[32:35], v4 offset:45056
 v_mfma_f32_16x16x32_bf16 v[60:63], a[0:3], v[188:191], v[60:63]
 v_mfma_f32_16x16x32_bf16 v[12:15], a[4:7], v[188:191], v[12:15]
 ds_read_b128 a[36:39], v4 offset:50176
 buffer_load_dword v28, v27, s[24:27], 0 offen sc1
 v_mfma_f32_16x16x32_bf16 v[8:11], a[4:7], v[180:183], v[8:11]
 v_mfma_f32_16x16x32_bf16 v[56:59], a[8:11], v[196:199], v[56:59]
 ds_read_b128 a[40:43], v4 offset:55296
 buffer_load_dwordx4 a[184:187], v2, s[12:15], s39 offen offset:0 sc1
 v_mfma_f32_16x16x32_bf16 v[60:63], a[8:11], v[204:207], v[60:63]
 v_mfma_f32_16x16x32_bf16 v[12:15], a[12:15], v[204:207], v[12:15]
 ds_read_b128 a[44:47], v4 offset:60416
 v_mfma_f32_16x16x32_bf16 v[8:11], a[12:15], v[196:199], v[8:11]
 s_waitcnt lgkmcnt(4)
 v_mfma_f32_16x16x32_bf16 v[56:59], a[16:19], v[212:215], v[56:59]
 ds_read_b128 a[48:51], v5 offset:0
 v_mfma_f32_16x16x32_bf16 v[60:63], a[16:19], v[220:223], v[60:63]
 v_mfma_f32_16x16x32_bf16 v[12:15], a[20:23], v[220:223], v[12:15]
 ds_read_b128 a[52:55], v5 offset:5120
 buffer_load_dwordx4 a[188:191], v2, s[12:15], s39 offen offset:1024 sc1
 v_mfma_f32_16x16x32_bf16 v[8:11], a[20:23], v[212:215], v[8:11]
 v_mfma_f32_16x16x32_bf16 v[56:59], a[24:27], v[228:231], v[56:59]
 ds_read_b128 a[56:59], v5 offset:10240
 v_mfma_f32_16x16x32_bf16 v[60:63], a[24:27], v[236:239], v[60:63]
 v_mfma_f32_16x16x32_bf16 v[12:15], a[28:31], v[236:239], v[12:15]
 ds_read_b128 a[60:63], v5 offset:15360
 v_mfma_f32_16x16x32_bf16 v[8:11], a[28:31], v[228:231], v[8:11]
 s_waitcnt lgkmcnt(4)
 v_mfma_f32_16x16x32_bf16 v[144:147], a[32:35], a[192:195], v[144:147]
 ds_read_b128 a[0:3], v2 offset:16384
 buffer_load_dwordx4 v[176:179], v2, s[12:15], s39 offen offset:2048 sc1
 v_mfma_f32_16x16x32_bf16 v[148:151], a[32:35], a[196:199], v[148:151]
 v_cvt_pk_bf16_f32 v56, v56, v57
 v_cvt_pk_bf16_f32 v57, v58, v59
 v_mfma_f32_16x16x32_bf16 v[20:23], a[36:39], a[196:199], v[20:23]
 ds_read_b128 a[4:7], v2 offset:21504
 v_cvt_pk_bf16_f32 v58, v60, v61
 v_mfma_f32_16x16x32_bf16 v[16:19], a[36:39], a[192:195], v[16:19]
 v_cvt_pk_bf16_f32 v59, v62, v63
 s_add_u32 s76, s47, 65536
 v_mfma_f32_16x16x32_bf16 v[144:147], a[40:43], a[200:203], v[144:147]
 ds_read_b128 a[8:11], v2 offset:0
 buffer_store_dwordx4 v[56:59], v2, s[80:83], s76 offen sc1
 v_mfma_f32_16x16x32_bf16 v[148:151], a[40:43], a[204:207], v[148:151]
 v_cvt_pk_bf16_f32 v8, v8, v9
 v_cvt_pk_bf16_f32 v9, v10, v11
L_pg17:
 s_cbranch_execz L_hopr5
 v_mfma_f32_16x16x32_bf16 v[20:23], a[44:47], a[204:207], v[20:23]
 ds_read_b128 a[12:15], v2 offset:5120
 v_cvt_pk_bf16_f32 v10, v12, v13
 buffer_load_dwordx4 v[184:187], v2, s[12:15], s39 offen offset:3072 sc1
 v_mfma_f32_16x16x32_bf16 v[16:19], a[44:47], a[200:203], v[16:19]
 v_cvt_pk_bf16_f32 v11, v14, v15
 s_add_u32 s76, s47, 147456
 s_waitcnt lgkmcnt(4)
 v_mfma_f32_16x16x32_bf16 v[144:147], a[48:51], a[208:211], v[144:147]
 ds_read_b128 a[16:19], v2 offset:49152
 buffer_store_dwordx4 v[8:11], v2, s[80:83], s76 offen sc1
 v_mfma_f32_16x16x32_bf16 v[148:151], a[48:51], a[212:215], v[148:151]
 v_mfma_f32_16x16x32_bf16 v[20:23], a[52:55], a[212:215], v[20:23]
 ds_read_b128 a[20:23], v2 offset:54272
 v_mfma_f32_16x16x32_bf16 v[16:19], a[52:55], a[208:211], v[16:19]
 v_mfma_f32_16x16x32_bf16 v[144:147], a[56:59], a[216:219], v[144:147]
 ds_read_b128 a[24:27], v2 offset:32768
 buffer_load_dwordx4 v[192:195], v3, s[12:15], s39 offen offset:0 sc1
 v_mfma_f32_16x16x32_bf16 v[148:151], a[56:59], a[220:223], v[148:151]
 v_mfma_f32_16x16x32_bf16 v[20:23], a[60:63], a[220:223], v[20:23]
 ds_read_b128 a[28:31], v2 offset:37888
 v_mfma_f32_16x16x32_bf16 v[16:19], a[60:63], a[216:219], v[16:19]
 s_waitcnt vmcnt(12)
 v_add_u32_e64 v29, 9, v0
 buffer_store_dword v29, v26, s[24:27], 0 offen sc1
 s_waitcnt lgkmcnt(4)
 v_mfma_f32_16x16x32_bf16 v[144:147], a[0:3], a[224:227], v[144:147]
 ds_read_b128 a[32:35], v2 offset:26624
 s_waitcnt vmcnt(8)
 v_sub_u32 v28, v28, v0
 v_subrev_u32 v28, 8, v28
 v_cmp_ge_u32 vcc, 4, v28
 s_mov_b32 s79, 0
 s_cmp_eq_u64 vcc, -1
 s_cbranch_scc0 L_pl7
L_pd7:
 v_mfma_f32_16x16x32_bf16 v[148:151], a[0:3], a[228:231], v[148:151]
 buffer_load_dwordx4 v[124:127], v2, s[80:83], s40 offen offset:0 sc1
 v_mfma_f32_16x16x32_bf16 v[20:23], a[4:7], a[228:231], v[20:23]
 ds_read_b128 a[36:39], v2 offset:31744
 v_mfma_f32_16x16x32_bf16 v[16:19], a[4:7], a[224:227], v[16:19]
 v_mfma_f32_16x16x32_bf16 v[144:147], a[8:11], a[232:235], v[144:147]
 ds_read_b128 a[40:43], v2 offset:10240
 v_mfma_f32_16x16x32_bf16 v[148:151], a[8:11], a[236:239], v[148:151]
 v_mfma_f32_16x16x32_bf16 v[20:23], a[12:15], a[236:239], v[20:23]
 ds_read_b128 a[44:47], v2 offset:15360
 v_mfma_f32_16x16x32_bf16 v[16:19], a[12:15], a[232:235], v[16:19]
 buffer_load_dwordx4 v[128:131], v2, s[80:83], s40 offen offset:1024 sc1
 s_waitcnt lgkmcnt(4)
 v_mfma_f32_16x16x32_bf16 v[144:147], a[16:19], a[240:243], v[144:147]
 ds_read_b128 a[48:51], v2 offset:59392
 v_mfma_f32_16x16x32_bf16 v[148:151], a[16:19], a[244:247], v[148:151]
 v_mfma_f32_16x16x32_bf16 v[20:23], a[20:23], a[244:247], v[20:23]
 ds_read_b128 a[52:55], v2 offset:64512
 v_mfma_f32_16x16x32_bf16 v[16:19], a[20:23], a[240:243], v[16:19]
 v_mfma_f32_16x16x32_bf16 v[144:147], a[24:27], a[248:251], v[144:147]
 ds_read_b128 a[56:59], v2 offset:43008
 v_mfma_f32_16x16x32_bf16 v[148:151], a[24:27], a[252:255], v[148:151]
 buffer_load_dwordx4 v[132:135], v2, s[80:83], s40 offen offset:2048 sc1
 v_mfma_f32_16x16x32_bf16 v[20:23], a[28:31], a[252:255], v[20:23]
 ds_read_b128 a[60:63], v2 offset:48128
 v_mfma_f32_16x16x32_bf16 v[16:19], a[28:31], a[248:251], v[16:19]
 s_waitcnt lgkmcnt(4)
 v_mfma_f32_16x16x32_bf16 v[144:147], a[32:35], v[180:183], v[144:147]
 v_mfma_f32_16x16x32_bf16 v[148:151], a[32:35], v[188:191], v[148:151]
 v_mfma_f32_16x16x32_bf16 v[20:23], a[36:39], v[188:191], v[20:23]
 v_mfma_f32_16x16x32_bf16 v[16:19], a[36:39], v[180:183], v[16:19]
 buffer_load_dwordx4 v[200:203], v2, s[80:83], s40 offen offset:3072 sc1
 v_mfma_f32_16x16x32_bf16 v[144:147], a[40:43], v[196:199], v[144:147]
 v_mfma_f32_16x16x32_bf16 v[148:151], a[40:43], v[204:207], v[148:151]
 v_mfma_f32_16x16x32_bf16 v[20:23], a[44:47], v[204:207], v[20:23]
 v_mfma_f32_16x16x32_bf16 v[16:19], a[44:47], v[196:199], v[16:19]
 s_waitcnt lgkmcnt(0)
 v_mfma_f32_16x16x32_bf16 v[144:147], a[48:51], v[212:215], v[144:147]
 v_mfma_f32_16x16x32_bf16 v[148:151], a[48:51], v[220:223], v[148:151]
 buffer_load_dwordx4 v[208:211], v3, s[80:83], s40 offen offset:0 sc1
 v_mfma_f32_16x16x32_bf16 v[20:23], a[52:55], v[220:223], v[20:23]
 v_mfma_f32_16x16x32_bf16 v[16:19], a[52:55], v[212:215], v[16:19]
 v_mfma_f32_16x16x32_bf16 v[144:147], a[56:59], v[228:231], v[144:147]
 v_mfma_f32_16x16x32_bf16 v[148:151], a[56:59], v[236:239], v[148:151]
 v_mfma_f32_16x16x32_bf16 v[20:23], a[60:63], v[236:239], v[20:23]
 v_mfma_f32_16x16x32_bf16 v[16:19], a[60:63], v[228:231], v[16:19]
 buffer_load_dwordx4 v[216:219], v3, s[80:83], s40 offen offset:1024 sc1
 v_mfma_f32_16x16x32_bf16 a[140:143], a[80:83], a[64:67], a[140:143]
 v_mfma_f32_16x16x32_bf16 v[64:67], a[80:83], a[68:71], 0
 s_nop 1
 v_cvt_pk_bf16_f32 v144, v144, v145
 v_cvt_pk_bf16_f32 v145, v146, v147
 s_barrier
 v_mfma_f32_16x16x32_bf16 v[84:87], a[80:83], a[72:75], 0
 v_cvt_pk_bf16_f32 v146, v148, v149
 v_cvt_pk_bf16_f32 v147, v150, v151
 v_mfma_f32_16x16x32_bf16 v[104:107], a[80:83], a[76:79], 0
 s_add_u32 s76, s47, 73728
 buffer_store_dwordx4 v[144:147], v2, s[80:83], s76 offen sc1
 v_mfma_f32_16x16x32_bf16 a[140:143], a[116:119], a[100:103], a[140:143]
 v_cvt_pk_bf16_f32 v16, v16, v17
 v_cvt_pk_bf16_f32 v17, v18, v19
 v_mfma_f32_16x16x32_bf16 v[64:67], a[116:119], a[104:107], v[64:67]
 v_cvt_pk_bf16_f32 v18, v20, v21
 v_cvt_pk_bf16_f32 v19, v22, v23
 v_mfma_f32_16x16x32_bf16 v[84:87], a[116:119], a[108:111], v[84:87]
 s_add_u32 s76, s47, 155648
 buffer_store_dwordx4 v[16:19], v2, s[80:83], s76 offen sc1
 v_mfma_f32_16x16x32_bf16 v[104:107], a[116:119], a[112:115], v[104:107]
 s_waitcnt vmcnt(15)
 v_mfma_f32_16x16x32_bf16 a[140:143], a[184:187], a[168:171], a[140:143]
 buffer_load_dwordx4 v[224:227], v3, s[80:83], s40 offen offset:2048 sc1
 v_mfma_f32_16x16x32_bf16 v[64:67], a[184:187], a[172:175], v[64:67]
 v_mfma_f32_16x16x32_bf16 v[84:87], a[184:187], a[176:179], v[84:87]
 v_mfma_f32_16x16x32_bf16 v[104:107], a[184:187], a[180:183], v[104:107]
 v_mfma_f32_16x16x32_bf16 a[144:147], a[84:87], a[64:67], a[144:147]
 s_nop 2
 ds_write_b128 v136, a[140:143] offset:0
 v_mfma_f32_16x16x32_bf16 v[68:71], a[84:87], a[68:71], 0
 v_mfma_f32_16x16x32_bf16 v[88:91], a[84:87], a[72:75], 0
 buffer_load_dwordx4 v[232:235], v3, s[80:83], s40 offen offset:3072 sc1
 v_mfma_f32_16x16x32_bf16 v[108:111], a[84:87], a[76:79], 0
 ds_write_b128 v137, v[64:67] offset:0
 v_mfma_f32_16x16x32_bf16 a[144:147], a[120:123], a[100:103], a[144:147]
 v_mfma_f32_16x16x32_bf16 v[68:71], a[120:123], a[104:107], v[68:71]
 buffer_load_dword v28, v27, s[24:27], 0 offen sc1
 v_mfma_f32_16x16x32_bf16 v[88:91], a[120:123], a[108:111], v[88:91]
 ds_write_b128 v138, v[84:87] offset:0
 v_mfma_f32_16x16x32_bf16 v[108:111], a[120:123], a[112:115], v[108:111]
 s_waitcnt vmcnt(17)
 v_mfma_f32_16x16x32_bf16 a[144:147], a[188:191], a[168:171], a[144:147]
 v_mfma_f32_16x16x32_bf16 v[68:71], a[188:191], a[172:175], v[68:71]
 ds_write_b128 v139, v[104:107] offset:0
 v_mfma_f32_16x16x32_bf16 v[88:91], a[188:191], a[176:179], v[88:91]
 v_mfma_f32_16x16x32_bf16 v[108:111], a[188:191], a[180:183], v[108:111]
 v_mfma_f32_16x16x32_bf16 a[148:151], a[88:91], a[64:67], a[148:151]
 s_nop 2
 ds_write_b128 v136, a[144:147] offset:4096
 v_mfma_f32_16x16x32_bf16 v[72:75], a[88:91], a[68:71], 0
 v_mfma_f32_16x16x32_bf16 v[92:95], a[88:91], a[72:75], 0
 v_mfma_f32_16x16x32_bf16 v[112:115], a[88:91], a[76:79], 0
 ds_write_b128 v137, v[68:71] offset:4096
 v_mfma_f32_16x16x32_bf16 a[148:151], a[124:127], a[100:103], a[148:151]
 v_mfma_f32_16x16x32_bf16 v[72:75], a[124:127], a[104:107], v[72:75]
 v_mfma_f32_16x16x32_bf16 v[92:95], a[124:127], a[108:111], v[92:95]
 ds_write_b128 v138, v[88:91] offset:4096
 v_mfma_f32_16x16x32_bf16 v[112:115], a[124:127], a[112:115], v[112:115]
 s_waitcnt vmcnt(16)
 v_mfma_f32_16x16x32_bf16 a[148:151], v[176:179], a[168:171], a[148:151]
 v_mfma_f32_16x16x32_bf16 v[72:75], v[176:179], a[172:175], v[72:75]
 ds_write_b128 v139, v[108:111] offset:4096
 v_mfma_f32_16x16x32_bf16 v[92:95], v[176:179], a[176:179], v[92:95]
 v_mfma_f32_16x16x32_bf16 v[112:115], v[176:179], a[180:183], v[112:115]
 v_mfma_f32_16x16x32_bf16 a[152:155], a[92:95], a[64:67], a[152:155]
 s_nop 2
 ds_write_b128 v136, a[148:151] offset:8192
 v_mfma_f32_16x16x32_bf16 v[76:79], a[92:95], a[68:71], 0
 v_mfma_f32_16x16x32_bf16 v[96:99], a[92:95], a[72:75], 0
 v_mfma_f32_16x16x32_bf16 v[116:119], a[92:95], a[76:79], 0
 ds_write_b128 v137, v[72:75] offset:8192
 v_mfma_f32_16x16x32_bf16 a[152:155], a[160:163], a[100:103], a[152:155]
 v_mfma_f32_16x16x32_bf16 v[76:79], a[160:163], a[104:107], v[76:79]
 v_mfma_f32_16x16x32_bf16 v[96:99], a[160:163], a[108:111], v[96:99]
 ds_write_b128 v138, v[92:95] offset:8192
 v_mfma_f32_16x16x32_bf16 v[116:119], a[160:163], a[112:115], v[116:119]
 s_waitcnt vmcnt(14)
 v_mfma_f32_16x16x32_bf16 a[152:155], v[184:187], a[168:171], a[152:155]
 v_mfma_f32_16x16x32_bf16 v[76:79], v[184:187], a[172:175], v[76:79]
 ds_write_b128 v139, v[112:115] offset:8192
 v_mfma_f32_16x16x32_bf16 v[96:99], v[184:187], a[176:179], v[96:99]
 v_mfma_f32_16x16x32_bf16 v[116:119], v[184:187], a[180:183], v[116:119]
 v_mfma_f32_16x16x32_bf16 a[156:159], a[96:99], a[64:67], a[156:159]
 s_nop 2
 ds_write_b128 v136, a[152:155] offset:12288
 v_mfma_f32_16x16x32_bf16 v[80:83], a[96:99], a[68:71], 0
 v_mfma_f32_16x16x32_bf16 v[100:103], a[96:99], a[72:75], 0
 v_mfma_f32_16x16x32_bf16 v[120:123], a[96:99], a[76:79], 0
 ds_write_b128 v137, v[76:79] offset:12288
 v_mfma_f32_16x16x32_bf16 a[156:159], a[164:167], a[100:103], a[156:159]
 v_mfma_f32_16x16x32_bf16 v[80:83], a[164:167], a[104:107], v[80:83]
 v_mfma_f32_16x16x32_bf16 v[100:103], a[164:167], a[108:111], v[100:103]
 ds_write_b128 v138, v[96:99] offset:12288
 v_mfma_f32_16x16x32_bf16 v[120:123], a[164:167], a[112:115], v[120:123]
 s_waitcnt vmcnt(12)
 v_mfma_f32_16x16x32_bf16 a[156:159], v[192:195], a[168:171], a[156:159]
 v_mfma_f32_16x16x32_bf16 v[80:83], v[192:195], a[172:175], v[80:83]
 ds_write_b128 v139, v[116:119] offset:12288
 v_mfma_f32_16x16x32_bf16 v[100:103], v[192:195], a[176:179], v[100:103]
 v_mfma_f32_16x16x32_bf16 v[120:123], v[192:195], a[180:183], v[120:123]
 s_nop 3
 ds_write_b128 v136, a[156:159] offset:16384
 ds_write_b128 v137, v[80:83] offset:16384
 s_nop 0
 ds_write_b128 v138, v[100:103] offset:16384
 ds_write_b128 v139, v[120:123] offset:16384
 s_add_u32 s40, s41, 24576
 s_mov_b32 s3, 0xbfb8aa3b
 s_waitcnt lgkmcnt(0)
 s_barrier
 ds_read_b128 v[64:67], v25 offset:0
 ds_read_b128 v[68:71], v25 offset:1024
 ds_read_b128 v[72:75], v25 offset:2048
 ds_read_b128 v[76:79], v25 offset:3072
 ds_read_b128 v[80:83], v25 offset:20480
 ds_read_b128 v[84:87], v25 offset:21504
 ds_read_b128 v[88:91], v25 offset:22528
 ds_read_b128 v[92:95], v25 offset:23552
 ds_read_b128 v[96:99], v252 offset:0
 ds_read_b128 v[100:103], v252 offset:1024
 ds_read_b128 v[104:107], v252 offset:2048
 ds_read_b128 v[108:111], v252 offset:3072
 ds_read_b128 v[160:163], v252 offset:20480
 ds_read_b128 v[164:167], v252 offset:21504
 ds_read_b128 v[168:171], v252 offset:22528
 ds_read_b128 v[172:175], v252 offset:23552
 s_waitcnt vmcnt(3)
 v_add_u32 v29, 10, v0
 buffer_store_dword v29, v26, s[24:27], 0 offen sc1
 s_waitcnt vmcnt(1)
 v_sub_u32 v28, v28, v0
 v_subrev_u32 v28, 9, v28
 v_cmp_ge_u32 vcc, 3, v28
 s_mov_b32 s79, 0
 s_cmp_eq_u64 vcc, -1
 s_cbranch_scc0 L_pl8
L_pd8:
 buffer_load_dwordx4 v[32:35], v2, s[80:83], s41 offen offset:0 sc1
 buffer_load_dwordx4 v[36:39], v2, s[80:83], s41 offen offset:1024 sc1
 buffer_load_dwordx4 v[40:43], v2, s[80:83], s41 offen offset:2048 sc1
 buffer_load_dwordx4 v[44:47], v2, s[80:83], s41 offen offset:3072 sc1
 buffer_load_dwordx4 v[48:51], v3, s[80:83], s41 offen offset:0 sc1
 buffer_load_dwordx4 v[52:55], v3, s[80:83], s41 offen offset:1024 sc1
 buffer_load_dwordx4 v[152:155], v3, s[80:83], s41 offen offset:2048 sc1
 buffer_load_dwordx4 v[156:159], v3, s[80:83], s41 offen offset:3072 sc1
 v_mov_b64 v[144:145], 0
 ds_read_b128 v[176:179], v252 offset:12288
 ds_read_b128 v[180:183], v252 offset:13312
 ds_read_b128 v[184:187], v252 offset:14336
 ds_read_b128 v[188:191], v252 offset:15360
 ds_read_b128 v[8:11], v252 offset:32768
 ds_read_b128 v[12:15], v252 offset:33792
 ds_read_b128 v[16:19], v252 offset:34816
 ds_read_b128 v[20:23], v252 offset:35840
 s_waitcnt lgkmcnt(15)
 v_pk_add_f32 v[64:65], v[64:65], v[68:69]
 v_pk_add_f32 v[66:67], v[66:67], v[70:71]
 v_pk_add_f32 v[72:73], v[72:73], v[76:77]
 v_mfma_f32_16x16x32_bf16 v[112:115], v[142:145], v[124:127], 0
 v_pk_add_f32 v[74:75], v[74:75], v[78:79]
 v_pk_add_f32 v[64:65], v[64:65], v[72:73]
 v_pk_add_f32 v[66:67], v[66:67], v[74:75]
 v_mfma_f32_16x16x32_bf16 v[116:119], v[140:143], v[124:127], 0
 v_mul_f32 v68, s3, v64
 v_mul_f32 v69, s3, v65
 v_mul_f32 v70, s3, v66
 v_mfma_f32_16x16x32_bf16 v[112:115], v[142:145], v[128:131], v[112:115]
 v_mul_f32 v71, s3, v67
 v_exp_f32 v68, v68
 v_exp_f32_e64 v69, v69
 v_mfma_f32_16x16x32_bf16 v[116:119], v[140:143], v[128:131], v[116:119]
 v_exp_f32 v70, v70
 v_exp_f32 v71, v71
 v_lshlrev_b32_e64 v72, 16, v240
 v_mfma_f32_16x16x32_bf16 v[112:115], v[142:145], v[132:135], v[112:115]
 v_lshlrev_b32 v74, 16, v241
 v_add_f32 v68, 1.0, v68
 v_add_f32_e64 v69, 1.0, v69
 v_mfma_f32_16x16x32_bf16 v[116:119], v[140:143], v[132:135], v[116:119]
 v_add_f32 v70, 1.0, v70
 v_add_f32 v71, 1.0, v71
 v_rcp_f32_e64 v68, v68
 v_mfma_f32_16x16x32_bf16 v[112:115], v[142:145], v[200:203], v[112:115]
 v_rcp_f32 v69, v69
 v_rcp_f32 v70, v70
 buffer_load_dword v28, v27, s[24:27], 0 offen sc1
 v_rcp_f32_e64 v71, v71
 v_mfma_f32_16x16x32_bf16 v[116:119], v[140:143], v[200:203], v[116:119]
 v_and_b32 v73, s61, v240
 v_and_b32 v75, s61, v241
 v_pk_mul_f32 v[64:65], v[64:65], v[68:69]
 v_mfma_f32_16x16x32_bf16 v[112:115], v[142:145], v[208:211], v[112:115]
 v_pk_mul_f32 v[66:67], v[66:67], v[70:71]
 v_pk_add_f32 v[80:81], v[80:81], v[84:85]
 v_pk_add_f32 v[82:83], v[82:83], v[86:87]
 v_mfma_f32_16x16x32_bf16 v[116:119], v[140:143], v[208:211], v[116:119]
 v_pk_add_f32 v[88:89], v[88:89], v[92:93]
 v_pk_add_f32 v[90:91], v[90:91], v[94:95]
 v_pk_add_f32 v[80:81], v[80:81], v[88:89]
 v_mfma_f32_16x16x32_bf16 v[112:115], v[142:145], v[216:219], v[112:115]
 v_pk_add_f32 v[82:83], v[82:83], v[90:91]
 v_mul_f32 v84, s3, v80
 v_mul_f32 v85, s3, v81
 v_mfma_f32_16x16x32_bf16 v[116:119], v[140:143], v[216:219], v[116:119]
 v_mul_f32 v86, s3, v82
 v_mul_f32 v87, s3, v83
 v_exp_f32_e64 v84, v84
 v_mfma_f32_16x16x32_bf16 v[112:115], v[142:145], v[224:227], v[112:115]
 v_exp_f32 v85, v85
 v_exp_f32 v86, v86
 v_exp_f32_e64 v87, v87
 v_mfma_f32_16x16x32_bf16 v[116:119], v[140:143], v[224:227], v[116:119]
 v_lshlrev_b32 v88, 16, v242
 v_lshlrev_b32 v90, 16, v243
 v_add_f32_e64 v84, 1.0, v84
 v_mfma_f32_16x16x32_bf16 v[112:115], v[142:145], v[232:235], v[112:115]
 v_add_f32 v85, 1.0, v85
 v_add_f32 v86, 1.0, v86
 v_add_f32_e64 v87, 1.0, v87
 v_mfma_f32_16x16x32_bf16 v[116:119], v[140:143], v[232:235], v[116:119]
 v_rcp_f32 v84, v84
 v_rcp_f32 v85, v85
 v_rcp_f32 v86, v86
 v_rcp_f32 v87, v87
 v_and_b32 v89, s61, v242
 v_and_b32 v91, s61, v243
 v_pk_mul_f32 v[80:81], v[80:81], v[84:85]
 v_pk_mul_f32 v[82:83], v[82:83], v[86:87]
 v_pk_fma_f32 v[112:113], v[112:113], v[64:65], v[72:73]
 v_pk_fma_f32 v[114:115], v[114:115], v[66:67], v[74:75]
 v_pk_fma_f32 v[116:117], v[116:117], v[80:81], v[88:89]
 v_pk_fma_f32 v[118:119], v[118:119], v[82:83], v[90:91]
 v_cvt_pk_bf16_f32 v112, v112, v113
 v_cvt_pk_bf16_f32 v113, v114, v115
 ds_bpermute_b32 v112, v253, v112
 ds_bpermute_b32 v113, v253, v113
 v_cvt_pk_bf16_f32 v116, v116, v117
 v_cvt_pk_bf16_f32 v117, v118, v119
 ds_bpermute_b32 v116, v253, v116
 ds_bpermute_b32 v117, v253, v117
 s_waitcnt lgkmcnt(4)
 v_pk_add_f32 v[96:97], v[96:97], v[100:101]
 v_pk_add_f32 v[98:99], v[98:99], v[102:103]
 v_pk_add_f32 v[104:105], v[104:105], v[108:109]
 s_waitcnt vmcnt(8)
 v_mfma_f32_16x16x32_bf16 v[120:123], v[142:145], v[32:35], 0
 v_pk_add_f32 v[106:107], v[106:107], v[110:111]
 v_pk_add_f32 v[96:97], v[96:97], v[104:105]
 v_pk_add_f32 v[98:99], v[98:99], v[106:107]
 v_mfma_f32_16x16x32_bf16 v[56:59], v[140:143], v[32:35], 0
 v_mul_f32 v100, s3, v96
 v_mul_f32 v101, s3, v97
 v_mul_f32 v102, s3, v98
 s_waitcnt vmcnt(7)
 v_mfma_f32_16x16x32_bf16 v[120:123], v[142:145], v[36:39], v[120:123]
 v_mul_f32 v103, s3, v99
 v_exp_f32 v100, v100
 v_exp_f32_e64 v101, v101
 v_mfma_f32_16x16x32_bf16 v[56:59], v[140:143], v[36:39], v[56:59]
 v_exp_f32 v102, v102
 v_exp_f32 v103, v103
 v_lshlrev_b32 v104, 16, v244
 s_waitcnt vmcnt(6)
 v_mfma_f32_16x16x32_bf16 v[120:123], v[142:145], v[40:43], v[120:123]
 v_lshlrev_b32 v106, 16, v245
 v_add_f32 v100, 1.0, v100
 v_add_f32_e64 v101, 1.0, v101
 v_mfma_f32_16x16x32_bf16 v[56:59], v[140:143], v[40:43], v[56:59]
 s_waitcnt lgkmcnt(2)
 buffer_store_dwordx2 v[112:113], v6, s[4:7], s42 offen offset:0
 s_waitcnt lgkmcnt(0)
 buffer_store_dwordx2 v[116:117], v24, s[4:7], s42 offen offset:0
 s_waitcnt vmcnt(2)
 v_sub_u32 v28, v28, v0
 v_subrev_u32 v28, 10, v28
 v_cmp_ge_u32 vcc, 2, v28
 s_mov_b32 s79, 0
 s_cmp_eq_u64 vcc, -1
 s_cbranch_scc0 L_pl9
L_pd9:
 s_cmp_lt_u32 s58, 2
 s_cselect_b32 s40, s40, s41
 s_cselect_b64 exec, -1, 1
 buffer_load_dwordx4 a[192:195], v2, s[80:83], s40 offen offset:0 sc1
 buffer_load_dwordx4 a[196:199], v2, s[80:83], s40 offen offset:1024 sc1
 buffer_load_dwordx4 a[200:203], v2, s[80:83], s40 offen offset:2048 sc1
 buffer_load_dwordx4 a[204:207], v2, s[80:83], s40 offen offset:3072 sc1
 buffer_load_dwordx4 a[208:211], v3, s[80:83], s40 offen offset:0 sc1
 buffer_load_dwordx4 a[212:215], v3, s[80:83], s40 offen offset:1024 sc1
 buffer_load_dwordx4 a[216:219], v3, s[80:83], s40 offen offset:2048 sc1
 buffer_load_dwordx4 a[220:223], v3, s[80:83], s40 offen offset:3072 sc1
 s_mov_b64 exec, -1
 v_add_f32 v102, 1.0, v102
 v_add_f32 v103, 1.0, v103
 v_rcp_f32 v100, v100
 v_mfma_f32_16x16x32_bf16 v[120:123], v[142:145], v[44:47], v[120:123]
 v_rcp_f32 v101, v101
 v_rcp_f32 v102, v102
 v_rcp_f32_e64 v103, v103
 v_mfma_f32_16x16x32_bf16 v[56:59], v[140:143], v[44:47], v[56:59]
 v_and_b32 v105, s61, v244
 v_and_b32 v107, s61, v245
 v_pk_mul_f32 v[96:97], v[96:97], v[100:101]
 v_mfma_f32_16x16x32_bf16 v[120:123], v[142:145], v[48:51], v[120:123]
 v_pk_mul_f32 v[98:99], v[98:99], v[102:103]
 v_pk_add_f32 v[160:161], v[160:161], v[164:165]
 v_pk_add_f32 v[162:163], v[162:163], v[166:167]
 v_mfma_f32_16x16x32_bf16 v[56:59], v[140:143], v[48:51], v[56:59]
 v_pk_add_f32 v[168:169], v[168:169], v[172:173]
 v_pk_add_f32 v[170:171], v[170:171], v[174:175]
 v_pk_add_f32 v[160:161], v[160:161], v[168:169]
 v_mfma_f32_16x16x32_bf16 v[120:123], v[142:145], v[52:55], v[120:123]
 v_pk_add_f32 v[162:163], v[162:163], v[170:171]
 v_mul_f32 v164, s3, v160
 v_mul_f32 v165, s3, v161
 v_mfma_f32_16x16x32_bf16 v[56:59], v[140:143], v[52:55], v[56:59]
 v_mul_f32 v166, s3, v162
 v_mul_f32 v167, s3, v163
 v_exp_f32_e64 v164, v164
 v_mfma_f32_16x16x32_bf16 v[120:123], v[142:145], v[152:155], v[120:123]
 v_exp_f32 v165, v165
 v_exp_f32 v166, v166
 v_exp_f32_e64 v167, v167
 v_mfma_f32_16x16x32_bf16 v[56:59], v[140:143], v[152:155], v[56:59]
 v_lshlrev_b32 v168, 16, v246
 v_lshlrev_b32 v170, 16, v247
 v_add_f32_e64 v164, 1.0, v164
 v_mfma_f32_16x16x32_bf16 v[120:123], v[142:145], v[156:159], v[120:123]
 v_add_f32 v165, 1.0, v165
 v_add_f32 v166, 1.0, v166
 v_add_f32_e64 v167, 1.0, v167
 v_mfma_f32_16x16x32_bf16 v[56:59], v[140:143], v[156:159], v[56:59]
 v_rcp_f32 v164, v164
 v_rcp_f32 v165, v165
 v_rcp_f32 v166, v166
 v_rcp_f32 v167, v167
 v_and_b32 v169, s61, v246
 v_and_b32 v171, s61, v247
 v_pk_mul_f32 v[160:161], v[160:161], v[164:165]
 v_pk_mul_f32 v[162:163], v[162:163], v[166:167]
 v_pk_fma_f32 v[120:121], v[120:121], v[96:97], v[104:105]
 v_pk_fma_f32 v[122:123], v[122:123], v[98:99], v[106:107]
 v_pk_fma_f32 v[56:57], v[56:57], v[160:161], v[168:169]
 v_pk_fma_f32 v[58:59], v[58:59], v[162:163], v[170:171]
 v_cvt_pk_bf16_f32 v120, v120, v121
 v_cvt_pk_bf16_f32 v121, v122, v123
 ds_bpermute_b32 v120, v253, v120
 ds_bpermute_b32 v121, v253, v121
 v_cvt_pk_bf16_f32 v56, v56, v57
 v_cvt_pk_bf16_f32 v57, v58, v59
 ds_bpermute_b32 v56, v253, v56
 ds_bpermute_b32 v57, v253, v57
 s_waitcnt lgkmcnt(2)
 buffer_store_dwordx2 v[120:121], v6, s[4:7], s43 offen offset:0
 s_waitcnt lgkmcnt(0)
 buffer_store_dwordx2 v[56:57], v24, s[4:7], s43 offen offset:0
 s_cmp_lt_u32 s58, 2
 s_cbranch_scc0 L_fin
 v_pk_add_f32 v[176:177], v[176:177], v[180:181]
 v_pk_add_f32 v[178:179], v[178:179], v[182:183]
 v_pk_add_f32 v[184:185], v[184:185], v[188:189]
 v_pk_add_f32 v[186:187], v[186:187], v[190:191]
 v_pk_add_f32 v[176:177], v[176:177], v[184:185]
 v_pk_add_f32 v[178:179], v[178:179], v[186:187]
 v_mul_f32 v180, s3, v176
 v_mul_f32 v181, s3, v177
 v_mul_f32 v182, s3, v178
 v_mul_f32 v183, s3, v179
 v_exp_f32 v180, v180
 v_exp_f32 v181, v181
 v_exp_f32 v182, v182
 v_exp_f32 v183, v183
 v_lshlrev_b32 v184, 16, v248
 v_lshlrev_b32 v186, 16, v249
 v_add_f32 v180, 1.0, v180
 v_add_f32 v181, 1.0, v181
 v_add_f32 v182, 1.0, v182
 v_add_f32 v183, 1.0, v183
 v_rcp_f32 v180, v180
 v_rcp_f32 v181, v181
 v_rcp_f32 v182, v182
 v_rcp_f32 v183, v183
 v_and_b32 v185, s61, v248
 v_and_b32 v187, s61, v249
 v_pk_mul_f32 v[176:177], v[176:177], v[180:181]
 v_pk_mul_f32 v[178:179], v[178:179], v[182:183]
 v_pk_add_f32 v[8:9], v[8:9], v[12:13]
 v_pk_add_f32 v[10:11], v[10:11], v[14:15]
 v_pk_add_f32 v[16:17], v[16:17], v[20:21]
 v_pk_add_f32 v[18:19], v[18:19], v[22:23]
 v_pk_add_f32 v[8:9], v[8:9], v[16:17]
 v_pk_add_f32 v[10:11], v[10:11], v[18:19]
 v_mul_f32 v12, s3, v8
 v_mul_f32 v13, s3, v9
 v_mul_f32 v14, s3, v10
 v_mul_f32 v15, s3, v11
 v_exp_f32 v12, v12
 v_exp_f32 v13, v13
 v_exp_f32 v14, v14
 v_exp_f32 v15, v15
 v_lshlrev_b32 v16, 16, v250
 v_lshlrev_b32 v18, 16, v251
 v_add_f32 v12, 1.0, v12
 v_add_f32 v13, 1.0, v13
 v_add_f32 v14, 1.0, v14
 v_add_f32 v15, 1.0, v15
 v_rcp_f32 v12, v12
 v_rcp_f32 v13, v13
 v_rcp_f32 v14, v14
 v_rcp_f32 v15, v15
 v_and_b32 v17, s61, v250
 v_and_b32 v19, s61, v251
 v_pk_mul_f32 v[8:9], v[8:9], v[12:13]
 v_pk_mul_f32 v[10:11], v[10:11], v[14:15]
 s_waitcnt vmcnt(9)
 v_mfma_f32_16x16x32_bf16 v[60:63], v[142:145], a[192:195], 0
 v_mfma_f32_16x16x32_bf16 v[148:151], v[140:143], a[192:195], 0
 s_waitcnt vmcnt(8)
 v_mfma_f32_16x16x32_bf16 v[60:63], v[142:145], a[196:199], v[60:63]
 v_mfma_f32_16x16x32_bf16 v[148:151], v[140:143], a[196:199], v[148:151]
 s_waitcnt vmcnt(7)
 v_mfma_f32_16x16x32_bf16 v[60:63], v[142:145], a[200:203], v[60:63]
 v_mfma_f32_16x16x32_bf16 v[148:151], v[140:143], a[200:203], v[148:151]
 s_waitcnt vmcnt(6)
 v_mfma_f32_16x16x32_bf16 v[60:63], v[142:145], a[204:207], v[60:63]
 v_mfma_f32_16x16x32_bf16 v[148:151], v[140:143], a[204:207], v[148:151]
 s_waitcnt vmcnt(5)
 v_mfma_f32_16x16x32_bf16 v[60:63], v[142:145], a[208:211], v[60:63]
 v_mfma_f32_16x16x32_bf16 v[148:151], v[140:143], a[208:211], v[148:151]
 s_waitcnt vmcnt(4)
 v_mfma_f32_16x16x32_bf16 v[60:63], v[142:145], a[212:215], v[60:63]
 v_mfma_f32_16x16x32_bf16 v[148:151], v[140:143], a[212:215], v[148:151]
 s_waitcnt vmcnt(3)
 v_mfma_f32_16x16x32_bf16 v[60:63], v[142:145], a[216:219], v[60:63]
 v_mfma_f32_16x16x32_bf16 v[148:151], v[140:143], a[216:219], v[148:151]
 s_waitcnt vmcnt(2)
 v_mfma_f32_16x16x32_bf16 v[60:63], v[142:145], a[220:223], v[60:63]
 v_mfma_f32_16x16x32_bf16 v[148:151], v[140:143], a[220:223], v[148:151]
 s_nop 6
 v_pk_fma_f32 v[60:61], v[60:61], v[176:177], v[184:185]
 v_pk_fma_f32 v[62:63], v[62:63], v[178:179], v[186:187]
 v_pk_fma_f32 v[148:149], v[148:149], v[8:9], v[16:17]
 v_pk_fma_f32 v[150:151], v[150:151], v[10:11], v[18:19]
 v_cvt_pk_bf16_f32 v60, v60, v61
 v_cvt_pk_bf16_f32 v61, v62, v63
 ds_bpermute_b32 v60, v253, v60
 ds_bpermute_b32 v61, v253, v61
 v_cvt_pk_bf16_f32 v148, v148, v149
 v_cvt_pk_bf16_f32 v149, v150, v151
 ds_bpermute_b32 v148, v253, v148
 ds_bpermute_b32 v149, v253, v149
 s_waitcnt lgkmcnt(2)
 buffer_store_dwordx2 v[60:61], v6, s[4:7], s43 offen offset:96
 s_waitcnt lgkmcnt(0)
 buffer_store_dwordx2 v[148:149], v24, s[4:7], s43 offen offset:96
L_fin:
 s_endpgm
L_pl1:
 s_sleep 2
 buffer_load_dword v28, v27, s[24:27], 0 offen sc1
 s_waitcnt vmcnt(0)
 v_sub_u32 v28, v28, v0
 v_subrev_u32 v28, 1, v28
 v_cmp_ge_u32 vcc, 11, v28
 s_add_u32 s79, s79, 1
 s_cmp_eq_u64 vcc, -1
 s_cbranch_scc1 L_pd1
 s_cmp_lt_u32 s79, 0x8000
 s_cbranch_scc1 L_pl1
 s_branch L_pd1
L_pl2:
 s_sleep 2
 buffer_load_dword v28, v27, s[24:27], 0 offen sc1
 s_waitcnt vmcnt(0)
 v_sub_u32 v28, v28, v0
 v_subrev_u32 v28, 2, v28
 v_cmp_ge_u32 vcc, 10, v28
 s_add_u32 s79, s79, 1
 s_cmp_eq_u64 vcc, -1
 s_cbranch_scc1 L_pd2
 s_cmp_lt_u32 s79, 0x8000
 s_cbranch_scc1 L_pl2
 s_branch L_pd2
L_hdp:
 s_cmp_eq_u32 s73, 0
 s_cbranch_scc0 L_hdap
 v_cndmask_b32 v144, v25, v144, s[84:85]
 v_cndmask_b32 v145, v25, v145, s[86:87]
 v_cndmask_b32 v146, v25, v146, s[92:93]
 v_cndmask_b32 v147, v25, v147, s[94:95]
 v_cndmask_b32 v156, v25, v156, s[84:85]
 v_cndmask_b32 v157, v25, v157, s[86:87]
 v_cndmask_b32 v158, v25, v158, s[92:93]
 v_cndmask_b32 v159, v25, v159, s[94:95]
 v_mov_b32 v148, v25
 v_mov_b32 v149, v25
 v_mov_b32 v150, v25
 v_mov_b32 v151, v25
 s_mov_b32 s73, 1
 s_mov_b32 s70, 0
 s_branch L_hdrp
L_hdap:
 v_mov_b32 v144, v25
 v_mov_b32 v145, v25
 v_mov_b32 v146, v25
 v_mov_b32 v147, v25
 v_mov_b32 v148, v25
 v_mov_b32 v149, v25
 v_mov_b32 v150, v25
 v_mov_b32 v151, v25
 v_mov_b32 v152, v25
 v_mov_b32 v153, v25
 v_mov_b32 v154, v25
 v_mov_b32 v155, v25
 v_mov_b32 v156, v25
 v_mov_b32 v157, v25
 v_mov_b32 v158, v25
 v_mov_b32 v159, v25
 s_movk_i32 s70, 1000
 s_nop 0
 s_branch L_hdrp
L_hdfD1:
 s_cmp_eq_u32 s73, 0
 s_cbranch_scc0 L_hdafD1
 v_cndmask_b32 v144, v25, v144, s[84:85]
 v_cndmask_b32 v145, v25, v145, s[86:87]
 v_cndmask_b32 v146, v25, v146, s[92:93]
 v_cndmask_b32 v147, v25, v147, s[94:95]
 v_cndmask_b32 v156, v25, v156, s[84:85]
 v_cndmask_b32 v157, v25, v157, s[86:87]
 v_cndmask_b32 v158, v25, v158, s[92:93]
 v_cndmask_b32 v159, v25, v159, s[94:95]
 v_mov_b32 v148, v25
 v_mov_b32 v149, v25
 v_mov_b32 v150, v25
 v_mov_b32 v151, v25
 s_mov_b32 s73, 1
 s_mov_b32 s70, 0
 s_branch L_hdrfD1
L_hdafD1:
 v_mov_b32 v144, v25
 v_mov_b32 v145, v25
 v_mov_b32 v146, v25
 v_mov_b32 v147, v25
 v_mov_b32 v148, v25
 v_mov_b32 v149, v25
 v_mov_b32 v150, v25
 v_mov_b32 v151, v25
 v_mov_b32 v152, v25
 v_mov_b32 v153, v25
 v_mov_b32 v154, v25
 v_mov_b32 v155, v25
 v_mov_b32 v156, v25
 v_mov_b32 v157, v25
 v_mov_b32 v158, v25
 v_mov_b32 v159, v25
 s_movk_i32 s70, 1000
 s_nop 0
 s_branch L_hdrfD1
L_hdsD0:
 s_cmp_eq_u32 s73, 0
 s_cbranch_scc0 L_hdasD0
 v_cndmask_b32 v144, v25, v144, s[84:85]
 v_cndmask_b32 v145, v25, v145, s[86:87]
 v_cndmask_b32 v146, v25, v146, s[92:93]
 v_cndmask_b32 v147, v25, v147, s[94:95]
 v_cndmask_b32 v156, v25, v156, s[84:85]
 v_cndmask_b32 v157, v25, v157, s[86:87]
 v_cndmask_b32 v158, v25, v158, s[92:93]
 v_cndmask_b32 v159, v25, v159, s[94:95]
 v_mov_b32 v148, v25
 v_mov_b32 v149, v25
 v_mov_b32 v150, v25
 v_mov_b32 v151, v25
 s_mov_b32 s73, 1
 s_mov_b32 s70, 0
 s_branch L_hdrsD0
L_hdasD0:
 v_mov_b32 v144, v25
 v_mov_b32 v145, v25
 v_mov_b32 v146, v25
 v_mov_b32 v147, v25
 v_mov_b32 v148, v25
 v_mov_b32 v149, v25
 v_mov_b32 v150, v25
 v_mov_b32 v151, v25
 v_mov_b32 v152, v25
 v_mov_b32 v153, v25
 v_mov_b32 v154, v25
 v_mov_b32 v155, v25
 v_mov_b32 v156, v25
 v_mov_b32 v157, v25
 v_mov_b32 v158, v25
 v_mov_b32 v159, v25
 s_movk_i32 s70, 1000
 s_nop 0
 s_branch L_hdrsD0
L_hdsD1:
 s_cmp_eq_u32 s73, 0
 s_cbranch_scc0 L_hdasD1
 v_cndmask_b32 v144, v25, v144, s[84:85]
 v_cndmask_b32 v145, v25, v145, s[86:87]
 v_cndmask_b32 v146, v25, v146, s[92:93]
 v_cndmask_b32 v147, v25, v147, s[94:95]
 v_cndmask_b32 v156, v25, v156, s[84:85]
 v_cndmask_b32 v157, v25, v157, s[86:87]
 v_cndmask_b32 v158, v25, v158, s[92:93]
 v_cndmask_b32 v159, v25, v159, s[94:95]
 v_mov_b32 v148, v25
 v_mov_b32 v149, v25
 v_mov_b32 v150, v25
 v_mov_b32 v151, v25
 s_mov_b32 s73, 1
 s_mov_b32 s70, 0
 s_branch L_hdrsD1
L_hdasD1:
 v_mov_b32 v144, v25
 v_mov_b32 v145, v25
 v_mov_b32 v146, v25
 v_mov_b32 v147, v25
 v_mov_b32 v148, v25
 v_mov_b32 v149, v25
 v_mov_b32 v150, v25
 v_mov_b32 v151, v25
 v_mov_b32 v152, v25
 v_mov_b32 v153, v25
 v_mov_b32 v154, v25
 v_mov_b32 v155, v25
 v_mov_b32 v156, v25
 v_mov_b32 v157, v25
 v_mov_b32 v158, v25
 v_mov_b32 v159, v25
 s_movk_i32 s70, 1000
 s_nop 0
 s_branch L_hdrsD1
L_pl3:
 s_sleep 2
 buffer_load_dword v28, v27, s[24:27], 0 offen sc1
 s_waitcnt vmcnt(0)
 v_sub_u32 v28, v28, v0
 v_subrev_u32 v28, 3, v28
 v_cmp_ge_u32 vcc, 9, v28
 s_add_u32 s79, s79, 1
 s_cmp_eq_u64 vcc, -1
 s_cbranch_scc1 L_pd3
 s_cmp_lt_u32 s79, 0x8000
 s_cbranch_scc1 L_pl3
 s_branch L_pd3
L_pl4:
 s_sleep 2
 buffer_load_dword v28, v27, s[24:27], 0 offen sc1
 s_waitcnt vmcnt(0)
 v_sub_u32 v28, v28, v0
 v_subrev_u32 v28, 4, v28
 v_cmp_ge_u32 vcc, 8, v28
 s_add_u32 s79, s79, 1
 s_cmp_eq_u64 vcc, -1
 s_cbranch_scc1 L_pd4
 s_cmp_lt_u32 s79, 0x8000
 s_cbranch_scc1 L_pl4
 s_branch L_pd4
L_hdlD0:
 s_cmp_eq_u32 s73, 0
 s_cbranch_scc0 L_hdalD0
 v_cndmask_b32 v144, v25, v144, s[84:85]
 v_cndmask_b32 v145, v25, v145, s[86:87]
 v_cndmask_b32 v146, v25, v146, s[92:93]
 v_cndmask_b32 v147, v25, v147, s[94:95]
 v_cndmask_b32 v156, v25, v156, s[84:85]
 v_cndmask_b32 v157, v25, v157, s[86:87]
 v_cndmask_b32 v158, v25, v158, s[92:93]
 v_cndmask_b32 v159, v25, v159, s[94:95]
 v_mov_b32 v148, v25
 v_mov_b32 v149, v25
 v_mov_b32 v150, v25
 v_mov_b32 v151, v25
 s_mov_b32 s73, 1
 s_mov_b32 s70, 0
 s_branch L_hdrlD0
L_hdalD0:
 v_mov_b32 v144, v25
 v_mov_b32 v145, v25
 v_mov_b32 v146, v25
 v_mov_b32 v147, v25
 v_mov_b32 v148, v25
 v_mov_b32 v149, v25
 v_mov_b32 v150, v25
 v_mov_b32 v151, v25
 v_mov_b32 v152, v25
 v_mov_b32 v153, v25
 v_mov_b32 v154, v25
 v_mov_b32 v155, v25
 v_mov_b32 v156, v25
 v_mov_b32 v157, v25
 v_mov_b32 v158, v25
 v_mov_b32 v159, v25
 s_movk_i32 s70, 1000
 s_nop 0
 s_branch L_hdrlD0
L_hdlD1:
 s_cmp_eq_u32 s73, 0
 s_cbranch_scc0 L_hdalD1
 v_cndmask_b32 v144, v25, v144, s[84:85]
 v_cndmask_b32 v145, v25, v145, s[86:87]
 v_cndmask_b32 v146, v25, v146, s[92:93]
 v_cndmask_b32 v147, v25, v147, s[94:95]
 v_cndmask_b32 v156, v25, v156, s[84:85]
 v_cndmask_b32 v157, v25, v157, s[86:87]
 v_cndmask_b32 v158, v25, v158, s[92:93]
 v_cndmask_b32 v159, v25, v159, s[94:95]
 v_mov_b32 v148, v25
 v_mov_b32 v149, v25
 v_mov_b32 v150, v25
 v_mov_b32 v151, v25
 s_mov_b32 s73, 1
 s_mov_b32 s70, 0
 s_branch L_hdrlD1
L_hdalD1:
 v_mov_b32 v144, v25
 v_mov_b32 v145, v25
 v_mov_b32 v146, v25
 v_mov_b32 v147, v25
 v_mov_b32 v148, v25
 v_mov_b32 v149, v25
 v_mov_b32 v150, v25
 v_mov_b32 v151, v25
 v_mov_b32 v152, v25
 v_mov_b32 v153, v25
 v_mov_b32 v154, v25
 v_mov_b32 v155, v25
 v_mov_b32 v156, v25
 v_mov_b32 v157, v25
 v_mov_b32 v158, v25
 v_mov_b32 v159, v25
 s_movk_i32 s70, 1000
 s_nop 0
 s_branch L_hdrlD1
L_hs0:
 s_cmp_eq_u32 s58, 1
 s_cbranch_scc1 L_hs0a
 s_cmp_eq_u32 s58, 3
 s_cbranch_scc1 L_hs0b
 v_cndmask_b32 v160, v25, v160, s[84:85]
 v_cndmask_b32 v161, v25, v161, s[86:87]
 v_cndmask_b32 v162, v25, v162, s[92:93]
 v_cndmask_b32 v163, v25, v163, s[94:95]
 v_cndmask_b32 v172, v25, v172, s[84:85]
 v_cndmask_b32 v173, v25, v173, s[86:87]
 v_cndmask_b32 v174, v25, v174, s[92:93]
 v_cndmask_b32 v175, v25, v175, s[94:95]
 v_mov_b32 v164, v25
 v_mov_b32 v165, v25
 v_mov_b32 v166, v25
 v_mov_b32 v167, v25
 s_nop 0
 s_branch L_topL
L_hs0a:
 v_mov_b32 v160, v25
 v_mov_b32 v161, v25
 v_mov_b32 v162, v25
 v_mov_b32 v163, v25
 v_mov_b32 v164, v25
 v_mov_b32 v165, v25
 v_mov_b32 v166, v25
 v_mov_b32 v167, v25
 v_mov_b32 v168, v25
 v_mov_b32 v169, v25
 v_mov_b32 v170, v25
 v_mov_b32 v171, v25
 v_mov_b32 v172, v25
 v_mov_b32 v173, v25
 v_mov_b32 v174, v25
 v_mov_b32 v175, v25
 v_mov_b32 v8, v25
 v_mov_b32 v9, v25
 v_mov_b32 v10, v25
 v_mov_b32 v11, v25
 v_mov_b32 v12, v25
 v_mov_b32 v13, v25
 v_mov_b32 v14, v25
 v_mov_b32 v15, v25
 v_mov_b32 v16, v25
 v_mov_b32 v17, v25
 v_mov_b32 v18, v25
 v_mov_b32 v19, v25
 v_mov_b32 v20, v25
 v_mov_b32 v21, v25
 v_mov_b32 v22, v25
 v_mov_b32 v23, v25
 s_nop 0
 s_branch L_topL
L_hs0b:
 v_cndmask_b32 v8, v25, v8, s[84:85]
 v_cndmask_b32 v9, v25, v9, s[86:87]
 v_cndmask_b32 v10, v25, v10, s[92:93]
 v_cndmask_b32 v11, v25, v11, s[94:95]
 v_cndmask_b32 v20, v25, v20, s[84:85]
 v_cndmask_b32 v21, v25, v21, s[86:87]
 v_cndmask_b32 v22, v25, v22, s[92:93]
 v_cndmask_b32 v23, v25, v23, s[94:95]
 v_mov_b32 v12, v25
 v_mov_b32 v13, v25
 v_mov_b32 v14, v25
 v_mov_b32 v15, v25
 s_nop 0
 s_branch L_topL
L_hmid:
 s_bitcmp1_b32 s71, 0
 s_cbranch_scc0 L_hm1
 s_nop 7
 v_add_f32 v242, v240, v244
 v_cmp_gt_f32 vcc, 0x5f800000, v242
 s_cmp_eq_u64 vcc, -1
 s_cbranch_scc0 L_slowL
L_slowLr:
 v_rcp_f32 v240, v240
 v_rcp_f32 v244, v244
 s_mov_b32 s3, s91
 v_pk_mul_f32 v[176:177], v[176:177], v[240:241] op_sel_hi:[1,0]
 v_pk_mul_f32 v[178:179], v[178:179], v[240:241] op_sel_hi:[1,0]
 v_pk_mul_f32 v[180:181], v[180:181], v[240:241] op_sel_hi:[1,0]
 v_pk_mul_f32 v[182:183], v[182:183], v[240:241] op_sel_hi:[1,0]
 v_cvt_pk_bf16_f32 v32, v176, v177
 v_cvt_pk_bf16_f32 v33, v178, v179
 v_cvt_pk_bf16_f32 v34, v180, v181
 v_cvt_pk_bf16_f32 v35, v182, v183
 buffer_store_dwordx4 v[32:35], v2, s[20:23], s3 offen offset:0 sc1
 v_pk_mul_f32 v[184:185], v[184:185], v[244:245] op_sel_hi:[1,0]
 v_pk_mul_f32 v[186:187], v[186:187], v[244:245] op_sel_hi:[1,0]
 v_pk_mul_f32 v[188:189], v[188:189], v[244:245] op_sel_hi:[1,0]
 v_pk_mul_f32 v[190:191], v[190:191], v[244:245] op_sel_hi:[1,0]
 v_cvt_pk_bf16_f32 v36, v184, v185
 v_cvt_pk_bf16_f32 v37, v186, v187
 v_cvt_pk_bf16_f32 v38, v188, v189
 v_cvt_pk_bf16_f32 v39, v190, v191
 buffer_store_dwordx4 v[36:39], v2, s[20:23], s3 offen offset:1024 sc1
 v_pk_mul_f32 v[192:193], v[192:193], v[240:241] op_sel_hi:[1,0]
 v_pk_mul_f32 v[194:195], v[194:195], v[240:241] op_sel_hi:[1,0]
 v_pk_mul_f32 v[196:197], v[196:197], v[240:241] op_sel_hi:[1,0]
 v_pk_mul_f32 v[198:199], v[198:199], v[240:241] op_sel_hi:[1,0]
 v_cvt_pk_bf16_f32 v40, v192, v193
 v_cvt_pk_bf16_f32 v41, v194, v195
 v_cvt_pk_bf16_f32 v42, v196, v197
 v_cvt_pk_bf16_f32 v43, v198, v199
 buffer_store_dwordx4 v[40:43], v3, s[20:23], s3 offen offset:0 sc1
 v_pk_mul_f32 v[200:201], v[200:201], v[244:245] op_sel_hi:[1,0]
 v_pk_mul_f32 v[202:203], v[202:203], v[244:245] op_sel_hi:[1,0]
 v_pk_mul_f32 v[204:205], v[204:205], v[244:245] op_sel_hi:[1,0]
 v_pk_mul_f32 v[206:207], v[206:207], v[244:245] op_sel_hi:[1,0]
 v_cvt_pk_bf16_f32 v44, v200, v201
 v_cvt_pk_bf16_f32 v45, v202, v203
 v_cvt_pk_bf16_f32 v46, v204, v205
 v_cvt_pk_bf16_f32 v47, v206, v207
 buffer_store_dwordx4 v[44:47], v3, s[20:23], s3 offen offset:1024 sc1
 s_add_u32 s3, s3, 0x2000
 v_pk_mul_f32 v[208:209], v[208:209], v[240:241] op_sel_hi:[1,0]
 v_pk_mul_f32 v[210:211], v[210:211], v[240:241] op_sel_hi:[1,0]
 v_pk_mul_f32 v[212:213], v[212:213], v[240:241] op_sel_hi:[1,0]
 v_pk_mul_f32 v[214:215], v[214:215], v[240:241] op_sel_hi:[1,0]
 v_cvt_pk_bf16_f32 v48, v208, v209
 v_cvt_pk_bf16_f32 v49, v210, v211
 v_cvt_pk_bf16_f32 v50, v212, v213
 v_cvt_pk_bf16_f32 v51, v214, v215
 buffer_store_dwordx4 v[48:51], v2, s[20:23], s3 offen offset:0 sc1
 v_pk_mul_f32 v[216:217], v[216:217], v[244:245] op_sel_hi:[1,0]
 v_pk_mul_f32 v[218:219], v[218:219], v[244:245] op_sel_hi:[1,0]
 v_pk_mul_f32 v[220:221], v[220:221], v[244:245] op_sel_hi:[1,0]
 v_pk_mul_f32 v[222:223], v[222:223], v[244:245] op_sel_hi:[1,0]
 v_cvt_pk_bf16_f32 v52, v216, v217
 v_cvt_pk_bf16_f32 v53, v218, v219
 v_cvt_pk_bf16_f32 v54, v220, v221
 v_cvt_pk_bf16_f32 v55, v222, v223
 buffer_store_dwordx4 v[52:55], v2, s[20:23], s3 offen offset:1024 sc1
 v_pk_mul_f32 v[224:225], v[224:225], v[240:241] op_sel_hi:[1,0]
 v_pk_mul_f32 v[226:227], v[226:227], v[240:241] op_sel_hi:[1,0]
 v_pk_mul_f32 v[228:229], v[228:229], v[240:241] op_sel_hi:[1,0]
 v_pk_mul_f32 v[230:231], v[230:231], v[240:241] op_sel_hi:[1,0]
 v_cvt_pk_bf16_f32 v56, v224, v225
 v_cvt_pk_bf16_f32 v57, v226, v227
 v_cvt_pk_bf16_f32 v58, v228, v229
 v_cvt_pk_bf16_f32 v59, v230, v231
 buffer_store_dwordx4 v[56:59], v3, s[20:23], s3 offen offset:0 sc1
 v_pk_mul_f32 v[232:233], v[232:233], v[244:245] op_sel_hi:[1,0]
 v_pk_mul_f32 v[234:235], v[234:235], v[244:245] op_sel_hi:[1,0]
 v_pk_mul_f32 v[236:237], v[236:237], v[244:245] op_sel_hi:[1,0]
 v_pk_mul_f32 v[238:239], v[238:239], v[244:245] op_sel_hi:[1,0]
 v_cvt_pk_bf16_f32 v60, v232, v233
 v_cvt_pk_bf16_f32 v61, v234, v235
 v_cvt_pk_bf16_f32 v62, v236, v237
 v_cvt_pk_bf16_f32 v63, v238, v239
 buffer_store_dwordx4 v[60:63], v3, s[20:23], s3 offen offset:1024 sc1
 v_mov_b64 v[176:177], 0
 v_mov_b64 v[178:179], 0
 v_mov_b64 v[180:181], 0
 v_mov_b64 v[182:183], 0
 v_mov_b64 v[184:185], 0
 v_mov_b64 v[186:187], 0
 v_mov_b64 v[188:189], 0
 v_mov_b64 v[190:191], 0
 v_mov_b64 v[192:193], 0
 v_mov_b64 v[194:195], 0
 v_mov_b64 v[196:197], 0
 v_mov_b64 v[198:199], 0
 v_mov_b64 v[200:201], 0
 v_mov_b64 v[202:203], 0
 v_mov_b64 v[204:205], 0
 v_mov_b64 v[206:207], 0
 v_mov_b64 v[208:209], 0
 v_mov_b64 v[210:211], 0
 v_mov_b64 v[212:213], 0
 v_mov_b64 v[214:215], 0
 v_mov_b64 v[216:217], 0
 v_mov_b64 v[218:219], 0
 v_mov_b64 v[220:221], 0
 v_mov_b64 v[222:223], 0
 v_mov_b64 v[224:225], 0
 v_mov_b64 v[226:227], 0
 v_mov_b64 v[228:229], 0
 v_mov_b64 v[230:231], 0
 v_mov_b64 v[232:233], 0
 v_mov_b64 v[234:235], 0
 v_mov_b64 v[236:237], 0
 v_mov_b64 v[238:239], 0
 v_mov_b64 v[240:241], 0
 v_mov_b64 v[242:243], 0
 v_mov_b64 v[244:245], 0
 v_mov_b64 v[246:247], 0
 s_bitcmp1_b32 s71, 1
 s_mov_b32 s71, 0
 s_cbranch_scc0 L_hmidr
L_hm1:
 s_cmp_eq_u32 s58, 0
 s_cbranch_scc1 L_hm2
 s_cmp_eq_u32 s58, 3
 s_cbranch_scc0 L_hmidr2
 v_cndmask_b32 v160, v25, v160, s[84:85]
 v_cndmask_b32 v161, v25, v161, s[86:87]
 v_cndmask_b32 v162, v25, v162, s[92:93]
 v_cndmask_b32 v163, v25, v163, s[94:95]
 v_cndmask_b32 v172, v25, v172, s[84:85]
 v_cndmask_b32 v173, v25, v173, s[86:87]
 v_cndmask_b32 v174, v25, v174, s[92:93]
 v_cndmask_b32 v175, v25, v175, s[94:95]
 v_mov_b32 v164, v25
 v_mov_b32 v165, v25
 v_mov_b32 v166, v25
 v_mov_b32 v167, v25
 v_mov_b32 v8, v25
 v_mov_b32 v9, v25
 v_mov_b32 v10, v25
 v_mov_b32 v11, v25
 v_mov_b32 v12, v25
 v_mov_b32 v13, v25
 v_mov_b32 v14, v25
 v_mov_b32 v15, v25
 v_mov_b32 v16, v25
 v_mov_b32 v17, v25
 v_mov_b32 v18, v25
 v_mov_b32 v19, v25
 v_mov_b32 v20, v25
 v_mov_b32 v21, v25
 v_mov_b32 v22, v25
 v_mov_b32 v23, v25
 s_nop 0
 s_branch L_hmidr2
L_hm2:
 v_mov_b32 v160, v25
 v_mov_b32 v161, v25
 v_mov_b32 v162, v25
 v_mov_b32 v163, v25
 v_mov_b32 v164, v25
 v_mov_b32 v165, v25
 v_mov_b32 v166, v25
 v_mov_b32 v167, v25
 v_mov_b32 v168, v25
 v_mov_b32 v169, v25
 v_mov_b32 v170, v25
 v_mov_b32 v171, v25
 v_mov_b32 v172, v25
 v_mov_b32 v173, v25
 v_mov_b32 v174, v25
 v_mov_b32 v175, v25
 v_cndmask_b32 v8, v25, v8, s[84:85]
 v_cndmask_b32 v9, v25, v9, s[86:87]
 v_cndmask_b32 v10, v25, v10, s[92:93]
 v_cndmask_b32 v11, v25, v11, s[94:95]
 v_cndmask_b32 v20, v25, v20, s[84:85]
 v_cndmask_b32 v21, v25, v21, s[86:87]
 v_cndmask_b32 v22, v25, v22, s[92:93]
 v_cndmask_b32 v23, v25, v23, s[94:95]
 v_mov_b32 v12, v25
 v_mov_b32 v13, v25
 v_mov_b32 v14, v25
 v_mov_b32 v15, v25
 s_nop 0
 s_branch L_hmidr2
L_slowL:
 s_waitcnt vmcnt(0) lgkmcnt(0)
 s_lshl_b32 s97, s60, 2
 s_add_u32 s97, s97, s58
 s_nop 7
 s_nop 7
 v_mov_b32 v144, 0
 v_mov_b32 v145, 0
 v_mov_b32 v146, 0
 v_mov_b32 v147, 0
 v_mov_b32 v148, 0
 v_mov_b32 v149, 0
 v_mov_b32 v150, 0
 v_mov_b32 v151, 0
 v_mov_b32 v152, 0
 v_mov_b32 v153, 0
 v_mov_b32 v154, 0
 v_mov_b32 v155, 0
 v_mov_b32 v156, 0
 v_mov_b32 v157, 0
 v_mov_b32 v158, 0
 v_mov_b32 v159, 0
 v_mov_b32 v136, v25
 v_mov_b32 v137, v25
 s_mov_b32 s79, 0
L_slowL1:
 s_lshr_b32 s78, s79, 1
 s_lshl_b32 s78, s78, 15
 s_and_b32 s3, s79, 1
 s_lshl_b32 s3, s3, 13
 s_add_u32 s78, s78, s3
 buffer_load_dwordx4 a[192:195], v2, s[4:7], s78 offen offset:0 sc1
 buffer_load_dwordx4 a[196:199], v2, s[4:7], s78 offen offset:1024 sc1
 buffer_load_dwordx4 a[200:203], v2, s[4:7], s78 offen offset:2048 sc1
 buffer_load_dwordx4 a[204:207], v2, s[4:7], s78 offen offset:3072 sc1
 buffer_load_dwordx4 a[208:211], v3, s[4:7], s78 offen offset:0 sc1
 buffer_load_dwordx4 a[212:215], v3, s[4:7], s78 offen offset:1024 sc1
 buffer_load_dwordx4 a[216:219], v3, s[4:7], s78 offen offset:2048 sc1
 buffer_load_dwordx4 a[220:223], v3, s[4:7], s78 offen offset:3072 sc1
 s_cmp_eq_u32 s79, s97
 s_cbranch_scc0 L_slowL1m
 v_cndmask_b32 v144, v25, v144, s[84:85]
 v_cndmask_b32 v145, v25, v145, s[86:87]
 v_cndmask_b32 v146, v25, v146, s[92:93]
 v_cndmask_b32 v147, v25, v147, s[94:95]
 v_cndmask_b32 v156, v25, v156, s[84:85]
 v_cndmask_b32 v157, v25, v157, s[86:87]
 v_cndmask_b32 v158, v25, v158, s[92:93]
 v_cndmask_b32 v159, v25, v159, s[94:95]
 v_mov_b32 v148, v25
 v_mov_b32 v149, v25
 v_mov_b32 v150, v25
 v_mov_b32 v151, v25
L_slowL1m:
 s_nop 1
 s_waitcnt vmcnt(7)
 v_mfma_f32_16x16x32_bf16 v[96:99], a[192:195], v[32:35], v[144:147]
 v_mfma_f32_16x16x32_bf16 v[104:107], a[192:195], v[48:51], v[152:155]
 s_waitcnt vmcnt(3)
 v_mfma_f32_16x16x32_bf16 v[100:103], a[208:211], v[32:35], v[148:151]
 v_mfma_f32_16x16x32_bf16 v[108:111], a[208:211], v[48:51], v[156:159]
 v_mfma_f32_16x16x32_bf16 v[96:99], a[196:199], v[36:39], v[96:99]
 v_mfma_f32_16x16x32_bf16 v[104:107], a[196:199], v[52:55], v[104:107]
 s_waitcnt vmcnt(2)
 v_mfma_f32_16x16x32_bf16 v[100:103], a[212:215], v[36:39], v[100:103]
 v_mfma_f32_16x16x32_bf16 v[108:111], a[212:215], v[52:55], v[108:111]
 v_mfma_f32_16x16x32_bf16 v[96:99], a[200:203], v[40:43], v[96:99]
 v_mfma_f32_16x16x32_bf16 v[104:107], a[200:203], v[56:59], v[104:107]
 s_waitcnt vmcnt(1)
 v_mfma_f32_16x16x32_bf16 v[100:103], a[216:219], v[40:43], v[100:103]
 v_mfma_f32_16x16x32_bf16 v[108:111], a[216:219], v[56:59], v[108:111]
 v_mfma_f32_16x16x32_bf16 v[96:99], a[204:207], v[44:47], v[96:99]
 v_mfma_f32_16x16x32_bf16 v[104:107], a[204:207], v[60:63], v[104:107]
 s_waitcnt vmcnt(0)
 v_mfma_f32_16x16x32_bf16 v[100:103], a[220:223], v[44:47], v[100:103]
 v_mfma_f32_16x16x32_bf16 v[108:111], a[220:223], v[60:63], v[108:111]
 s_nop 3
 v_max3_f32 v136, v136, v96, v97
 v_max3_f32 v136, v136, v98, v99
 s_nop 0
 v_max3_f32 v136, v136, v100, v101
 v_max3_f32 v136, v136, v102, v103
 v_max3_f32 v137, v137, v104, v105
 v_max3_f32 v137, v137, v106, v107
 v_max3_f32 v137, v137, v108, v109
 v_max3_f32 v137, v137, v110, v111
 s_add_u32 s79, s79, 1
 s_cmp_le_u32 s79, s97
 s_nop 7
 s_cbranch_scc1 L_slowL1
 v_mov_b32 v138, v136
 s_nop 1
 v_permlane16_swap_b32 v136, v138
 v_max_f32 v136, v136, v138
 v_mov_b32 v138, v136
 s_nop 1
 v_permlane32_swap_b32 v136, v138
 v_max_f32 v136, v136, v138
 v_sub_f32 v144, 0, v136
 v_sub_f32 v145, 0, v136
 v_sub_f32 v146, 0, v136
 v_sub_f32 v147, 0, v136
 v_sub_f32 v148, 0, v136
 v_sub_f32 v149, 0, v136
 v_sub_f32 v150, 0, v136
 v_sub_f32 v151, 0, v136
 v_mov_b32 v138, v137
 s_nop 1
 v_permlane16_swap_b32 v137, v138
 v_max_f32 v137, v137, v138
 v_mov_b32 v138, v137
 s_nop 1
 v_permlane32_swap_b32 v137, v138
 v_max_f32 v137, v137, v138
 v_sub_f32 v152, 0, v137
 v_sub_f32 v153, 0, v137
 v_sub_f32 v154, 0, v137
 v_sub_f32 v155, 0, v137
 v_sub_f32 v156, 0, v137
 v_sub_f32 v157, 0, v137
 v_sub_f32 v158, 0, v137
 v_sub_f32 v159, 0, v137
 v_mov_b64 v[176:177], 0
 v_mov_b64 v[178:179], 0
 v_mov_b64 v[180:181], 0
 v_mov_b64 v[182:183], 0
 v_mov_b64 v[184:185], 0
 v_mov_b64 v[186:187], 0
 v_mov_b64 v[188:189], 0
 v_mov_b64 v[190:191], 0
 v_mov_b64 v[192:193], 0
 v_mov_b64 v[194:195], 0
 v_mov_b64 v[196:197], 0
 v_mov_b64 v[198:199], 0
 v_mov_b64 v[200:201], 0
 v_mov_b64 v[202:203], 0
 v_mov_b64 v[204:205], 0
 v_mov_b64 v[206:207], 0
 v_mov_b64 v[208:209], 0
 v_mov_b64 v[210:211], 0
 v_mov_b64 v[212:213], 0
 v_mov_b64 v[214:215], 0
 v_mov_b64 v[216:217], 0
 v_mov_b64 v[218:219], 0
 v_mov_b64 v[220:221], 0
 v_mov_b64 v[222:223], 0
 v_mov_b64 v[224:225], 0
 v_mov_b64 v[226:227], 0
 v_mov_b64 v[228:229], 0
 v_mov_b64 v[230:231], 0
 v_mov_b64 v[232:233], 0
 v_mov_b64 v[234:235], 0
 v_mov_b64 v[236:237], 0
 v_mov_b64 v[238:239], 0
 v_mov_b64 v[240:241], 0
 v_mov_b64 v[242:243], 0
 v_mov_b64 v[244:245], 0
 v_mov_b64 v[246:247], 0
 s_mov_b32 s79, 0
L_slowL2:
 s_lshr_b32 s78, s79, 1
 s_lshl_b32 s78, s78, 15
 s_and_b32 s3, s79, 1
 s_lshl_b32 s3, s3, 13
 s_add_u32 s78, s78, s3
 buffer_load_dwordx4 a[192:195], v2, s[4:7], s78 offen offset:0 sc1
 buffer_load_dwordx4 a[196:199], v2, s[4:7], s78 offen offset:1024 sc1
 buffer_load_dwordx4 a[200:203], v2, s[4:7], s78 offen offset:2048 sc1
 buffer_load_dwordx4 a[204:207], v2, s[4:7], s78 offen offset:3072 sc1
 buffer_load_dwordx4 a[208:211], v3, s[4:7], s78 offen offset:0 sc1
 buffer_load_dwordx4 a[212:215], v3, s[4:7], s78 offen offset:1024 sc1
 buffer_load_dwordx4 a[216:219], v3, s[4:7], s78 offen offset:2048 sc1
 buffer_load_dwordx4 a[220:223], v3, s[4:7], s78 offen offset:3072 sc1
 s_cmp_eq_u32 s79, s97
 s_cbranch_scc0 L_slowL2m
 v_cndmask_b32 v144, v25, v144, s[84:85]
 v_cndmask_b32 v145, v25, v145, s[86:87]
 v_cndmask_b32 v146, v25, v146, s[92:93]
 v_cndmask_b32 v147, v25, v147, s[94:95]
 v_cndmask_b32 v156, v25, v156, s[84:85]
 v_cndmask_b32 v157, v25, v157, s[86:87]
 v_cndmask_b32 v158, v25, v158, s[92:93]
 v_cndmask_b32 v159, v25, v159, s[94:95]
 v_mov_b32 v148, v25
 v_mov_b32 v149, v25
 v_mov_b32 v150, v25
 v_mov_b32 v151, v25
L_slowL2m:
 s_nop 1
 s_waitcnt vmcnt(7)
 v_mfma_f32_16x16x32_bf16 v[96:99], a[192:195], v[32:35], v[144:147]
 v_mfma_f32_16x16x32_bf16 v[104:107], a[192:195], v[48:51], v[152:155]
 s_waitcnt vmcnt(3)
 v_mfma_f32_16x16x32_bf16 v[100:103], a[208:211], v[32:35], v[148:151]
 v_mfma_f32_16x16x32_bf16 v[108:111], a[208:211], v[48:51], v[156:159]
 v_mfma_f32_16x16x32_bf16 v[96:99], a[196:199], v[36:39], v[96:99]
 v_mfma_f32_16x16x32_bf16 v[104:107], a[196:199], v[52:55], v[104:107]
 s_waitcnt vmcnt(2)
 v_mfma_f32_16x16x32_bf16 v[100:103], a[212:215], v[36:39], v[100:103]
 v_mfma_f32_16x16x32_bf16 v[108:111], a[212:215], v[52:55], v[108:111]
 v_mfma_f32_16x16x32_bf16 v[96:99], a[200:203], v[40:43], v[96:99]
 v_mfma_f32_16x16x32_bf16 v[104:107], a[200:203], v[56:59], v[104:107]
 s_waitcnt vmcnt(1)
 v_mfma_f32_16x16x32_bf16 v[100:103], a[216:219], v[40:43], v[100:103]
 v_mfma_f32_16x16x32_bf16 v[108:111], a[216:219], v[56:59], v[108:111]
 v_mfma_f32_16x16x32_bf16 v[96:99], a[204:207], v[44:47], v[96:99]
 v_mfma_f32_16x16x32_bf16 v[104:107], a[204:207], v[60:63], v[104:107]
 s_waitcnt vmcnt(0)
 v_mfma_f32_16x16x32_bf16 v[100:103], a[220:223], v[44:47], v[100:103]
 v_mfma_f32_16x16x32_bf16 v[108:111], a[220:223], v[60:63], v[108:111]
 s_add_u32 s78, s78, 0x4000
 s_nop 2
 v_exp_f32 v96, v96
 v_exp_f32 v97, v97
 v_exp_f32 v98, v98
 v_exp_f32 v99, v99
 v_exp_f32 v100, v100
 v_exp_f32 v101, v101
 v_exp_f32 v102, v102
 v_exp_f32 v103, v103
 v_exp_f32 v104, v104
 v_exp_f32 v105, v105
 v_exp_f32 v106, v106
 v_exp_f32 v107, v107
 v_exp_f32 v108, v108
 v_exp_f32 v109, v109
 v_exp_f32 v110, v110
 v_exp_f32 v111, v111
 buffer_load_dwordx4 a[192:195], v2, s[4:7], s78 offen offset:0 sc1
 buffer_load_dwordx4 a[196:199], v2, s[4:7], s78 offen offset:1024 sc1
 buffer_load_dwordx4 a[200:203], v2, s[4:7], s78 offen offset:2048 sc1
 buffer_load_dwordx4 a[204:207], v2, s[4:7], s78 offen offset:3072 sc1
 buffer_load_dwordx4 a[208:211], v3, s[4:7], s78 offen offset:0 sc1
 buffer_load_dwordx4 a[212:215], v3, s[4:7], s78 offen offset:1024 sc1
 buffer_load_dwordx4 a[216:219], v3, s[4:7], s78 offen offset:2048 sc1
 buffer_load_dwordx4 a[220:223], v3, s[4:7], s78 offen offset:3072 sc1
 v_cvt_pk_bf16_f32 v128, v96, v97
 v_cvt_pk_bf16_f32 v129, v98, v99
 v_cvt_pk_bf16_f32 v130, v100, v101
 v_cvt_pk_bf16_f32 v131, v102, v103
 v_cvt_pk_bf16_f32 v132, v104, v105
 v_cvt_pk_bf16_f32 v133, v106, v107
 v_cvt_pk_bf16_f32 v134, v108, v109
 v_cvt_pk_bf16_f32 v135, v110, v111
 v_mfma_f32_16x16x32_bf16 v[240:243], a[136:139], v[128:131], v[240:243]
 s_nop 0
 v_mfma_f32_16x16x32_bf16 v[244:247], a[136:139], v[132:135], v[244:247]
 s_waitcnt vmcnt(7)
 v_mfma_f32_16x16x32_bf16 v[184:187], a[192:195], v[132:135], v[184:187]
 v_mfma_f32_16x16x32_bf16 v[176:179], a[192:195], v[128:131], v[176:179]
 s_waitcnt vmcnt(6)
 v_mfma_f32_16x16x32_bf16 v[180:183], a[196:199], v[128:131], v[180:183]
 v_mfma_f32_16x16x32_bf16 v[188:191], a[196:199], v[132:135], v[188:191]
 s_waitcnt vmcnt(5)
 v_mfma_f32_16x16x32_bf16 v[200:203], a[200:203], v[132:135], v[200:203]
 v_mfma_f32_16x16x32_bf16 v[192:195], a[200:203], v[128:131], v[192:195]
 s_waitcnt vmcnt(4)
 v_mfma_f32_16x16x32_bf16 v[196:199], a[204:207], v[128:131], v[196:199]
 v_mfma_f32_16x16x32_bf16 v[204:207], a[204:207], v[132:135], v[204:207]
 s_waitcnt vmcnt(3)
 v_mfma_f32_16x16x32_bf16 v[216:219], a[208:211], v[132:135], v[216:219]
 v_mfma_f32_16x16x32_bf16 v[208:211], a[208:211], v[128:131], v[208:211]
 s_waitcnt vmcnt(2)
 v_mfma_f32_16x16x32_bf16 v[212:215], a[212:215], v[128:131], v[212:215]
 v_mfma_f32_16x16x32_bf16 v[220:223], a[212:215], v[132:135], v[220:223]
 s_waitcnt vmcnt(1)
 v_mfma_f32_16x16x32_bf16 v[232:235], a[216:219], v[132:135], v[232:235]
 v_mfma_f32_16x16x32_bf16 v[224:227], a[216:219], v[128:131], v[224:227]
 s_waitcnt vmcnt(0)
 v_mfma_f32_16x16x32_bf16 v[228:231], a[220:223], v[128:131], v[228:231]
 v_mfma_f32_16x16x32_bf16 v[236:239], a[220:223], v[132:135], v[236:239]
 s_add_u32 s79, s79, 1
 s_cmp_le_u32 s79, s97
 s_nop 7
 s_cbranch_scc1 L_slowL2
 s_nop 7
 s_branch L_slowLr
L_slowH:
 s_waitcnt vmcnt(0) lgkmcnt(0)
 s_lshl_b32 s97, s60, 2
 s_sub_u32 s97, 60, s97
 s_xor_b32 s3, s58, 1
 s_add_u32 s97, s97, s3
 s_nop 7
 s_nop 7
 v_mov_b32 v144, 0
 v_mov_b32 v145, 0
 v_mov_b32 v146, 0
 v_mov_b32 v147, 0
 v_mov_b32 v148, 0
 v_mov_b32 v149, 0
 v_mov_b32 v150, 0
 v_mov_b32 v151, 0
 v_mov_b32 v152, 0
 v_mov_b32 v153, 0
 v_mov_b32 v154, 0
 v_mov_b32 v155, 0
 v_mov_b32 v156, 0
 v_mov_b32 v157, 0
 v_mov_b32 v158, 0
 v_mov_b32 v159, 0
 v_mov_b32 v16, v25
 v_mov_b32 v17, v25
 s_mov_b32 s79, 0
L_slowH1:
 s_lshr_b32 s78, s79, 1
 s_lshl_b32 s78, s78, 15
 s_and_b32 s3, s79, 1
 s_lshl_b32 s3, s3, 13
 s_add_u32 s78, s78, s3
 buffer_load_dwordx4 a[192:195], v2, s[4:7], s78 offen offset:0 sc1
 buffer_load_dwordx4 a[196:199], v2, s[4:7], s78 offen offset:1024 sc1
 buffer_load_dwordx4 a[200:203], v2, s[4:7], s78 offen offset:2048 sc1
 buffer_load_dwordx4 a[204:207], v2, s[4:7], s78 offen offset:3072 sc1
 buffer_load_dwordx4 a[208:211], v3, s[4:7], s78 offen offset:0 sc1
 buffer_load_dwordx4 a[212:215], v3, s[4:7], s78 offen offset:1024 sc1
 buffer_load_dwordx4 a[216:219], v3, s[4:7], s78 offen offset:2048 sc1
 buffer_load_dwordx4 a[220:223], v3, s[4:7], s78 offen offset:3072 sc1
 s_cmp_eq_u32 s79, s97
 s_cbranch_scc0 L_slowH1m
 v_cndmask_b32 v144, v25, v144, s[84:85]
 v_cndmask_b32 v145, v25, v145, s[86:87]
 v_cndmask_b32 v146, v25, v146, s[92:93]
 v_cndmask_b32 v147, v25, v147, s[94:95]
 v_cndmask_b32 v156, v25, v156, s[84:85]
 v_cndmask_b32 v157, v25, v157, s[86:87]
 v_cndmask_b32 v158, v25, v158, s[92:93]
 v_cndmask_b32 v159, v25, v159, s[94:95]
 v_mov_b32 v148, v25
 v_mov_b32 v149, v25
 v_mov_b32 v150, v25
 v_mov_b32 v151, v25
L_slowH1m:
 s_nop 1
 s_waitcnt vmcnt(7)
 v_mfma_f32_16x16x32_bf16 v[160:163], a[192:195], a[224:227], v[144:147]
 v_mfma_f32_16x16x32_bf16 v[168:171], a[192:195], a[240:243], v[152:155]
 s_waitcnt vmcnt(3)
 v_mfma_f32_16x16x32_bf16 v[164:167], a[208:211], a[224:227], v[148:151]
 v_mfma_f32_16x16x32_bf16 v[172:175], a[208:211], a[240:243], v[156:159]
 v_mfma_f32_16x16x32_bf16 v[160:163], a[196:199], a[228:231], v[160:163]
 v_mfma_f32_16x16x32_bf16 v[168:171], a[196:199], a[244:247], v[168:171]
 s_waitcnt vmcnt(2)
 v_mfma_f32_16x16x32_bf16 v[164:167], a[212:215], a[228:231], v[164:167]
 v_mfma_f32_16x16x32_bf16 v[172:175], a[212:215], a[244:247], v[172:175]
 v_mfma_f32_16x16x32_bf16 v[160:163], a[200:203], a[232:235], v[160:163]
 v_mfma_f32_16x16x32_bf16 v[168:171], a[200:203], a[248:251], v[168:171]
 s_waitcnt vmcnt(1)
 v_mfma_f32_16x16x32_bf16 v[164:167], a[216:219], a[232:235], v[164:167]
 v_mfma_f32_16x16x32_bf16 v[172:175], a[216:219], a[248:251], v[172:175]
 v_mfma_f32_16x16x32_bf16 v[160:163], a[204:207], a[236:239], v[160:163]
 v_mfma_f32_16x16x32_bf16 v[168:171], a[204:207], a[252:255], v[168:171]
 s_waitcnt vmcnt(0)
 v_mfma_f32_16x16x32_bf16 v[164:167], a[220:223], a[236:239], v[164:167]
 v_mfma_f32_16x16x32_bf16 v[172:175], a[220:223], a[252:255], v[172:175]
 s_nop 3
 v_max3_f32 v16, v16, v160, v161
 v_max3_f32 v16, v16, v162, v163
 s_nop 0
 v_max3_f32 v16, v16, v164, v165
 v_max3_f32 v16, v16, v166, v167
 v_max3_f32 v17, v17, v168, v169
 v_max3_f32 v17, v17, v170, v171
 v_max3_f32 v17, v17, v172, v173
 v_max3_f32 v17, v17, v174, v175
 s_add_u32 s79, s79, 1
 s_cmp_le_u32 s79, s97
 s_nop 7
 s_cbranch_scc1 L_slowH1
 v_mov_b32 v18, v16
 s_nop 1
 v_permlane16_swap_b32 v16, v18
 v_max_f32 v16, v16, v18
 v_mov_b32 v18, v16
 s_nop 1
 v_permlane32_swap_b32 v16, v18
 v_max_f32 v16, v16, v18
 v_sub_f32 v144, 0, v16
 v_sub_f32 v145, 0, v16
 v_sub_f32 v146, 0, v16
 v_sub_f32 v147, 0, v16
 v_sub_f32 v148, 0, v16
 v_sub_f32 v149, 0, v16
 v_sub_f32 v150, 0, v16
 v_sub_f32 v151, 0, v16
 v_mov_b32 v18, v17
 s_nop 1
 v_permlane16_swap_b32 v17, v18
 v_max_f32 v17, v17, v18
 v_mov_b32 v18, v17
 s_nop 1
 v_permlane32_swap_b32 v17, v18
 v_max_f32 v17, v17, v18
 v_sub_f32 v152, 0, v17
 v_sub_f32 v153, 0, v17
 v_sub_f32 v154, 0, v17
 v_sub_f32 v155, 0, v17
 v_sub_f32 v156, 0, v17
 v_sub_f32 v157, 0, v17
 v_sub_f32 v158, 0, v17
 v_sub_f32 v159, 0, v17
 v_mov_b64 v[176:177], 0
 v_mov_b64 v[178:179], 0
 v_mov_b64 v[180:181], 0
 v_mov_b64 v[182:183], 0
 v_mov_b64 v[184:185], 0
 v_mov_b64 v[186:187], 0
 v_mov_b64 v[188:189], 0
 v_mov_b64 v[190:191], 0
 v_mov_b64 v[192:193], 0
 v_mov_b64 v[194:195], 0
 v_mov_b64 v[196:197], 0
 v_mov_b64 v[198:199], 0
 v_mov_b64 v[200:201], 0
 v_mov_b64 v[202:203], 0
 v_mov_b64 v[204:205], 0
 v_mov_b64 v[206:207], 0
 v_mov_b64 v[208:209], 0
 v_mov_b64 v[210:211], 0
 v_mov_b64 v[212:213], 0
 v_mov_b64 v[214:215], 0
 v_mov_b64 v[216:217], 0
 v_mov_b64 v[218:219], 0
 v_mov_b64 v[220:221], 0
 v_mov_b64 v[222:223], 0
 v_mov_b64 v[224:225], 0
 v_mov_b64 v[226:227], 0
 v_mov_b64 v[228:229], 0
 v_mov_b64 v[230:231], 0
 v_mov_b64 v[232:233], 0
 v_mov_b64 v[234:235], 0
 v_mov_b64 v[236:237], 0
 v_mov_b64 v[238:239], 0
 v_mov_b64 v[240:241], 0
 v_mov_b64 v[242:243], 0
 v_mov_b64 v[244:245], 0
 v_mov_b64 v[246:247], 0
 ds_write_b128 v24, v[176:179] offset:0
 ds_write_b128 v24, v[176:179] offset:1024
 ds_write_b128 v24, v[176:179] offset:2048
 ds_write_b128 v24, v[176:179] offset:3072
 ds_write_b128 v24, v[176:179] offset:4096
 ds_write_b128 v24, v[176:179] offset:5120
 ds_write_b128 v24, v[176:179] offset:6144
 ds_write_b128 v24, v[176:179] offset:7168
 ds_write_b128 v24, v[176:179] offset:8192
 ds_write_b128 v24, v[176:179] offset:9216
 ds_write_b128 v24, v[176:179] offset:10240
 ds_write_b128 v24, v[176:179] offset:11264
 ds_write_b128 v24, v[176:179] offset:12288
 ds_write_b128 v24, v[176:179] offset:13312
 ds_write_b128 v24, v[176:179] offset:14336
 ds_write_b128 v24, v[176:179] offset:15360
 s_waitcnt lgkmcnt(0)
 s_mov_b32 s79, 0
L_slowH2:
 s_lshr_b32 s78, s79, 1
 s_lshl_b32 s78, s78, 15
 s_and_b32 s3, s79, 1
 s_lshl_b32 s3, s3, 13
 s_add_u32 s78, s78, s3
 buffer_load_dwordx4 a[192:195], v2, s[4:7], s78 offen offset:0 sc1
 buffer_load_dwordx4 a[196:199], v2, s[4:7], s78 offen offset:1024 sc1
 buffer_load_dwordx4 a[200:203], v2, s[4:7], s78 offen offset:2048 sc1
 buffer_load_dwordx4 a[204:207], v2, s[4:7], s78 offen offset:3072 sc1
 buffer_load_dwordx4 a[208:211], v3, s[4:7], s78 offen offset:0 sc1
 buffer_load_dwordx4 a[212:215], v3, s[4:7], s78 offen offset:1024 sc1
 buffer_load_dwordx4 a[216:219], v3, s[4:7], s78 offen offset:2048 sc1
 buffer_load_dwordx4 a[220:223], v3, s[4:7], s78 offen offset:3072 sc1
 s_cmp_eq_u32 s79, s97
 s_cbranch_scc0 L_slowH2m
 v_cndmask_b32 v144, v25, v144, s[84:85]
 v_cndmask_b32 v145, v25, v145, s[86:87]
 v_cndmask_b32 v146, v25, v146, s[92:93]
 v_cndmask_b32 v147, v25, v147, s[94:95]
 v_cndmask_b32 v156, v25, v156, s[84:85]
 v_cndmask_b32 v157, v25, v157, s[86:87]
 v_cndmask_b32 v158, v25, v158, s[92:93]
 v_cndmask_b32 v159, v25, v159, s[94:95]
 v_mov_b32 v148, v25
 v_mov_b32 v149, v25
 v_mov_b32 v150, v25
 v_mov_b32 v151, v25
L_slowH2m:
 s_nop 1
 s_waitcnt vmcnt(7)
 v_mfma_f32_16x16x32_bf16 v[160:163], a[192:195], a[224:227], v[144:147]
 v_mfma_f32_16x16x32_bf16 v[168:171], a[192:195], a[240:243], v[152:155]
 s_waitcnt vmcnt(3)
 v_mfma_f32_16x16x32_bf16 v[164:167], a[208:211], a[224:227], v[148:151]
 v_mfma_f32_16x16x32_bf16 v[172:175], a[208:211], a[240:243], v[156:159]
 v_mfma_f32_16x16x32_bf16 v[160:163], a[196:199], a[228:231], v[160:163]
 v_mfma_f32_16x16x32_bf16 v[168:171], a[196:199], a[244:247], v[168:171]
 s_waitcnt vmcnt(2)
 v_mfma_f32_16x16x32_bf16 v[164:167], a[212:215], a[228:231], v[164:167]
 v_mfma_f32_16x16x32_bf16 v[172:175], a[212:215], a[244:247], v[172:175]
 v_mfma_f32_16x16x32_bf16 v[160:163], a[200:203], a[232:235], v[160:163]
 v_mfma_f32_16x16x32_bf16 v[168:171], a[200:203], a[248:251], v[168:171]
 s_waitcnt vmcnt(1)
 v_mfma_f32_16x16x32_bf16 v[164:167], a[216:219], a[232:235], v[164:167]
 v_mfma_f32_16x16x32_bf16 v[172:175], a[216:219], a[248:251], v[172:175]
 v_mfma_f32_16x16x32_bf16 v[160:163], a[204:207], a[236:239], v[160:163]
 v_mfma_f32_16x16x32_bf16 v[168:171], a[204:207], a[252:255], v[168:171]
 s_waitcnt vmcnt(0)
 v_mfma_f32_16x16x32_bf16 v[164:167], a[220:223], a[236:239], v[164:167]
 v_mfma_f32_16x16x32_bf16 v[172:175], a[220:223], a[252:255], v[172:175]
 s_add_u32 s78, s78, 0x4000
 s_nop 2
 v_exp_f32 v160, v160
 v_exp_f32 v161, v161
 v_exp_f32 v162, v162
 v_exp_f32 v163, v163
 v_exp_f32 v164, v164
 v_exp_f32 v165, v165
 v_exp_f32 v166, v166
 v_exp_f32 v167, v167
 v_exp_f32 v168, v168
 v_exp_f32 v169, v169
 v_exp_f32 v170, v170
 v_exp_f32 v171, v171
 v_exp_f32 v172, v172
 v_exp_f32 v173, v173
 v_exp_f32 v174, v174
 v_exp_f32 v175, v175
 buffer_load_dwordx4 a[192:195], v2, s[4:7], s78 offen offset:0 sc1
 buffer_load_dwordx4 a[196:199], v2, s[4:7], s78 offen offset:1024 sc1
 buffer_load_dwordx4 a[200:203], v2, s[4:7], s78 offen offset:2048 sc1
 buffer_load_dwordx4 a[204:207], v2, s[4:7], s78 offen offset:3072 sc1
 buffer_load_dwordx4 a[208:211], v3, s[4:7], s78 offen offset:0 sc1
 buffer_load_dwordx4 a[212:215], v3, s[4:7], s78 offen offset:1024 sc1
 buffer_load_dwordx4 a[216:219], v3, s[4:7], s78 offen offset:2048 sc1
 buffer_load_dwordx4 a[220:223], v3, s[4:7], s78 offen offset:3072 sc1
 v_cvt_pk_bf16_f32 v8, v160, v161
 v_cvt_pk_bf16_f32 v9, v162, v163
 v_cvt_pk_bf16_f32 v10, v164, v165
 v_cvt_pk_bf16_f32 v11, v166, v167
 v_cvt_pk_bf16_f32 v12, v168, v169
 v_cvt_pk_bf16_f32 v13, v170, v171
 v_cvt_pk_bf16_f32 v14, v172, v173
 v_cvt_pk_bf16_f32 v15, v174, v175
 v_mfma_f32_16x16x32_bf16 v[240:243], a[136:139], v[8:11], v[240:243]
 s_nop 0
 v_mfma_f32_16x16x32_bf16 v[244:247], a[136:139], v[12:15], v[244:247]
 s_waitcnt vmcnt(7)
 v_mfma_f32_16x16x32_bf16 v[184:187], a[192:195], v[12:15], v[184:187]
 v_mfma_f32_16x16x32_bf16 v[176:179], a[192:195], v[8:11], v[176:179]
 s_waitcnt vmcnt(6)
 v_mfma_f32_16x16x32_bf16 v[180:183], a[196:199], v[8:11], v[180:183]
 v_mfma_f32_16x16x32_bf16 v[188:191], a[196:199], v[12:15], v[188:191]
 s_waitcnt vmcnt(5)
 v_mfma_f32_16x16x32_bf16 v[200:203], a[200:203], v[12:15], v[200:203]
 v_mfma_f32_16x16x32_bf16 v[192:195], a[200:203], v[8:11], v[192:195]
 s_waitcnt vmcnt(4)
 v_mfma_f32_16x16x32_bf16 v[196:199], a[204:207], v[8:11], v[196:199]
 v_mfma_f32_16x16x32_bf16 v[204:207], a[204:207], v[12:15], v[204:207]
 s_waitcnt vmcnt(3)
 v_mfma_f32_16x16x32_bf16 v[216:219], a[208:211], v[12:15], v[216:219]
 v_mfma_f32_16x16x32_bf16 v[208:211], a[208:211], v[8:11], v[208:211]
 s_waitcnt vmcnt(2)
 v_mfma_f32_16x16x32_bf16 v[212:215], a[212:215], v[8:11], v[212:215]
 v_mfma_f32_16x16x32_bf16 v[220:223], a[212:215], v[12:15], v[220:223]
 s_waitcnt vmcnt(1)
 v_mfma_f32_16x16x32_bf16 v[232:235], a[216:219], v[12:15], v[232:235]
 v_mfma_f32_16x16x32_bf16 v[224:227], a[216:219], v[8:11], v[224:227]
 s_waitcnt vmcnt(0)
 v_mfma_f32_16x16x32_bf16 v[228:231], a[220:223], v[8:11], v[228:231]
 v_mfma_f32_16x16x32_bf16 v[236:239], a[220:223], v[12:15], v[236:239]
 s_add_u32 s79, s79, 1
 s_cmp_le_u32 s79, s97
 s_nop 7
 s_cbranch_scc1 L_slowH2
 s_nop 7
 s_branch L_slowHr
L_pl5:
 s_sleep 2
 buffer_load_dword v28, v27, s[24:27], 0 offen sc1
 s_waitcnt vmcnt(0)
 v_sub_u32 v28, v28, v0
 v_subrev_u32 v28, 6, v28
 v_cmp_ge_u32 vcc, 6, v28
 s_add_u32 s79, s79, 1
 s_cmp_eq_u64 vcc, -1
 s_cbranch_scc1 L_pd5
 s_cmp_lt_u32 s79, 0x8000
 s_cbranch_scc1 L_pl5
 s_branch L_pd5
L_pl6:
 s_sleep 2
 buffer_load_dword v28, v27, s[24:27], 0 offen sc1
 s_waitcnt vmcnt(0)
 v_sub_u32 v28, v28, v0
 v_subrev_u32 v28, 7, v28
 v_cmp_ge_u32 vcc, 5, v28
 s_add_u32 s79, s79, 1
 s_cmp_eq_u64 vcc, -1
 s_cbranch_scc1 L_pd6
 s_cmp_lt_u32 s79, 0x8000
 s_cbranch_scc1 L_pl6
 s_branch L_pd6
L_pl7:
 s_sleep 2
 buffer_load_dword v28, v27, s[24:27], 0 offen sc1
 s_waitcnt vmcnt(0)
 v_sub_u32 v28, v28, v0
 v_subrev_u32 v28, 8, v28
 v_cmp_ge_u32 vcc, 4, v28
 s_add_u32 s79, s79, 1
 s_cmp_eq_u64 vcc, -1
 s_cbranch_scc1 L_pd7
 s_cmp_lt_u32 s79, 0x8000
 s_cbranch_scc1 L_pl7
 s_branch L_pd7
L_pl8:
 s_sleep 2
 buffer_load_dword v28, v27, s[24:27], 0 offen sc1
 s_waitcnt vmcnt(0)
 v_sub_u32 v28, v28, v0
 v_subrev_u32 v28, 9, v28
 v_cmp_ge_u32 vcc, 3, v28
 s_add_u32 s79, s79, 1
 s_cmp_eq_u64 vcc, -1
 s_cbranch_scc1 L_pd8
 s_cmp_lt_u32 s79, 0x8000
 s_cbranch_scc1 L_pl8
 s_branch L_pd8
L_pl9:
 s_sleep 2
 buffer_load_dword v28, v27, s[24:27], 0 offen sc1
 s_waitcnt vmcnt(0)
 v_sub_u32 v28, v28, v0
 v_subrev_u32 v28, 10, v28
 v_cmp_ge_u32 vcc, 2, v28
 s_add_u32 s79, s79, 1
 s_cmp_eq_u64 vcc, -1
 s_cbranch_scc1 L_pd9
 s_cmp_lt_u32 s79, 0x8000
 s_cbranch_scc1 L_pl9
 s_branch L_pd9
L_end:
.section .rodata,"a"
.p2align 6
.amdhsa_kernel recurrent_scan__compressed_kv_cla__geglu_ffn__prompt_kernel
  .amdhsa_next_free_vgpr 512
  .amdhsa_next_free_sgpr 102
  .amdhsa_accum_offset 256
  .amdhsa_group_segment_fixed_size 0
  .amdhsa_kernarg_size 104
  .amdhsa_user_sgpr_count 2
  .amdhsa_user_sgpr_kernarg_segment_ptr 1
  .amdhsa_system_sgpr_workgroup_id_x 1
.end_amdhsa_kernel
```
